```python
import torch

def _softmax(x, axis=-1):
    return torch.softmax(x, dim=axis)

def _gelu(x):
    return torch.nn.functional.gelu(x, approximate='tanh')

def _silu(x):
    return torch.nn.functional.silu(x)

def _sigmoid(x):
    return torch.sigmoid(x)

def _layernorm(x, axis=-1, eps=1e-05):
    m = x.mean(dim=axis, keepdim=True)
    v = x.var(dim=axis, keepdim=True, unbiased=False)
    return (x - m) / torch.sqrt(v + eps)

def _scatter_add(tgt, idx, src, axis=0):
    return tgt.clone().index_add_(axis, idx, src)

def _segment_sum(src, seg, n):
    out = torch.zeros((n,) + src.shape[1:], dtype=src.dtype)
    return out.index_add_(0, seg, src)

def _pad(x, pw):
    flat = tuple((v for pair in reversed(pw) for v in pair))
    return torch.nn.functional.pad(x, flat)
kernel_name = 'concat_heads__grouped_kv_mqa__memory_aug_recurrent_mem_tr__prompt'

def setup_inputs():

    _w = lambda a: (lambda t: t.to(torch.bfloat16) if t.is_floating_point() else t)(torch.as_tensor(a))

    def _A_setup():
        B, S, D, H = (1, 2048, 576, 32)
        Dh = D // H
        return {'x': _w((lambda *s: torch.randn(*s, dtype=torch.bfloat16) * 0.05)(B, S, D)), 'wq': _w((lambda *s: torch.randn(*s, dtype=torch.bfloat16) * 1.6)(D, H * Dh)), 'wk': _w((lambda *s: torch.randn(*s, dtype=torch.bfloat16) * 1.6)(D, Dh)), 'wv': _w((lambda *s: torch.randn(*s, dtype=torch.bfloat16) * 0.05)(D, Dh)), 'wo': _w((lambda *s: torch.randn(*s, dtype=torch.bfloat16) * 0.05)(H * Dh, D))}
    _A_in = _A_setup()

    def _B_setup():
        B, S, Dm = (1, 2048, 576)
        H, Dh = (32, 128)
        M, seg = (8, 32)
        seg = min(seg, S)
        S = S // seg * seg
        return {'x': _w((lambda *s: torch.randn(*s, dtype=torch.bfloat16) * 0.05)(B, S, Dm)), 'mem0': _w((lambda *s: torch.randn(*s, dtype=torch.bfloat16) * 0.8)(B, M, Dm)), 'Wq': _w((lambda *s: torch.randn(*s, dtype=torch.bfloat16) * 1.6)(Dm, H, Dh) * Dm ** (-0.5)), 'Wk': _w((lambda *s: torch.randn(*s, dtype=torch.bfloat16) * 1.6)(Dm, H, Dh) * Dm ** (-0.5)), 'Wv': _w((lambda *s: torch.randn(*s, dtype=torch.bfloat16) * 0.8)(Dm, H, Dh) * Dm ** (-0.5)), 'Wo': _w((lambda *s: torch.randn(*s, dtype=torch.bfloat16) * 0.8)(H, Dh, Dm) * (H * Dh) ** (-0.5)), 'seg_len': seg}
    _B_in = _B_setup()
    return {'A_x': _A_in['x'], 'A_wq': _A_in['wq'], 'A_wk': _A_in['wk'], 'A_wv': _A_in['wv'], 'A_wo': _A_in['wo'], 'B_x': _B_in['x'], 'B_mem0': _B_in['mem0'], 'B_Wq': _B_in['Wq'], 'B_Wk': _B_in['Wk'], 'B_Wv': _B_in['Wv'], 'B_Wo': _B_in['Wo'], 'B_seg_len': _B_in['seg_len']}

def reference(A_x, A_wq, A_wk, A_wv, A_wo, B_x, B_mem0, B_Wq, B_Wk, B_Wv, B_Wo, B_seg_len):

    def _A_ref(x, wq, wk, wv, wo):
        B, S, D = x.shape
        H = 32
        Dh = D // H
        q = (lambda x, *d: x.permute(*d))((x @ wq).reshape(B, S, H, Dh), 0, 2, 1, 3)
        k = x @ wk
        v = x @ wv
        scores = torch.einsum('bhqd,bkd->bhqk', q, k) * Dh ** (-0.5)
        p = _softmax(scores, axis=-1)
        o = torch.einsum('bhqk,bkd->bhqd', p, v)
        return (lambda x, *d: x.permute(*d))(o, 0, 2, 1, 3).reshape(B, S, H * Dh) @ wo

    def _B_ref(x, mem0, Wq, Wk, Wv, Wo, seg_len):
        B, S, Dm = x.shape
        H, Dh = (Wq.shape[1], Wq.shape[2])
        M = mem0.shape[1]
        scale = Dh ** (-0.5)
        n_seg = S // seg_len
        L = M + seg_len
        idx = torch.arange(L)
        mask = (idx[:, None] < M) | (idx[:, None] >= idx[None, :])
        mem = mem0
        outs = []
        for s in range(n_seg):
            xs = x[:, s * seg_len:(s + 1) * seg_len, :].clone()
            h = torch.concatenate([mem, xs], axis=1)
            q = torch.einsum('btd,dhe->bhte', h, Wq)
            k = torch.einsum('btd,dhe->bhte', h, Wk)
            v = torch.einsum('btd,dhe->bhte', h, Wv)
            scores = torch.einsum('bhqe,bhke->bhqk', q, k) * scale
            scores = torch.where(mask[None, None], scores, -1000000000.0)
            p = _softmax(scores, axis=-1)
            o = torch.einsum('bhqk,bhke->bhqe', p, v)
            o = torch.einsum('bhte,hed->btd', o, Wo)
            mem = o[:, :M, :].clone()
            outs.append(o[:, M:, :])
        return torch.concatenate(outs, axis=1)
    a = _A_ref(A_x, A_wq, A_wk, A_wv, A_wo)
    b = _B_ref(B_x, B_mem0, B_Wq, B_Wk, B_Wv, B_Wo, B_seg_len)
    return torch.concatenate([a, b], axis=-1)
```

```asm
; @launch grid=(256,1,1) block=(256,1,1) lds=163840
.amdgcn_target "amdgcn-amd-amdhsa--gfx950"
.text
.globl concat_heads__grouped_kv_mqa__memory_aug_recurrent_mem_tr__prompt_kernel
.p2align 8
.type concat_heads__grouped_kv_mqa__memory_aug_recurrent_mem_tr__prompt_kernel,@function
concat_heads__grouped_kv_mqa__memory_aug_recurrent_mem_tr__prompt_kernel:
  s_cmp_ge_u32 s2, 256
  s_cbranch_scc1 L_exit
  s_load_dwordx2 s[66:67], s[0:1], 104
  s_getreg_b32 s20, hwreg(HW_REG_XCC_ID)
  s_and_b32 s20, s20, 7
  v_lshrrev_b32 v1, 6, v0
  s_nop 0
  v_readfirstlane_b32 s13, v1
  s_mov_b32 s50, 0
  s_waitcnt lgkmcnt(0)
  s_cmp_lg_u32 s13, 0
  s_cbranch_scc1 L_gotrole
  s_mov_b64 exec, 1
  s_lshl_b32 s21, s20, 2
  s_add_u32 s21, s21, 128
  s_cmp_eq_u32 s20, 0
  s_cselect_b32 s21, 0, s21
  v_mov_b32 v2, s21
  v_mov_b32 v3, 1
  global_atomic_add v4, v2, v3, s[66:67] sc0
  s_waitcnt vmcnt(0)
  v_readfirstlane_b32 s22, v4
  s_nop 0
  s_cmp_lt_u32 s22, 32
  s_cbranch_scc1 L_tk
  v_mov_b32 v2, 0
  global_atomic_add v4, v2, v3, s[66:67] offset:64 sc0
  s_waitcnt vmcnt(0)
  v_readfirstlane_b32 s23, v4
  s_mov_b32 s40, 0
L_ovf:
  global_load_dwordx4 v[4:7], v2, s[66:67] offset:128 sc1
  global_load_dwordx4 v[8:11], v2, s[66:67] offset:144 sc1
  global_load_dword v4, v2, s[66:67] offset:0 sc1
  s_add_u32 s40, s40, 1
  s_cmp_gt_u32 s40, 400000
  s_cbranch_scc1 L_norole
  s_waitcnt vmcnt(0)
  v_readfirstlane_b32 s24, v4
  v_readfirstlane_b32 s25, v5
  v_readfirstlane_b32 s26, v6
  v_readfirstlane_b32 s27, v7
  v_readfirstlane_b32 s28, v8
  v_readfirstlane_b32 s29, v9
  v_readfirstlane_b32 s30, v10
  v_readfirstlane_b32 s31, v11
  s_mov_b32 s32, 0
  s_add_u32 s32, s32, s24
  s_add_u32 s32, s32, s25
  s_add_u32 s32, s32, s26
  s_add_u32 s32, s32, s27
  s_add_u32 s32, s32, s28
  s_add_u32 s32, s32, s29
  s_add_u32 s32, s32, s30
  s_add_u32 s32, s32, s31
  s_cmp_lt_u32 s32, 256
  s_cbranch_scc1 L_ovf
  s_min_u32 s33, s24, 32
  s_sub_u32 s34, 32, s33
  s_cmp_ge_u32 s23, s34
  s_cbranch_scc1 L_ovf0
  s_mov_b32 s20, 0
  s_add_u32 s22, s33, s23
  s_branch L_tk
L_ovf0:
  s_sub_u32 s23, s23, s34
  s_min_u32 s33, s25, 32
  s_sub_u32 s34, 32, s33
  s_cmp_ge_u32 s23, s34
  s_cbranch_scc1 L_ovf1
  s_mov_b32 s20, 1
  s_add_u32 s22, s33, s23
  s_branch L_tk
L_ovf1:
  s_sub_u32 s23, s23, s34
  s_min_u32 s33, s26, 32
  s_sub_u32 s34, 32, s33
  s_cmp_ge_u32 s23, s34
  s_cbranch_scc1 L_ovf2
  s_mov_b32 s20, 2
  s_add_u32 s22, s33, s23
  s_branch L_tk
L_ovf2:
  s_sub_u32 s23, s23, s34
  s_min_u32 s33, s27, 32
  s_sub_u32 s34, 32, s33
  s_cmp_ge_u32 s23, s34
  s_cbranch_scc1 L_ovf3
  s_mov_b32 s20, 3
  s_add_u32 s22, s33, s23
  s_branch L_tk
L_ovf3:
  s_sub_u32 s23, s23, s34
  s_min_u32 s33, s28, 32
  s_sub_u32 s34, 32, s33
  s_cmp_ge_u32 s23, s34
  s_cbranch_scc1 L_ovf4
  s_mov_b32 s20, 4
  s_add_u32 s22, s33, s23
  s_branch L_tk
L_ovf4:
  s_sub_u32 s23, s23, s34
  s_min_u32 s33, s29, 32
  s_sub_u32 s34, 32, s33
  s_cmp_ge_u32 s23, s34
  s_cbranch_scc1 L_ovf5
  s_mov_b32 s20, 5
  s_add_u32 s22, s33, s23
  s_branch L_tk
L_ovf5:
  s_sub_u32 s23, s23, s34
  s_min_u32 s33, s30, 32
  s_sub_u32 s34, 32, s33
  s_cmp_ge_u32 s23, s34
  s_cbranch_scc1 L_ovf6
  s_mov_b32 s20, 6
  s_add_u32 s22, s33, s23
  s_branch L_tk
L_ovf6:
  s_sub_u32 s23, s23, s34
  s_min_u32 s33, s31, 32
  s_sub_u32 s34, 32, s33
  s_cmp_ge_u32 s23, s34
  s_cbranch_scc1 L_ovf7
  s_mov_b32 s20, 7
  s_add_u32 s22, s33, s23
  s_branch L_tk
L_ovf7:
  s_sub_u32 s23, s23, s34
L_norole:
  s_mov_b32 s20, 1
  s_mov_b32 s22, 31
L_tk:
  s_lshl_b32 s20, s20, 5
  s_add_u32 s20, s20, s22
  v_mov_b32 v2, 0
  v_mov_b32 v3, s20
  ds_write_b32 v2, v3
  s_mov_b64 exec, -1
  s_waitcnt lgkmcnt(0)
L_gotrole:
  s_barrier
  v_mov_b32 v2, 0
  ds_read_b32 v3, v2
  s_waitcnt lgkmcnt(0)
  v_readfirstlane_b32 s20, v3
  s_barrier
  s_mov_b32 s98, s20
  s_and_b32 s12, s20, 31
  s_lshr_b32 s21, s20, 5
  s_cmp_eq_u32 s21, 0
  s_cbranch_scc1 L_blk_C
  s_cmp_eq_u32 s21, 1
  s_cbranch_scc1 L_blk_L
  s_cmp_eq_u32 s21, 2
  s_cbranch_scc1 L_blk_O
  s_cmp_eq_u32 s21, 3
  s_cbranch_scc1 L_blk_Q
  s_cmp_eq_u32 s21, 4
  s_cbranch_scc1 L_blk_A
  s_cmp_eq_u32 s21, 5
  s_cbranch_scc1 L_blk_K
  s_cmp_eq_u32 s21, 6
  s_cbranch_scc1 L_blk_B
  s_cmp_eq_u32 s21, 7
  s_cbranch_scc1 L_blk_V
  s_branch L_end
L_blk_L:
  s_add_u32 s12, s12, 32
  s_cmp_lt_u32 s12, 36
  s_cbranch_scc1 L_op
  s_sub_u32 s12, s12, 36
  s_cmp_lt_u32 s12, 8
  s_cbranch_scc1 L_fi
  s_branch L_end
L_blk_B:
  s_add_u32 s12, s12, 32
  s_branch L_a
L_fi:
  s_load_dwordx2 s[4:5], s[0:1], 112
  s_load_dwordx2 s[66:67], s[0:1], 104
  v_lshlrev_b32 v2, 4, v0
  s_mul_i32 s20, s12, 11
  s_add_u32 s21, s20, 11
  s_waitcnt lgkmcnt(0)
  s_mov_b32 s6, 268435456
  s_mov_b32 s7, 0x20000
FI_1:
  s_lshl_b32 s22, s20, 12
  s_add_u32 s23, s22, 585728
  s_cmp_ge_u32 s20, 81
  s_cselect_b32 s22, s23, s22
  s_sub_u32 s23, s20, 72
  s_cmp_lt_u32 s23, 7
  s_cselect_b32 s23, -1, 0
  s_waitcnt vmcnt(0)
  v_mov_b32 v4, s23
  v_mov_b32 v5, s23
  v_mov_b32 v6, s23
  v_mov_b32 v7, s23
  buffer_store_dwordx4 v[4:7], v2, s[4:7], s22 offen sc1
  s_add_u32 s20, s20, 1
  s_cmp_lt_u32 s20, s21
  s_cbranch_scc1 FI_1
  s_waitcnt vmcnt(0)
  s_barrier
  s_cmp_lg_u32 s13, 0
  s_cbranch_scc1 L_end
  v_mov_b32 v4, 0
  v_mov_b32 v5, 1
  s_mov_b64 exec, 1
  global_atomic_add v4, v5, s[66:67] offset:192
  s_branch L_end
L_blk_K:
  s_load_dwordx2 s[4:5], s[0:1], 112
  s_load_dwordx2 s[8:9], s[0:1], 64
  s_load_dwordx2 s[16:17], s[0:1], 40
  s_load_dwordx2 s[66:67], s[0:1], 104
  v_and_b32 v1, 63, v0
  v_lshlrev_b32 v2, 4, v1
  v_and_b32 v3, 31, v1
  s_waitcnt vmcnt(0)
  v_lshrrev_b32 v4, 5, v1
  v_bfe_u32 v5, v1, 4, 1
  v_bfe_u32 v6, v1, 2, 2
  v_and_b32 v7, 3, v1
  v_lshrrev_b32 v8, 4, v1
  v_and_b32 v9, 15, v1
  v_lshlrev_b32 v15, 2, v8
  v_xor_b32 v9, v9, v15
  v_lshlrev_b32 v9, 4, v9
  v_lshl_add_u32 v9, v8, 13, v9
  s_lshl_b32 s36, s12, 8
  v_add_u32 v9, s36, v9
  v_lshl_add_u32 v8, v4, 5, v6
  v_lshlrev_b32 v8, 8, v8
  v_lshl_add_u32 v8, v5, 5, v8
  v_lshl_add_u32 v8, v7, 3, v8
  v_xor_b32 v15, s13, v6
  v_lshl_add_u32 v10, v15, 6, v8
  v_lshrrev_b32 v15, 3, v1
  v_mul_u32_u24 v14, 1152, v15
  v_lshrrev_b32 v15, 4, v1
  v_and_b32 v12, 7, v1
  v_xor_b32 v15, v15, v12
  v_xor_b32 v12, 4, v15
  v_lshl_add_u32 v12, v12, 4, v14
  v_lshl_add_u32 v14, v15, 4, v14
  s_lshl_b32 s22, s13, 12
  v_bfe_u32 v15, v3, 1, 3
  v_lshlrev_b32 v16, 2, v4
  v_xor_b32 v15, v15, v16
  v_lshlrev_b32 v19, 7, v3
  v_lshl_add_u32 v16, v15, 4, v19
  v_xor_b32 v17, 16, v16
  v_xor_b32 v18, 32, v16
  v_xor_b32 v19, 48, v16
  s_waitcnt lgkmcnt(0)
  s_mov_b32 s6, 268435456
  s_mov_b32 s7, 0x20000
  s_mov_b32 s10, 4718592
  s_mov_b32 s11, 0x20000
  s_mov_b32 s18, 2359296
  s_mov_b32 s19, 0x20000
  s_mul_i32 s36, s13, 36864
  s_mul_i32 s37, s13, 1179648
  s_mov_b32 s38, 0
  v_add_u32 v20, 49152, v16
  v_add_u32 v21, 49152, v17
  v_add_u32 v22, 49152, v18
  v_add_u32 v23, 49152, v19
  v_add_u32 v24, 98304, v16
  v_add_u32 v25, 98304, v17
  v_add_u32 v26, 98304, v18
  v_add_u32 v27, 98304, v19
WD_2:
  s_mov_b32 m0, s36
  s_add_u32 s36, s36, 1024
  buffer_load_dwordx4 v9, s[8:11], s37 offen lds
  s_add_u32 s37, s37, 32768
  s_add_u32 s38, s38, 1
  s_cmp_lt_u32 s38, 36
  s_cbranch_scc1 WD_2
  s_lshl_b32 s39, s12, 2
  s_add_u32 s39, s39, s13
  s_mul_i32 s39, s39, 18432
  v_lshlrev_b32 v15, 7, v1
  buffer_load_dword v100, v15, s[16:19], s39 offen
  s_add_u32 s39, s39, 8192
  buffer_load_dword v101, v15, s[16:19], s39 offen
  s_add_u32 s39, s39, 2048
  buffer_load_dword v102, v15, s[16:19], s39 offen
  s_add_u32 s39, s39, 2048
  s_mul_i32 s21, s13, 36864
  s_mov_b32 s23, 0
  s_lshl_b32 s25, s12, 9
  s_add_u32 s25, s25, 917504
  s_lshl_b32 s24, s12, 14
  s_add_u32 s24, s24, 16777216
  s_lshl_b32 s36, s13, 11
  s_add_u32 s24, s24, s36
  s_waitcnt vmcnt(3)
  s_barrier
  ds_read_b64_tr_b16 a[0:1], v10 offset:0
  ds_read_b64_tr_b16 a[2:3], v10 offset:1024
  ds_read_b64_tr_b16 a[4:5], v10 offset:2048
  ds_read_b64_tr_b16 a[6:7], v10 offset:3072
  ds_read_b64_tr_b16 a[8:9], v10 offset:4096
  ds_read_b64_tr_b16 a[10:11], v10 offset:5120
  ds_read_b64_tr_b16 a[12:13], v10 offset:6144
  ds_read_b64_tr_b16 a[14:15], v10 offset:7168
  ds_read_b64_tr_b16 a[16:17], v10 offset:16384
  ds_read_b64_tr_b16 a[18:19], v10 offset:17408
  ds_read_b64_tr_b16 a[20:21], v10 offset:18432
  ds_read_b64_tr_b16 a[22:23], v10 offset:19456
  ds_read_b64_tr_b16 a[24:25], v10 offset:20480
  ds_read_b64_tr_b16 a[26:27], v10 offset:21504
  ds_read_b64_tr_b16 a[28:29], v10 offset:22528
  ds_read_b64_tr_b16 a[30:31], v10 offset:23552
  ds_read_b64_tr_b16 a[32:33], v10 offset:32768
  ds_read_b64_tr_b16 a[34:35], v10 offset:33792
  ds_read_b64_tr_b16 a[36:37], v10 offset:34816
  ds_read_b64_tr_b16 a[38:39], v10 offset:35840
  ds_read_b64_tr_b16 a[40:41], v10 offset:36864
  ds_read_b64_tr_b16 a[42:43], v10 offset:37888
  ds_read_b64_tr_b16 a[44:45], v10 offset:38912
  ds_read_b64_tr_b16 a[46:47], v10 offset:39936
  v_add_u32 v10, 49152, v10
  ds_read_b64_tr_b16 a[48:49], v10 offset:0
  ds_read_b64_tr_b16 a[50:51], v10 offset:1024
  ds_read_b64_tr_b16 a[52:53], v10 offset:2048
  ds_read_b64_tr_b16 a[54:55], v10 offset:3072
  ds_read_b64_tr_b16 a[56:57], v10 offset:4096
  ds_read_b64_tr_b16 a[58:59], v10 offset:5120
  ds_read_b64_tr_b16 a[60:61], v10 offset:6144
  ds_read_b64_tr_b16 a[62:63], v10 offset:7168
  ds_read_b64_tr_b16 a[64:65], v10 offset:16384
  ds_read_b64_tr_b16 a[66:67], v10 offset:17408
  ds_read_b64_tr_b16 a[68:69], v10 offset:18432
  ds_read_b64_tr_b16 a[70:71], v10 offset:19456
  ds_read_b64_tr_b16 a[72:73], v10 offset:20480
  ds_read_b64_tr_b16 a[74:75], v10 offset:21504
  ds_read_b64_tr_b16 a[76:77], v10 offset:22528
  ds_read_b64_tr_b16 a[78:79], v10 offset:23552
  ds_read_b64_tr_b16 a[80:81], v10 offset:32768
  ds_read_b64_tr_b16 a[82:83], v10 offset:33792
  ds_read_b64_tr_b16 a[84:85], v10 offset:34816
  ds_read_b64_tr_b16 a[86:87], v10 offset:35840
  ds_read_b64_tr_b16 a[88:89], v10 offset:36864
  ds_read_b64_tr_b16 a[90:91], v10 offset:37888
  ds_read_b64_tr_b16 a[92:93], v10 offset:38912
  ds_read_b64_tr_b16 a[94:95], v10 offset:39936
  v_add_u32 v10, 49152, v10
  ds_read_b64_tr_b16 a[96:97], v10 offset:0
  ds_read_b64_tr_b16 a[98:99], v10 offset:1024
  ds_read_b64_tr_b16 a[100:101], v10 offset:2048
  ds_read_b64_tr_b16 a[102:103], v10 offset:3072
  ds_read_b64_tr_b16 a[104:105], v10 offset:4096
  ds_read_b64_tr_b16 a[106:107], v10 offset:5120
  ds_read_b64_tr_b16 a[108:109], v10 offset:6144
  ds_read_b64_tr_b16 a[110:111], v10 offset:7168
  ds_read_b64_tr_b16 a[112:113], v10 offset:16384
  ds_read_b64_tr_b16 a[114:115], v10 offset:17408
  ds_read_b64_tr_b16 a[116:117], v10 offset:18432
  ds_read_b64_tr_b16 a[118:119], v10 offset:19456
  ds_read_b64_tr_b16 a[120:121], v10 offset:20480
  ds_read_b64_tr_b16 a[122:123], v10 offset:21504
  ds_read_b64_tr_b16 a[124:125], v10 offset:22528
  ds_read_b64_tr_b16 a[126:127], v10 offset:23552
  ds_read_b64_tr_b16 a[128:129], v10 offset:32768
  ds_read_b64_tr_b16 a[130:131], v10 offset:33792
  ds_read_b64_tr_b16 a[132:133], v10 offset:34816
  ds_read_b64_tr_b16 a[134:135], v10 offset:35840
  ds_read_b64_tr_b16 a[136:137], v10 offset:36864
  ds_read_b64_tr_b16 a[138:139], v10 offset:37888
  ds_read_b64_tr_b16 a[140:141], v10 offset:38912
  ds_read_b64_tr_b16 a[142:143], v10 offset:39936
  s_waitcnt lgkmcnt(0)
  s_barrier
  s_add_u32 m0, s22, 0
  s_add_u32 s39, s21, 0
  buffer_load_dwordx4 v14, s[16:19], s39 offen offset:0 lds
  s_add_u32 s39, s21, 8192
  buffer_load_dwordx4 v12, s[16:19], s39 offen offset:1024 lds
  s_add_u32 s39, s21, 16384
  buffer_load_dwordx4 v14, s[16:19], s39 offen offset:2048 lds
  s_add_u32 s39, s21, 24576
  buffer_load_dwordx4 v12, s[16:19], s39 offen offset:3072 lds
  s_add_u32 s21, s21, 128
  s_add_u32 m0, s22, 16384
  s_add_u32 s39, s21, 0
  buffer_load_dwordx4 v14, s[16:19], s39 offen offset:0 lds
  s_add_u32 s39, s21, 8192
  buffer_load_dwordx4 v12, s[16:19], s39 offen offset:1024 lds
  s_add_u32 s39, s21, 16384
  buffer_load_dwordx4 v14, s[16:19], s39 offen offset:2048 lds
  s_add_u32 s39, s21, 24576
  buffer_load_dwordx4 v12, s[16:19], s39 offen offset:3072 lds
  s_add_u32 s21, s21, 128
  s_add_u32 m0, s22, 32768
  s_add_u32 s39, s21, 0
  buffer_load_dwordx4 v14, s[16:19], s39 offen offset:0 lds
  s_add_u32 s39, s21, 8192
  buffer_load_dwordx4 v12, s[16:19], s39 offen offset:1024 lds
  s_add_u32 s39, s21, 16384
  buffer_load_dwordx4 v14, s[16:19], s39 offen offset:2048 lds
  s_add_u32 s39, s21, 24576
  buffer_load_dwordx4 v12, s[16:19], s39 offen offset:3072 lds
  s_add_u32 s21, s21, 128
  s_add_u32 m0, s22, 49152
  s_add_u32 s39, s21, 0
  buffer_load_dwordx4 v14, s[16:19], s39 offen offset:0 lds
  s_add_u32 s39, s21, 8192
  buffer_load_dwordx4 v12, s[16:19], s39 offen offset:1024 lds
  s_add_u32 s39, s21, 16384
  buffer_load_dwordx4 v14, s[16:19], s39 offen offset:2048 lds
  s_add_u32 s39, s21, 24576
  buffer_load_dwordx4 v12, s[16:19], s39 offen offset:3072 lds
  s_add_u32 s21, s21, 128
  s_add_u32 m0, s22, 65536
  s_add_u32 s39, s21, 0
  buffer_load_dwordx4 v14, s[16:19], s39 offen offset:0 lds
  s_add_u32 s39, s21, 8192
  buffer_load_dwordx4 v12, s[16:19], s39 offen offset:1024 lds
  s_add_u32 s39, s21, 16384
  buffer_load_dwordx4 v14, s[16:19], s39 offen offset:2048 lds
  s_add_u32 s39, s21, 24576
  buffer_load_dwordx4 v12, s[16:19], s39 offen offset:3072 lds
  s_add_u32 s21, s21, 128
  s_add_u32 m0, s22, 81920
  s_add_u32 s39, s21, 0
  buffer_load_dwordx4 v14, s[16:19], s39 offen offset:0 lds
  s_add_u32 s39, s21, 8192
  buffer_load_dwordx4 v12, s[16:19], s39 offen offset:1024 lds
  s_add_u32 s39, s21, 16384
  buffer_load_dwordx4 v14, s[16:19], s39 offen offset:2048 lds
  s_add_u32 s39, s21, 24576
  buffer_load_dwordx4 v12, s[16:19], s39 offen offset:3072 lds
  s_add_u32 s21, s21, 128
  s_add_u32 m0, s22, 98304
  s_add_u32 s39, s21, 0
  buffer_load_dwordx4 v14, s[16:19], s39 offen offset:0 lds
  s_add_u32 s39, s21, 8192
  buffer_load_dwordx4 v12, s[16:19], s39 offen offset:1024 lds
  s_add_u32 s39, s21, 16384
  buffer_load_dwordx4 v14, s[16:19], s39 offen offset:2048 lds
  s_add_u32 s39, s21, 24576
  buffer_load_dwordx4 v12, s[16:19], s39 offen offset:3072 lds
  s_add_u32 s21, s21, 128
  s_add_u32 m0, s22, 114688
  s_add_u32 s39, s21, 0
  buffer_load_dwordx4 v14, s[16:19], s39 offen offset:0 lds
  s_add_u32 s39, s21, 8192
  buffer_load_dwordx4 v12, s[16:19], s39 offen offset:1024 lds
  s_add_u32 s39, s21, 16384
  buffer_load_dwordx4 v14, s[16:19], s39 offen offset:2048 lds
  s_add_u32 s39, s21, 24576
  buffer_load_dwordx4 v12, s[16:19], s39 offen offset:3072 lds
  s_add_u32 s21, s21, 128
  s_mov_b32 s40, 0
  v_mov_b32 v8, 0
WI_3:
  global_load_dword v9, v8, s[66:67] offset:192 sc1
  s_add_u32 s40, s40, 1
  s_cmp_gt_u32 s40, 400000
  s_cbranch_scc1 L_fail
  s_waitcnt vmcnt(0)
  v_readfirstlane_b32 s37, v9
  s_nop 0
  s_cmp_lt_u32 s37, 8
  s_cbranch_scc1 WI_3
  s_waitcnt vmcnt(28)
  s_barrier
  ds_read_b128 v[32:35], v16 offset:0
  ds_read_b128 v[36:39], v16 offset:4096
  ds_read_b128 v[40:43], v16 offset:8192
  ds_read_b128 v[44:47], v16 offset:12288
  ds_read_b128 v[48:51], v17 offset:0
  ds_read_b128 v[52:55], v17 offset:4096
RND_4:
  s_waitcnt lgkmcnt(5)
  v_mfma_f32_32x32x16_bf16 a[144:159], a[0:3], v[32:35], 0
  ds_read_b128 v[56:59], v17 offset:8192
  s_waitcnt lgkmcnt(5)
  v_mfma_f32_32x32x16_bf16 a[160:175], a[0:3], v[36:39], 0
  ds_read_b128 v[60:63], v17 offset:12288
  s_waitcnt lgkmcnt(5)
  v_mfma_f32_32x32x16_bf16 a[176:191], a[0:3], v[40:43], 0
  ds_read_b128 v[32:35], v18 offset:0
  s_waitcnt lgkmcnt(5)
  v_mfma_f32_32x32x16_bf16 a[192:207], a[0:3], v[44:47], 0
  ds_read_b128 v[36:39], v18 offset:4096
  s_waitcnt lgkmcnt(5)
  v_mfma_f32_32x32x16_bf16 a[144:159], a[4:7], v[48:51], a[144:159]
  ds_read_b128 v[40:43], v18 offset:8192
  s_waitcnt lgkmcnt(5)
  v_mfma_f32_32x32x16_bf16 a[160:175], a[4:7], v[52:55], a[160:175]
  ds_read_b128 v[44:47], v18 offset:12288
  s_waitcnt lgkmcnt(5)
  v_mfma_f32_32x32x16_bf16 a[176:191], a[4:7], v[56:59], a[176:191]
  ds_read_b128 v[48:51], v19 offset:0
  s_waitcnt lgkmcnt(5)
  v_mfma_f32_32x32x16_bf16 a[192:207], a[4:7], v[60:63], a[192:207]
  ds_read_b128 v[52:55], v19 offset:4096
  s_waitcnt vmcnt(24)
  s_barrier
  s_add_u32 m0, s22, 131072
  s_add_u32 s39, s21, 0
  buffer_load_dwordx4 v14, s[16:19], s39 offen offset:0 lds
  s_add_u32 s39, s21, 8192
  buffer_load_dwordx4 v12, s[16:19], s39 offen offset:1024 lds
  s_add_u32 s39, s21, 16384
  buffer_load_dwordx4 v14, s[16:19], s39 offen offset:2048 lds
  s_add_u32 s39, s21, 24576
  buffer_load_dwordx4 v12, s[16:19], s39 offen offset:3072 lds
  s_add_u32 s21, s21, 146432
  s_waitcnt lgkmcnt(5)
  v_mfma_f32_32x32x16_bf16 a[144:159], a[8:11], v[32:35], a[144:159]
  ds_read_b128 v[56:59], v19 offset:8192
  s_waitcnt lgkmcnt(5)
  v_mfma_f32_32x32x16_bf16 a[160:175], a[8:11], v[36:39], a[160:175]
  ds_read_b128 v[60:63], v19 offset:12288
  s_waitcnt lgkmcnt(5)
  v_mfma_f32_32x32x16_bf16 a[176:191], a[8:11], v[40:43], a[176:191]
  ds_read_b128 v[32:35], v16 offset:16384
  s_waitcnt lgkmcnt(5)
  v_mfma_f32_32x32x16_bf16 a[192:207], a[8:11], v[44:47], a[192:207]
  ds_read_b128 v[36:39], v16 offset:20480
  s_waitcnt lgkmcnt(5)
  v_mfma_f32_32x32x16_bf16 a[144:159], a[12:15], v[48:51], a[144:159]
  ds_read_b128 v[40:43], v16 offset:24576
  s_waitcnt lgkmcnt(5)
  v_mfma_f32_32x32x16_bf16 a[160:175], a[12:15], v[52:55], a[160:175]
  ds_read_b128 v[44:47], v16 offset:28672
  s_waitcnt lgkmcnt(5)
  v_mfma_f32_32x32x16_bf16 a[176:191], a[12:15], v[56:59], a[176:191]
  ds_read_b128 v[48:51], v17 offset:16384
  s_waitcnt lgkmcnt(5)
  v_mfma_f32_32x32x16_bf16 a[192:207], a[12:15], v[60:63], a[192:207]
  ds_read_b128 v[52:55], v17 offset:20480
  s_waitcnt lgkmcnt(5)
  v_mfma_f32_32x32x16_bf16 a[144:159], a[16:19], v[32:35], a[144:159]
  ds_read_b128 v[56:59], v17 offset:24576
  s_waitcnt lgkmcnt(5)
  v_mfma_f32_32x32x16_bf16 a[160:175], a[16:19], v[36:39], a[160:175]
  ds_read_b128 v[60:63], v17 offset:28672
  s_waitcnt lgkmcnt(5)
  v_mfma_f32_32x32x16_bf16 a[176:191], a[16:19], v[40:43], a[176:191]
  ds_read_b128 v[32:35], v18 offset:16384
  s_waitcnt lgkmcnt(5)
  v_mfma_f32_32x32x16_bf16 a[192:207], a[16:19], v[44:47], a[192:207]
  ds_read_b128 v[36:39], v18 offset:20480
  s_waitcnt lgkmcnt(5)
  v_mfma_f32_32x32x16_bf16 a[144:159], a[20:23], v[48:51], a[144:159]
  ds_read_b128 v[40:43], v18 offset:24576
  s_waitcnt lgkmcnt(5)
  v_mfma_f32_32x32x16_bf16 a[160:175], a[20:23], v[52:55], a[160:175]
  ds_read_b128 v[44:47], v18 offset:28672
  s_waitcnt lgkmcnt(5)
  v_mfma_f32_32x32x16_bf16 a[176:191], a[20:23], v[56:59], a[176:191]
  ds_read_b128 v[48:51], v19 offset:16384
  s_waitcnt lgkmcnt(5)
  v_mfma_f32_32x32x16_bf16 a[192:207], a[20:23], v[60:63], a[192:207]
  ds_read_b128 v[52:55], v19 offset:20480
  s_waitcnt vmcnt(24)
  s_barrier
  s_add_u32 m0, s22, 0
  s_add_u32 s39, s21, 0
  buffer_load_dwordx4 v14, s[16:19], s39 offen offset:0 lds
  s_add_u32 s39, s21, 8192
  buffer_load_dwordx4 v12, s[16:19], s39 offen offset:1024 lds
  s_add_u32 s39, s21, 16384
  buffer_load_dwordx4 v14, s[16:19], s39 offen offset:2048 lds
  s_add_u32 s39, s21, 24576
  buffer_load_dwordx4 v12, s[16:19], s39 offen offset:3072 lds
  s_add_u32 s21, s21, 128
  s_waitcnt lgkmcnt(5)
  v_mfma_f32_32x32x16_bf16 a[144:159], a[24:27], v[32:35], a[144:159]
  ds_read_b128 v[56:59], v19 offset:24576
  s_waitcnt lgkmcnt(5)
  v_mfma_f32_32x32x16_bf16 a[160:175], a[24:27], v[36:39], a[160:175]
  ds_read_b128 v[60:63], v19 offset:28672
  s_waitcnt lgkmcnt(5)
  v_mfma_f32_32x32x16_bf16 a[176:191], a[24:27], v[40:43], a[176:191]
  ds_read_b128 v[32:35], v16 offset:32768
  s_waitcnt lgkmcnt(5)
  v_mfma_f32_32x32x16_bf16 a[192:207], a[24:27], v[44:47], a[192:207]
  ds_read_b128 v[36:39], v16 offset:36864
  s_waitcnt lgkmcnt(5)
  v_mfma_f32_32x32x16_bf16 a[144:159], a[28:31], v[48:51], a[144:159]
  ds_read_b128 v[40:43], v16 offset:40960
  s_waitcnt lgkmcnt(5)
  v_mfma_f32_32x32x16_bf16 a[160:175], a[28:31], v[52:55], a[160:175]
  ds_read_b128 v[44:47], v16 offset:45056
  s_waitcnt lgkmcnt(5)
  v_mfma_f32_32x32x16_bf16 a[176:191], a[28:31], v[56:59], a[176:191]
  ds_read_b128 v[48:51], v17 offset:32768
  s_waitcnt lgkmcnt(5)
  v_mfma_f32_32x32x16_bf16 a[192:207], a[28:31], v[60:63], a[192:207]
  ds_read_b128 v[52:55], v17 offset:36864
  s_waitcnt lgkmcnt(5)
  v_mfma_f32_32x32x16_bf16 a[144:159], a[32:35], v[32:35], a[144:159]
  ds_read_b128 v[56:59], v17 offset:40960
  s_waitcnt lgkmcnt(5)
  v_mfma_f32_32x32x16_bf16 a[160:175], a[32:35], v[36:39], a[160:175]
  ds_read_b128 v[60:63], v17 offset:45056
  s_waitcnt lgkmcnt(5)
  v_mfma_f32_32x32x16_bf16 a[176:191], a[32:35], v[40:43], a[176:191]
  ds_read_b128 v[32:35], v18 offset:32768
  s_waitcnt lgkmcnt(5)
  v_mfma_f32_32x32x16_bf16 a[192:207], a[32:35], v[44:47], a[192:207]
  ds_read_b128 v[36:39], v18 offset:36864
  s_waitcnt lgkmcnt(5)
  v_mfma_f32_32x32x16_bf16 a[144:159], a[36:39], v[48:51], a[144:159]
  ds_read_b128 v[40:43], v18 offset:40960
  s_waitcnt lgkmcnt(5)
  v_mfma_f32_32x32x16_bf16 a[160:175], a[36:39], v[52:55], a[160:175]
  ds_read_b128 v[44:47], v18 offset:45056
  s_waitcnt lgkmcnt(5)
  v_mfma_f32_32x32x16_bf16 a[176:191], a[36:39], v[56:59], a[176:191]
  ds_read_b128 v[48:51], v19 offset:32768
  s_waitcnt lgkmcnt(5)
  v_mfma_f32_32x32x16_bf16 a[192:207], a[36:39], v[60:63], a[192:207]
  ds_read_b128 v[52:55], v19 offset:36864
  s_waitcnt vmcnt(8)
  s_barrier
  s_cmp_lg_u32 s13, 0
  s_cbranch_scc1 NF_5
  v_mov_b32 v8, 0
  v_mov_b32 v9, s23
  buffer_store_dword v9, v8, s[4:7], s25 offen sc1
NF_5:
  s_add_u32 m0, s22, 16384
  s_add_u32 s39, s21, 0
  buffer_load_dwordx4 v14, s[16:19], s39 offen offset:0 lds
  s_add_u32 s39, s21, 8192
  buffer_load_dwordx4 v12, s[16:19], s39 offen offset:1024 lds
  s_add_u32 s39, s21, 16384
  buffer_load_dwordx4 v14, s[16:19], s39 offen offset:2048 lds
  s_add_u32 s39, s21, 24576
  buffer_load_dwordx4 v12, s[16:19], s39 offen offset:3072 lds
  s_add_u32 s21, s21, 128
  s_waitcnt lgkmcnt(5)
  v_mfma_f32_32x32x16_bf16 a[144:159], a[40:43], v[32:35], a[144:159]
  ds_read_b128 v[56:59], v19 offset:40960
  s_waitcnt lgkmcnt(5)
  v_mfma_f32_32x32x16_bf16 a[160:175], a[40:43], v[36:39], a[160:175]
  ds_read_b128 v[60:63], v19 offset:45056
  s_waitcnt lgkmcnt(5)
  v_mfma_f32_32x32x16_bf16 a[176:191], a[40:43], v[40:43], a[176:191]
  ds_read_b128 v[32:35], v20 offset:0
  s_waitcnt lgkmcnt(5)
  v_mfma_f32_32x32x16_bf16 a[192:207], a[40:43], v[44:47], a[192:207]
  ds_read_b128 v[36:39], v20 offset:4096
  s_waitcnt lgkmcnt(5)
  v_mfma_f32_32x32x16_bf16 a[144:159], a[44:47], v[48:51], a[144:159]
  ds_read_b128 v[40:43], v20 offset:8192
  s_waitcnt lgkmcnt(5)
  v_mfma_f32_32x32x16_bf16 a[160:175], a[44:47], v[52:55], a[160:175]
  ds_read_b128 v[44:47], v20 offset:12288
  s_waitcnt lgkmcnt(5)
  v_mfma_f32_32x32x16_bf16 a[176:191], a[44:47], v[56:59], a[176:191]
  ds_read_b128 v[48:51], v21 offset:0
  s_waitcnt lgkmcnt(5)
  v_mfma_f32_32x32x16_bf16 a[192:207], a[44:47], v[60:63], a[192:207]
  ds_read_b128 v[52:55], v21 offset:4096
  s_waitcnt lgkmcnt(5)
  v_mfma_f32_32x32x16_bf16 a[144:159], a[48:51], v[32:35], a[144:159]
  ds_read_b128 v[56:59], v21 offset:8192
  s_waitcnt lgkmcnt(5)
  v_mfma_f32_32x32x16_bf16 a[160:175], a[48:51], v[36:39], a[160:175]
  ds_read_b128 v[60:63], v21 offset:12288
  s_waitcnt lgkmcnt(5)
  v_mfma_f32_32x32x16_bf16 a[176:191], a[48:51], v[40:43], a[176:191]
  ds_read_b128 v[32:35], v22 offset:0
  s_waitcnt lgkmcnt(5)
  v_mfma_f32_32x32x16_bf16 a[192:207], a[48:51], v[44:47], a[192:207]
  ds_read_b128 v[36:39], v22 offset:4096
  s_waitcnt lgkmcnt(5)
  v_mfma_f32_32x32x16_bf16 a[144:159], a[52:55], v[48:51], a[144:159]
  ds_read_b128 v[40:43], v22 offset:8192
  s_waitcnt lgkmcnt(5)
  v_mfma_f32_32x32x16_bf16 a[160:175], a[52:55], v[52:55], a[160:175]
  ds_read_b128 v[44:47], v22 offset:12288
  s_waitcnt lgkmcnt(5)
  v_mfma_f32_32x32x16_bf16 a[176:191], a[52:55], v[56:59], a[176:191]
  ds_read_b128 v[48:51], v23 offset:0
  s_waitcnt lgkmcnt(5)
  v_mfma_f32_32x32x16_bf16 a[192:207], a[52:55], v[60:63], a[192:207]
  ds_read_b128 v[52:55], v23 offset:4096
  s_waitcnt vmcnt(24)
  s_barrier
  s_add_u32 m0, s22, 32768
  s_add_u32 s39, s21, 0
  buffer_load_dwordx4 v14, s[16:19], s39 offen offset:0 lds
  s_add_u32 s39, s21, 8192
  buffer_load_dwordx4 v12, s[16:19], s39 offen offset:1024 lds
  s_add_u32 s39, s21, 16384
  buffer_load_dwordx4 v14, s[16:19], s39 offen offset:2048 lds
  s_add_u32 s39, s21, 24576
  buffer_load_dwordx4 v12, s[16:19], s39 offen offset:3072 lds
  s_add_u32 s21, s21, 128
  s_waitcnt lgkmcnt(5)
  v_mfma_f32_32x32x16_bf16 a[144:159], a[56:59], v[32:35], a[144:159]
  ds_read_b128 v[56:59], v23 offset:8192
  s_waitcnt lgkmcnt(5)
  v_mfma_f32_32x32x16_bf16 a[160:175], a[56:59], v[36:39], a[160:175]
  ds_read_b128 v[60:63], v23 offset:12288
  s_waitcnt lgkmcnt(5)
  v_mfma_f32_32x32x16_bf16 a[176:191], a[56:59], v[40:43], a[176:191]
  ds_read_b128 v[32:35], v20 offset:16384
  s_waitcnt lgkmcnt(5)
  v_mfma_f32_32x32x16_bf16 a[192:207], a[56:59], v[44:47], a[192:207]
  ds_read_b128 v[36:39], v20 offset:20480
  s_waitcnt lgkmcnt(5)
  v_mfma_f32_32x32x16_bf16 a[144:159], a[60:63], v[48:51], a[144:159]
  ds_read_b128 v[40:43], v20 offset:24576
  s_waitcnt lgkmcnt(5)
  v_mfma_f32_32x32x16_bf16 a[160:175], a[60:63], v[52:55], a[160:175]
  ds_read_b128 v[44:47], v20 offset:28672
  s_waitcnt lgkmcnt(5)
  v_mfma_f32_32x32x16_bf16 a[176:191], a[60:63], v[56:59], a[176:191]
  ds_read_b128 v[48:51], v21 offset:16384
  s_waitcnt lgkmcnt(5)
  v_mfma_f32_32x32x16_bf16 a[192:207], a[60:63], v[60:63], a[192:207]
  ds_read_b128 v[52:55], v21 offset:20480
  s_waitcnt lgkmcnt(5)
  v_mfma_f32_32x32x16_bf16 a[144:159], a[64:67], v[32:35], a[144:159]
  ds_read_b128 v[56:59], v21 offset:24576
  s_waitcnt lgkmcnt(5)
  v_mfma_f32_32x32x16_bf16 a[160:175], a[64:67], v[36:39], a[160:175]
  ds_read_b128 v[60:63], v21 offset:28672
  s_waitcnt lgkmcnt(5)
  v_mfma_f32_32x32x16_bf16 a[176:191], a[64:67], v[40:43], a[176:191]
  ds_read_b128 v[32:35], v22 offset:16384
  s_waitcnt lgkmcnt(5)
  v_mfma_f32_32x32x16_bf16 a[192:207], a[64:67], v[44:47], a[192:207]
  ds_read_b128 v[36:39], v22 offset:20480
  s_waitcnt lgkmcnt(5)
  v_mfma_f32_32x32x16_bf16 a[144:159], a[68:71], v[48:51], a[144:159]
  ds_read_b128 v[40:43], v22 offset:24576
  s_waitcnt lgkmcnt(5)
  v_mfma_f32_32x32x16_bf16 a[160:175], a[68:71], v[52:55], a[160:175]
  ds_read_b128 v[44:47], v22 offset:28672
  s_waitcnt lgkmcnt(5)
  v_mfma_f32_32x32x16_bf16 a[176:191], a[68:71], v[56:59], a[176:191]
  ds_read_b128 v[48:51], v23 offset:16384
  s_waitcnt lgkmcnt(5)
  v_mfma_f32_32x32x16_bf16 a[192:207], a[68:71], v[60:63], a[192:207]
  ds_read_b128 v[52:55], v23 offset:20480
  s_waitcnt vmcnt(24)
  s_barrier
  s_add_u32 m0, s22, 49152
  s_add_u32 s39, s21, 0
  buffer_load_dwordx4 v14, s[16:19], s39 offen offset:0 lds
  s_add_u32 s39, s21, 8192
  buffer_load_dwordx4 v12, s[16:19], s39 offen offset:1024 lds
  s_add_u32 s39, s21, 16384
  buffer_load_dwordx4 v14, s[16:19], s39 offen offset:2048 lds
  s_add_u32 s39, s21, 24576
  buffer_load_dwordx4 v12, s[16:19], s39 offen offset:3072 lds
  s_add_u32 s21, s21, 128
  s_waitcnt lgkmcnt(5)
  v_mfma_f32_32x32x16_bf16 a[144:159], a[72:75], v[32:35], a[144:159]
  ds_read_b128 v[56:59], v23 offset:24576
  s_waitcnt lgkmcnt(5)
  v_mfma_f32_32x32x16_bf16 a[160:175], a[72:75], v[36:39], a[160:175]
  ds_read_b128 v[60:63], v23 offset:28672
  s_waitcnt lgkmcnt(5)
  v_mfma_f32_32x32x16_bf16 a[176:191], a[72:75], v[40:43], a[176:191]
  ds_read_b128 v[32:35], v20 offset:32768
  s_waitcnt lgkmcnt(5)
  v_mfma_f32_32x32x16_bf16 a[192:207], a[72:75], v[44:47], a[192:207]
  ds_read_b128 v[36:39], v20 offset:36864
  s_waitcnt lgkmcnt(5)
  v_mfma_f32_32x32x16_bf16 a[144:159], a[76:79], v[48:51], a[144:159]
  ds_read_b128 v[40:43], v20 offset:40960
  s_waitcnt lgkmcnt(5)
  v_mfma_f32_32x32x16_bf16 a[160:175], a[76:79], v[52:55], a[160:175]
  ds_read_b128 v[44:47], v20 offset:45056
  s_waitcnt lgkmcnt(5)
  v_mfma_f32_32x32x16_bf16 a[176:191], a[76:79], v[56:59], a[176:191]
  ds_read_b128 v[48:51], v21 offset:32768
  s_waitcnt lgkmcnt(5)
  v_mfma_f32_32x32x16_bf16 a[192:207], a[76:79], v[60:63], a[192:207]
  ds_read_b128 v[52:55], v21 offset:36864
  s_waitcnt lgkmcnt(5)
  v_mfma_f32_32x32x16_bf16 a[144:159], a[80:83], v[32:35], a[144:159]
  ds_read_b128 v[56:59], v21 offset:40960
  s_waitcnt lgkmcnt(5)
  v_mfma_f32_32x32x16_bf16 a[160:175], a[80:83], v[36:39], a[160:175]
  ds_read_b128 v[60:63], v21 offset:45056
  s_waitcnt lgkmcnt(5)
  v_mfma_f32_32x32x16_bf16 a[176:191], a[80:83], v[40:43], a[176:191]
  ds_read_b128 v[32:35], v22 offset:32768
  s_waitcnt lgkmcnt(5)
  v_mfma_f32_32x32x16_bf16 a[192:207], a[80:83], v[44:47], a[192:207]
  ds_read_b128 v[36:39], v22 offset:36864
  s_waitcnt lgkmcnt(5)
  v_mfma_f32_32x32x16_bf16 a[144:159], a[84:87], v[48:51], a[144:159]
  ds_read_b128 v[40:43], v22 offset:40960
  s_waitcnt lgkmcnt(5)
  v_mfma_f32_32x32x16_bf16 a[160:175], a[84:87], v[52:55], a[160:175]
  ds_read_b128 v[44:47], v22 offset:45056
  s_waitcnt lgkmcnt(5)
  v_mfma_f32_32x32x16_bf16 a[176:191], a[84:87], v[56:59], a[176:191]
  ds_read_b128 v[48:51], v23 offset:32768
  s_waitcnt lgkmcnt(5)
  v_mfma_f32_32x32x16_bf16 a[192:207], a[84:87], v[60:63], a[192:207]
  ds_read_b128 v[52:55], v23 offset:36864
  s_waitcnt vmcnt(24)
  s_barrier
  s_add_u32 m0, s22, 65536
  s_add_u32 s39, s21, 0
  buffer_load_dwordx4 v14, s[16:19], s39 offen offset:0 lds
  s_add_u32 s39, s21, 8192
  buffer_load_dwordx4 v12, s[16:19], s39 offen offset:1024 lds
  s_add_u32 s39, s21, 16384
  buffer_load_dwordx4 v14, s[16:19], s39 offen offset:2048 lds
  s_add_u32 s39, s21, 24576
  buffer_load_dwordx4 v12, s[16:19], s39 offen offset:3072 lds
  s_add_u32 s21, s21, 128
  s_waitcnt lgkmcnt(5)
  v_mfma_f32_32x32x16_bf16 a[144:159], a[88:91], v[32:35], a[144:159]
  ds_read_b128 v[56:59], v23 offset:40960
  s_waitcnt lgkmcnt(5)
  v_mfma_f32_32x32x16_bf16 a[160:175], a[88:91], v[36:39], a[160:175]
  ds_read_b128 v[60:63], v23 offset:45056
  s_waitcnt lgkmcnt(5)
  v_mfma_f32_32x32x16_bf16 a[176:191], a[88:91], v[40:43], a[176:191]
  ds_read_b128 v[32:35], v24 offset:0
  s_waitcnt lgkmcnt(5)
  v_mfma_f32_32x32x16_bf16 a[192:207], a[88:91], v[44:47], a[192:207]
  ds_read_b128 v[36:39], v24 offset:4096
  s_waitcnt lgkmcnt(5)
  v_mfma_f32_32x32x16_bf16 a[144:159], a[92:95], v[48:51], a[144:159]
  ds_read_b128 v[40:43], v24 offset:8192
  s_waitcnt lgkmcnt(5)
  v_mfma_f32_32x32x16_bf16 a[160:175], a[92:95], v[52:55], a[160:175]
  ds_read_b128 v[44:47], v24 offset:12288
  s_waitcnt lgkmcnt(5)
  v_mfma_f32_32x32x16_bf16 a[176:191], a[92:95], v[56:59], a[176:191]
  ds_read_b128 v[48:51], v25 offset:0
  s_waitcnt lgkmcnt(5)
  v_mfma_f32_32x32x16_bf16 a[192:207], a[92:95], v[60:63], a[192:207]
  ds_read_b128 v[52:55], v25 offset:4096
  s_waitcnt lgkmcnt(5)
  v_mfma_f32_32x32x16_bf16 a[144:159], a[96:99], v[32:35], a[144:159]
  ds_read_b128 v[56:59], v25 offset:8192
  s_waitcnt lgkmcnt(5)
  v_mfma_f32_32x32x16_bf16 a[160:175], a[96:99], v[36:39], a[160:175]
  ds_read_b128 v[60:63], v25 offset:12288
  s_waitcnt lgkmcnt(5)
  v_mfma_f32_32x32x16_bf16 a[176:191], a[96:99], v[40:43], a[176:191]
  ds_read_b128 v[32:35], v26 offset:0
  s_waitcnt lgkmcnt(5)
  v_mfma_f32_32x32x16_bf16 a[192:207], a[96:99], v[44:47], a[192:207]
  ds_read_b128 v[36:39], v26 offset:4096
  s_waitcnt lgkmcnt(5)
  v_mfma_f32_32x32x16_bf16 a[144:159], a[100:103], v[48:51], a[144:159]
  ds_read_b128 v[40:43], v26 offset:8192
  s_waitcnt lgkmcnt(5)
  v_mfma_f32_32x32x16_bf16 a[160:175], a[100:103], v[52:55], a[160:175]
  ds_read_b128 v[44:47], v26 offset:12288
  s_waitcnt lgkmcnt(5)
  v_mfma_f32_32x32x16_bf16 a[176:191], a[100:103], v[56:59], a[176:191]
  ds_read_b128 v[48:51], v27 offset:0
  s_waitcnt lgkmcnt(5)
  v_mfma_f32_32x32x16_bf16 a[192:207], a[100:103], v[60:63], a[192:207]
  ds_read_b128 v[52:55], v27 offset:4096
  s_waitcnt vmcnt(24)
  s_barrier
  s_add_u32 m0, s22, 81920
  s_add_u32 s39, s21, 0
  buffer_load_dwordx4 v14, s[16:19], s39 offen offset:0 lds
  s_add_u32 s39, s21, 8192
  buffer_load_dwordx4 v12, s[16:19], s39 offen offset:1024 lds
  s_add_u32 s39, s21, 16384
  buffer_load_dwordx4 v14, s[16:19], s39 offen offset:2048 lds
  s_add_u32 s39, s21, 24576
  buffer_load_dwordx4 v12, s[16:19], s39 offen offset:3072 lds
  s_add_u32 s21, s21, 128
  s_waitcnt lgkmcnt(5)
  v_mfma_f32_32x32x16_bf16 a[144:159], a[104:107], v[32:35], a[144:159]
  ds_read_b128 v[56:59], v27 offset:8192
  s_waitcnt lgkmcnt(5)
  v_mfma_f32_32x32x16_bf16 a[160:175], a[104:107], v[36:39], a[160:175]
  ds_read_b128 v[60:63], v27 offset:12288
  s_waitcnt lgkmcnt(5)
  v_mfma_f32_32x32x16_bf16 a[176:191], a[104:107], v[40:43], a[176:191]
  ds_read_b128 v[32:35], v24 offset:16384
  s_waitcnt lgkmcnt(5)
  v_mfma_f32_32x32x16_bf16 a[192:207], a[104:107], v[44:47], a[192:207]
  ds_read_b128 v[36:39], v24 offset:20480
  s_waitcnt lgkmcnt(5)
  v_mfma_f32_32x32x16_bf16 a[144:159], a[108:111], v[48:51], a[144:159]
  ds_read_b128 v[40:43], v24 offset:24576
  s_waitcnt lgkmcnt(5)
  v_mfma_f32_32x32x16_bf16 a[160:175], a[108:111], v[52:55], a[160:175]
  ds_read_b128 v[44:47], v24 offset:28672
  s_waitcnt lgkmcnt(5)
  v_mfma_f32_32x32x16_bf16 a[176:191], a[108:111], v[56:59], a[176:191]
  ds_read_b128 v[48:51], v25 offset:16384
  s_waitcnt lgkmcnt(5)
  v_mfma_f32_32x32x16_bf16 a[192:207], a[108:111], v[60:63], a[192:207]
  ds_read_b128 v[52:55], v25 offset:20480
  s_waitcnt lgkmcnt(5)
  v_mfma_f32_32x32x16_bf16 a[144:159], a[112:115], v[32:35], a[144:159]
  ds_read_b128 v[56:59], v25 offset:24576
  s_waitcnt lgkmcnt(5)
  v_mfma_f32_32x32x16_bf16 a[160:175], a[112:115], v[36:39], a[160:175]
  ds_read_b128 v[60:63], v25 offset:28672
  s_waitcnt lgkmcnt(5)
  v_mfma_f32_32x32x16_bf16 a[176:191], a[112:115], v[40:43], a[176:191]
  ds_read_b128 v[32:35], v26 offset:16384
  s_waitcnt lgkmcnt(5)
  v_mfma_f32_32x32x16_bf16 a[192:207], a[112:115], v[44:47], a[192:207]
  ds_read_b128 v[36:39], v26 offset:20480
  s_waitcnt lgkmcnt(5)
  v_mfma_f32_32x32x16_bf16 a[144:159], a[116:119], v[48:51], a[144:159]
  ds_read_b128 v[40:43], v26 offset:24576
  s_waitcnt lgkmcnt(5)
  v_mfma_f32_32x32x16_bf16 a[160:175], a[116:119], v[52:55], a[160:175]
  ds_read_b128 v[44:47], v26 offset:28672
  s_waitcnt lgkmcnt(5)
  v_mfma_f32_32x32x16_bf16 a[176:191], a[116:119], v[56:59], a[176:191]
  ds_read_b128 v[48:51], v27 offset:16384
  s_waitcnt lgkmcnt(5)
  v_mfma_f32_32x32x16_bf16 a[192:207], a[116:119], v[60:63], a[192:207]
  ds_read_b128 v[52:55], v27 offset:20480
  s_waitcnt vmcnt(24)
  s_barrier
  s_add_u32 m0, s22, 98304
  s_add_u32 s39, s21, 0
  buffer_load_dwordx4 v14, s[16:19], s39 offen offset:0 lds
  s_add_u32 s39, s21, 8192
  buffer_load_dwordx4 v12, s[16:19], s39 offen offset:1024 lds
  s_add_u32 s39, s21, 16384
  buffer_load_dwordx4 v14, s[16:19], s39 offen offset:2048 lds
  s_add_u32 s39, s21, 24576
  buffer_load_dwordx4 v12, s[16:19], s39 offen offset:3072 lds
  s_add_u32 s21, s21, 128
  s_waitcnt lgkmcnt(5)
  v_mfma_f32_32x32x16_bf16 a[144:159], a[120:123], v[32:35], a[144:159]
  ds_read_b128 v[56:59], v27 offset:24576
  s_waitcnt lgkmcnt(5)
  v_mfma_f32_32x32x16_bf16 a[160:175], a[120:123], v[36:39], a[160:175]
  ds_read_b128 v[60:63], v27 offset:28672
  s_waitcnt lgkmcnt(5)
  v_mfma_f32_32x32x16_bf16 a[176:191], a[120:123], v[40:43], a[176:191]
  ds_read_b128 v[32:35], v24 offset:32768
  s_waitcnt lgkmcnt(5)
  v_mfma_f32_32x32x16_bf16 a[192:207], a[120:123], v[44:47], a[192:207]
  ds_read_b128 v[36:39], v24 offset:36864
  s_waitcnt lgkmcnt(5)
  v_mfma_f32_32x32x16_bf16 a[144:159], a[124:127], v[48:51], a[144:159]
  ds_read_b128 v[40:43], v24 offset:40960
  s_waitcnt lgkmcnt(5)
  v_mfma_f32_32x32x16_bf16 a[160:175], a[124:127], v[52:55], a[160:175]
  ds_read_b128 v[44:47], v24 offset:45056
  s_waitcnt lgkmcnt(5)
  v_mfma_f32_32x32x16_bf16 a[176:191], a[124:127], v[56:59], a[176:191]
  ds_read_b128 v[48:51], v25 offset:32768
  s_waitcnt lgkmcnt(5)
  v_mfma_f32_32x32x16_bf16 a[192:207], a[124:127], v[60:63], a[192:207]
  ds_read_b128 v[52:55], v25 offset:36864
  s_waitcnt lgkmcnt(5)
  v_mfma_f32_32x32x16_bf16 a[144:159], a[128:131], v[32:35], a[144:159]
  ds_read_b128 v[56:59], v25 offset:40960
  s_waitcnt lgkmcnt(5)
  v_mfma_f32_32x32x16_bf16 a[160:175], a[128:131], v[36:39], a[160:175]
  ds_read_b128 v[60:63], v25 offset:45056
  s_waitcnt lgkmcnt(5)
  v_mfma_f32_32x32x16_bf16 a[176:191], a[128:131], v[40:43], a[176:191]
  ds_read_b128 v[32:35], v26 offset:32768
  s_waitcnt lgkmcnt(5)
  v_mfma_f32_32x32x16_bf16 a[192:207], a[128:131], v[44:47], a[192:207]
  ds_read_b128 v[36:39], v26 offset:36864
  s_waitcnt lgkmcnt(5)
  v_mfma_f32_32x32x16_bf16 a[144:159], a[132:135], v[48:51], a[144:159]
  ds_read_b128 v[40:43], v26 offset:40960
  s_waitcnt lgkmcnt(5)
  v_mfma_f32_32x32x16_bf16 a[160:175], a[132:135], v[52:55], a[160:175]
  ds_read_b128 v[44:47], v26 offset:45056
  s_waitcnt lgkmcnt(5)
  v_mfma_f32_32x32x16_bf16 a[176:191], a[132:135], v[56:59], a[176:191]
  ds_read_b128 v[48:51], v27 offset:32768
  s_waitcnt lgkmcnt(5)
  v_mfma_f32_32x32x16_bf16 a[192:207], a[132:135], v[60:63], a[192:207]
  ds_read_b128 v[52:55], v27 offset:36864
  s_waitcnt vmcnt(24)
  s_barrier
  s_add_u32 m0, s22, 114688
  s_add_u32 s39, s21, 0
  buffer_load_dwordx4 v14, s[16:19], s39 offen offset:0 lds
  s_add_u32 s39, s21, 8192
  buffer_load_dwordx4 v12, s[16:19], s39 offen offset:1024 lds
  s_add_u32 s39, s21, 16384
  buffer_load_dwordx4 v14, s[16:19], s39 offen offset:2048 lds
  s_add_u32 s39, s21, 24576
  buffer_load_dwordx4 v12, s[16:19], s39 offen offset:3072 lds
  s_add_u32 s21, s21, 128
  s_waitcnt lgkmcnt(5)
  v_mfma_f32_32x32x16_bf16 a[144:159], a[136:139], v[32:35], a[144:159]
  ds_read_b128 v[56:59], v27 offset:40960
  s_waitcnt lgkmcnt(5)
  v_mfma_f32_32x32x16_bf16 a[160:175], a[136:139], v[36:39], a[160:175]
  ds_read_b128 v[60:63], v27 offset:45056
  s_waitcnt lgkmcnt(5)
  v_mfma_f32_32x32x16_bf16 a[176:191], a[136:139], v[40:43], a[176:191]
  ds_read_b128 v[32:35], v16 offset:0
  s_waitcnt lgkmcnt(5)
  v_mfma_f32_32x32x16_bf16 a[192:207], a[136:139], v[44:47], a[192:207]
  ds_read_b128 v[36:39], v16 offset:4096
  s_waitcnt lgkmcnt(5)
  v_mfma_f32_32x32x16_bf16 a[144:159], a[140:143], v[48:51], a[144:159]
  ds_read_b128 v[40:43], v16 offset:8192
  s_waitcnt lgkmcnt(5)
  v_mfma_f32_32x32x16_bf16 a[160:175], a[140:143], v[52:55], a[160:175]
  ds_read_b128 v[44:47], v16 offset:12288
  s_waitcnt lgkmcnt(5)
  v_mfma_f32_32x32x16_bf16 a[176:191], a[140:143], v[56:59], a[176:191]
  ds_read_b128 v[48:51], v17 offset:0
  s_waitcnt lgkmcnt(5)
  v_mfma_f32_32x32x16_bf16 a[192:207], a[140:143], v[60:63], a[192:207]
  ds_read_b128 v[52:55], v17 offset:4096
  s_nop 1
  v_accvgpr_read_b32 v128, a144
  v_accvgpr_read_b32 v129, a145
  v_accvgpr_read_b32 v130, a146
  v_accvgpr_read_b32 v131, a147
  v_accvgpr_read_b32 v132, a148
  v_accvgpr_read_b32 v133, a149
  v_accvgpr_read_b32 v134, a150
  v_accvgpr_read_b32 v135, a151
  v_accvgpr_read_b32 v136, a152
  v_accvgpr_read_b32 v137, a153
  v_accvgpr_read_b32 v138, a154
  v_accvgpr_read_b32 v139, a155
  v_accvgpr_read_b32 v140, a156
  v_accvgpr_read_b32 v141, a157
  v_accvgpr_read_b32 v142, a158
  v_accvgpr_read_b32 v143, a159
  v_cvt_pk_bf16_f32 v96, v128, v129
  v_cvt_pk_bf16_f32 v97, v130, v131
  v_cvt_pk_bf16_f32 v98, v136, v137
  v_cvt_pk_bf16_f32 v99, v138, v139
  buffer_store_dwordx4 v[96:99], v2, s[4:7], s24 offen offset:0 sc1
  v_cvt_pk_bf16_f32 v100, v132, v133
  v_cvt_pk_bf16_f32 v101, v134, v135
  v_cvt_pk_bf16_f32 v102, v140, v141
  v_cvt_pk_bf16_f32 v103, v142, v143
  buffer_store_dwordx4 v[100:103], v2, s[4:7], s24 offen offset:1024 sc1
  s_add_u32 s24, s24, 524288
  v_accvgpr_read_b32 v128, a160
  v_accvgpr_read_b32 v129, a161
  v_accvgpr_read_b32 v130, a162
  v_accvgpr_read_b32 v131, a163
  v_accvgpr_read_b32 v132, a164
  v_accvgpr_read_b32 v133, a165
  v_accvgpr_read_b32 v134, a166
  v_accvgpr_read_b32 v135, a167
  v_accvgpr_read_b32 v136, a168
  v_accvgpr_read_b32 v137, a169
  v_accvgpr_read_b32 v138, a170
  v_accvgpr_read_b32 v139, a171
  v_accvgpr_read_b32 v140, a172
  v_accvgpr_read_b32 v141, a173
  v_accvgpr_read_b32 v142, a174
  v_accvgpr_read_b32 v143, a175
  v_cvt_pk_bf16_f32 v104, v128, v129
  v_cvt_pk_bf16_f32 v105, v130, v131
  v_cvt_pk_bf16_f32 v106, v136, v137
  v_cvt_pk_bf16_f32 v107, v138, v139
  buffer_store_dwordx4 v[104:107], v2, s[4:7], s24 offen offset:0 sc1
  v_cvt_pk_bf16_f32 v108, v132, v133
  v_cvt_pk_bf16_f32 v109, v134, v135
  v_cvt_pk_bf16_f32 v110, v140, v141
  v_cvt_pk_bf16_f32 v111, v142, v143
  buffer_store_dwordx4 v[108:111], v2, s[4:7], s24 offen offset:1024 sc1
  s_add_u32 s24, s24, 524288
  v_accvgpr_read_b32 v128, a176
  v_accvgpr_read_b32 v129, a177
  v_accvgpr_read_b32 v130, a178
  v_accvgpr_read_b32 v131, a179
  v_accvgpr_read_b32 v132, a180
  v_accvgpr_read_b32 v133, a181
  v_accvgpr_read_b32 v134, a182
  v_accvgpr_read_b32 v135, a183
  v_accvgpr_read_b32 v136, a184
  v_accvgpr_read_b32 v137, a185
  v_accvgpr_read_b32 v138, a186
  v_accvgpr_read_b32 v139, a187
  v_accvgpr_read_b32 v140, a188
  v_accvgpr_read_b32 v141, a189
  v_accvgpr_read_b32 v142, a190
  v_accvgpr_read_b32 v143, a191
  v_cvt_pk_bf16_f32 v112, v128, v129
  v_cvt_pk_bf16_f32 v113, v130, v131
  v_cvt_pk_bf16_f32 v114, v136, v137
  v_cvt_pk_bf16_f32 v115, v138, v139
  buffer_store_dwordx4 v[112:115], v2, s[4:7], s24 offen offset:0 sc1
  v_cvt_pk_bf16_f32 v116, v132, v133
  v_cvt_pk_bf16_f32 v117, v134, v135
  v_cvt_pk_bf16_f32 v118, v140, v141
  v_cvt_pk_bf16_f32 v119, v142, v143
  buffer_store_dwordx4 v[116:119], v2, s[4:7], s24 offen offset:1024 sc1
  s_add_u32 s24, s24, 524288
  v_accvgpr_read_b32 v128, a192
  v_accvgpr_read_b32 v129, a193
  v_accvgpr_read_b32 v130, a194
  v_accvgpr_read_b32 v131, a195
  v_accvgpr_read_b32 v132, a196
  v_accvgpr_read_b32 v133, a197
  v_accvgpr_read_b32 v134, a198
  v_accvgpr_read_b32 v135, a199
  v_accvgpr_read_b32 v136, a200
  v_accvgpr_read_b32 v137, a201
  v_accvgpr_read_b32 v138, a202
  v_accvgpr_read_b32 v139, a203
  v_accvgpr_read_b32 v140, a204
  v_accvgpr_read_b32 v141, a205
  v_accvgpr_read_b32 v142, a206
  v_accvgpr_read_b32 v143, a207
  v_cvt_pk_bf16_f32 v120, v128, v129
  v_cvt_pk_bf16_f32 v121, v130, v131
  v_cvt_pk_bf16_f32 v122, v136, v137
  v_cvt_pk_bf16_f32 v123, v138, v139
  buffer_store_dwordx4 v[120:123], v2, s[4:7], s24 offen offset:0 sc1
  v_cvt_pk_bf16_f32 v124, v132, v133
  v_cvt_pk_bf16_f32 v125, v134, v135
  v_cvt_pk_bf16_f32 v126, v140, v141
  v_cvt_pk_bf16_f32 v127, v142, v143
  buffer_store_dwordx4 v[124:127], v2, s[4:7], s24 offen offset:1024 sc1
  s_add_u32 s24, s24, 524288
  s_add_u32 s23, s23, 1
  s_cmp_lt_u32 s23, 16
  s_cbranch_scc1 RND_4
  s_waitcnt vmcnt(0) lgkmcnt(0)
  s_barrier
  s_cmp_lg_u32 s13, 0
  s_cbranch_scc1 NF_6
  v_mov_b32 v8, 0
  v_mov_b32 v9, 16
  buffer_store_dword v9, v8, s[4:7], s25 offen sc1
NF_6:
  s_add_u32 s12, s12, 36
  s_branch L_op
L_blk_V:
  s_load_dwordx2 s[4:5], s[0:1], 112
  s_load_dwordx2 s[8:9], s[0:1], 72
  s_load_dwordx2 s[16:17], s[0:1], 40
  s_load_dwordx2 s[66:67], s[0:1], 104
  v_and_b32 v1, 63, v0
  v_lshlrev_b32 v2, 4, v1
  v_and_b32 v3, 31, v1
  s_waitcnt vmcnt(0)
  v_lshrrev_b32 v4, 5, v1
  v_bfe_u32 v5, v1, 4, 1
  v_bfe_u32 v6, v1, 2, 2
  v_and_b32 v7, 3, v1
  v_lshrrev_b32 v8, 4, v1
  v_and_b32 v9, 15, v1
  v_lshlrev_b32 v15, 2, v8
  v_xor_b32 v9, v9, v15
  v_lshlrev_b32 v9, 4, v9
  v_lshl_add_u32 v9, v8, 13, v9
  s_lshl_b32 s36, s12, 8
  v_add_u32 v9, s36, v9
  v_lshl_add_u32 v8, v4, 5, v6
  v_lshlrev_b32 v8, 8, v8
  v_lshl_add_u32 v8, v5, 5, v8
  v_lshl_add_u32 v8, v7, 3, v8
  v_xor_b32 v15, s13, v6
  v_lshl_add_u32 v10, v15, 6, v8
  v_lshrrev_b32 v15, 3, v1
  v_mul_u32_u24 v14, 1152, v15
  v_lshrrev_b32 v15, 4, v1
  v_and_b32 v12, 7, v1
  v_xor_b32 v15, v15, v12
  v_xor_b32 v12, 4, v15
  v_lshl_add_u32 v12, v12, 4, v14
  v_lshl_add_u32 v14, v15, 4, v14
  s_lshl_b32 s22, s13, 12
  v_bfe_u32 v15, v3, 1, 3
  v_lshlrev_b32 v16, 2, v4
  v_xor_b32 v15, v15, v16
  v_lshlrev_b32 v19, 7, v3
  v_lshl_add_u32 v16, v15, 4, v19
  v_xor_b32 v17, 16, v16
  v_xor_b32 v18, 32, v16
  v_xor_b32 v19, 48, v16
  s_waitcnt lgkmcnt(0)
  s_mov_b32 s6, 268435456
  s_mov_b32 s7, 0x20000
  s_mov_b32 s10, 4718592
  s_mov_b32 s11, 0x20000
  s_mov_b32 s18, 2359296
  s_mov_b32 s19, 0x20000
  s_mul_i32 s36, s13, 36864
  s_mul_i32 s37, s13, 1179648
  s_mov_b32 s38, 0
  v_add_u32 v20, 49152, v16
  v_add_u32 v21, 49152, v17
  v_add_u32 v22, 49152, v18
  v_add_u32 v23, 49152, v19
  v_add_u32 v24, 98304, v16
  v_add_u32 v25, 98304, v17
  v_add_u32 v26, 98304, v18
  v_add_u32 v27, 98304, v19
WD_7:
  s_mov_b32 m0, s36
  s_add_u32 s36, s36, 1024
  buffer_load_dwordx4 v9, s[8:11], s37 offen lds
  s_add_u32 s37, s37, 32768
  s_add_u32 s38, s38, 1
  s_cmp_lt_u32 s38, 36
  s_cbranch_scc1 WD_7
  s_lshl_b32 s39, s12, 2
  s_add_u32 s39, s39, s13
  s_mul_i32 s39, s39, 18432
  v_lshlrev_b32 v15, 7, v1
  buffer_load_dword v100, v15, s[16:19], s39 offen
  s_add_u32 s39, s39, 8192
  buffer_load_dword v101, v15, s[16:19], s39 offen
  s_add_u32 s39, s39, 2048
  buffer_load_dword v102, v15, s[16:19], s39 offen
  s_add_u32 s39, s39, 2048
  s_mul_i32 s21, s13, 36864
  s_mov_b32 s23, 0
  s_lshl_b32 s25, s12, 9
  s_add_u32 s25, s25, 917760
  s_lshl_b32 s24, s12, 14
  s_add_u32 s24, s24, 16785408
  s_lshl_b32 s36, s13, 11
  s_add_u32 s24, s24, s36
  s_waitcnt vmcnt(3)
  s_barrier
  ds_read_b64_tr_b16 a[0:1], v10 offset:0
  ds_read_b64_tr_b16 a[2:3], v10 offset:1024
  ds_read_b64_tr_b16 a[4:5], v10 offset:2048
  ds_read_b64_tr_b16 a[6:7], v10 offset:3072
  ds_read_b64_tr_b16 a[8:9], v10 offset:4096
  ds_read_b64_tr_b16 a[10:11], v10 offset:5120
  ds_read_b64_tr_b16 a[12:13], v10 offset:6144
  ds_read_b64_tr_b16 a[14:15], v10 offset:7168
  ds_read_b64_tr_b16 a[16:17], v10 offset:16384
  ds_read_b64_tr_b16 a[18:19], v10 offset:17408
  ds_read_b64_tr_b16 a[20:21], v10 offset:18432
  ds_read_b64_tr_b16 a[22:23], v10 offset:19456
  ds_read_b64_tr_b16 a[24:25], v10 offset:20480
  ds_read_b64_tr_b16 a[26:27], v10 offset:21504
  ds_read_b64_tr_b16 a[28:29], v10 offset:22528
  ds_read_b64_tr_b16 a[30:31], v10 offset:23552
  ds_read_b64_tr_b16 a[32:33], v10 offset:32768
  ds_read_b64_tr_b16 a[34:35], v10 offset:33792
  ds_read_b64_tr_b16 a[36:37], v10 offset:34816
  ds_read_b64_tr_b16 a[38:39], v10 offset:35840
  ds_read_b64_tr_b16 a[40:41], v10 offset:36864
  ds_read_b64_tr_b16 a[42:43], v10 offset:37888
  ds_read_b64_tr_b16 a[44:45], v10 offset:38912
  ds_read_b64_tr_b16 a[46:47], v10 offset:39936
  v_add_u32 v10, 49152, v10
  ds_read_b64_tr_b16 a[48:49], v10 offset:0
  ds_read_b64_tr_b16 a[50:51], v10 offset:1024
  ds_read_b64_tr_b16 a[52:53], v10 offset:2048
  ds_read_b64_tr_b16 a[54:55], v10 offset:3072
  ds_read_b64_tr_b16 a[56:57], v10 offset:4096
  ds_read_b64_tr_b16 a[58:59], v10 offset:5120
  ds_read_b64_tr_b16 a[60:61], v10 offset:6144
  ds_read_b64_tr_b16 a[62:63], v10 offset:7168
  ds_read_b64_tr_b16 a[64:65], v10 offset:16384
  ds_read_b64_tr_b16 a[66:67], v10 offset:17408
  ds_read_b64_tr_b16 a[68:69], v10 offset:18432
  ds_read_b64_tr_b16 a[70:71], v10 offset:19456
  ds_read_b64_tr_b16 a[72:73], v10 offset:20480
  ds_read_b64_tr_b16 a[74:75], v10 offset:21504
  ds_read_b64_tr_b16 a[76:77], v10 offset:22528
  ds_read_b64_tr_b16 a[78:79], v10 offset:23552
  ds_read_b64_tr_b16 a[80:81], v10 offset:32768
  ds_read_b64_tr_b16 a[82:83], v10 offset:33792
  ds_read_b64_tr_b16 a[84:85], v10 offset:34816
  ds_read_b64_tr_b16 a[86:87], v10 offset:35840
  ds_read_b64_tr_b16 a[88:89], v10 offset:36864
  ds_read_b64_tr_b16 a[90:91], v10 offset:37888
  ds_read_b64_tr_b16 a[92:93], v10 offset:38912
  ds_read_b64_tr_b16 a[94:95], v10 offset:39936
  v_add_u32 v10, 49152, v10
  ds_read_b64_tr_b16 a[96:97], v10 offset:0
  ds_read_b64_tr_b16 a[98:99], v10 offset:1024
  ds_read_b64_tr_b16 a[100:101], v10 offset:2048
  ds_read_b64_tr_b16 a[102:103], v10 offset:3072
  ds_read_b64_tr_b16 a[104:105], v10 offset:4096
  ds_read_b64_tr_b16 a[106:107], v10 offset:5120
  ds_read_b64_tr_b16 a[108:109], v10 offset:6144
  ds_read_b64_tr_b16 a[110:111], v10 offset:7168
  ds_read_b64_tr_b16 a[112:113], v10 offset:16384
  ds_read_b64_tr_b16 a[114:115], v10 offset:17408
  ds_read_b64_tr_b16 a[116:117], v10 offset:18432
  ds_read_b64_tr_b16 a[118:119], v10 offset:19456
  ds_read_b64_tr_b16 a[120:121], v10 offset:20480
  ds_read_b64_tr_b16 a[122:123], v10 offset:21504
  ds_read_b64_tr_b16 a[124:125], v10 offset:22528
  ds_read_b64_tr_b16 a[126:127], v10 offset:23552
  ds_read_b64_tr_b16 a[128:129], v10 offset:32768
  ds_read_b64_tr_b16 a[130:131], v10 offset:33792
  ds_read_b64_tr_b16 a[132:133], v10 offset:34816
  ds_read_b64_tr_b16 a[134:135], v10 offset:35840
  ds_read_b64_tr_b16 a[136:137], v10 offset:36864
  ds_read_b64_tr_b16 a[138:139], v10 offset:37888
  ds_read_b64_tr_b16 a[140:141], v10 offset:38912
  ds_read_b64_tr_b16 a[142:143], v10 offset:39936
  s_waitcnt lgkmcnt(0)
  s_barrier
  s_add_u32 m0, s22, 0
  s_add_u32 s39, s21, 0
  buffer_load_dwordx4 v14, s[16:19], s39 offen offset:0 lds
  s_add_u32 s39, s21, 8192
  buffer_load_dwordx4 v12, s[16:19], s39 offen offset:1024 lds
  s_add_u32 s39, s21, 16384
  buffer_load_dwordx4 v14, s[16:19], s39 offen offset:2048 lds
  s_add_u32 s39, s21, 24576
  buffer_load_dwordx4 v12, s[16:19], s39 offen offset:3072 lds
  s_add_u32 s21, s21, 128
  s_add_u32 m0, s22, 16384
  s_add_u32 s39, s21, 0
  buffer_load_dwordx4 v14, s[16:19], s39 offen offset:0 lds
  s_add_u32 s39, s21, 8192
  buffer_load_dwordx4 v12, s[16:19], s39 offen offset:1024 lds
  s_add_u32 s39, s21, 16384
  buffer_load_dwordx4 v14, s[16:19], s39 offen offset:2048 lds
  s_add_u32 s39, s21, 24576
  buffer_load_dwordx4 v12, s[16:19], s39 offen offset:3072 lds
  s_add_u32 s21, s21, 128
  s_add_u32 m0, s22, 32768
  s_add_u32 s39, s21, 0
  buffer_load_dwordx4 v14, s[16:19], s39 offen offset:0 lds
  s_add_u32 s39, s21, 8192
  buffer_load_dwordx4 v12, s[16:19], s39 offen offset:1024 lds
  s_add_u32 s39, s21, 16384
  buffer_load_dwordx4 v14, s[16:19], s39 offen offset:2048 lds
  s_add_u32 s39, s21, 24576
  buffer_load_dwordx4 v12, s[16:19], s39 offen offset:3072 lds
  s_add_u32 s21, s21, 128
  s_add_u32 m0, s22, 49152
  s_add_u32 s39, s21, 0
  buffer_load_dwordx4 v14, s[16:19], s39 offen offset:0 lds
  s_add_u32 s39, s21, 8192
  buffer_load_dwordx4 v12, s[16:19], s39 offen offset:1024 lds
  s_add_u32 s39, s21, 16384
  buffer_load_dwordx4 v14, s[16:19], s39 offen offset:2048 lds
  s_add_u32 s39, s21, 24576
  buffer_load_dwordx4 v12, s[16:19], s39 offen offset:3072 lds
  s_add_u32 s21, s21, 128
  s_add_u32 m0, s22, 65536
  s_add_u32 s39, s21, 0
  buffer_load_dwordx4 v14, s[16:19], s39 offen offset:0 lds
  s_add_u32 s39, s21, 8192
  buffer_load_dwordx4 v12, s[16:19], s39 offen offset:1024 lds
  s_add_u32 s39, s21, 16384
  buffer_load_dwordx4 v14, s[16:19], s39 offen offset:2048 lds
  s_add_u32 s39, s21, 24576
  buffer_load_dwordx4 v12, s[16:19], s39 offen offset:3072 lds
  s_add_u32 s21, s21, 128
  s_add_u32 m0, s22, 81920
  s_add_u32 s39, s21, 0
  buffer_load_dwordx4 v14, s[16:19], s39 offen offset:0 lds
  s_add_u32 s39, s21, 8192
  buffer_load_dwordx4 v12, s[16:19], s39 offen offset:1024 lds
  s_add_u32 s39, s21, 16384
  buffer_load_dwordx4 v14, s[16:19], s39 offen offset:2048 lds
  s_add_u32 s39, s21, 24576
  buffer_load_dwordx4 v12, s[16:19], s39 offen offset:3072 lds
  s_add_u32 s21, s21, 128
  s_add_u32 m0, s22, 98304
  s_add_u32 s39, s21, 0
  buffer_load_dwordx4 v14, s[16:19], s39 offen offset:0 lds
  s_add_u32 s39, s21, 8192
  buffer_load_dwordx4 v12, s[16:19], s39 offen offset:1024 lds
  s_add_u32 s39, s21, 16384
  buffer_load_dwordx4 v14, s[16:19], s39 offen offset:2048 lds
  s_add_u32 s39, s21, 24576
  buffer_load_dwordx4 v12, s[16:19], s39 offen offset:3072 lds
  s_add_u32 s21, s21, 128
  s_add_u32 m0, s22, 114688
  s_add_u32 s39, s21, 0
  buffer_load_dwordx4 v14, s[16:19], s39 offen offset:0 lds
  s_add_u32 s39, s21, 8192
  buffer_load_dwordx4 v12, s[16:19], s39 offen offset:1024 lds
  s_add_u32 s39, s21, 16384
  buffer_load_dwordx4 v14, s[16:19], s39 offen offset:2048 lds
  s_add_u32 s39, s21, 24576
  buffer_load_dwordx4 v12, s[16:19], s39 offen offset:3072 lds
  s_add_u32 s21, s21, 128
  s_mov_b32 s40, 0
  v_mov_b32 v8, 0
WI_8:
  global_load_dword v9, v8, s[66:67] offset:192 sc1
  s_add_u32 s40, s40, 1
  s_cmp_gt_u32 s40, 400000
  s_cbranch_scc1 L_fail
  s_waitcnt vmcnt(0)
  v_readfirstlane_b32 s37, v9
  s_nop 0
  s_cmp_lt_u32 s37, 8
  s_cbranch_scc1 WI_8
  s_waitcnt vmcnt(28)
  s_barrier
  ds_read_b128 v[32:35], v16 offset:0
  ds_read_b128 v[36:39], v16 offset:4096
  ds_read_b128 v[40:43], v16 offset:8192
  ds_read_b128 v[44:47], v16 offset:12288
  ds_read_b128 v[48:51], v17 offset:0
  ds_read_b128 v[52:55], v17 offset:4096
RND_9:
  s_waitcnt lgkmcnt(5)
  v_mfma_f32_32x32x16_bf16 a[144:159], v[32:35], a[0:3], 0
  ds_read_b128 v[56:59], v17 offset:8192
  s_waitcnt lgkmcnt(5)
  v_mfma_f32_32x32x16_bf16 a[160:175], v[36:39], a[0:3], 0
  ds_read_b128 v[60:63], v17 offset:12288
  s_waitcnt lgkmcnt(5)
  v_mfma_f32_32x32x16_bf16 a[176:191], v[40:43], a[0:3], 0
  ds_read_b128 v[32:35], v18 offset:0
  s_waitcnt lgkmcnt(5)
  v_mfma_f32_32x32x16_bf16 a[192:207], v[44:47], a[0:3], 0
  ds_read_b128 v[36:39], v18 offset:4096
  s_waitcnt lgkmcnt(5)
  v_mfma_f32_32x32x16_bf16 a[144:159], v[48:51], a[4:7], a[144:159]
  ds_read_b128 v[40:43], v18 offset:8192
  s_waitcnt lgkmcnt(5)
  v_mfma_f32_32x32x16_bf16 a[160:175], v[52:55], a[4:7], a[160:175]
  ds_read_b128 v[44:47], v18 offset:12288
  s_waitcnt lgkmcnt(5)
  v_mfma_f32_32x32x16_bf16 a[176:191], v[56:59], a[4:7], a[176:191]
  ds_read_b128 v[48:51], v19 offset:0
  s_waitcnt lgkmcnt(5)
  v_mfma_f32_32x32x16_bf16 a[192:207], v[60:63], a[4:7], a[192:207]
  ds_read_b128 v[52:55], v19 offset:4096
  s_waitcnt vmcnt(24)
  s_barrier
  s_add_u32 m0, s22, 131072
  s_add_u32 s39, s21, 0
  buffer_load_dwordx4 v14, s[16:19], s39 offen offset:0 lds
  s_add_u32 s39, s21, 8192
  buffer_load_dwordx4 v12, s[16:19], s39 offen offset:1024 lds
  s_add_u32 s39, s21, 16384
  buffer_load_dwordx4 v14, s[16:19], s39 offen offset:2048 lds
  s_add_u32 s39, s21, 24576
  buffer_load_dwordx4 v12, s[16:19], s39 offen offset:3072 lds
  s_add_u32 s21, s21, 146432
  s_waitcnt lgkmcnt(5)
  v_mfma_f32_32x32x16_bf16 a[144:159], v[32:35], a[8:11], a[144:159]
  ds_read_b128 v[56:59], v19 offset:8192
  s_waitcnt lgkmcnt(5)
  v_mfma_f32_32x32x16_bf16 a[160:175], v[36:39], a[8:11], a[160:175]
  ds_read_b128 v[60:63], v19 offset:12288
  s_waitcnt lgkmcnt(5)
  v_mfma_f32_32x32x16_bf16 a[176:191], v[40:43], a[8:11], a[176:191]
  ds_read_b128 v[32:35], v16 offset:16384
  s_waitcnt lgkmcnt(5)
  v_mfma_f32_32x32x16_bf16 a[192:207], v[44:47], a[8:11], a[192:207]
  ds_read_b128 v[36:39], v16 offset:20480
  s_waitcnt lgkmcnt(5)
  v_mfma_f32_32x32x16_bf16 a[144:159], v[48:51], a[12:15], a[144:159]
  ds_read_b128 v[40:43], v16 offset:24576
  s_waitcnt lgkmcnt(5)
  v_mfma_f32_32x32x16_bf16 a[160:175], v[52:55], a[12:15], a[160:175]
  ds_read_b128 v[44:47], v16 offset:28672
  s_waitcnt lgkmcnt(5)
  v_mfma_f32_32x32x16_bf16 a[176:191], v[56:59], a[12:15], a[176:191]
  ds_read_b128 v[48:51], v17 offset:16384
  s_waitcnt lgkmcnt(5)
  v_mfma_f32_32x32x16_bf16 a[192:207], v[60:63], a[12:15], a[192:207]
  ds_read_b128 v[52:55], v17 offset:20480
  s_waitcnt lgkmcnt(5)
  v_mfma_f32_32x32x16_bf16 a[144:159], v[32:35], a[16:19], a[144:159]
  ds_read_b128 v[56:59], v17 offset:24576
  s_waitcnt lgkmcnt(5)
  v_mfma_f32_32x32x16_bf16 a[160:175], v[36:39], a[16:19], a[160:175]
  ds_read_b128 v[60:63], v17 offset:28672
  s_waitcnt lgkmcnt(5)
  v_mfma_f32_32x32x16_bf16 a[176:191], v[40:43], a[16:19], a[176:191]
  ds_read_b128 v[32:35], v18 offset:16384
  s_waitcnt lgkmcnt(5)
  v_mfma_f32_32x32x16_bf16 a[192:207], v[44:47], a[16:19], a[192:207]
  ds_read_b128 v[36:39], v18 offset:20480
  s_waitcnt lgkmcnt(5)
  v_mfma_f32_32x32x16_bf16 a[144:159], v[48:51], a[20:23], a[144:159]
  ds_read_b128 v[40:43], v18 offset:24576
  s_waitcnt lgkmcnt(5)
  v_mfma_f32_32x32x16_bf16 a[160:175], v[52:55], a[20:23], a[160:175]
  ds_read_b128 v[44:47], v18 offset:28672
  s_waitcnt lgkmcnt(5)
  v_mfma_f32_32x32x16_bf16 a[176:191], v[56:59], a[20:23], a[176:191]
  ds_read_b128 v[48:51], v19 offset:16384
  s_waitcnt lgkmcnt(5)
  v_mfma_f32_32x32x16_bf16 a[192:207], v[60:63], a[20:23], a[192:207]
  ds_read_b128 v[52:55], v19 offset:20480
  s_waitcnt vmcnt(24)
  s_barrier
  s_add_u32 m0, s22, 0
  s_add_u32 s39, s21, 0
  buffer_load_dwordx4 v14, s[16:19], s39 offen offset:0 lds
  s_add_u32 s39, s21, 8192
  buffer_load_dwordx4 v12, s[16:19], s39 offen offset:1024 lds
  s_add_u32 s39, s21, 16384
  buffer_load_dwordx4 v14, s[16:19], s39 offen offset:2048 lds
  s_add_u32 s39, s21, 24576
  buffer_load_dwordx4 v12, s[16:19], s39 offen offset:3072 lds
  s_add_u32 s21, s21, 128
  s_waitcnt lgkmcnt(5)
  v_mfma_f32_32x32x16_bf16 a[144:159], v[32:35], a[24:27], a[144:159]
  ds_read_b128 v[56:59], v19 offset:24576
  s_waitcnt lgkmcnt(5)
  v_mfma_f32_32x32x16_bf16 a[160:175], v[36:39], a[24:27], a[160:175]
  ds_read_b128 v[60:63], v19 offset:28672
  s_waitcnt lgkmcnt(5)
  v_mfma_f32_32x32x16_bf16 a[176:191], v[40:43], a[24:27], a[176:191]
  ds_read_b128 v[32:35], v16 offset:32768
  s_waitcnt lgkmcnt(5)
  v_mfma_f32_32x32x16_bf16 a[192:207], v[44:47], a[24:27], a[192:207]
  ds_read_b128 v[36:39], v16 offset:36864
  s_waitcnt lgkmcnt(5)
  v_mfma_f32_32x32x16_bf16 a[144:159], v[48:51], a[28:31], a[144:159]
  ds_read_b128 v[40:43], v16 offset:40960
  s_waitcnt lgkmcnt(5)
  v_mfma_f32_32x32x16_bf16 a[160:175], v[52:55], a[28:31], a[160:175]
  ds_read_b128 v[44:47], v16 offset:45056
  s_waitcnt lgkmcnt(5)
  v_mfma_f32_32x32x16_bf16 a[176:191], v[56:59], a[28:31], a[176:191]
  ds_read_b128 v[48:51], v17 offset:32768
  s_waitcnt lgkmcnt(5)
  v_mfma_f32_32x32x16_bf16 a[192:207], v[60:63], a[28:31], a[192:207]
  ds_read_b128 v[52:55], v17 offset:36864
  s_waitcnt lgkmcnt(5)
  v_mfma_f32_32x32x16_bf16 a[144:159], v[32:35], a[32:35], a[144:159]
  ds_read_b128 v[56:59], v17 offset:40960
  s_waitcnt lgkmcnt(5)
  v_mfma_f32_32x32x16_bf16 a[160:175], v[36:39], a[32:35], a[160:175]
  ds_read_b128 v[60:63], v17 offset:45056
  s_waitcnt lgkmcnt(5)
  v_mfma_f32_32x32x16_bf16 a[176:191], v[40:43], a[32:35], a[176:191]
  ds_read_b128 v[32:35], v18 offset:32768
  s_waitcnt lgkmcnt(5)
  v_mfma_f32_32x32x16_bf16 a[192:207], v[44:47], a[32:35], a[192:207]
  ds_read_b128 v[36:39], v18 offset:36864
  s_waitcnt lgkmcnt(5)
  v_mfma_f32_32x32x16_bf16 a[144:159], v[48:51], a[36:39], a[144:159]
  ds_read_b128 v[40:43], v18 offset:40960
  s_waitcnt lgkmcnt(5)
  v_mfma_f32_32x32x16_bf16 a[160:175], v[52:55], a[36:39], a[160:175]
  ds_read_b128 v[44:47], v18 offset:45056
  s_waitcnt lgkmcnt(5)
  v_mfma_f32_32x32x16_bf16 a[176:191], v[56:59], a[36:39], a[176:191]
  ds_read_b128 v[48:51], v19 offset:32768
  s_waitcnt lgkmcnt(5)
  v_mfma_f32_32x32x16_bf16 a[192:207], v[60:63], a[36:39], a[192:207]
  ds_read_b128 v[52:55], v19 offset:36864
  s_waitcnt vmcnt(8)
  s_barrier
  s_cmp_lg_u32 s13, 0
  s_cbranch_scc1 NF_10
  v_mov_b32 v8, 0
  v_mov_b32 v9, s23
  buffer_store_dword v9, v8, s[4:7], s25 offen sc1
NF_10:
  s_add_u32 m0, s22, 16384
  s_add_u32 s39, s21, 0
  buffer_load_dwordx4 v14, s[16:19], s39 offen offset:0 lds
  s_add_u32 s39, s21, 8192
  buffer_load_dwordx4 v12, s[16:19], s39 offen offset:1024 lds
  s_add_u32 s39, s21, 16384
  buffer_load_dwordx4 v14, s[16:19], s39 offen offset:2048 lds
  s_add_u32 s39, s21, 24576
  buffer_load_dwordx4 v12, s[16:19], s39 offen offset:3072 lds
  s_add_u32 s21, s21, 128
  s_waitcnt lgkmcnt(5)
  v_mfma_f32_32x32x16_bf16 a[144:159], v[32:35], a[40:43], a[144:159]
  ds_read_b128 v[56:59], v19 offset:40960
  s_waitcnt lgkmcnt(5)
  v_mfma_f32_32x32x16_bf16 a[160:175], v[36:39], a[40:43], a[160:175]
  ds_read_b128 v[60:63], v19 offset:45056
  s_waitcnt lgkmcnt(5)
  v_mfma_f32_32x32x16_bf16 a[176:191], v[40:43], a[40:43], a[176:191]
  ds_read_b128 v[32:35], v20 offset:0
  s_waitcnt lgkmcnt(5)
  v_mfma_f32_32x32x16_bf16 a[192:207], v[44:47], a[40:43], a[192:207]
  ds_read_b128 v[36:39], v20 offset:4096
  s_waitcnt lgkmcnt(5)
  v_mfma_f32_32x32x16_bf16 a[144:159], v[48:51], a[44:47], a[144:159]
  ds_read_b128 v[40:43], v20 offset:8192
  s_waitcnt lgkmcnt(5)
  v_mfma_f32_32x32x16_bf16 a[160:175], v[52:55], a[44:47], a[160:175]
  ds_read_b128 v[44:47], v20 offset:12288
  s_waitcnt lgkmcnt(5)
  v_mfma_f32_32x32x16_bf16 a[176:191], v[56:59], a[44:47], a[176:191]
  ds_read_b128 v[48:51], v21 offset:0
  s_waitcnt lgkmcnt(5)
  v_mfma_f32_32x32x16_bf16 a[192:207], v[60:63], a[44:47], a[192:207]
  ds_read_b128 v[52:55], v21 offset:4096
  s_waitcnt lgkmcnt(5)
  v_mfma_f32_32x32x16_bf16 a[144:159], v[32:35], a[48:51], a[144:159]
  ds_read_b128 v[56:59], v21 offset:8192
  s_waitcnt lgkmcnt(5)
  v_mfma_f32_32x32x16_bf16 a[160:175], v[36:39], a[48:51], a[160:175]
  ds_read_b128 v[60:63], v21 offset:12288
  s_waitcnt lgkmcnt(5)
  v_mfma_f32_32x32x16_bf16 a[176:191], v[40:43], a[48:51], a[176:191]
  ds_read_b128 v[32:35], v22 offset:0
  s_waitcnt lgkmcnt(5)
  v_mfma_f32_32x32x16_bf16 a[192:207], v[44:47], a[48:51], a[192:207]
  ds_read_b128 v[36:39], v22 offset:4096
  s_waitcnt lgkmcnt(5)
  v_mfma_f32_32x32x16_bf16 a[144:159], v[48:51], a[52:55], a[144:159]
  ds_read_b128 v[40:43], v22 offset:8192
  s_waitcnt lgkmcnt(5)
  v_mfma_f32_32x32x16_bf16 a[160:175], v[52:55], a[52:55], a[160:175]
  ds_read_b128 v[44:47], v22 offset:12288
  s_waitcnt lgkmcnt(5)
  v_mfma_f32_32x32x16_bf16 a[176:191], v[56:59], a[52:55], a[176:191]
  ds_read_b128 v[48:51], v23 offset:0
  s_waitcnt lgkmcnt(5)
  v_mfma_f32_32x32x16_bf16 a[192:207], v[60:63], a[52:55], a[192:207]
  ds_read_b128 v[52:55], v23 offset:4096
  s_waitcnt vmcnt(24)
  s_barrier
  s_add_u32 m0, s22, 32768
  s_add_u32 s39, s21, 0
  buffer_load_dwordx4 v14, s[16:19], s39 offen offset:0 lds
  s_add_u32 s39, s21, 8192
  buffer_load_dwordx4 v12, s[16:19], s39 offen offset:1024 lds
  s_add_u32 s39, s21, 16384
  buffer_load_dwordx4 v14, s[16:19], s39 offen offset:2048 lds
  s_add_u32 s39, s21, 24576
  buffer_load_dwordx4 v12, s[16:19], s39 offen offset:3072 lds
  s_add_u32 s21, s21, 128
  s_waitcnt lgkmcnt(5)
  v_mfma_f32_32x32x16_bf16 a[144:159], v[32:35], a[56:59], a[144:159]
  ds_read_b128 v[56:59], v23 offset:8192
  s_waitcnt lgkmcnt(5)
  v_mfma_f32_32x32x16_bf16 a[160:175], v[36:39], a[56:59], a[160:175]
  ds_read_b128 v[60:63], v23 offset:12288
  s_waitcnt lgkmcnt(5)
  v_mfma_f32_32x32x16_bf16 a[176:191], v[40:43], a[56:59], a[176:191]
  ds_read_b128 v[32:35], v20 offset:16384
  s_waitcnt lgkmcnt(5)
  v_mfma_f32_32x32x16_bf16 a[192:207], v[44:47], a[56:59], a[192:207]
  ds_read_b128 v[36:39], v20 offset:20480
  s_waitcnt lgkmcnt(5)
  v_mfma_f32_32x32x16_bf16 a[144:159], v[48:51], a[60:63], a[144:159]
  ds_read_b128 v[40:43], v20 offset:24576
  s_waitcnt lgkmcnt(5)
  v_mfma_f32_32x32x16_bf16 a[160:175], v[52:55], a[60:63], a[160:175]
  ds_read_b128 v[44:47], v20 offset:28672
  s_waitcnt lgkmcnt(5)
  v_mfma_f32_32x32x16_bf16 a[176:191], v[56:59], a[60:63], a[176:191]
  ds_read_b128 v[48:51], v21 offset:16384
  s_waitcnt lgkmcnt(5)
  v_mfma_f32_32x32x16_bf16 a[192:207], v[60:63], a[60:63], a[192:207]
  ds_read_b128 v[52:55], v21 offset:20480
  s_waitcnt lgkmcnt(5)
  v_mfma_f32_32x32x16_bf16 a[144:159], v[32:35], a[64:67], a[144:159]
  ds_read_b128 v[56:59], v21 offset:24576
  s_waitcnt lgkmcnt(5)
  v_mfma_f32_32x32x16_bf16 a[160:175], v[36:39], a[64:67], a[160:175]
  ds_read_b128 v[60:63], v21 offset:28672
  s_waitcnt lgkmcnt(5)
  v_mfma_f32_32x32x16_bf16 a[176:191], v[40:43], a[64:67], a[176:191]
  ds_read_b128 v[32:35], v22 offset:16384
  s_waitcnt lgkmcnt(5)
  v_mfma_f32_32x32x16_bf16 a[192:207], v[44:47], a[64:67], a[192:207]
  ds_read_b128 v[36:39], v22 offset:20480
  s_waitcnt lgkmcnt(5)
  v_mfma_f32_32x32x16_bf16 a[144:159], v[48:51], a[68:71], a[144:159]
  ds_read_b128 v[40:43], v22 offset:24576
  s_waitcnt lgkmcnt(5)
  v_mfma_f32_32x32x16_bf16 a[160:175], v[52:55], a[68:71], a[160:175]
  ds_read_b128 v[44:47], v22 offset:28672
  s_waitcnt lgkmcnt(5)
  v_mfma_f32_32x32x16_bf16 a[176:191], v[56:59], a[68:71], a[176:191]
  ds_read_b128 v[48:51], v23 offset:16384
  s_waitcnt lgkmcnt(5)
  v_mfma_f32_32x32x16_bf16 a[192:207], v[60:63], a[68:71], a[192:207]
  ds_read_b128 v[52:55], v23 offset:20480
  s_waitcnt vmcnt(24)
  s_barrier
  s_add_u32 m0, s22, 49152
  s_add_u32 s39, s21, 0
  buffer_load_dwordx4 v14, s[16:19], s39 offen offset:0 lds
  s_add_u32 s39, s21, 8192
  buffer_load_dwordx4 v12, s[16:19], s39 offen offset:1024 lds
  s_add_u32 s39, s21, 16384
  buffer_load_dwordx4 v14, s[16:19], s39 offen offset:2048 lds
  s_add_u32 s39, s21, 24576
  buffer_load_dwordx4 v12, s[16:19], s39 offen offset:3072 lds
  s_add_u32 s21, s21, 128
  s_waitcnt lgkmcnt(5)
  v_mfma_f32_32x32x16_bf16 a[144:159], v[32:35], a[72:75], a[144:159]
  ds_read_b128 v[56:59], v23 offset:24576
  s_waitcnt lgkmcnt(5)
  v_mfma_f32_32x32x16_bf16 a[160:175], v[36:39], a[72:75], a[160:175]
  ds_read_b128 v[60:63], v23 offset:28672
  s_waitcnt lgkmcnt(5)
  v_mfma_f32_32x32x16_bf16 a[176:191], v[40:43], a[72:75], a[176:191]
  ds_read_b128 v[32:35], v20 offset:32768
  s_waitcnt lgkmcnt(5)
  v_mfma_f32_32x32x16_bf16 a[192:207], v[44:47], a[72:75], a[192:207]
  ds_read_b128 v[36:39], v20 offset:36864
  s_waitcnt lgkmcnt(5)
  v_mfma_f32_32x32x16_bf16 a[144:159], v[48:51], a[76:79], a[144:159]
  ds_read_b128 v[40:43], v20 offset:40960
  s_waitcnt lgkmcnt(5)
  v_mfma_f32_32x32x16_bf16 a[160:175], v[52:55], a[76:79], a[160:175]
  ds_read_b128 v[44:47], v20 offset:45056
  s_waitcnt lgkmcnt(5)
  v_mfma_f32_32x32x16_bf16 a[176:191], v[56:59], a[76:79], a[176:191]
  ds_read_b128 v[48:51], v21 offset:32768
  s_waitcnt lgkmcnt(5)
  v_mfma_f32_32x32x16_bf16 a[192:207], v[60:63], a[76:79], a[192:207]
  ds_read_b128 v[52:55], v21 offset:36864
  s_waitcnt lgkmcnt(5)
  v_mfma_f32_32x32x16_bf16 a[144:159], v[32:35], a[80:83], a[144:159]
  ds_read_b128 v[56:59], v21 offset:40960
  s_waitcnt lgkmcnt(5)
  v_mfma_f32_32x32x16_bf16 a[160:175], v[36:39], a[80:83], a[160:175]
  ds_read_b128 v[60:63], v21 offset:45056
  s_waitcnt lgkmcnt(5)
  v_mfma_f32_32x32x16_bf16 a[176:191], v[40:43], a[80:83], a[176:191]
  ds_read_b128 v[32:35], v22 offset:32768
  s_waitcnt lgkmcnt(5)
  v_mfma_f32_32x32x16_bf16 a[192:207], v[44:47], a[80:83], a[192:207]
  ds_read_b128 v[36:39], v22 offset:36864
  s_waitcnt lgkmcnt(5)
  v_mfma_f32_32x32x16_bf16 a[144:159], v[48:51], a[84:87], a[144:159]
  ds_read_b128 v[40:43], v22 offset:40960
  s_waitcnt lgkmcnt(5)
  v_mfma_f32_32x32x16_bf16 a[160:175], v[52:55], a[84:87], a[160:175]
  ds_read_b128 v[44:47], v22 offset:45056
  s_waitcnt lgkmcnt(5)
  v_mfma_f32_32x32x16_bf16 a[176:191], v[56:59], a[84:87], a[176:191]
  ds_read_b128 v[48:51], v23 offset:32768
  s_waitcnt lgkmcnt(5)
  v_mfma_f32_32x32x16_bf16 a[192:207], v[60:63], a[84:87], a[192:207]
  ds_read_b128 v[52:55], v23 offset:36864
  s_waitcnt vmcnt(24)
  s_barrier
  s_add_u32 m0, s22, 65536
  s_add_u32 s39, s21, 0
  buffer_load_dwordx4 v14, s[16:19], s39 offen offset:0 lds
  s_add_u32 s39, s21, 8192
  buffer_load_dwordx4 v12, s[16:19], s39 offen offset:1024 lds
  s_add_u32 s39, s21, 16384
  buffer_load_dwordx4 v14, s[16:19], s39 offen offset:2048 lds
  s_add_u32 s39, s21, 24576
  buffer_load_dwordx4 v12, s[16:19], s39 offen offset:3072 lds
  s_add_u32 s21, s21, 128
  s_waitcnt lgkmcnt(5)
  v_mfma_f32_32x32x16_bf16 a[144:159], v[32:35], a[88:91], a[144:159]
  ds_read_b128 v[56:59], v23 offset:40960
  s_waitcnt lgkmcnt(5)
  v_mfma_f32_32x32x16_bf16 a[160:175], v[36:39], a[88:91], a[160:175]
  ds_read_b128 v[60:63], v23 offset:45056
  s_waitcnt lgkmcnt(5)
  v_mfma_f32_32x32x16_bf16 a[176:191], v[40:43], a[88:91], a[176:191]
  ds_read_b128 v[32:35], v24 offset:0
  s_waitcnt lgkmcnt(5)
  v_mfma_f32_32x32x16_bf16 a[192:207], v[44:47], a[88:91], a[192:207]
  ds_read_b128 v[36:39], v24 offset:4096
  s_waitcnt lgkmcnt(5)
  v_mfma_f32_32x32x16_bf16 a[144:159], v[48:51], a[92:95], a[144:159]
  ds_read_b128 v[40:43], v24 offset:8192
  s_waitcnt lgkmcnt(5)
  v_mfma_f32_32x32x16_bf16 a[160:175], v[52:55], a[92:95], a[160:175]
  ds_read_b128 v[44:47], v24 offset:12288
  s_waitcnt lgkmcnt(5)
  v_mfma_f32_32x32x16_bf16 a[176:191], v[56:59], a[92:95], a[176:191]
  ds_read_b128 v[48:51], v25 offset:0
  s_waitcnt lgkmcnt(5)
  v_mfma_f32_32x32x16_bf16 a[192:207], v[60:63], a[92:95], a[192:207]
  ds_read_b128 v[52:55], v25 offset:4096
  s_waitcnt lgkmcnt(5)
  v_mfma_f32_32x32x16_bf16 a[144:159], v[32:35], a[96:99], a[144:159]
  ds_read_b128 v[56:59], v25 offset:8192
  s_waitcnt lgkmcnt(5)
  v_mfma_f32_32x32x16_bf16 a[160:175], v[36:39], a[96:99], a[160:175]
  ds_read_b128 v[60:63], v25 offset:12288
  s_waitcnt lgkmcnt(5)
  v_mfma_f32_32x32x16_bf16 a[176:191], v[40:43], a[96:99], a[176:191]
  ds_read_b128 v[32:35], v26 offset:0
  s_waitcnt lgkmcnt(5)
  v_mfma_f32_32x32x16_bf16 a[192:207], v[44:47], a[96:99], a[192:207]
  ds_read_b128 v[36:39], v26 offset:4096
  s_waitcnt lgkmcnt(5)
  v_mfma_f32_32x32x16_bf16 a[144:159], v[48:51], a[100:103], a[144:159]
  ds_read_b128 v[40:43], v26 offset:8192
  s_waitcnt lgkmcnt(5)
  v_mfma_f32_32x32x16_bf16 a[160:175], v[52:55], a[100:103], a[160:175]
  ds_read_b128 v[44:47], v26 offset:12288
  s_waitcnt lgkmcnt(5)
  v_mfma_f32_32x32x16_bf16 a[176:191], v[56:59], a[100:103], a[176:191]
  ds_read_b128 v[48:51], v27 offset:0
  s_waitcnt lgkmcnt(5)
  v_mfma_f32_32x32x16_bf16 a[192:207], v[60:63], a[100:103], a[192:207]
  ds_read_b128 v[52:55], v27 offset:4096
  s_waitcnt vmcnt(24)
  s_barrier
  s_add_u32 m0, s22, 81920
  s_add_u32 s39, s21, 0
  buffer_load_dwordx4 v14, s[16:19], s39 offen offset:0 lds
  s_add_u32 s39, s21, 8192
  buffer_load_dwordx4 v12, s[16:19], s39 offen offset:1024 lds
  s_add_u32 s39, s21, 16384
  buffer_load_dwordx4 v14, s[16:19], s39 offen offset:2048 lds
  s_add_u32 s39, s21, 24576
  buffer_load_dwordx4 v12, s[16:19], s39 offen offset:3072 lds
  s_add_u32 s21, s21, 128
  s_waitcnt lgkmcnt(5)
  v_mfma_f32_32x32x16_bf16 a[144:159], v[32:35], a[104:107], a[144:159]
  ds_read_b128 v[56:59], v27 offset:8192
  s_waitcnt lgkmcnt(5)
  v_mfma_f32_32x32x16_bf16 a[160:175], v[36:39], a[104:107], a[160:175]
  ds_read_b128 v[60:63], v27 offset:12288
  s_waitcnt lgkmcnt(5)
  v_mfma_f32_32x32x16_bf16 a[176:191], v[40:43], a[104:107], a[176:191]
  ds_read_b128 v[32:35], v24 offset:16384
  s_waitcnt lgkmcnt(5)
  v_mfma_f32_32x32x16_bf16 a[192:207], v[44:47], a[104:107], a[192:207]
  ds_read_b128 v[36:39], v24 offset:20480
  s_waitcnt lgkmcnt(5)
  v_mfma_f32_32x32x16_bf16 a[144:159], v[48:51], a[108:111], a[144:159]
  ds_read_b128 v[40:43], v24 offset:24576
  s_waitcnt lgkmcnt(5)
  v_mfma_f32_32x32x16_bf16 a[160:175], v[52:55], a[108:111], a[160:175]
  ds_read_b128 v[44:47], v24 offset:28672
  s_waitcnt lgkmcnt(5)
  v_mfma_f32_32x32x16_bf16 a[176:191], v[56:59], a[108:111], a[176:191]
  ds_read_b128 v[48:51], v25 offset:16384
  s_waitcnt lgkmcnt(5)
  v_mfma_f32_32x32x16_bf16 a[192:207], v[60:63], a[108:111], a[192:207]
  ds_read_b128 v[52:55], v25 offset:20480
  s_waitcnt lgkmcnt(5)
  v_mfma_f32_32x32x16_bf16 a[144:159], v[32:35], a[112:115], a[144:159]
  ds_read_b128 v[56:59], v25 offset:24576
  s_waitcnt lgkmcnt(5)
  v_mfma_f32_32x32x16_bf16 a[160:175], v[36:39], a[112:115], a[160:175]
  ds_read_b128 v[60:63], v25 offset:28672
  s_waitcnt lgkmcnt(5)
  v_mfma_f32_32x32x16_bf16 a[176:191], v[40:43], a[112:115], a[176:191]
  ds_read_b128 v[32:35], v26 offset:16384
  s_waitcnt lgkmcnt(5)
  v_mfma_f32_32x32x16_bf16 a[192:207], v[44:47], a[112:115], a[192:207]
  ds_read_b128 v[36:39], v26 offset:20480
  s_waitcnt lgkmcnt(5)
  v_mfma_f32_32x32x16_bf16 a[144:159], v[48:51], a[116:119], a[144:159]
  ds_read_b128 v[40:43], v26 offset:24576
  s_waitcnt lgkmcnt(5)
  v_mfma_f32_32x32x16_bf16 a[160:175], v[52:55], a[116:119], a[160:175]
  ds_read_b128 v[44:47], v26 offset:28672
  s_waitcnt lgkmcnt(5)
  v_mfma_f32_32x32x16_bf16 a[176:191], v[56:59], a[116:119], a[176:191]
  ds_read_b128 v[48:51], v27 offset:16384
  s_waitcnt lgkmcnt(5)
  v_mfma_f32_32x32x16_bf16 a[192:207], v[60:63], a[116:119], a[192:207]
  ds_read_b128 v[52:55], v27 offset:20480
  s_waitcnt vmcnt(24)
  s_barrier
  s_add_u32 m0, s22, 98304
  s_add_u32 s39, s21, 0
  buffer_load_dwordx4 v14, s[16:19], s39 offen offset:0 lds
  s_add_u32 s39, s21, 8192
  buffer_load_dwordx4 v12, s[16:19], s39 offen offset:1024 lds
  s_add_u32 s39, s21, 16384
  buffer_load_dwordx4 v14, s[16:19], s39 offen offset:2048 lds
  s_add_u32 s39, s21, 24576
  buffer_load_dwordx4 v12, s[16:19], s39 offen offset:3072 lds
  s_add_u32 s21, s21, 128
  s_waitcnt lgkmcnt(5)
  v_mfma_f32_32x32x16_bf16 a[144:159], v[32:35], a[120:123], a[144:159]
  ds_read_b128 v[56:59], v27 offset:24576
  s_waitcnt lgkmcnt(5)
  v_mfma_f32_32x32x16_bf16 a[160:175], v[36:39], a[120:123], a[160:175]
  ds_read_b128 v[60:63], v27 offset:28672
  s_waitcnt lgkmcnt(5)
  v_mfma_f32_32x32x16_bf16 a[176:191], v[40:43], a[120:123], a[176:191]
  ds_read_b128 v[32:35], v24 offset:32768
  s_waitcnt lgkmcnt(5)
  v_mfma_f32_32x32x16_bf16 a[192:207], v[44:47], a[120:123], a[192:207]
  ds_read_b128 v[36:39], v24 offset:36864
  s_waitcnt lgkmcnt(5)
  v_mfma_f32_32x32x16_bf16 a[144:159], v[48:51], a[124:127], a[144:159]
  ds_read_b128 v[40:43], v24 offset:40960
  s_waitcnt lgkmcnt(5)
  v_mfma_f32_32x32x16_bf16 a[160:175], v[52:55], a[124:127], a[160:175]
  ds_read_b128 v[44:47], v24 offset:45056
  s_waitcnt lgkmcnt(5)
  v_mfma_f32_32x32x16_bf16 a[176:191], v[56:59], a[124:127], a[176:191]
  ds_read_b128 v[48:51], v25 offset:32768
  s_waitcnt lgkmcnt(5)
  v_mfma_f32_32x32x16_bf16 a[192:207], v[60:63], a[124:127], a[192:207]
  ds_read_b128 v[52:55], v25 offset:36864
  s_waitcnt lgkmcnt(5)
  v_mfma_f32_32x32x16_bf16 a[144:159], v[32:35], a[128:131], a[144:159]
  ds_read_b128 v[56:59], v25 offset:40960
  s_waitcnt lgkmcnt(5)
  v_mfma_f32_32x32x16_bf16 a[160:175], v[36:39], a[128:131], a[160:175]
  ds_read_b128 v[60:63], v25 offset:45056
  s_waitcnt lgkmcnt(5)
  v_mfma_f32_32x32x16_bf16 a[176:191], v[40:43], a[128:131], a[176:191]
  ds_read_b128 v[32:35], v26 offset:32768
  s_waitcnt lgkmcnt(5)
  v_mfma_f32_32x32x16_bf16 a[192:207], v[44:47], a[128:131], a[192:207]
  ds_read_b128 v[36:39], v26 offset:36864
  s_waitcnt lgkmcnt(5)
  v_mfma_f32_32x32x16_bf16 a[144:159], v[48:51], a[132:135], a[144:159]
  ds_read_b128 v[40:43], v26 offset:40960
  s_waitcnt lgkmcnt(5)
  v_mfma_f32_32x32x16_bf16 a[160:175], v[52:55], a[132:135], a[160:175]
  ds_read_b128 v[44:47], v26 offset:45056
  s_waitcnt lgkmcnt(5)
  v_mfma_f32_32x32x16_bf16 a[176:191], v[56:59], a[132:135], a[176:191]
  ds_read_b128 v[48:51], v27 offset:32768
  s_waitcnt lgkmcnt(5)
  v_mfma_f32_32x32x16_bf16 a[192:207], v[60:63], a[132:135], a[192:207]
  ds_read_b128 v[52:55], v27 offset:36864
  s_waitcnt vmcnt(24)
  s_barrier
  s_add_u32 m0, s22, 114688
  s_add_u32 s39, s21, 0
  buffer_load_dwordx4 v14, s[16:19], s39 offen offset:0 lds
  s_add_u32 s39, s21, 8192
  buffer_load_dwordx4 v12, s[16:19], s39 offen offset:1024 lds
  s_add_u32 s39, s21, 16384
  buffer_load_dwordx4 v14, s[16:19], s39 offen offset:2048 lds
  s_add_u32 s39, s21, 24576
  buffer_load_dwordx4 v12, s[16:19], s39 offen offset:3072 lds
  s_add_u32 s21, s21, 128
  s_waitcnt lgkmcnt(5)
  v_mfma_f32_32x32x16_bf16 a[144:159], v[32:35], a[136:139], a[144:159]
  ds_read_b128 v[56:59], v27 offset:40960
  s_waitcnt lgkmcnt(5)
  v_mfma_f32_32x32x16_bf16 a[160:175], v[36:39], a[136:139], a[160:175]
  ds_read_b128 v[60:63], v27 offset:45056
  s_waitcnt lgkmcnt(5)
  v_mfma_f32_32x32x16_bf16 a[176:191], v[40:43], a[136:139], a[176:191]
  ds_read_b128 v[32:35], v16 offset:0
  s_waitcnt lgkmcnt(5)
  v_mfma_f32_32x32x16_bf16 a[192:207], v[44:47], a[136:139], a[192:207]
  ds_read_b128 v[36:39], v16 offset:4096
  s_waitcnt lgkmcnt(5)
  v_mfma_f32_32x32x16_bf16 a[144:159], v[48:51], a[140:143], a[144:159]
  ds_read_b128 v[40:43], v16 offset:8192
  s_waitcnt lgkmcnt(5)
  v_mfma_f32_32x32x16_bf16 a[160:175], v[52:55], a[140:143], a[160:175]
  ds_read_b128 v[44:47], v16 offset:12288
  s_waitcnt lgkmcnt(5)
  v_mfma_f32_32x32x16_bf16 a[176:191], v[56:59], a[140:143], a[176:191]
  ds_read_b128 v[48:51], v17 offset:0
  s_waitcnt lgkmcnt(5)
  v_mfma_f32_32x32x16_bf16 a[192:207], v[60:63], a[140:143], a[192:207]
  ds_read_b128 v[52:55], v17 offset:4096
  s_nop 1
  v_accvgpr_read_b32 v128, a144
  v_accvgpr_read_b32 v129, a145
  v_accvgpr_read_b32 v130, a146
  v_accvgpr_read_b32 v131, a147
  v_accvgpr_read_b32 v132, a148
  v_accvgpr_read_b32 v133, a149
  v_accvgpr_read_b32 v134, a150
  v_accvgpr_read_b32 v135, a151
  v_accvgpr_read_b32 v136, a152
  v_accvgpr_read_b32 v137, a153
  v_accvgpr_read_b32 v138, a154
  v_accvgpr_read_b32 v139, a155
  v_accvgpr_read_b32 v140, a156
  v_accvgpr_read_b32 v141, a157
  v_accvgpr_read_b32 v142, a158
  v_accvgpr_read_b32 v143, a159
  v_cvt_pk_bf16_f32 v96, v128, v129
  v_cvt_pk_bf16_f32 v97, v130, v131
  v_cvt_pk_bf16_f32 v98, v136, v137
  v_cvt_pk_bf16_f32 v99, v138, v139
  buffer_store_dwordx4 v[96:99], v2, s[4:7], s24 offen offset:0 sc1
  v_cvt_pk_bf16_f32 v100, v132, v133
  v_cvt_pk_bf16_f32 v101, v134, v135
  v_cvt_pk_bf16_f32 v102, v140, v141
  v_cvt_pk_bf16_f32 v103, v142, v143
  buffer_store_dwordx4 v[100:103], v2, s[4:7], s24 offen offset:1024 sc1
  s_add_u32 s24, s24, 524288
  v_accvgpr_read_b32 v128, a160
  v_accvgpr_read_b32 v129, a161
  v_accvgpr_read_b32 v130, a162
  v_accvgpr_read_b32 v131, a163
  v_accvgpr_read_b32 v132, a164
  v_accvgpr_read_b32 v133, a165
  v_accvgpr_read_b32 v134, a166
  v_accvgpr_read_b32 v135, a167
  v_accvgpr_read_b32 v136, a168
  v_accvgpr_read_b32 v137, a169
  v_accvgpr_read_b32 v138, a170
  v_accvgpr_read_b32 v139, a171
  v_accvgpr_read_b32 v140, a172
  v_accvgpr_read_b32 v141, a173
  v_accvgpr_read_b32 v142, a174
  v_accvgpr_read_b32 v143, a175
  v_cvt_pk_bf16_f32 v104, v128, v129
  v_cvt_pk_bf16_f32 v105, v130, v131
  v_cvt_pk_bf16_f32 v106, v136, v137
  v_cvt_pk_bf16_f32 v107, v138, v139
  buffer_store_dwordx4 v[104:107], v2, s[4:7], s24 offen offset:0 sc1
  v_cvt_pk_bf16_f32 v108, v132, v133
  v_cvt_pk_bf16_f32 v109, v134, v135
  v_cvt_pk_bf16_f32 v110, v140, v141
  v_cvt_pk_bf16_f32 v111, v142, v143
  buffer_store_dwordx4 v[108:111], v2, s[4:7], s24 offen offset:1024 sc1
  s_add_u32 s24, s24, 524288
  v_accvgpr_read_b32 v128, a176
  v_accvgpr_read_b32 v129, a177
  v_accvgpr_read_b32 v130, a178
  v_accvgpr_read_b32 v131, a179
  v_accvgpr_read_b32 v132, a180
  v_accvgpr_read_b32 v133, a181
  v_accvgpr_read_b32 v134, a182
  v_accvgpr_read_b32 v135, a183
  v_accvgpr_read_b32 v136, a184
  v_accvgpr_read_b32 v137, a185
  v_accvgpr_read_b32 v138, a186
  v_accvgpr_read_b32 v139, a187
  v_accvgpr_read_b32 v140, a188
  v_accvgpr_read_b32 v141, a189
  v_accvgpr_read_b32 v142, a190
  v_accvgpr_read_b32 v143, a191
  v_cvt_pk_bf16_f32 v112, v128, v129
  v_cvt_pk_bf16_f32 v113, v130, v131
  v_cvt_pk_bf16_f32 v114, v136, v137
  v_cvt_pk_bf16_f32 v115, v138, v139
  buffer_store_dwordx4 v[112:115], v2, s[4:7], s24 offen offset:0 sc1
  v_cvt_pk_bf16_f32 v116, v132, v133
  v_cvt_pk_bf16_f32 v117, v134, v135
  v_cvt_pk_bf16_f32 v118, v140, v141
  v_cvt_pk_bf16_f32 v119, v142, v143
  buffer_store_dwordx4 v[116:119], v2, s[4:7], s24 offen offset:1024 sc1
  s_add_u32 s24, s24, 524288
  v_accvgpr_read_b32 v128, a192
  v_accvgpr_read_b32 v129, a193
  v_accvgpr_read_b32 v130, a194
  v_accvgpr_read_b32 v131, a195
  v_accvgpr_read_b32 v132, a196
  v_accvgpr_read_b32 v133, a197
  v_accvgpr_read_b32 v134, a198
  v_accvgpr_read_b32 v135, a199
  v_accvgpr_read_b32 v136, a200
  v_accvgpr_read_b32 v137, a201
  v_accvgpr_read_b32 v138, a202
  v_accvgpr_read_b32 v139, a203
  v_accvgpr_read_b32 v140, a204
  v_accvgpr_read_b32 v141, a205
  v_accvgpr_read_b32 v142, a206
  v_accvgpr_read_b32 v143, a207
  v_cvt_pk_bf16_f32 v120, v128, v129
  v_cvt_pk_bf16_f32 v121, v130, v131
  v_cvt_pk_bf16_f32 v122, v136, v137
  v_cvt_pk_bf16_f32 v123, v138, v139
  buffer_store_dwordx4 v[120:123], v2, s[4:7], s24 offen offset:0 sc1
  v_cvt_pk_bf16_f32 v124, v132, v133
  v_cvt_pk_bf16_f32 v125, v134, v135
  v_cvt_pk_bf16_f32 v126, v140, v141
  v_cvt_pk_bf16_f32 v127, v142, v143
  buffer_store_dwordx4 v[124:127], v2, s[4:7], s24 offen offset:1024 sc1
  s_add_u32 s24, s24, 524288
  s_add_u32 s23, s23, 1
  s_cmp_lt_u32 s23, 16
  s_cbranch_scc1 RND_9
  s_waitcnt vmcnt(0) lgkmcnt(0)
  s_barrier
  s_cmp_lg_u32 s13, 0
  s_cbranch_scc1 NF_11
  v_mov_b32 v8, 0
  v_mov_b32 v9, 16
  buffer_store_dword v9, v8, s[4:7], s25 offen sc1
NF_11:
  s_add_u32 s12, s12, 68
  s_cmp_lt_u32 s12, 72
  s_cbranch_scc1 L_op
  s_branch L_end
L_blk_Q:
  s_load_dwordx2 s[4:5], s[0:1], 112
  s_load_dwordx2 s[8:9], s[0:1], 56
  s_load_dwordx2 s[16:17], s[0:1], 40
  s_load_dwordx2 s[66:67], s[0:1], 104
  v_and_b32 v1, 63, v0
  v_lshlrev_b32 v2, 4, v1
  v_and_b32 v3, 31, v1
  s_waitcnt vmcnt(0)
  v_lshrrev_b32 v4, 5, v1
  v_bfe_u32 v5, v1, 4, 1
  v_bfe_u32 v6, v1, 2, 2
  v_and_b32 v7, 3, v1
  v_lshrrev_b32 v8, 4, v1
  v_and_b32 v9, 15, v1
  v_lshlrev_b32 v15, 2, v8
  v_xor_b32 v9, v9, v15
  v_lshlrev_b32 v9, 4, v9
  v_lshl_add_u32 v9, v8, 13, v9
  s_lshl_b32 s36, s12, 8
  v_add_u32 v9, s36, v9
  v_lshl_add_u32 v8, v4, 5, v6
  v_lshlrev_b32 v8, 8, v8
  v_lshl_add_u32 v8, v5, 5, v8
  v_lshl_add_u32 v8, v7, 3, v8
  v_xor_b32 v15, s13, v6
  v_lshl_add_u32 v10, v15, 6, v8
  v_lshrrev_b32 v15, 3, v1
  v_mul_u32_u24 v14, 1152, v15
  v_lshrrev_b32 v15, 4, v1
  v_and_b32 v12, 7, v1
  v_xor_b32 v15, v15, v12
  v_xor_b32 v12, 4, v15
  v_lshl_add_u32 v12, v12, 4, v14
  v_lshl_add_u32 v14, v15, 4, v14
  s_lshl_b32 s22, s13, 12
  v_bfe_u32 v15, v3, 1, 3
  v_lshlrev_b32 v16, 2, v4
  v_xor_b32 v15, v15, v16
  v_lshlrev_b32 v19, 7, v3
  v_lshl_add_u32 v16, v15, 4, v19
  v_xor_b32 v17, 16, v16
  v_xor_b32 v18, 32, v16
  v_xor_b32 v19, 48, v16
  s_waitcnt lgkmcnt(0)
  s_mov_b32 s6, 268435456
  s_mov_b32 s7, 0x20000
  s_mov_b32 s10, 4718592
  s_mov_b32 s11, 0x20000
  s_mov_b32 s18, 2359296
  s_mov_b32 s19, 0x20000
  s_mul_i32 s36, s13, 36864
  s_mul_i32 s37, s13, 1179648
  s_mov_b32 s38, 0
  v_add_u32 v20, 49152, v16
  v_add_u32 v21, 49152, v17
  v_add_u32 v22, 49152, v18
  v_add_u32 v23, 49152, v19
  v_add_u32 v24, 98304, v16
  v_add_u32 v25, 98304, v17
  v_add_u32 v26, 98304, v18
  v_add_u32 v27, 98304, v19
WD_12:
  s_mov_b32 m0, s36
  s_add_u32 s36, s36, 1024
  buffer_load_dwordx4 v9, s[8:11], s37 offen lds
  s_add_u32 s37, s37, 32768
  s_add_u32 s38, s38, 1
  s_cmp_lt_u32 s38, 36
  s_cbranch_scc1 WD_12
  s_lshl_b32 s39, s12, 2
  s_add_u32 s39, s39, s13
  s_mul_i32 s39, s39, 18432
  v_lshlrev_b32 v15, 7, v1
  buffer_load_dword v100, v15, s[16:19], s39 offen
  s_add_u32 s39, s39, 8192
  buffer_load_dword v101, v15, s[16:19], s39 offen
  s_add_u32 s39, s39, 2048
  buffer_load_dword v102, v15, s[16:19], s39 offen
  s_add_u32 s39, s39, 2048
  s_mul_i32 s21, s13, 36864
  s_mov_b32 s23, 0
  s_lshl_b32 s25, s12, 9
  s_add_u32 s25, s25, 917504
  s_lshl_b32 s24, s12, 13
  s_add_u32 s24, s24, 83886080
  s_lshl_b32 s36, s13, 11
  s_add_u32 s24, s24, s36
  s_waitcnt vmcnt(3)
  s_barrier
  ds_read_b64_tr_b16 a[0:1], v10 offset:0
  ds_read_b64_tr_b16 a[2:3], v10 offset:1024
  ds_read_b64_tr_b16 a[4:5], v10 offset:2048
  ds_read_b64_tr_b16 a[6:7], v10 offset:3072
  ds_read_b64_tr_b16 a[8:9], v10 offset:4096
  ds_read_b64_tr_b16 a[10:11], v10 offset:5120
  ds_read_b64_tr_b16 a[12:13], v10 offset:6144
  ds_read_b64_tr_b16 a[14:15], v10 offset:7168
  ds_read_b64_tr_b16 a[16:17], v10 offset:16384
  ds_read_b64_tr_b16 a[18:19], v10 offset:17408
  ds_read_b64_tr_b16 a[20:21], v10 offset:18432
  ds_read_b64_tr_b16 a[22:23], v10 offset:19456
  ds_read_b64_tr_b16 a[24:25], v10 offset:20480
  ds_read_b64_tr_b16 a[26:27], v10 offset:21504
  ds_read_b64_tr_b16 a[28:29], v10 offset:22528
  ds_read_b64_tr_b16 a[30:31], v10 offset:23552
  ds_read_b64_tr_b16 a[32:33], v10 offset:32768
  ds_read_b64_tr_b16 a[34:35], v10 offset:33792
  ds_read_b64_tr_b16 a[36:37], v10 offset:34816
  ds_read_b64_tr_b16 a[38:39], v10 offset:35840
  ds_read_b64_tr_b16 a[40:41], v10 offset:36864
  ds_read_b64_tr_b16 a[42:43], v10 offset:37888
  ds_read_b64_tr_b16 a[44:45], v10 offset:38912
  ds_read_b64_tr_b16 a[46:47], v10 offset:39936
  v_add_u32 v10, 49152, v10
  ds_read_b64_tr_b16 a[48:49], v10 offset:0
  ds_read_b64_tr_b16 a[50:51], v10 offset:1024
  ds_read_b64_tr_b16 a[52:53], v10 offset:2048
  ds_read_b64_tr_b16 a[54:55], v10 offset:3072
  ds_read_b64_tr_b16 a[56:57], v10 offset:4096
  ds_read_b64_tr_b16 a[58:59], v10 offset:5120
  ds_read_b64_tr_b16 a[60:61], v10 offset:6144
  ds_read_b64_tr_b16 a[62:63], v10 offset:7168
  ds_read_b64_tr_b16 a[64:65], v10 offset:16384
  ds_read_b64_tr_b16 a[66:67], v10 offset:17408
  ds_read_b64_tr_b16 a[68:69], v10 offset:18432
  ds_read_b64_tr_b16 a[70:71], v10 offset:19456
  ds_read_b64_tr_b16 a[72:73], v10 offset:20480
  ds_read_b64_tr_b16 a[74:75], v10 offset:21504
  ds_read_b64_tr_b16 a[76:77], v10 offset:22528
  ds_read_b64_tr_b16 a[78:79], v10 offset:23552
  ds_read_b64_tr_b16 a[80:81], v10 offset:32768
  ds_read_b64_tr_b16 a[82:83], v10 offset:33792
  ds_read_b64_tr_b16 a[84:85], v10 offset:34816
  ds_read_b64_tr_b16 a[86:87], v10 offset:35840
  ds_read_b64_tr_b16 a[88:89], v10 offset:36864
  ds_read_b64_tr_b16 a[90:91], v10 offset:37888
  ds_read_b64_tr_b16 a[92:93], v10 offset:38912
  ds_read_b64_tr_b16 a[94:95], v10 offset:39936
  v_add_u32 v10, 49152, v10
  ds_read_b64_tr_b16 a[96:97], v10 offset:0
  ds_read_b64_tr_b16 a[98:99], v10 offset:1024
  ds_read_b64_tr_b16 a[100:101], v10 offset:2048
  ds_read_b64_tr_b16 a[102:103], v10 offset:3072
  ds_read_b64_tr_b16 a[104:105], v10 offset:4096
  ds_read_b64_tr_b16 a[106:107], v10 offset:5120
  ds_read_b64_tr_b16 a[108:109], v10 offset:6144
  ds_read_b64_tr_b16 a[110:111], v10 offset:7168
  ds_read_b64_tr_b16 a[112:113], v10 offset:16384
  ds_read_b64_tr_b16 a[114:115], v10 offset:17408
  ds_read_b64_tr_b16 a[116:117], v10 offset:18432
  ds_read_b64_tr_b16 a[118:119], v10 offset:19456
  ds_read_b64_tr_b16 a[120:121], v10 offset:20480
  ds_read_b64_tr_b16 a[122:123], v10 offset:21504
  ds_read_b64_tr_b16 a[124:125], v10 offset:22528
  ds_read_b64_tr_b16 a[126:127], v10 offset:23552
  ds_read_b64_tr_b16 a[128:129], v10 offset:32768
  ds_read_b64_tr_b16 a[130:131], v10 offset:33792
  ds_read_b64_tr_b16 a[132:133], v10 offset:34816
  ds_read_b64_tr_b16 a[134:135], v10 offset:35840
  ds_read_b64_tr_b16 a[136:137], v10 offset:36864
  ds_read_b64_tr_b16 a[138:139], v10 offset:37888
  ds_read_b64_tr_b16 a[140:141], v10 offset:38912
  ds_read_b64_tr_b16 a[142:143], v10 offset:39936
  s_waitcnt lgkmcnt(0)
  s_barrier
  s_add_u32 m0, s22, 0
  s_add_u32 s39, s21, 0
  buffer_load_dwordx4 v14, s[16:19], s39 offen offset:0 lds
  s_add_u32 s39, s21, 8192
  buffer_load_dwordx4 v12, s[16:19], s39 offen offset:1024 lds
  s_add_u32 s39, s21, 16384
  buffer_load_dwordx4 v14, s[16:19], s39 offen offset:2048 lds
  s_add_u32 s39, s21, 24576
  buffer_load_dwordx4 v12, s[16:19], s39 offen offset:3072 lds
  s_add_u32 s21, s21, 128
  s_add_u32 m0, s22, 16384
  s_add_u32 s39, s21, 0
  buffer_load_dwordx4 v14, s[16:19], s39 offen offset:0 lds
  s_add_u32 s39, s21, 8192
  buffer_load_dwordx4 v12, s[16:19], s39 offen offset:1024 lds
  s_add_u32 s39, s21, 16384
  buffer_load_dwordx4 v14, s[16:19], s39 offen offset:2048 lds
  s_add_u32 s39, s21, 24576
  buffer_load_dwordx4 v12, s[16:19], s39 offen offset:3072 lds
  s_add_u32 s21, s21, 128
  s_add_u32 m0, s22, 32768
  s_add_u32 s39, s21, 0
  buffer_load_dwordx4 v14, s[16:19], s39 offen offset:0 lds
  s_add_u32 s39, s21, 8192
  buffer_load_dwordx4 v12, s[16:19], s39 offen offset:1024 lds
  s_add_u32 s39, s21, 16384
  buffer_load_dwordx4 v14, s[16:19], s39 offen offset:2048 lds
  s_add_u32 s39, s21, 24576
  buffer_load_dwordx4 v12, s[16:19], s39 offen offset:3072 lds
  s_add_u32 s21, s21, 128
  s_add_u32 m0, s22, 49152
  s_add_u32 s39, s21, 0
  buffer_load_dwordx4 v14, s[16:19], s39 offen offset:0 lds
  s_add_u32 s39, s21, 8192
  buffer_load_dwordx4 v12, s[16:19], s39 offen offset:1024 lds
  s_add_u32 s39, s21, 16384
  buffer_load_dwordx4 v14, s[16:19], s39 offen offset:2048 lds
  s_add_u32 s39, s21, 24576
  buffer_load_dwordx4 v12, s[16:19], s39 offen offset:3072 lds
  s_add_u32 s21, s21, 128
  s_add_u32 m0, s22, 65536
  s_add_u32 s39, s21, 0
  buffer_load_dwordx4 v14, s[16:19], s39 offen offset:0 lds
  s_add_u32 s39, s21, 8192
  buffer_load_dwordx4 v12, s[16:19], s39 offen offset:1024 lds
  s_add_u32 s39, s21, 16384
  buffer_load_dwordx4 v14, s[16:19], s39 offen offset:2048 lds
  s_add_u32 s39, s21, 24576
  buffer_load_dwordx4 v12, s[16:19], s39 offen offset:3072 lds
  s_add_u32 s21, s21, 128
  s_add_u32 m0, s22, 81920
  s_add_u32 s39, s21, 0
  buffer_load_dwordx4 v14, s[16:19], s39 offen offset:0 lds
  s_add_u32 s39, s21, 8192
  buffer_load_dwordx4 v12, s[16:19], s39 offen offset:1024 lds
  s_add_u32 s39, s21, 16384
  buffer_load_dwordx4 v14, s[16:19], s39 offen offset:2048 lds
  s_add_u32 s39, s21, 24576
  buffer_load_dwordx4 v12, s[16:19], s39 offen offset:3072 lds
  s_add_u32 s21, s21, 128
  s_add_u32 m0, s22, 98304
  s_add_u32 s39, s21, 0
  buffer_load_dwordx4 v14, s[16:19], s39 offen offset:0 lds
  s_add_u32 s39, s21, 8192
  buffer_load_dwordx4 v12, s[16:19], s39 offen offset:1024 lds
  s_add_u32 s39, s21, 16384
  buffer_load_dwordx4 v14, s[16:19], s39 offen offset:2048 lds
  s_add_u32 s39, s21, 24576
  buffer_load_dwordx4 v12, s[16:19], s39 offen offset:3072 lds
  s_add_u32 s21, s21, 128
  s_add_u32 m0, s22, 114688
  s_add_u32 s39, s21, 0
  buffer_load_dwordx4 v14, s[16:19], s39 offen offset:0 lds
  s_add_u32 s39, s21, 8192
  buffer_load_dwordx4 v12, s[16:19], s39 offen offset:1024 lds
  s_add_u32 s39, s21, 16384
  buffer_load_dwordx4 v14, s[16:19], s39 offen offset:2048 lds
  s_add_u32 s39, s21, 24576
  buffer_load_dwordx4 v12, s[16:19], s39 offen offset:3072 lds
  s_add_u32 s21, s21, 128
  s_waitcnt vmcnt(28)
  s_barrier
  ds_read_b128 v[32:35], v16 offset:0
  ds_read_b128 v[36:39], v16 offset:4096
  ds_read_b128 v[40:43], v16 offset:8192
  ds_read_b128 v[44:47], v16 offset:12288
  ds_read_b128 v[48:51], v17 offset:0
  ds_read_b128 v[52:55], v17 offset:4096
RND_13:
  s_waitcnt lgkmcnt(5)
  v_mfma_f32_32x32x16_bf16 a[144:159], a[0:3], v[32:35], 0
  ds_read_b128 v[56:59], v17 offset:8192
  s_waitcnt lgkmcnt(5)
  v_mfma_f32_32x32x16_bf16 a[160:175], a[0:3], v[36:39], 0
  ds_read_b128 v[60:63], v17 offset:12288
  s_waitcnt lgkmcnt(5)
  v_mfma_f32_32x32x16_bf16 a[176:191], a[0:3], v[40:43], 0
  ds_read_b128 v[32:35], v18 offset:0
  s_waitcnt lgkmcnt(5)
  v_mfma_f32_32x32x16_bf16 a[192:207], a[0:3], v[44:47], 0
  ds_read_b128 v[36:39], v18 offset:4096
  s_waitcnt lgkmcnt(5)
  v_mfma_f32_32x32x16_bf16 a[144:159], a[4:7], v[48:51], a[144:159]
  ds_read_b128 v[40:43], v18 offset:8192
  s_waitcnt lgkmcnt(5)
  v_mfma_f32_32x32x16_bf16 a[160:175], a[4:7], v[52:55], a[160:175]
  ds_read_b128 v[44:47], v18 offset:12288
  s_waitcnt lgkmcnt(5)
  v_mfma_f32_32x32x16_bf16 a[176:191], a[4:7], v[56:59], a[176:191]
  ds_read_b128 v[48:51], v19 offset:0
  s_waitcnt lgkmcnt(5)
  v_mfma_f32_32x32x16_bf16 a[192:207], a[4:7], v[60:63], a[192:207]
  ds_read_b128 v[52:55], v19 offset:4096
  s_waitcnt vmcnt(24)
  s_barrier
  s_add_u32 m0, s22, 131072
  s_add_u32 s39, s21, 0
  buffer_load_dwordx4 v14, s[16:19], s39 offen offset:0 lds
  s_add_u32 s39, s21, 8192
  buffer_load_dwordx4 v12, s[16:19], s39 offen offset:1024 lds
  s_add_u32 s39, s21, 16384
  buffer_load_dwordx4 v14, s[16:19], s39 offen offset:2048 lds
  s_add_u32 s39, s21, 24576
  buffer_load_dwordx4 v12, s[16:19], s39 offen offset:3072 lds
  s_add_u32 s21, s21, 146432
  s_waitcnt lgkmcnt(5)
  v_mfma_f32_32x32x16_bf16 a[144:159], a[8:11], v[32:35], a[144:159]
  ds_read_b128 v[56:59], v19 offset:8192
  s_waitcnt lgkmcnt(5)
  v_mfma_f32_32x32x16_bf16 a[160:175], a[8:11], v[36:39], a[160:175]
  ds_read_b128 v[60:63], v19 offset:12288
  s_waitcnt lgkmcnt(5)
  v_mfma_f32_32x32x16_bf16 a[176:191], a[8:11], v[40:43], a[176:191]
  ds_read_b128 v[32:35], v16 offset:16384
  s_waitcnt lgkmcnt(5)
  v_mfma_f32_32x32x16_bf16 a[192:207], a[8:11], v[44:47], a[192:207]
  ds_read_b128 v[36:39], v16 offset:20480
  s_waitcnt lgkmcnt(5)
  v_mfma_f32_32x32x16_bf16 a[144:159], a[12:15], v[48:51], a[144:159]
  ds_read_b128 v[40:43], v16 offset:24576
  s_waitcnt lgkmcnt(5)
  v_mfma_f32_32x32x16_bf16 a[160:175], a[12:15], v[52:55], a[160:175]
  ds_read_b128 v[44:47], v16 offset:28672
  s_waitcnt lgkmcnt(5)
  v_mfma_f32_32x32x16_bf16 a[176:191], a[12:15], v[56:59], a[176:191]
  ds_read_b128 v[48:51], v17 offset:16384
  s_waitcnt lgkmcnt(5)
  v_mfma_f32_32x32x16_bf16 a[192:207], a[12:15], v[60:63], a[192:207]
  ds_read_b128 v[52:55], v17 offset:20480
  s_waitcnt lgkmcnt(5)
  v_mfma_f32_32x32x16_bf16 a[144:159], a[16:19], v[32:35], a[144:159]
  ds_read_b128 v[56:59], v17 offset:24576
  s_waitcnt lgkmcnt(5)
  v_mfma_f32_32x32x16_bf16 a[160:175], a[16:19], v[36:39], a[160:175]
  ds_read_b128 v[60:63], v17 offset:28672
  s_waitcnt lgkmcnt(5)
  v_mfma_f32_32x32x16_bf16 a[176:191], a[16:19], v[40:43], a[176:191]
  ds_read_b128 v[32:35], v18 offset:16384
  s_waitcnt lgkmcnt(5)
  v_mfma_f32_32x32x16_bf16 a[192:207], a[16:19], v[44:47], a[192:207]
  ds_read_b128 v[36:39], v18 offset:20480
  s_waitcnt lgkmcnt(5)
  v_mfma_f32_32x32x16_bf16 a[144:159], a[20:23], v[48:51], a[144:159]
  ds_read_b128 v[40:43], v18 offset:24576
  s_waitcnt lgkmcnt(5)
  v_mfma_f32_32x32x16_bf16 a[160:175], a[20:23], v[52:55], a[160:175]
  ds_read_b128 v[44:47], v18 offset:28672
  s_waitcnt lgkmcnt(5)
  v_mfma_f32_32x32x16_bf16 a[176:191], a[20:23], v[56:59], a[176:191]
  ds_read_b128 v[48:51], v19 offset:16384
  s_waitcnt lgkmcnt(5)
  v_mfma_f32_32x32x16_bf16 a[192:207], a[20:23], v[60:63], a[192:207]
  ds_read_b128 v[52:55], v19 offset:20480
  s_waitcnt vmcnt(24)
  s_barrier
  s_add_u32 m0, s22, 0
  s_add_u32 s39, s21, 0
  buffer_load_dwordx4 v14, s[16:19], s39 offen offset:0 lds
  s_add_u32 s39, s21, 8192
  buffer_load_dwordx4 v12, s[16:19], s39 offen offset:1024 lds
  s_add_u32 s39, s21, 16384
  buffer_load_dwordx4 v14, s[16:19], s39 offen offset:2048 lds
  s_add_u32 s39, s21, 24576
  buffer_load_dwordx4 v12, s[16:19], s39 offen offset:3072 lds
  s_add_u32 s21, s21, 128
  s_waitcnt lgkmcnt(5)
  v_mfma_f32_32x32x16_bf16 a[144:159], a[24:27], v[32:35], a[144:159]
  ds_read_b128 v[56:59], v19 offset:24576
  s_waitcnt lgkmcnt(5)
  v_mfma_f32_32x32x16_bf16 a[160:175], a[24:27], v[36:39], a[160:175]
  ds_read_b128 v[60:63], v19 offset:28672
  s_waitcnt lgkmcnt(5)
  v_mfma_f32_32x32x16_bf16 a[176:191], a[24:27], v[40:43], a[176:191]
  ds_read_b128 v[32:35], v16 offset:32768
  s_waitcnt lgkmcnt(5)
  v_mfma_f32_32x32x16_bf16 a[192:207], a[24:27], v[44:47], a[192:207]
  ds_read_b128 v[36:39], v16 offset:36864
  s_waitcnt lgkmcnt(5)
  v_mfma_f32_32x32x16_bf16 a[144:159], a[28:31], v[48:51], a[144:159]
  ds_read_b128 v[40:43], v16 offset:40960
  s_waitcnt lgkmcnt(5)
  v_mfma_f32_32x32x16_bf16 a[160:175], a[28:31], v[52:55], a[160:175]
  ds_read_b128 v[44:47], v16 offset:45056
  s_waitcnt lgkmcnt(5)
  v_mfma_f32_32x32x16_bf16 a[176:191], a[28:31], v[56:59], a[176:191]
  ds_read_b128 v[48:51], v17 offset:32768
  s_waitcnt lgkmcnt(5)
  v_mfma_f32_32x32x16_bf16 a[192:207], a[28:31], v[60:63], a[192:207]
  ds_read_b128 v[52:55], v17 offset:36864
  s_waitcnt lgkmcnt(5)
  v_mfma_f32_32x32x16_bf16 a[144:159], a[32:35], v[32:35], a[144:159]
  ds_read_b128 v[56:59], v17 offset:40960
  s_waitcnt lgkmcnt(5)
  v_mfma_f32_32x32x16_bf16 a[160:175], a[32:35], v[36:39], a[160:175]
  ds_read_b128 v[60:63], v17 offset:45056
  s_waitcnt lgkmcnt(5)
  v_mfma_f32_32x32x16_bf16 a[176:191], a[32:35], v[40:43], a[176:191]
  ds_read_b128 v[32:35], v18 offset:32768
  s_waitcnt lgkmcnt(5)
  v_mfma_f32_32x32x16_bf16 a[192:207], a[32:35], v[44:47], a[192:207]
  ds_read_b128 v[36:39], v18 offset:36864
  s_waitcnt lgkmcnt(5)
  v_mfma_f32_32x32x16_bf16 a[144:159], a[36:39], v[48:51], a[144:159]
  ds_read_b128 v[40:43], v18 offset:40960
  s_waitcnt lgkmcnt(5)
  v_mfma_f32_32x32x16_bf16 a[160:175], a[36:39], v[52:55], a[160:175]
  ds_read_b128 v[44:47], v18 offset:45056
  s_waitcnt lgkmcnt(5)
  v_mfma_f32_32x32x16_bf16 a[176:191], a[36:39], v[56:59], a[176:191]
  ds_read_b128 v[48:51], v19 offset:32768
  s_waitcnt lgkmcnt(5)
  v_mfma_f32_32x32x16_bf16 a[192:207], a[36:39], v[60:63], a[192:207]
  ds_read_b128 v[52:55], v19 offset:36864
  s_waitcnt vmcnt(24)
  s_barrier
  s_add_u32 m0, s22, 16384
  s_add_u32 s39, s21, 0
  buffer_load_dwordx4 v14, s[16:19], s39 offen offset:0 lds
  s_add_u32 s39, s21, 8192
  buffer_load_dwordx4 v12, s[16:19], s39 offen offset:1024 lds
  s_add_u32 s39, s21, 16384
  buffer_load_dwordx4 v14, s[16:19], s39 offen offset:2048 lds
  s_add_u32 s39, s21, 24576
  buffer_load_dwordx4 v12, s[16:19], s39 offen offset:3072 lds
  s_add_u32 s21, s21, 128
  s_waitcnt lgkmcnt(5)
  v_mfma_f32_32x32x16_bf16 a[144:159], a[40:43], v[32:35], a[144:159]
  ds_read_b128 v[56:59], v19 offset:40960
  s_waitcnt lgkmcnt(5)
  v_mfma_f32_32x32x16_bf16 a[160:175], a[40:43], v[36:39], a[160:175]
  ds_read_b128 v[60:63], v19 offset:45056
  s_waitcnt lgkmcnt(5)
  v_mfma_f32_32x32x16_bf16 a[176:191], a[40:43], v[40:43], a[176:191]
  ds_read_b128 v[32:35], v20 offset:0
  s_waitcnt lgkmcnt(5)
  v_mfma_f32_32x32x16_bf16 a[192:207], a[40:43], v[44:47], a[192:207]
  ds_read_b128 v[36:39], v20 offset:4096
  s_waitcnt lgkmcnt(5)
  v_mfma_f32_32x32x16_bf16 a[144:159], a[44:47], v[48:51], a[144:159]
  ds_read_b128 v[40:43], v20 offset:8192
  s_waitcnt lgkmcnt(5)
  v_mfma_f32_32x32x16_bf16 a[160:175], a[44:47], v[52:55], a[160:175]
  ds_read_b128 v[44:47], v20 offset:12288
  s_waitcnt lgkmcnt(5)
  v_mfma_f32_32x32x16_bf16 a[176:191], a[44:47], v[56:59], a[176:191]
  ds_read_b128 v[48:51], v21 offset:0
  s_waitcnt lgkmcnt(5)
  v_mfma_f32_32x32x16_bf16 a[192:207], a[44:47], v[60:63], a[192:207]
  ds_read_b128 v[52:55], v21 offset:4096
  s_waitcnt lgkmcnt(5)
  v_mfma_f32_32x32x16_bf16 a[144:159], a[48:51], v[32:35], a[144:159]
  ds_read_b128 v[56:59], v21 offset:8192
  s_waitcnt lgkmcnt(5)
  v_mfma_f32_32x32x16_bf16 a[160:175], a[48:51], v[36:39], a[160:175]
  ds_read_b128 v[60:63], v21 offset:12288
  s_waitcnt lgkmcnt(5)
  v_mfma_f32_32x32x16_bf16 a[176:191], a[48:51], v[40:43], a[176:191]
  ds_read_b128 v[32:35], v22 offset:0
  s_waitcnt lgkmcnt(5)
  v_mfma_f32_32x32x16_bf16 a[192:207], a[48:51], v[44:47], a[192:207]
  ds_read_b128 v[36:39], v22 offset:4096
  s_waitcnt lgkmcnt(5)
  v_mfma_f32_32x32x16_bf16 a[144:159], a[52:55], v[48:51], a[144:159]
  ds_read_b128 v[40:43], v22 offset:8192
  s_waitcnt lgkmcnt(5)
  v_mfma_f32_32x32x16_bf16 a[160:175], a[52:55], v[52:55], a[160:175]
  ds_read_b128 v[44:47], v22 offset:12288
  s_waitcnt lgkmcnt(5)
  v_mfma_f32_32x32x16_bf16 a[176:191], a[52:55], v[56:59], a[176:191]
  ds_read_b128 v[48:51], v23 offset:0
  s_waitcnt lgkmcnt(5)
  v_mfma_f32_32x32x16_bf16 a[192:207], a[52:55], v[60:63], a[192:207]
  ds_read_b128 v[52:55], v23 offset:4096
  s_waitcnt vmcnt(24)
  s_barrier
  s_add_u32 m0, s22, 32768
  s_add_u32 s39, s21, 0
  buffer_load_dwordx4 v14, s[16:19], s39 offen offset:0 lds
  s_add_u32 s39, s21, 8192
  buffer_load_dwordx4 v12, s[16:19], s39 offen offset:1024 lds
  s_add_u32 s39, s21, 16384
  buffer_load_dwordx4 v14, s[16:19], s39 offen offset:2048 lds
  s_add_u32 s39, s21, 24576
  buffer_load_dwordx4 v12, s[16:19], s39 offen offset:3072 lds
  s_add_u32 s21, s21, 128
  s_waitcnt lgkmcnt(5)
  v_mfma_f32_32x32x16_bf16 a[144:159], a[56:59], v[32:35], a[144:159]
  ds_read_b128 v[56:59], v23 offset:8192
  s_waitcnt lgkmcnt(5)
  v_mfma_f32_32x32x16_bf16 a[160:175], a[56:59], v[36:39], a[160:175]
  ds_read_b128 v[60:63], v23 offset:12288
  s_waitcnt lgkmcnt(5)
  v_mfma_f32_32x32x16_bf16 a[176:191], a[56:59], v[40:43], a[176:191]
  ds_read_b128 v[32:35], v20 offset:16384
  s_waitcnt lgkmcnt(5)
  v_mfma_f32_32x32x16_bf16 a[192:207], a[56:59], v[44:47], a[192:207]
  ds_read_b128 v[36:39], v20 offset:20480
  s_waitcnt lgkmcnt(5)
  v_mfma_f32_32x32x16_bf16 a[144:159], a[60:63], v[48:51], a[144:159]
  ds_read_b128 v[40:43], v20 offset:24576
  s_waitcnt lgkmcnt(5)
  v_mfma_f32_32x32x16_bf16 a[160:175], a[60:63], v[52:55], a[160:175]
  ds_read_b128 v[44:47], v20 offset:28672
  s_waitcnt lgkmcnt(5)
  v_mfma_f32_32x32x16_bf16 a[176:191], a[60:63], v[56:59], a[176:191]
  ds_read_b128 v[48:51], v21 offset:16384
  s_waitcnt lgkmcnt(5)
  v_mfma_f32_32x32x16_bf16 a[192:207], a[60:63], v[60:63], a[192:207]
  ds_read_b128 v[52:55], v21 offset:20480
  s_waitcnt lgkmcnt(5)
  v_mfma_f32_32x32x16_bf16 a[144:159], a[64:67], v[32:35], a[144:159]
  ds_read_b128 v[56:59], v21 offset:24576
  s_waitcnt lgkmcnt(5)
  v_mfma_f32_32x32x16_bf16 a[160:175], a[64:67], v[36:39], a[160:175]
  ds_read_b128 v[60:63], v21 offset:28672
  s_waitcnt lgkmcnt(5)
  v_mfma_f32_32x32x16_bf16 a[176:191], a[64:67], v[40:43], a[176:191]
  ds_read_b128 v[32:35], v22 offset:16384
  s_waitcnt lgkmcnt(5)
  v_mfma_f32_32x32x16_bf16 a[192:207], a[64:67], v[44:47], a[192:207]
  ds_read_b128 v[36:39], v22 offset:20480
  s_waitcnt lgkmcnt(5)
  v_mfma_f32_32x32x16_bf16 a[144:159], a[68:71], v[48:51], a[144:159]
  ds_read_b128 v[40:43], v22 offset:24576
  s_waitcnt lgkmcnt(5)
  v_mfma_f32_32x32x16_bf16 a[160:175], a[68:71], v[52:55], a[160:175]
  ds_read_b128 v[44:47], v22 offset:28672
  s_waitcnt lgkmcnt(5)
  v_mfma_f32_32x32x16_bf16 a[176:191], a[68:71], v[56:59], a[176:191]
  ds_read_b128 v[48:51], v23 offset:16384
  s_waitcnt lgkmcnt(5)
  v_mfma_f32_32x32x16_bf16 a[192:207], a[68:71], v[60:63], a[192:207]
  ds_read_b128 v[52:55], v23 offset:20480
  s_waitcnt vmcnt(24)
  s_barrier
  s_add_u32 m0, s22, 49152
  s_add_u32 s39, s21, 0
  buffer_load_dwordx4 v14, s[16:19], s39 offen offset:0 lds
  s_add_u32 s39, s21, 8192
  buffer_load_dwordx4 v12, s[16:19], s39 offen offset:1024 lds
  s_add_u32 s39, s21, 16384
  buffer_load_dwordx4 v14, s[16:19], s39 offen offset:2048 lds
  s_add_u32 s39, s21, 24576
  buffer_load_dwordx4 v12, s[16:19], s39 offen offset:3072 lds
  s_add_u32 s21, s21, 128
  s_waitcnt lgkmcnt(5)
  v_mfma_f32_32x32x16_bf16 a[144:159], a[72:75], v[32:35], a[144:159]
  ds_read_b128 v[56:59], v23 offset:24576
  s_waitcnt lgkmcnt(5)
  v_mfma_f32_32x32x16_bf16 a[160:175], a[72:75], v[36:39], a[160:175]
  ds_read_b128 v[60:63], v23 offset:28672
  s_waitcnt lgkmcnt(5)
  v_mfma_f32_32x32x16_bf16 a[176:191], a[72:75], v[40:43], a[176:191]
  ds_read_b128 v[32:35], v20 offset:32768
  s_waitcnt lgkmcnt(5)
  v_mfma_f32_32x32x16_bf16 a[192:207], a[72:75], v[44:47], a[192:207]
  ds_read_b128 v[36:39], v20 offset:36864
  s_waitcnt lgkmcnt(5)
  v_mfma_f32_32x32x16_bf16 a[144:159], a[76:79], v[48:51], a[144:159]
  ds_read_b128 v[40:43], v20 offset:40960
  s_waitcnt lgkmcnt(5)
  v_mfma_f32_32x32x16_bf16 a[160:175], a[76:79], v[52:55], a[160:175]
  ds_read_b128 v[44:47], v20 offset:45056
  s_waitcnt lgkmcnt(5)
  v_mfma_f32_32x32x16_bf16 a[176:191], a[76:79], v[56:59], a[176:191]
  ds_read_b128 v[48:51], v21 offset:32768
  s_waitcnt lgkmcnt(5)
  v_mfma_f32_32x32x16_bf16 a[192:207], a[76:79], v[60:63], a[192:207]
  ds_read_b128 v[52:55], v21 offset:36864
  s_waitcnt lgkmcnt(5)
  v_mfma_f32_32x32x16_bf16 a[144:159], a[80:83], v[32:35], a[144:159]
  ds_read_b128 v[56:59], v21 offset:40960
  s_waitcnt lgkmcnt(5)
  v_mfma_f32_32x32x16_bf16 a[160:175], a[80:83], v[36:39], a[160:175]
  ds_read_b128 v[60:63], v21 offset:45056
  s_waitcnt lgkmcnt(5)
  v_mfma_f32_32x32x16_bf16 a[176:191], a[80:83], v[40:43], a[176:191]
  ds_read_b128 v[32:35], v22 offset:32768
  s_waitcnt lgkmcnt(5)
  v_mfma_f32_32x32x16_bf16 a[192:207], a[80:83], v[44:47], a[192:207]
  ds_read_b128 v[36:39], v22 offset:36864
  s_waitcnt lgkmcnt(5)
  v_mfma_f32_32x32x16_bf16 a[144:159], a[84:87], v[48:51], a[144:159]
  ds_read_b128 v[40:43], v22 offset:40960
  s_waitcnt lgkmcnt(5)
  v_mfma_f32_32x32x16_bf16 a[160:175], a[84:87], v[52:55], a[160:175]
  ds_read_b128 v[44:47], v22 offset:45056
  s_waitcnt lgkmcnt(5)
  v_mfma_f32_32x32x16_bf16 a[176:191], a[84:87], v[56:59], a[176:191]
  ds_read_b128 v[48:51], v23 offset:32768
  s_waitcnt lgkmcnt(5)
  v_mfma_f32_32x32x16_bf16 a[192:207], a[84:87], v[60:63], a[192:207]
  ds_read_b128 v[52:55], v23 offset:36864
  s_waitcnt vmcnt(24)
  s_barrier
  s_add_u32 m0, s22, 65536
  s_add_u32 s39, s21, 0
  buffer_load_dwordx4 v14, s[16:19], s39 offen offset:0 lds
  s_add_u32 s39, s21, 8192
  buffer_load_dwordx4 v12, s[16:19], s39 offen offset:1024 lds
  s_add_u32 s39, s21, 16384
  buffer_load_dwordx4 v14, s[16:19], s39 offen offset:2048 lds
  s_add_u32 s39, s21, 24576
  buffer_load_dwordx4 v12, s[16:19], s39 offen offset:3072 lds
  s_add_u32 s21, s21, 128
  s_waitcnt lgkmcnt(5)
  v_mfma_f32_32x32x16_bf16 a[144:159], a[88:91], v[32:35], a[144:159]
  ds_read_b128 v[56:59], v23 offset:40960
  s_waitcnt lgkmcnt(5)
  v_mfma_f32_32x32x16_bf16 a[160:175], a[88:91], v[36:39], a[160:175]
  ds_read_b128 v[60:63], v23 offset:45056
  s_waitcnt lgkmcnt(5)
  v_mfma_f32_32x32x16_bf16 a[176:191], a[88:91], v[40:43], a[176:191]
  ds_read_b128 v[32:35], v24 offset:0
  s_waitcnt lgkmcnt(5)
  v_mfma_f32_32x32x16_bf16 a[192:207], a[88:91], v[44:47], a[192:207]
  ds_read_b128 v[36:39], v24 offset:4096
  s_waitcnt lgkmcnt(5)
  v_mfma_f32_32x32x16_bf16 a[144:159], a[92:95], v[48:51], a[144:159]
  ds_read_b128 v[40:43], v24 offset:8192
  s_waitcnt lgkmcnt(5)
  v_mfma_f32_32x32x16_bf16 a[160:175], a[92:95], v[52:55], a[160:175]
  ds_read_b128 v[44:47], v24 offset:12288
  s_waitcnt lgkmcnt(5)
  v_mfma_f32_32x32x16_bf16 a[176:191], a[92:95], v[56:59], a[176:191]
  ds_read_b128 v[48:51], v25 offset:0
  s_waitcnt lgkmcnt(5)
  v_mfma_f32_32x32x16_bf16 a[192:207], a[92:95], v[60:63], a[192:207]
  ds_read_b128 v[52:55], v25 offset:4096
  s_waitcnt lgkmcnt(5)
  v_mfma_f32_32x32x16_bf16 a[144:159], a[96:99], v[32:35], a[144:159]
  ds_read_b128 v[56:59], v25 offset:8192
  s_waitcnt lgkmcnt(5)
  v_mfma_f32_32x32x16_bf16 a[160:175], a[96:99], v[36:39], a[160:175]
  ds_read_b128 v[60:63], v25 offset:12288
  s_waitcnt lgkmcnt(5)
  v_mfma_f32_32x32x16_bf16 a[176:191], a[96:99], v[40:43], a[176:191]
  ds_read_b128 v[32:35], v26 offset:0
  s_waitcnt lgkmcnt(5)
  v_mfma_f32_32x32x16_bf16 a[192:207], a[96:99], v[44:47], a[192:207]
  ds_read_b128 v[36:39], v26 offset:4096
  s_waitcnt lgkmcnt(5)
  v_mfma_f32_32x32x16_bf16 a[144:159], a[100:103], v[48:51], a[144:159]
  ds_read_b128 v[40:43], v26 offset:8192
  s_waitcnt lgkmcnt(5)
  v_mfma_f32_32x32x16_bf16 a[160:175], a[100:103], v[52:55], a[160:175]
  ds_read_b128 v[44:47], v26 offset:12288
  s_waitcnt lgkmcnt(5)
  v_mfma_f32_32x32x16_bf16 a[176:191], a[100:103], v[56:59], a[176:191]
  ds_read_b128 v[48:51], v27 offset:0
  s_waitcnt lgkmcnt(5)
  v_mfma_f32_32x32x16_bf16 a[192:207], a[100:103], v[60:63], a[192:207]
  ds_read_b128 v[52:55], v27 offset:4096
  s_waitcnt vmcnt(24)
  s_barrier
  s_add_u32 m0, s22, 81920
  s_add_u32 s39, s21, 0
  buffer_load_dwordx4 v14, s[16:19], s39 offen offset:0 lds
  s_add_u32 s39, s21, 8192
  buffer_load_dwordx4 v12, s[16:19], s39 offen offset:1024 lds
  s_add_u32 s39, s21, 16384
  buffer_load_dwordx4 v14, s[16:19], s39 offen offset:2048 lds
  s_add_u32 s39, s21, 24576
  buffer_load_dwordx4 v12, s[16:19], s39 offen offset:3072 lds
  s_add_u32 s21, s21, 128
  s_waitcnt lgkmcnt(5)
  v_mfma_f32_32x32x16_bf16 a[144:159], a[104:107], v[32:35], a[144:159]
  ds_read_b128 v[56:59], v27 offset:8192
  s_waitcnt lgkmcnt(5)
  v_mfma_f32_32x32x16_bf16 a[160:175], a[104:107], v[36:39], a[160:175]
  ds_read_b128 v[60:63], v27 offset:12288
  s_waitcnt lgkmcnt(5)
  v_mfma_f32_32x32x16_bf16 a[176:191], a[104:107], v[40:43], a[176:191]
  ds_read_b128 v[32:35], v24 offset:16384
  s_waitcnt lgkmcnt(5)
  v_mfma_f32_32x32x16_bf16 a[192:207], a[104:107], v[44:47], a[192:207]
  ds_read_b128 v[36:39], v24 offset:20480
  s_waitcnt lgkmcnt(5)
  v_mfma_f32_32x32x16_bf16 a[144:159], a[108:111], v[48:51], a[144:159]
  ds_read_b128 v[40:43], v24 offset:24576
  s_waitcnt lgkmcnt(5)
  v_mfma_f32_32x32x16_bf16 a[160:175], a[108:111], v[52:55], a[160:175]
  ds_read_b128 v[44:47], v24 offset:28672
  s_waitcnt lgkmcnt(5)
  v_mfma_f32_32x32x16_bf16 a[176:191], a[108:111], v[56:59], a[176:191]
  ds_read_b128 v[48:51], v25 offset:16384
  s_waitcnt lgkmcnt(5)
  v_mfma_f32_32x32x16_bf16 a[192:207], a[108:111], v[60:63], a[192:207]
  ds_read_b128 v[52:55], v25 offset:20480
  s_waitcnt lgkmcnt(5)
  v_mfma_f32_32x32x16_bf16 a[144:159], a[112:115], v[32:35], a[144:159]
  ds_read_b128 v[56:59], v25 offset:24576
  s_waitcnt lgkmcnt(5)
  v_mfma_f32_32x32x16_bf16 a[160:175], a[112:115], v[36:39], a[160:175]
  ds_read_b128 v[60:63], v25 offset:28672
  s_waitcnt lgkmcnt(5)
  v_mfma_f32_32x32x16_bf16 a[176:191], a[112:115], v[40:43], a[176:191]
  ds_read_b128 v[32:35], v26 offset:16384
  s_waitcnt lgkmcnt(5)
  v_mfma_f32_32x32x16_bf16 a[192:207], a[112:115], v[44:47], a[192:207]
  ds_read_b128 v[36:39], v26 offset:20480
  s_waitcnt lgkmcnt(5)
  v_mfma_f32_32x32x16_bf16 a[144:159], a[116:119], v[48:51], a[144:159]
  ds_read_b128 v[40:43], v26 offset:24576
  s_waitcnt lgkmcnt(5)
  v_mfma_f32_32x32x16_bf16 a[160:175], a[116:119], v[52:55], a[160:175]
  ds_read_b128 v[44:47], v26 offset:28672
  s_waitcnt lgkmcnt(5)
  v_mfma_f32_32x32x16_bf16 a[176:191], a[116:119], v[56:59], a[176:191]
  ds_read_b128 v[48:51], v27 offset:16384
  s_waitcnt lgkmcnt(5)
  v_mfma_f32_32x32x16_bf16 a[192:207], a[116:119], v[60:63], a[192:207]
  ds_read_b128 v[52:55], v27 offset:20480
  s_waitcnt vmcnt(24)
  s_barrier
  s_add_u32 m0, s22, 98304
  s_add_u32 s39, s21, 0
  buffer_load_dwordx4 v14, s[16:19], s39 offen offset:0 lds
  s_add_u32 s39, s21, 8192
  buffer_load_dwordx4 v12, s[16:19], s39 offen offset:1024 lds
  s_add_u32 s39, s21, 16384
  buffer_load_dwordx4 v14, s[16:19], s39 offen offset:2048 lds
  s_add_u32 s39, s21, 24576
  buffer_load_dwordx4 v12, s[16:19], s39 offen offset:3072 lds
  s_add_u32 s21, s21, 128
  s_waitcnt lgkmcnt(5)
  v_mfma_f32_32x32x16_bf16 a[144:159], a[120:123], v[32:35], a[144:159]
  ds_read_b128 v[56:59], v27 offset:24576
  s_waitcnt lgkmcnt(5)
  v_mfma_f32_32x32x16_bf16 a[160:175], a[120:123], v[36:39], a[160:175]
  ds_read_b128 v[60:63], v27 offset:28672
  s_waitcnt lgkmcnt(5)
  v_mfma_f32_32x32x16_bf16 a[176:191], a[120:123], v[40:43], a[176:191]
  ds_read_b128 v[32:35], v24 offset:32768
  s_waitcnt lgkmcnt(5)
  v_mfma_f32_32x32x16_bf16 a[192:207], a[120:123], v[44:47], a[192:207]
  ds_read_b128 v[36:39], v24 offset:36864
  s_waitcnt lgkmcnt(5)
  v_mfma_f32_32x32x16_bf16 a[144:159], a[124:127], v[48:51], a[144:159]
  ds_read_b128 v[40:43], v24 offset:40960
  s_waitcnt lgkmcnt(5)
  v_mfma_f32_32x32x16_bf16 a[160:175], a[124:127], v[52:55], a[160:175]
  ds_read_b128 v[44:47], v24 offset:45056
  s_waitcnt lgkmcnt(5)
  v_mfma_f32_32x32x16_bf16 a[176:191], a[124:127], v[56:59], a[176:191]
  ds_read_b128 v[48:51], v25 offset:32768
  s_waitcnt lgkmcnt(5)
  v_mfma_f32_32x32x16_bf16 a[192:207], a[124:127], v[60:63], a[192:207]
  ds_read_b128 v[52:55], v25 offset:36864
  s_waitcnt lgkmcnt(5)
  v_mfma_f32_32x32x16_bf16 a[144:159], a[128:131], v[32:35], a[144:159]
  ds_read_b128 v[56:59], v25 offset:40960
  s_waitcnt lgkmcnt(5)
  v_mfma_f32_32x32x16_bf16 a[160:175], a[128:131], v[36:39], a[160:175]
  ds_read_b128 v[60:63], v25 offset:45056
  s_waitcnt lgkmcnt(5)
  v_mfma_f32_32x32x16_bf16 a[176:191], a[128:131], v[40:43], a[176:191]
  ds_read_b128 v[32:35], v26 offset:32768
  s_waitcnt lgkmcnt(5)
  v_mfma_f32_32x32x16_bf16 a[192:207], a[128:131], v[44:47], a[192:207]
  ds_read_b128 v[36:39], v26 offset:36864
  s_waitcnt lgkmcnt(5)
  v_mfma_f32_32x32x16_bf16 a[144:159], a[132:135], v[48:51], a[144:159]
  ds_read_b128 v[40:43], v26 offset:40960
  s_waitcnt lgkmcnt(5)
  v_mfma_f32_32x32x16_bf16 a[160:175], a[132:135], v[52:55], a[160:175]
  ds_read_b128 v[44:47], v26 offset:45056
  s_waitcnt lgkmcnt(5)
  v_mfma_f32_32x32x16_bf16 a[176:191], a[132:135], v[56:59], a[176:191]
  ds_read_b128 v[48:51], v27 offset:32768
  s_waitcnt lgkmcnt(5)
  v_mfma_f32_32x32x16_bf16 a[192:207], a[132:135], v[60:63], a[192:207]
  ds_read_b128 v[52:55], v27 offset:36864
  s_waitcnt vmcnt(24)
  s_barrier
  s_add_u32 m0, s22, 114688
  s_add_u32 s39, s21, 0
  buffer_load_dwordx4 v14, s[16:19], s39 offen offset:0 lds
  s_add_u32 s39, s21, 8192
  buffer_load_dwordx4 v12, s[16:19], s39 offen offset:1024 lds
  s_add_u32 s39, s21, 16384
  buffer_load_dwordx4 v14, s[16:19], s39 offen offset:2048 lds
  s_add_u32 s39, s21, 24576
  buffer_load_dwordx4 v12, s[16:19], s39 offen offset:3072 lds
  s_add_u32 s21, s21, 128
  s_waitcnt lgkmcnt(5)
  v_mfma_f32_32x32x16_bf16 a[144:159], a[136:139], v[32:35], a[144:159]
  ds_read_b128 v[56:59], v27 offset:40960
  s_waitcnt lgkmcnt(5)
  v_mfma_f32_32x32x16_bf16 a[160:175], a[136:139], v[36:39], a[160:175]
  ds_read_b128 v[60:63], v27 offset:45056
  s_waitcnt lgkmcnt(5)
  v_mfma_f32_32x32x16_bf16 a[176:191], a[136:139], v[40:43], a[176:191]
  ds_read_b128 v[32:35], v16 offset:0
  s_waitcnt lgkmcnt(5)
  v_mfma_f32_32x32x16_bf16 a[192:207], a[136:139], v[44:47], a[192:207]
  ds_read_b128 v[36:39], v16 offset:4096
  s_waitcnt lgkmcnt(5)
  v_mfma_f32_32x32x16_bf16 a[144:159], a[140:143], v[48:51], a[144:159]
  ds_read_b128 v[40:43], v16 offset:8192
  s_waitcnt lgkmcnt(5)
  v_mfma_f32_32x32x16_bf16 a[160:175], a[140:143], v[52:55], a[160:175]
  ds_read_b128 v[44:47], v16 offset:12288
  s_waitcnt lgkmcnt(5)
  v_mfma_f32_32x32x16_bf16 a[176:191], a[140:143], v[56:59], a[176:191]
  ds_read_b128 v[48:51], v17 offset:0
  s_waitcnt lgkmcnt(5)
  v_mfma_f32_32x32x16_bf16 a[192:207], a[140:143], v[60:63], a[192:207]
  ds_read_b128 v[52:55], v17 offset:4096
  s_nop 1
  v_accvgpr_read_b32 v128, a144
  v_accvgpr_read_b32 v129, a145
  v_accvgpr_read_b32 v130, a146
  v_accvgpr_read_b32 v131, a147
  v_accvgpr_read_b32 v132, a148
  v_accvgpr_read_b32 v133, a149
  v_accvgpr_read_b32 v134, a150
  v_accvgpr_read_b32 v135, a151
  v_accvgpr_read_b32 v136, a152
  v_accvgpr_read_b32 v137, a153
  v_accvgpr_read_b32 v138, a154
  v_accvgpr_read_b32 v139, a155
  v_accvgpr_read_b32 v140, a156
  v_accvgpr_read_b32 v141, a157
  v_accvgpr_read_b32 v142, a158
  v_accvgpr_read_b32 v143, a159
  v_cvt_pk_bf16_f32 v96, v128, v129
  v_cvt_pk_bf16_f32 v97, v130, v131
  v_cvt_pk_bf16_f32 v98, v136, v137
  v_cvt_pk_bf16_f32 v99, v138, v139
  buffer_store_dwordx4 v[96:99], v2, s[4:7], s24 offen offset:0
  v_cvt_pk_bf16_f32 v100, v132, v133
  v_cvt_pk_bf16_f32 v101, v134, v135
  v_cvt_pk_bf16_f32 v102, v140, v141
  v_cvt_pk_bf16_f32 v103, v142, v143
  buffer_store_dwordx4 v[100:103], v2, s[4:7], s24 offen offset:1024
  s_add_u32 s24, s24, 262144
  v_accvgpr_read_b32 v128, a160
  v_accvgpr_read_b32 v129, a161
  v_accvgpr_read_b32 v130, a162
  v_accvgpr_read_b32 v131, a163
  v_accvgpr_read_b32 v132, a164
  v_accvgpr_read_b32 v133, a165
  v_accvgpr_read_b32 v134, a166
  v_accvgpr_read_b32 v135, a167
  v_accvgpr_read_b32 v136, a168
  v_accvgpr_read_b32 v137, a169
  v_accvgpr_read_b32 v138, a170
  v_accvgpr_read_b32 v139, a171
  v_accvgpr_read_b32 v140, a172
  v_accvgpr_read_b32 v141, a173
  v_accvgpr_read_b32 v142, a174
  v_accvgpr_read_b32 v143, a175
  v_cvt_pk_bf16_f32 v104, v128, v129
  v_cvt_pk_bf16_f32 v105, v130, v131
  v_cvt_pk_bf16_f32 v106, v136, v137
  v_cvt_pk_bf16_f32 v107, v138, v139
  buffer_store_dwordx4 v[104:107], v2, s[4:7], s24 offen offset:0
  v_cvt_pk_bf16_f32 v108, v132, v133
  v_cvt_pk_bf16_f32 v109, v134, v135
  v_cvt_pk_bf16_f32 v110, v140, v141
  v_cvt_pk_bf16_f32 v111, v142, v143
  buffer_store_dwordx4 v[108:111], v2, s[4:7], s24 offen offset:1024
  s_add_u32 s24, s24, 262144
  v_accvgpr_read_b32 v128, a176
  v_accvgpr_read_b32 v129, a177
  v_accvgpr_read_b32 v130, a178
  v_accvgpr_read_b32 v131, a179
  v_accvgpr_read_b32 v132, a180
  v_accvgpr_read_b32 v133, a181
  v_accvgpr_read_b32 v134, a182
  v_accvgpr_read_b32 v135, a183
  v_accvgpr_read_b32 v136, a184
  v_accvgpr_read_b32 v137, a185
  v_accvgpr_read_b32 v138, a186
  v_accvgpr_read_b32 v139, a187
  v_accvgpr_read_b32 v140, a188
  v_accvgpr_read_b32 v141, a189
  v_accvgpr_read_b32 v142, a190
  v_accvgpr_read_b32 v143, a191
  v_cvt_pk_bf16_f32 v112, v128, v129
  v_cvt_pk_bf16_f32 v113, v130, v131
  v_cvt_pk_bf16_f32 v114, v136, v137
  v_cvt_pk_bf16_f32 v115, v138, v139
  buffer_store_dwordx4 v[112:115], v2, s[4:7], s24 offen offset:0
  v_cvt_pk_bf16_f32 v116, v132, v133
  v_cvt_pk_bf16_f32 v117, v134, v135
  v_cvt_pk_bf16_f32 v118, v140, v141
  v_cvt_pk_bf16_f32 v119, v142, v143
  buffer_store_dwordx4 v[116:119], v2, s[4:7], s24 offen offset:1024
  s_add_u32 s24, s24, 262144
  v_accvgpr_read_b32 v128, a192
  v_accvgpr_read_b32 v129, a193
  v_accvgpr_read_b32 v130, a194
  v_accvgpr_read_b32 v131, a195
  v_accvgpr_read_b32 v132, a196
  v_accvgpr_read_b32 v133, a197
  v_accvgpr_read_b32 v134, a198
  v_accvgpr_read_b32 v135, a199
  v_accvgpr_read_b32 v136, a200
  v_accvgpr_read_b32 v137, a201
  v_accvgpr_read_b32 v138, a202
  v_accvgpr_read_b32 v139, a203
  v_accvgpr_read_b32 v140, a204
  v_accvgpr_read_b32 v141, a205
  v_accvgpr_read_b32 v142, a206
  v_accvgpr_read_b32 v143, a207
  v_cvt_pk_bf16_f32 v120, v128, v129
  v_cvt_pk_bf16_f32 v121, v130, v131
  v_cvt_pk_bf16_f32 v122, v136, v137
  v_cvt_pk_bf16_f32 v123, v138, v139
  buffer_store_dwordx4 v[120:123], v2, s[4:7], s24 offen offset:0
  v_cvt_pk_bf16_f32 v124, v132, v133
  v_cvt_pk_bf16_f32 v125, v134, v135
  v_cvt_pk_bf16_f32 v126, v140, v141
  v_cvt_pk_bf16_f32 v127, v142, v143
  buffer_store_dwordx4 v[124:127], v2, s[4:7], s24 offen offset:1024
  s_add_u32 s24, s24, 262144
  s_add_u32 s23, s23, 1
  s_cmp_lt_u32 s23, 16
  s_cbranch_scc1 RND_13
  s_waitcnt vmcnt(0) lgkmcnt(0)
  s_barrier
  s_mov_b32 s40, 0
  v_mov_b32 v8, 0
WI_15:
  global_load_dword v9, v8, s[66:67] offset:192 sc1
  s_add_u32 s40, s40, 1
  s_cmp_gt_u32 s40, 400000
  s_cbranch_scc1 L_fail
  s_waitcnt vmcnt(0)
  v_readfirstlane_b32 s37, v9
  s_nop 0
  s_cmp_lt_u32 s37, 8
  s_cbranch_scc1 WI_15
  v_lshlrev_b32 v15, 2, v4
  v_mov_b32 v8, 0xf149f2ca
  v_add_u32 v9, 0, v15
  v_cmp_gt_u32 vcc, v9, v3
  s_nop 1
  v_cndmask_b32 v80, 0, v8, vcc
  v_add_u32 v9, 1, v15
  v_cmp_gt_u32 vcc, v9, v3
  s_nop 1
  v_cndmask_b32 v81, 0, v8, vcc
  v_add_u32 v9, 2, v15
  v_cmp_gt_u32 vcc, v9, v3
  s_nop 1
  v_cndmask_b32 v82, 0, v8, vcc
  v_add_u32 v9, 3, v15
  v_cmp_gt_u32 vcc, v9, v3
  s_nop 1
  v_cndmask_b32 v83, 0, v8, vcc
  v_add_u32 v9, 8, v15
  v_cmp_gt_u32 vcc, v9, v3
  s_nop 1
  v_cndmask_b32 v84, 0, v8, vcc
  v_add_u32 v9, 9, v15
  v_cmp_gt_u32 vcc, v9, v3
  s_nop 1
  v_cndmask_b32 v85, 0, v8, vcc
  v_add_u32 v9, 10, v15
  v_cmp_gt_u32 vcc, v9, v3
  s_nop 1
  v_cndmask_b32 v86, 0, v8, vcc
  v_add_u32 v9, 11, v15
  v_cmp_gt_u32 vcc, v9, v3
  s_nop 1
  v_cndmask_b32 v87, 0, v8, vcc
  v_add_u32 v9, 16, v15
  v_cmp_gt_u32 vcc, v9, v3
  s_nop 1
  v_cndmask_b32 v88, 0, v8, vcc
  v_add_u32 v9, 17, v15
  v_cmp_gt_u32 vcc, v9, v3
  s_nop 1
  v_cndmask_b32 v89, 0, v8, vcc
  v_add_u32 v9, 18, v15
  v_cmp_gt_u32 vcc, v9, v3
  s_nop 1
  v_cndmask_b32 v90, 0, v8, vcc
  v_add_u32 v9, 19, v15
  v_cmp_gt_u32 vcc, v9, v3
  s_nop 1
  v_cndmask_b32 v91, 0, v8, vcc
  v_add_u32 v9, 24, v15
  v_cmp_gt_u32 vcc, v9, v3
  s_nop 1
  v_cndmask_b32 v92, 0, v8, vcc
  v_add_u32 v9, 25, v15
  v_cmp_gt_u32 vcc, v9, v3
  s_nop 1
  v_cndmask_b32 v93, 0, v8, vcc
  v_add_u32 v9, 26, v15
  v_cmp_gt_u32 vcc, v9, v3
  s_nop 1
  v_cndmask_b32 v94, 0, v8, vcc
  v_add_u32 v9, 27, v15
  v_cmp_gt_u32 vcc, v9, v3
  s_nop 1
  v_cndmask_b32 v95, 0, v8, vcc
  v_and_b32 v28, 7, v1
  v_lshlrev_b32 v28, 4, v28
  v_lshl_add_u32 v28, v4, 7, v28
  v_and_b32 v29, 15, v1
  v_lshlrev_b32 v29, 4, v29
  v_lshl_add_u32 v29, v4, 8, v29
  v_lshl_add_u32 v29, v5, 3, v29
  s_mov_b32 s20, s13
  s_mov_b32 s23, 0
  s_mov_b32 s26, 0
  s_mov_b32 s27, 0
  s_lshl_b32 s28, s12, 7
  s_add_u32 s28, s28, 933888
SEG_16:
  s_lshl_b32 s24, s20, 5
  s_add_u32 s24, s24, s12
  s_lshl_b32 s36, s24, 13
  s_add_u32 s36, s36, 83886080
  s_add_u32 s37, s36, 4096
  buffer_load_dwordx4 v[96:99], v2, s[4:7], s36 offen offset:0 sc1
  buffer_load_dwordx4 v[100:103], v2, s[4:7], s36 offen offset:1024 sc1
  buffer_load_dwordx4 v[104:107], v2, s[4:7], s36 offen offset:2048 sc1
  buffer_load_dwordx4 v[108:111], v2, s[4:7], s36 offen offset:3072 sc1
  buffer_load_dwordx4 v[112:115], v2, s[4:7], s37 offen offset:0 sc1
  buffer_load_dwordx4 v[116:119], v2, s[4:7], s37 offen offset:1024 sc1
  buffer_load_dwordx4 v[120:123], v2, s[4:7], s37 offen offset:2048 sc1
  buffer_load_dwordx4 v[124:127], v2, s[4:7], s37 offen offset:3072 sc1
  s_lshl_b32 s30, s24, 14
  s_add_u32 s30, s30, 16777216
  s_lshl_b32 s31, s24, 11
  s_add_u32 s31, s31, 1048576
  s_lshl_b32 s32, s24, 12
  s_add_u32 s32, s32, 5242880
  s_lshl_b32 s33, s24, 13
  s_add_u32 s33, s33, 50331648
  s_add_u32 s29, s23, 1
  s_cmp_ge_u32 s26, s29
  s_cbranch_scc1 PK_18
  s_mov_b32 s40, 0
  v_mov_b32 v240, 0
PG_17:
  buffer_load_dword v241, v240, s[4:7], s25 offen offset:0 sc1
  buffer_load_dword v242, v240, s[4:7], s25 offen offset:256 sc1
  s_add_u32 s40, s40, 1
  s_cmp_gt_u32 s40, 400000
  s_cbranch_scc1 L_fail
  s_waitcnt vmcnt(0)
  v_min_u32 v241, v241, v242
  s_nop 0
  v_readfirstlane_b32 s26, v241
  s_nop 0
  s_cmp_ge_u32 s26, s29
  s_cbranch_scc1 PK_18
  s_sleep 4
  s_branch PG_17
PK_18:
  buffer_load_dwordx4 v[128:131], v2, s[4:7], s30 offen offset:0 sc1
  buffer_load_dwordx4 v[132:135], v2, s[4:7], s30 offen offset:1024 sc1
  buffer_load_dwordx4 v[136:139], v2, s[4:7], s30 offen offset:2048 sc1
  buffer_load_dwordx4 v[140:143], v2, s[4:7], s30 offen offset:3072 sc1
  s_add_u32 s30, s30, 4096
  buffer_load_dwordx4 v[144:147], v2, s[4:7], s30 offen offset:0 sc1
  buffer_load_dwordx4 v[148:151], v2, s[4:7], s30 offen offset:1024 sc1
  buffer_load_dwordx4 v[152:155], v2, s[4:7], s30 offen offset:2048 sc1
  buffer_load_dwordx4 v[156:159], v2, s[4:7], s30 offen offset:3072 sc1
  s_add_u32 s30, s30, 4096
  buffer_load_dwordx4 v[160:163], v2, s[4:7], s30 offen offset:0 sc1
  buffer_load_dwordx4 v[164:167], v2, s[4:7], s30 offen offset:1024 sc1
  buffer_load_dwordx4 v[168:171], v2, s[4:7], s30 offen offset:2048 sc1
  buffer_load_dwordx4 v[172:175], v2, s[4:7], s30 offen offset:3072 sc1
  s_add_u32 s30, s30, 4096
  buffer_load_dwordx4 v[176:179], v2, s[4:7], s30 offen offset:0 sc1
  buffer_load_dwordx4 v[180:183], v2, s[4:7], s30 offen offset:1024 sc1
  buffer_load_dwordx4 v[184:187], v2, s[4:7], s30 offen offset:2048 sc1
  buffer_load_dwordx4 v[188:191], v2, s[4:7], s30 offen offset:3072 sc1
  s_add_u32 s29, s20, 1
  s_cmp_lt_u32 s27, s29
  s_cbranch_scc1 QL_19
  buffer_load_dwordx4 v[32:35], v28, s[4:7], s31 offen offset:0 sc1
  buffer_load_dwordx4 v[36:39], v28, s[4:7], s31 offen offset:256 sc1
  buffer_load_dwordx4 v[40:43], v28, s[4:7], s31 offen offset:512 sc1
  buffer_load_dwordx4 v[44:47], v28, s[4:7], s31 offen offset:768 sc1
  buffer_load_dwordx4 v[48:51], v28, s[4:7], s31 offen offset:1024 sc1
  buffer_load_dwordx4 v[52:55], v28, s[4:7], s31 offen offset:1280 sc1
  buffer_load_dwordx4 v[56:59], v28, s[4:7], s31 offen offset:1536 sc1
  buffer_load_dwordx4 v[60:63], v28, s[4:7], s31 offen offset:1792 sc1
  buffer_load_dwordx2 v[192:193], v29, s[4:7], s32 offen offset:0 sc1
  buffer_load_dwordx2 v[194:195], v29, s[4:7], s32 offen offset:512 sc1
  buffer_load_dwordx2 v[196:197], v29, s[4:7], s32 offen offset:1024 sc1
  buffer_load_dwordx2 v[198:199], v29, s[4:7], s32 offen offset:1536 sc1
  buffer_load_dwordx2 v[200:201], v29, s[4:7], s32 offen offset:2048 sc1
  buffer_load_dwordx2 v[202:203], v29, s[4:7], s32 offen offset:2560 sc1
  buffer_load_dwordx2 v[204:205], v29, s[4:7], s32 offen offset:3072 sc1
  buffer_load_dwordx2 v[206:207], v29, s[4:7], s32 offen offset:3584 sc1
  s_waitcnt vmcnt(31)
  v_mfma_f32_32x32x16_bf16 v[208:223], v[128:131], v[96:99], v[80:95]
  s_waitcnt vmcnt(30)
  v_mfma_f32_32x32x16_bf16 v[208:223], v[132:135], v[100:103], v[208:223]
  s_waitcnt vmcnt(29)
  v_mfma_f32_32x32x16_bf16 v[208:223], v[136:139], v[104:107], v[208:223]
  s_waitcnt vmcnt(28)
  v_mfma_f32_32x32x16_bf16 v[208:223], v[140:143], v[108:111], v[208:223]
  s_waitcnt vmcnt(27)
  v_mfma_f32_32x32x16_bf16 v[208:223], v[144:147], v[112:115], v[208:223]
  s_waitcnt vmcnt(26)
  v_mfma_f32_32x32x16_bf16 v[208:223], v[148:151], v[116:119], v[208:223]
  s_waitcnt vmcnt(25)
  v_mfma_f32_32x32x16_bf16 v[208:223], v[152:155], v[120:123], v[208:223]
  s_waitcnt vmcnt(24)
  v_mfma_f32_32x32x16_bf16 v[208:223], v[156:159], v[124:127], v[208:223]
  s_branch QJ_20
QL_19:
  s_waitcnt vmcnt(15)
  v_mfma_f32_32x32x16_bf16 v[208:223], v[128:131], v[96:99], v[80:95]
  s_waitcnt vmcnt(14)
  v_mfma_f32_32x32x16_bf16 v[208:223], v[132:135], v[100:103], v[208:223]
  s_waitcnt vmcnt(13)
  v_mfma_f32_32x32x16_bf16 v[208:223], v[136:139], v[104:107], v[208:223]
  s_waitcnt vmcnt(12)
  v_mfma_f32_32x32x16_bf16 v[208:223], v[140:143], v[108:111], v[208:223]
  s_waitcnt vmcnt(11)
  v_mfma_f32_32x32x16_bf16 v[208:223], v[144:147], v[112:115], v[208:223]
  s_waitcnt vmcnt(10)
  v_mfma_f32_32x32x16_bf16 v[208:223], v[148:151], v[116:119], v[208:223]
  s_waitcnt vmcnt(9)
  v_mfma_f32_32x32x16_bf16 v[208:223], v[152:155], v[120:123], v[208:223]
  s_waitcnt vmcnt(8)
  v_mfma_f32_32x32x16_bf16 v[208:223], v[156:159], v[124:127], v[208:223]
  s_cmp_ge_u32 s27, s29
  s_cbranch_scc1 PK_22
  s_mov_b32 s40, 0
  v_mov_b32 v240, 0
PG_21:
  buffer_load_dword v241, v240, s[4:7], s28 offen offset:0 sc1
  s_add_u32 s40, s40, 1
  s_cmp_gt_u32 s40, 400000
  s_cbranch_scc1 L_fail
  s_waitcnt vmcnt(0)
  v_readfirstlane_b32 s27, v241
  s_nop 0
  s_cmp_ge_u32 s27, s29
  s_cbranch_scc1 PK_22
  s_sleep 2
  s_branch PG_21
PK_22:
  buffer_load_dwordx4 v[32:35], v28, s[4:7], s31 offen offset:0 sc1
  buffer_load_dwordx4 v[36:39], v28, s[4:7], s31 offen offset:256 sc1
  buffer_load_dwordx4 v[40:43], v28, s[4:7], s31 offen offset:512 sc1
  buffer_load_dwordx4 v[44:47], v28, s[4:7], s31 offen offset:768 sc1
  buffer_load_dwordx4 v[48:51], v28, s[4:7], s31 offen offset:1024 sc1
  buffer_load_dwordx4 v[52:55], v28, s[4:7], s31 offen offset:1280 sc1
  buffer_load_dwordx4 v[56:59], v28, s[4:7], s31 offen offset:1536 sc1
  buffer_load_dwordx4 v[60:63], v28, s[4:7], s31 offen offset:1792 sc1
  buffer_load_dwordx2 v[192:193], v29, s[4:7], s32 offen offset:0 sc1
  buffer_load_dwordx2 v[194:195], v29, s[4:7], s32 offen offset:512 sc1
  buffer_load_dwordx2 v[196:197], v29, s[4:7], s32 offen offset:1024 sc1
  buffer_load_dwordx2 v[198:199], v29, s[4:7], s32 offen offset:1536 sc1
  buffer_load_dwordx2 v[200:201], v29, s[4:7], s32 offen offset:2048 sc1
  buffer_load_dwordx2 v[202:203], v29, s[4:7], s32 offen offset:2560 sc1
  buffer_load_dwordx2 v[204:205], v29, s[4:7], s32 offen offset:3072 sc1
  buffer_load_dwordx2 v[206:207], v29, s[4:7], s32 offen offset:3584 sc1
QJ_20:
  s_nop 10
  v_max3_f32 v240, v208, v209, v210
  v_max3_f32 v240, v240, v211, v212
  v_max3_f32 v240, v240, v213, v214
  v_max3_f32 v240, v240, v215, v216
  v_max3_f32 v240, v240, v217, v218
  v_max3_f32 v240, v240, v219, v220
  v_max3_f32 v240, v240, v221, v222
  v_max_f32 v240, v240, v223
  s_waitcnt vmcnt(15)
  v_mfma_f32_32x32x16_bf16 v[224:239], v[32:35], v[96:99], 0
  s_waitcnt vmcnt(14)
  v_mfma_f32_32x32x16_bf16 v[224:239], v[36:39], v[100:103], v[224:239]
  s_waitcnt vmcnt(13)
  v_mfma_f32_32x32x16_bf16 v[224:239], v[40:43], v[104:107], v[224:239]
  s_waitcnt vmcnt(12)
  v_mfma_f32_32x32x16_bf16 v[224:239], v[44:47], v[108:111], v[224:239]
  s_waitcnt vmcnt(11)
  v_mfma_f32_32x32x16_bf16 v[224:239], v[48:51], v[112:115], v[224:239]
  s_waitcnt vmcnt(10)
  v_mfma_f32_32x32x16_bf16 v[224:239], v[52:55], v[116:119], v[224:239]
  s_waitcnt vmcnt(9)
  v_mfma_f32_32x32x16_bf16 v[224:239], v[56:59], v[120:123], v[224:239]
  s_waitcnt vmcnt(8)
  v_mfma_f32_32x32x16_bf16 v[224:239], v[60:63], v[124:127], v[224:239]
  s_mov_b32 s36, 0x3e0293ee
  s_nop 10
  v_max3_f32 v240, v240, v224, v225
  v_max3_f32 v240, v240, v226, v227
  v_mov_b32 v241, v240
  s_nop 1
  v_permlane32_swap_b32 v240, v241
  v_max_f32 v240, v240, v241
  v_mul_f32 v240, s36, v240
  v_fma_f32 v208, v208, s36, -v240
  v_fma_f32 v209, v209, s36, -v240
  v_fma_f32 v210, v210, s36, -v240
  v_fma_f32 v211, v211, s36, -v240
  v_fma_f32 v212, v212, s36, -v240
  v_fma_f32 v213, v213, s36, -v240
  v_fma_f32 v214, v214, s36, -v240
  v_fma_f32 v215, v215, s36, -v240
  v_fma_f32 v216, v216, s36, -v240
  v_fma_f32 v217, v217, s36, -v240
  v_fma_f32 v218, v218, s36, -v240
  v_fma_f32 v219, v219, s36, -v240
  v_fma_f32 v220, v220, s36, -v240
  v_fma_f32 v221, v221, s36, -v240
  v_fma_f32 v222, v222, s36, -v240
  v_fma_f32 v223, v223, s36, -v240
  v_fma_f32 v224, v224, s36, -v240
  v_fma_f32 v225, v225, s36, -v240
  v_fma_f32 v226, v226, s36, -v240
  v_fma_f32 v227, v227, s36, -v240
  v_exp_f32 v208, v208
  v_exp_f32 v209, v209
  v_exp_f32 v210, v210
  v_exp_f32 v211, v211
  v_exp_f32 v212, v212
  v_exp_f32 v213, v213
  v_exp_f32 v214, v214
  v_exp_f32 v215, v215
  v_exp_f32 v216, v216
  v_exp_f32 v217, v217
  v_exp_f32 v218, v218
  v_exp_f32 v219, v219
  v_exp_f32 v220, v220
  v_exp_f32 v221, v221
  v_exp_f32 v222, v222
  v_exp_f32 v223, v223
  v_exp_f32 v224, v224
  v_exp_f32 v225, v225
  v_exp_f32 v226, v226
  v_exp_f32 v227, v227
  v_cvt_pk_bf16_f32 v128, v208, v209
  v_cvt_pk_bf16_f32 v129, v210, v211
  v_cvt_pk_bf16_f32 v130, v216, v217
  v_cvt_pk_bf16_f32 v131, v218, v219
  v_cvt_pk_bf16_f32 v132, v212, v213
  v_cvt_pk_bf16_f32 v133, v214, v215
  v_cvt_pk_bf16_f32 v134, v220, v221
  v_cvt_pk_bf16_f32 v135, v222, v223
  v_cvt_pk_bf16_f32 v136, v224, v225
  v_cvt_pk_bf16_f32 v137, v226, v227
  v_cvt_pk_bf16_f32 v138, v224, v225
  v_cvt_pk_bf16_f32 v139, v226, v227
  v_mfma_f32_32x32x16_bf16 a[0:15], v[160:163], v[128:131], 0
  v_mfma_f32_32x32x16_bf16 a[0:15], v[164:167], v[132:135], a[0:15]
  s_waitcnt vmcnt(6)
  v_mfma_f32_32x32x16_bf16 a[0:15], v[192:195], v[136:139], a[0:15]
  v_add_f32 v208, v208, v209
  v_add_f32 v208, v208, v210
  v_add_f32 v208, v208, v211
  v_add_f32 v208, v208, v212
  v_add_f32 v208, v208, v213
  v_add_f32 v208, v208, v214
  v_add_f32 v208, v208, v215
  v_add_f32 v208, v208, v216
  v_add_f32 v208, v208, v217
  v_mfma_f32_32x32x16_bf16 a[16:31], v[168:171], v[128:131], 0
  v_mfma_f32_32x32x16_bf16 a[16:31], v[172:175], v[132:135], a[16:31]
  s_waitcnt vmcnt(4)
  v_mfma_f32_32x32x16_bf16 a[16:31], v[196:199], v[136:139], a[16:31]
  v_add_f32 v208, v208, v218
  v_add_f32 v208, v208, v219
  v_add_f32 v208, v208, v220
  v_add_f32 v208, v208, v221
  v_add_f32 v208, v208, v222
  v_add_f32 v208, v208, v223
  v_add_f32 v208, v208, v224
  v_add_f32 v208, v208, v225
  v_add_f32 v208, v208, v226
  v_add_f32 v208, v208, v227
  v_mfma_f32_32x32x16_bf16 a[32:47], v[176:179], v[128:131], 0
  v_mfma_f32_32x32x16_bf16 a[32:47], v[180:183], v[132:135], a[32:47]
  s_waitcnt vmcnt(2)
  v_mfma_f32_32x32x16_bf16 a[32:47], v[200:203], v[136:139], a[32:47]
  v_mfma_f32_32x32x16_bf16 a[48:63], v[184:187], v[128:131], 0
  v_mfma_f32_32x32x16_bf16 a[48:63], v[188:191], v[132:135], a[48:63]
  s_waitcnt vmcnt(0)
  v_mfma_f32_32x32x16_bf16 a[48:63], v[204:207], v[136:139], a[48:63]
  v_mov_b32 v241, v208
  s_nop 1
  v_permlane32_swap_b32 v208, v241
  v_add_f32 v208, v208, v241
  v_rcp_f32 v240, v208
  s_add_u32 s36, s33, 4096
  v_accvgpr_read_b32 v208, a0
  v_accvgpr_read_b32 v209, a1
  v_accvgpr_read_b32 v210, a2
  v_accvgpr_read_b32 v211, a3
  v_accvgpr_read_b32 v212, a4
  v_accvgpr_read_b32 v213, a5
  v_accvgpr_read_b32 v214, a6
  v_accvgpr_read_b32 v215, a7
  v_accvgpr_read_b32 v216, a8
  v_accvgpr_read_b32 v217, a9
  v_accvgpr_read_b32 v218, a10
  v_accvgpr_read_b32 v219, a11
  v_accvgpr_read_b32 v220, a12
  v_accvgpr_read_b32 v221, a13
  v_accvgpr_read_b32 v222, a14
  v_accvgpr_read_b32 v223, a15
  v_mul_f32 v208, v240, v208
  v_mul_f32 v209, v240, v209
  v_mul_f32 v210, v240, v210
  v_mul_f32 v211, v240, v211
  v_mul_f32 v212, v240, v212
  v_mul_f32 v213, v240, v213
  v_mul_f32 v214, v240, v214
  v_mul_f32 v215, v240, v215
  v_mul_f32 v216, v240, v216
  v_mul_f32 v217, v240, v217
  v_mul_f32 v218, v240, v218
  v_mul_f32 v219, v240, v219
  v_mul_f32 v220, v240, v220
  v_mul_f32 v221, v240, v221
  v_mul_f32 v222, v240, v222
  v_mul_f32 v223, v240, v223
  v_cvt_pk_bf16_f32 v96, v208, v209
  v_cvt_pk_bf16_f32 v97, v210, v211
  v_cvt_pk_bf16_f32 v98, v216, v217
  v_cvt_pk_bf16_f32 v99, v218, v219
  buffer_store_dwordx4 v[96:99], v2, s[4:7], s33 offen offset:0 sc1
  v_cvt_pk_bf16_f32 v100, v212, v213
  v_cvt_pk_bf16_f32 v101, v214, v215
  v_cvt_pk_bf16_f32 v102, v220, v221
  v_cvt_pk_bf16_f32 v103, v222, v223
  buffer_store_dwordx4 v[100:103], v2, s[4:7], s33 offen offset:1024 sc1
  v_accvgpr_read_b32 v208, a16
  v_accvgpr_read_b32 v209, a17
  v_accvgpr_read_b32 v210, a18
  v_accvgpr_read_b32 v211, a19
  v_accvgpr_read_b32 v212, a20
  v_accvgpr_read_b32 v213, a21
  v_accvgpr_read_b32 v214, a22
  v_accvgpr_read_b32 v215, a23
  v_accvgpr_read_b32 v216, a24
  v_accvgpr_read_b32 v217, a25
  v_accvgpr_read_b32 v218, a26
  v_accvgpr_read_b32 v219, a27
  v_accvgpr_read_b32 v220, a28
  v_accvgpr_read_b32 v221, a29
  v_accvgpr_read_b32 v222, a30
  v_accvgpr_read_b32 v223, a31
  v_mul_f32 v208, v240, v208
  v_mul_f32 v209, v240, v209
  v_mul_f32 v210, v240, v210
  v_mul_f32 v211, v240, v211
  v_mul_f32 v212, v240, v212
  v_mul_f32 v213, v240, v213
  v_mul_f32 v214, v240, v214
  v_mul_f32 v215, v240, v215
  v_mul_f32 v216, v240, v216
  v_mul_f32 v217, v240, v217
  v_mul_f32 v218, v240, v218
  v_mul_f32 v219, v240, v219
  v_mul_f32 v220, v240, v220
  v_mul_f32 v221, v240, v221
  v_mul_f32 v222, v240, v222
  v_mul_f32 v223, v240, v223
  v_cvt_pk_bf16_f32 v104, v208, v209
  v_cvt_pk_bf16_f32 v105, v210, v211
  v_cvt_pk_bf16_f32 v106, v216, v217
  v_cvt_pk_bf16_f32 v107, v218, v219
  buffer_store_dwordx4 v[104:107], v2, s[4:7], s33 offen offset:2048 sc1
  v_cvt_pk_bf16_f32 v108, v212, v213
  v_cvt_pk_bf16_f32 v109, v214, v215
  v_cvt_pk_bf16_f32 v110, v220, v221
  v_cvt_pk_bf16_f32 v111, v222, v223
  buffer_store_dwordx4 v[108:111], v2, s[4:7], s33 offen offset:3072 sc1
  v_accvgpr_read_b32 v208, a32
  v_accvgpr_read_b32 v209, a33
  v_accvgpr_read_b32 v210, a34
  v_accvgpr_read_b32 v211, a35
  v_accvgpr_read_b32 v212, a36
  v_accvgpr_read_b32 v213, a37
  v_accvgpr_read_b32 v214, a38
  v_accvgpr_read_b32 v215, a39
  v_accvgpr_read_b32 v216, a40
  v_accvgpr_read_b32 v217, a41
  v_accvgpr_read_b32 v218, a42
  v_accvgpr_read_b32 v219, a43
  v_accvgpr_read_b32 v220, a44
  v_accvgpr_read_b32 v221, a45
  v_accvgpr_read_b32 v222, a46
  v_accvgpr_read_b32 v223, a47
  v_mul_f32 v208, v240, v208
  v_mul_f32 v209, v240, v209
  v_mul_f32 v210, v240, v210
  v_mul_f32 v211, v240, v211
  v_mul_f32 v212, v240, v212
  v_mul_f32 v213, v240, v213
  v_mul_f32 v214, v240, v214
  v_mul_f32 v215, v240, v215
  v_mul_f32 v216, v240, v216
  v_mul_f32 v217, v240, v217
  v_mul_f32 v218, v240, v218
  v_mul_f32 v219, v240, v219
  v_mul_f32 v220, v240, v220
  v_mul_f32 v221, v240, v221
  v_mul_f32 v222, v240, v222
  v_mul_f32 v223, v240, v223
  v_cvt_pk_bf16_f32 v112, v208, v209
  v_cvt_pk_bf16_f32 v113, v210, v211
  v_cvt_pk_bf16_f32 v114, v216, v217
  v_cvt_pk_bf16_f32 v115, v218, v219
  buffer_store_dwordx4 v[112:115], v2, s[4:7], s36 offen offset:0 sc1
  v_cvt_pk_bf16_f32 v116, v212, v213
  v_cvt_pk_bf16_f32 v117, v214, v215
  v_cvt_pk_bf16_f32 v118, v220, v221
  v_cvt_pk_bf16_f32 v119, v222, v223
  buffer_store_dwordx4 v[116:119], v2, s[4:7], s36 offen offset:1024 sc1
  v_accvgpr_read_b32 v208, a48
  v_accvgpr_read_b32 v209, a49
  v_accvgpr_read_b32 v210, a50
  v_accvgpr_read_b32 v211, a51
  v_accvgpr_read_b32 v212, a52
  v_accvgpr_read_b32 v213, a53
  v_accvgpr_read_b32 v214, a54
  v_accvgpr_read_b32 v215, a55
  v_accvgpr_read_b32 v216, a56
  v_accvgpr_read_b32 v217, a57
  v_accvgpr_read_b32 v218, a58
  v_accvgpr_read_b32 v219, a59
  v_accvgpr_read_b32 v220, a60
  v_accvgpr_read_b32 v221, a61
  v_accvgpr_read_b32 v222, a62
  v_accvgpr_read_b32 v223, a63
  v_mul_f32 v208, v240, v208
  v_mul_f32 v209, v240, v209
  v_mul_f32 v210, v240, v210
  v_mul_f32 v211, v240, v211
  v_mul_f32 v212, v240, v212
  v_mul_f32 v213, v240, v213
  v_mul_f32 v214, v240, v214
  v_mul_f32 v215, v240, v215
  v_mul_f32 v216, v240, v216
  v_mul_f32 v217, v240, v217
  v_mul_f32 v218, v240, v218
  v_mul_f32 v219, v240, v219
  v_mul_f32 v220, v240, v220
  v_mul_f32 v221, v240, v221
  v_mul_f32 v222, v240, v222
  v_mul_f32 v223, v240, v223
  v_cvt_pk_bf16_f32 v120, v208, v209
  v_cvt_pk_bf16_f32 v121, v210, v211
  v_cvt_pk_bf16_f32 v122, v216, v217
  v_cvt_pk_bf16_f32 v123, v218, v219
  buffer_store_dwordx4 v[120:123], v2, s[4:7], s36 offen offset:2048 sc1
  v_cvt_pk_bf16_f32 v124, v212, v213
  v_cvt_pk_bf16_f32 v125, v214, v215
  v_cvt_pk_bf16_f32 v126, v220, v221
  v_cvt_pk_bf16_f32 v127, v222, v223
  buffer_store_dwordx4 v[124:127], v2, s[4:7], s36 offen offset:3072 sc1
  s_lshl_b32 s36, s24, 2
  s_add_u32 s36, s36, 937984
  v_mov_b32 v8, 0
  v_mov_b32 v9, 1
  s_add_u32 s23, s23, 1
  s_waitcnt vmcnt(0)
  buffer_store_dword v9, v8, s[4:7], s36 offen sc1
  s_add_u32 s20, s20, 4
  s_cmp_lt_u32 s20, 64
  s_cbranch_scc1 SEG_16
  s_branch L_end
L_blk_O:
L_op:
  s_load_dwordx2 s[4:5], s[0:1], 112
  s_load_dwordx2 s[8:9], s[0:1], 80
  s_load_dwordx2 s[16:17], s[0:1], 96
  s_load_dwordx2 s[66:67], s[0:1], 104
  v_and_b32 v1, 63, v0
  v_lshlrev_b32 v2, 4, v1
  v_and_b32 v3, 31, v1
  s_waitcnt vmcnt(0)
  v_lshrrev_b32 v4, 5, v1
  v_bfe_u32 v5, v1, 4, 1
  v_bfe_u32 v6, v1, 2, 2
  v_and_b32 v7, 3, v1
  s_cmp_ge_u32 s12, 36
  s_cselect_b32 s31, 1, 0
  s_cselect_b32 s36, 36, 0
  s_sub_u32 s12, s12, s36
  s_cmp_ge_u32 s12, 18
  s_cselect_b32 s20, 1, 0
  s_mul_i32 s36, s20, 18
  s_sub_u32 s21, s12, s36
  v_lshrrev_b32 v8, 2, v1
  v_mul_u32_u24 v8, 1152, v8
  v_lshl_add_u32 v8, v7, 4, v8
  s_lshl_b32 s36, s21, 6
  v_add_u32 v8, s36, v8
  s_mul_i32 s24, s13, 32768
  v_lshrrev_b32 v15, 4, v1
  v_lshl_add_u32 v9, v15, 2, v6
  v_lshlrev_b32 v9, 6, v9
  v_lshl_add_u32 v9, v7, 3, v9
  v_add_u32 v9, s24, v9
  s_waitcnt lgkmcnt(0)
  s_mov_b32 s6, 268435456
  s_mov_b32 s7, 0x20000
  s_mov_b32 s10, 4718592
  s_mov_b32 s11, 0x20000
  s_mov_b32 s18, 4718592
  s_mov_b32 s19, 0x20000
  s_mul_i32 s23, s13, 1179648
  s_add_u32 m0, s24, 0
  s_nop 0
  buffer_load_dwordx4 v8, s[8:11], s23 offen lds
  s_add_u32 s23, s23, 18432
  s_add_u32 m0, s24, 1024
  s_nop 0
  buffer_load_dwordx4 v8, s[8:11], s23 offen lds
  s_add_u32 s23, s23, 18432
  s_add_u32 m0, s24, 2048
  s_nop 0
  buffer_load_dwordx4 v8, s[8:11], s23 offen lds
  s_add_u32 s23, s23, 18432
  s_add_u32 m0, s24, 3072
  s_nop 0
  buffer_load_dwordx4 v8, s[8:11], s23 offen lds
  s_add_u32 s23, s23, 18432
  s_add_u32 m0, s24, 4096
  s_nop 0
  buffer_load_dwordx4 v8, s[8:11], s23 offen lds
  s_add_u32 s23, s23, 18432
  s_add_u32 m0, s24, 5120
  s_nop 0
  buffer_load_dwordx4 v8, s[8:11], s23 offen lds
  s_add_u32 s23, s23, 18432
  s_add_u32 m0, s24, 6144
  s_nop 0
  buffer_load_dwordx4 v8, s[8:11], s23 offen lds
  s_add_u32 s23, s23, 18432
  s_add_u32 m0, s24, 7168
  s_nop 0
  buffer_load_dwordx4 v8, s[8:11], s23 offen lds
  s_add_u32 s23, s23, 18432
  s_add_u32 m0, s24, 8192
  s_nop 0
  buffer_load_dwordx4 v8, s[8:11], s23 offen lds
  s_add_u32 s23, s23, 18432
  s_add_u32 m0, s24, 9216
  s_nop 0
  buffer_load_dwordx4 v8, s[8:11], s23 offen lds
  s_add_u32 s23, s23, 18432
  s_add_u32 m0, s24, 10240
  s_nop 0
  buffer_load_dwordx4 v8, s[8:11], s23 offen lds
  s_add_u32 s23, s23, 18432
  s_add_u32 m0, s24, 11264
  s_nop 0
  buffer_load_dwordx4 v8, s[8:11], s23 offen lds
  s_add_u32 s23, s23, 18432
  s_add_u32 m0, s24, 12288
  s_nop 0
  buffer_load_dwordx4 v8, s[8:11], s23 offen lds
  s_add_u32 s23, s23, 18432
  s_add_u32 m0, s24, 13312
  s_nop 0
  buffer_load_dwordx4 v8, s[8:11], s23 offen lds
  s_add_u32 s23, s23, 18432
  s_add_u32 m0, s24, 14336
  s_nop 0
  buffer_load_dwordx4 v8, s[8:11], s23 offen lds
  s_add_u32 s23, s23, 18432
  s_add_u32 m0, s24, 15360
  s_nop 0
  buffer_load_dwordx4 v8, s[8:11], s23 offen lds
  s_add_u32 s23, s23, 18432
  s_add_u32 m0, s24, 16384
  s_nop 0
  buffer_load_dwordx4 v8, s[8:11], s23 offen lds
  s_add_u32 s23, s23, 18432
  s_add_u32 m0, s24, 17408
  s_nop 0
  buffer_load_dwordx4 v8, s[8:11], s23 offen lds
  s_add_u32 s23, s23, 18432
  s_add_u32 m0, s24, 18432
  s_nop 0
  buffer_load_dwordx4 v8, s[8:11], s23 offen lds
  s_add_u32 s23, s23, 18432
  s_add_u32 m0, s24, 19456
  s_nop 0
  buffer_load_dwordx4 v8, s[8:11], s23 offen lds
  s_add_u32 s23, s23, 18432
  s_add_u32 m0, s24, 20480
  s_nop 0
  buffer_load_dwordx4 v8, s[8:11], s23 offen lds
  s_add_u32 s23, s23, 18432
  s_add_u32 m0, s24, 21504
  s_nop 0
  buffer_load_dwordx4 v8, s[8:11], s23 offen lds
  s_add_u32 s23, s23, 18432
  s_add_u32 m0, s24, 22528
  s_nop 0
  buffer_load_dwordx4 v8, s[8:11], s23 offen lds
  s_add_u32 s23, s23, 18432
  s_add_u32 m0, s24, 23552
  s_nop 0
  buffer_load_dwordx4 v8, s[8:11], s23 offen lds
  s_add_u32 s23, s23, 18432
  s_add_u32 m0, s24, 24576
  s_nop 0
  buffer_load_dwordx4 v8, s[8:11], s23 offen lds
  s_add_u32 s23, s23, 18432
  s_add_u32 m0, s24, 25600
  s_nop 0
  buffer_load_dwordx4 v8, s[8:11], s23 offen lds
  s_add_u32 s23, s23, 18432
  s_add_u32 m0, s24, 26624
  s_nop 0
  buffer_load_dwordx4 v8, s[8:11], s23 offen lds
  s_add_u32 s23, s23, 18432
  s_add_u32 m0, s24, 27648
  s_nop 0
  buffer_load_dwordx4 v8, s[8:11], s23 offen lds
  s_add_u32 s23, s23, 18432
  s_add_u32 m0, s24, 28672
  s_nop 0
  buffer_load_dwordx4 v8, s[8:11], s23 offen lds
  s_add_u32 s23, s23, 18432
  s_add_u32 m0, s24, 29696
  s_nop 0
  buffer_load_dwordx4 v8, s[8:11], s23 offen lds
  s_add_u32 s23, s23, 18432
  s_add_u32 m0, s24, 30720
  s_nop 0
  buffer_load_dwordx4 v8, s[8:11], s23 offen lds
  s_add_u32 s23, s23, 18432
  s_add_u32 m0, s24, 31744
  s_nop 0
  buffer_load_dwordx4 v8, s[8:11], s23 offen lds
  s_add_u32 s23, s23, 18432
  s_waitcnt vmcnt(24)
  ds_read_b64_tr_b16 a[0:1], v9 offset:0
  ds_read_b64_tr_b16 a[2:3], v9 offset:1024
  ds_read_b64_tr_b16 a[4:5], v9 offset:32
  ds_read_b64_tr_b16 a[6:7], v9 offset:1056
  ds_read_b64_tr_b16 a[8:9], v9 offset:2048
  ds_read_b64_tr_b16 a[10:11], v9 offset:3072
  ds_read_b64_tr_b16 a[12:13], v9 offset:2080
  ds_read_b64_tr_b16 a[14:15], v9 offset:3104
  ds_read_b64_tr_b16 a[16:17], v9 offset:4096
  ds_read_b64_tr_b16 a[18:19], v9 offset:5120
  ds_read_b64_tr_b16 a[20:21], v9 offset:4128
  ds_read_b64_tr_b16 a[22:23], v9 offset:5152
  ds_read_b64_tr_b16 a[24:25], v9 offset:6144
  ds_read_b64_tr_b16 a[26:27], v9 offset:7168
  ds_read_b64_tr_b16 a[28:29], v9 offset:6176
  ds_read_b64_tr_b16 a[30:31], v9 offset:7200
  s_waitcnt lgkmcnt(0)
  s_add_u32 m0, s24, 0
  s_nop 0
  buffer_load_dwordx4 v8, s[8:11], s23 offen lds
  s_add_u32 s23, s23, 18432
  s_add_u32 m0, s24, 1024
  s_nop 0
  buffer_load_dwordx4 v8, s[8:11], s23 offen lds
  s_add_u32 s23, s23, 18432
  s_add_u32 m0, s24, 2048
  s_nop 0
  buffer_load_dwordx4 v8, s[8:11], s23 offen lds
  s_add_u32 s23, s23, 18432
  s_add_u32 m0, s24, 3072
  s_nop 0
  buffer_load_dwordx4 v8, s[8:11], s23 offen lds
  s_add_u32 s23, s23, 18432
  s_add_u32 m0, s24, 4096
  s_nop 0
  buffer_load_dwordx4 v8, s[8:11], s23 offen lds
  s_add_u32 s23, s23, 18432
  s_add_u32 m0, s24, 5120
  s_nop 0
  buffer_load_dwordx4 v8, s[8:11], s23 offen lds
  s_add_u32 s23, s23, 18432
  s_add_u32 m0, s24, 6144
  s_nop 0
  buffer_load_dwordx4 v8, s[8:11], s23 offen lds
  s_add_u32 s23, s23, 18432
  s_add_u32 m0, s24, 7168
  s_nop 0
  buffer_load_dwordx4 v8, s[8:11], s23 offen lds
  s_add_u32 s23, s23, 18432
  s_waitcnt vmcnt(24)
  ds_read_b64_tr_b16 a[32:33], v9 offset:8192
  ds_read_b64_tr_b16 a[34:35], v9 offset:9216
  ds_read_b64_tr_b16 a[36:37], v9 offset:8224
  ds_read_b64_tr_b16 a[38:39], v9 offset:9248
  ds_read_b64_tr_b16 a[40:41], v9 offset:10240
  ds_read_b64_tr_b16 a[42:43], v9 offset:11264
  ds_read_b64_tr_b16 a[44:45], v9 offset:10272
  ds_read_b64_tr_b16 a[46:47], v9 offset:11296
  ds_read_b64_tr_b16 a[48:49], v9 offset:12288
  ds_read_b64_tr_b16 a[50:51], v9 offset:13312
  ds_read_b64_tr_b16 a[52:53], v9 offset:12320
  ds_read_b64_tr_b16 a[54:55], v9 offset:13344
  ds_read_b64_tr_b16 a[56:57], v9 offset:14336
  ds_read_b64_tr_b16 a[58:59], v9 offset:15360
  ds_read_b64_tr_b16 a[60:61], v9 offset:14368
  ds_read_b64_tr_b16 a[62:63], v9 offset:15392
  s_waitcnt lgkmcnt(0)
  s_add_u32 m0, s24, 8192
  s_nop 0
  buffer_load_dwordx4 v8, s[8:11], s23 offen lds
  s_add_u32 s23, s23, 18432
  s_add_u32 m0, s24, 9216
  s_nop 0
  buffer_load_dwordx4 v8, s[8:11], s23 offen lds
  s_add_u32 s23, s23, 18432
  s_add_u32 m0, s24, 10240
  s_nop 0
  buffer_load_dwordx4 v8, s[8:11], s23 offen lds
  s_add_u32 s23, s23, 18432
  s_add_u32 m0, s24, 11264
  s_nop 0
  buffer_load_dwordx4 v8, s[8:11], s23 offen lds
  s_add_u32 s23, s23, 18432
  s_add_u32 m0, s24, 12288
  s_nop 0
  buffer_load_dwordx4 v8, s[8:11], s23 offen lds
  s_add_u32 s23, s23, 18432
  s_add_u32 m0, s24, 13312
  s_nop 0
  buffer_load_dwordx4 v8, s[8:11], s23 offen lds
  s_add_u32 s23, s23, 18432
  s_add_u32 m0, s24, 14336
  s_nop 0
  buffer_load_dwordx4 v8, s[8:11], s23 offen lds
  s_add_u32 s23, s23, 18432
  s_add_u32 m0, s24, 15360
  s_nop 0
  buffer_load_dwordx4 v8, s[8:11], s23 offen lds
  s_add_u32 s23, s23, 18432
  s_waitcnt vmcnt(24)
  ds_read_b64_tr_b16 a[64:65], v9 offset:16384
  ds_read_b64_tr_b16 a[66:67], v9 offset:17408
  ds_read_b64_tr_b16 a[68:69], v9 offset:16416
  ds_read_b64_tr_b16 a[70:71], v9 offset:17440
  ds_read_b64_tr_b16 a[72:73], v9 offset:18432
  ds_read_b64_tr_b16 a[74:75], v9 offset:19456
  ds_read_b64_tr_b16 a[76:77], v9 offset:18464
  ds_read_b64_tr_b16 a[78:79], v9 offset:19488
  ds_read_b64_tr_b16 a[80:81], v9 offset:20480
  ds_read_b64_tr_b16 a[82:83], v9 offset:21504
  ds_read_b64_tr_b16 a[84:85], v9 offset:20512
  ds_read_b64_tr_b16 a[86:87], v9 offset:21536
  ds_read_b64_tr_b16 a[88:89], v9 offset:22528
  ds_read_b64_tr_b16 a[90:91], v9 offset:23552
  ds_read_b64_tr_b16 a[92:93], v9 offset:22560
  ds_read_b64_tr_b16 a[94:95], v9 offset:23584
  s_waitcnt lgkmcnt(0)
  s_add_u32 m0, s24, 16384
  s_nop 0
  buffer_load_dwordx4 v8, s[8:11], s23 offen lds
  s_add_u32 s23, s23, 18432
  s_add_u32 m0, s24, 17408
  s_nop 0
  buffer_load_dwordx4 v8, s[8:11], s23 offen lds
  s_add_u32 s23, s23, 18432
  s_add_u32 m0, s24, 18432
  s_nop 0
  buffer_load_dwordx4 v8, s[8:11], s23 offen lds
  s_add_u32 s23, s23, 18432
  s_add_u32 m0, s24, 19456
  s_nop 0
  buffer_load_dwordx4 v8, s[8:11], s23 offen lds
  s_add_u32 s23, s23, 18432
  s_add_u32 m0, s24, 20480
  s_nop 0
  buffer_load_dwordx4 v8, s[8:11], s23 offen lds
  s_add_u32 s23, s23, 18432
  s_add_u32 m0, s24, 21504
  s_nop 0
  buffer_load_dwordx4 v8, s[8:11], s23 offen lds
  s_add_u32 s23, s23, 18432
  s_add_u32 m0, s24, 22528
  s_nop 0
  buffer_load_dwordx4 v8, s[8:11], s23 offen lds
  s_add_u32 s23, s23, 18432
  s_add_u32 m0, s24, 23552
  s_nop 0
  buffer_load_dwordx4 v8, s[8:11], s23 offen lds
  s_add_u32 s23, s23, 18432
  s_waitcnt vmcnt(24)
  ds_read_b64_tr_b16 a[96:97], v9 offset:24576
  ds_read_b64_tr_b16 a[98:99], v9 offset:25600
  ds_read_b64_tr_b16 a[100:101], v9 offset:24608
  ds_read_b64_tr_b16 a[102:103], v9 offset:25632
  ds_read_b64_tr_b16 a[104:105], v9 offset:26624
  ds_read_b64_tr_b16 a[106:107], v9 offset:27648
  ds_read_b64_tr_b16 a[108:109], v9 offset:26656
  ds_read_b64_tr_b16 a[110:111], v9 offset:27680
  ds_read_b64_tr_b16 a[112:113], v9 offset:28672
  ds_read_b64_tr_b16 a[114:115], v9 offset:29696
  ds_read_b64_tr_b16 a[116:117], v9 offset:28704
  ds_read_b64_tr_b16 a[118:119], v9 offset:29728
  ds_read_b64_tr_b16 a[120:121], v9 offset:30720
  ds_read_b64_tr_b16 a[122:123], v9 offset:31744
  ds_read_b64_tr_b16 a[124:125], v9 offset:30752
  ds_read_b64_tr_b16 a[126:127], v9 offset:31776
  s_waitcnt lgkmcnt(0)
  s_add_u32 m0, s24, 24576
  s_nop 0
  buffer_load_dwordx4 v8, s[8:11], s23 offen lds
  s_add_u32 s23, s23, 18432
  s_add_u32 m0, s24, 25600
  s_nop 0
  buffer_load_dwordx4 v8, s[8:11], s23 offen lds
  s_add_u32 s23, s23, 18432
  s_add_u32 m0, s24, 26624
  s_nop 0
  buffer_load_dwordx4 v8, s[8:11], s23 offen lds
  s_add_u32 s23, s23, 18432
  s_add_u32 m0, s24, 27648
  s_nop 0
  buffer_load_dwordx4 v8, s[8:11], s23 offen lds
  s_add_u32 s23, s23, 18432
  s_add_u32 m0, s24, 28672
  s_nop 0
  buffer_load_dwordx4 v8, s[8:11], s23 offen lds
  s_add_u32 s23, s23, 18432
  s_add_u32 m0, s24, 29696
  s_nop 0
  buffer_load_dwordx4 v8, s[8:11], s23 offen lds
  s_add_u32 s23, s23, 18432
  s_add_u32 m0, s24, 30720
  s_nop 0
  buffer_load_dwordx4 v8, s[8:11], s23 offen lds
  s_add_u32 s23, s23, 18432
  s_add_u32 m0, s24, 31744
  s_nop 0
  buffer_load_dwordx4 v8, s[8:11], s23 offen lds
  s_add_u32 s23, s23, 18432
  s_waitcnt vmcnt(24)
  ds_read_b64_tr_b16 a[128:129], v9 offset:0
  ds_read_b64_tr_b16 a[130:131], v9 offset:1024
  ds_read_b64_tr_b16 a[132:133], v9 offset:32
  ds_read_b64_tr_b16 a[134:135], v9 offset:1056
  ds_read_b64_tr_b16 a[136:137], v9 offset:2048
  ds_read_b64_tr_b16 a[138:139], v9 offset:3072
  ds_read_b64_tr_b16 a[140:141], v9 offset:2080
  ds_read_b64_tr_b16 a[142:143], v9 offset:3104
  ds_read_b64_tr_b16 a[144:145], v9 offset:4096
  ds_read_b64_tr_b16 a[146:147], v9 offset:5120
  ds_read_b64_tr_b16 a[148:149], v9 offset:4128
  ds_read_b64_tr_b16 a[150:151], v9 offset:5152
  ds_read_b64_tr_b16 a[152:153], v9 offset:6144
  ds_read_b64_tr_b16 a[154:155], v9 offset:7168
  ds_read_b64_tr_b16 a[156:157], v9 offset:6176
  ds_read_b64_tr_b16 a[158:159], v9 offset:7200
  s_waitcnt vmcnt(16)
  ds_read_b64_tr_b16 a[160:161], v9 offset:8192
  ds_read_b64_tr_b16 a[162:163], v9 offset:9216
  ds_read_b64_tr_b16 a[164:165], v9 offset:8224
  ds_read_b64_tr_b16 a[166:167], v9 offset:9248
  ds_read_b64_tr_b16 a[168:169], v9 offset:10240
  ds_read_b64_tr_b16 a[170:171], v9 offset:11264
  ds_read_b64_tr_b16 a[172:173], v9 offset:10272
  ds_read_b64_tr_b16 a[174:175], v9 offset:11296
  ds_read_b64_tr_b16 a[176:177], v9 offset:12288
  ds_read_b64_tr_b16 a[178:179], v9 offset:13312
  ds_read_b64_tr_b16 a[180:181], v9 offset:12320
  ds_read_b64_tr_b16 a[182:183], v9 offset:13344
  ds_read_b64_tr_b16 a[184:185], v9 offset:14336
  ds_read_b64_tr_b16 a[186:187], v9 offset:15360
  ds_read_b64_tr_b16 a[188:189], v9 offset:14368
  ds_read_b64_tr_b16 a[190:191], v9 offset:15392
  s_waitcnt vmcnt(8)
  ds_read_b64_tr_b16 a[192:193], v9 offset:16384
  ds_read_b64_tr_b16 a[194:195], v9 offset:17408
  ds_read_b64_tr_b16 a[196:197], v9 offset:16416
  ds_read_b64_tr_b16 a[198:199], v9 offset:17440
  ds_read_b64_tr_b16 a[200:201], v9 offset:18432
  ds_read_b64_tr_b16 a[202:203], v9 offset:19456
  ds_read_b64_tr_b16 a[204:205], v9 offset:18464
  ds_read_b64_tr_b16 a[206:207], v9 offset:19488
  ds_read_b64_tr_b16 a[208:209], v9 offset:20480
  ds_read_b64_tr_b16 a[210:211], v9 offset:21504
  ds_read_b64_tr_b16 a[212:213], v9 offset:20512
  ds_read_b64_tr_b16 a[214:215], v9 offset:21536
  ds_read_b64_tr_b16 a[216:217], v9 offset:22528
  ds_read_b64_tr_b16 a[218:219], v9 offset:23552
  ds_read_b64_tr_b16 a[220:221], v9 offset:22560
  ds_read_b64_tr_b16 a[222:223], v9 offset:23584
  s_waitcnt vmcnt(0)
  ds_read_b64_tr_b16 a[224:225], v9 offset:24576
  ds_read_b64_tr_b16 a[226:227], v9 offset:25600
  ds_read_b64_tr_b16 a[228:229], v9 offset:24608
  ds_read_b64_tr_b16 a[230:231], v9 offset:25632
  ds_read_b64_tr_b16 a[232:233], v9 offset:26624
  ds_read_b64_tr_b16 a[234:235], v9 offset:27648
  ds_read_b64_tr_b16 a[236:237], v9 offset:26656
  ds_read_b64_tr_b16 a[238:239], v9 offset:27680
  ds_read_b64_tr_b16 a[240:241], v9 offset:28672
  ds_read_b64_tr_b16 a[242:243], v9 offset:29696
  ds_read_b64_tr_b16 a[244:245], v9 offset:28704
  ds_read_b64_tr_b16 a[246:247], v9 offset:29728
  ds_read_b64_tr_b16 a[248:249], v9 offset:30720
  ds_read_b64_tr_b16 a[250:251], v9 offset:31744
  ds_read_b64_tr_b16 a[252:253], v9 offset:30752
  ds_read_b64_tr_b16 a[254:255], v9 offset:31776
  v_and_b32 v14, 15, v1
  s_lshl_b32 s36, s20, 8
  v_lshlrev_b32 v28, 9, v15
  v_lshl_add_u32 v28, v14, 4, v28
  v_add_u32 v28, s36, v28
  s_lshl_b32 s36, s13, 11
  v_add_u32 v11, s36, v2
  s_lshl_b32 s36, s13, 9
  v_lshlrev_b32 v12, 3, v1
  v_add_u32 v12, s36, v12
  v_bfe_u32 v10, v1, 1, 4
  v_mul_u32_u24 v10, 2304, v10
  v_lshl_add_u32 v10, v4, 3, v10
  v_and_b32 v14, 1, v1
  v_lshl_add_u32 v10, v14, 2, v10
  s_lshl_b32 s36, s21, 6
  s_lshl_b32 s37, s13, 4
  s_add_u32 s36, s36, s37
  s_mul_i32 s37, s20, 36864
  s_add_u32 s36, s36, s37
  s_add_u32 s36, s36, 1152
  v_add_u32 v10, s36, v10
  v_and_b32 v13, 7, v1
  v_lshlrev_b32 v13, 2, v13
  s_lshl_b32 s36, s13, 5
  v_add_u32 v13, s36, v13
  s_mul_i32 s22, s31, 1
  s_mov_b32 s40, 0
  v_mov_b32 v8, 0
WI_23:
  global_load_dword v9, v8, s[66:67] offset:192 sc1
  s_add_u32 s40, s40, 1
  s_cmp_gt_u32 s40, 400000
  s_cbranch_scc1 L_fail
  s_waitcnt vmcnt(0)
  v_readfirstlane_b32 s37, v9
  s_nop 0
  s_cmp_lt_u32 s37, 8
  s_cbranch_scc1 WI_23
  s_waitcnt lgkmcnt(0)
  s_barrier
OSEG_24:
  s_cmp_ge_u32 s22, 0
  s_cselect_b32 s27, 2, 1
  s_add_u32 s27, s27, s22
  s_lshl_b32 s26, s22, 7
  s_add_u32 s26, s26, 937984
  s_lshl_b32 s29, s27, 7
  s_add_u32 s29, s29, 937984
  s_lshl_b32 s23, s22, 18
  s_lshl_b32 s36, s13, 16
  s_add_u32 s23, s23, s36
  s_add_u32 s23, s23, 50331648
  s_mov_b32 s40, 0
OP_25:
  buffer_load_dword v14, v13, s[4:7], s26 offen sc1
  buffer_load_dword v15, v13, s[4:7], s29 offen sc1
  s_add_u32 s40, s40, 1
  s_cmp_gt_u32 s40, 400000
  s_cbranch_scc1 L_fail
  s_waitcnt vmcnt(1)
  v_cmp_eq_u32 vcc, 0, v14
  s_cbranch_vccz OK_26
  s_sleep 1
  s_branch OP_25
OK_26:
  buffer_load_dwordx4 v[32:35], v28, s[4:7], s23 offen offset:0 sc1
  buffer_load_dwordx4 v[36:39], v28, s[4:7], s23 offen offset:2048 sc1
  s_add_u32 s23, s23, 4096
  buffer_load_dwordx4 v[40:43], v28, s[4:7], s23 offen offset:0 sc1
  buffer_load_dwordx4 v[44:47], v28, s[4:7], s23 offen offset:2048 sc1
  s_add_u32 s23, s23, 4096
  buffer_load_dwordx4 v[48:51], v28, s[4:7], s23 offen offset:0 sc1
  buffer_load_dwordx4 v[52:55], v28, s[4:7], s23 offen offset:2048 sc1
  s_add_u32 s23, s23, 4096
  buffer_load_dwordx4 v[56:59], v28, s[4:7], s23 offen offset:0 sc1
  buffer_load_dwordx4 v[60:63], v28, s[4:7], s23 offen offset:2048 sc1
  s_add_u32 s23, s23, 4096
  buffer_load_dwordx4 v[64:67], v28, s[4:7], s23 offen offset:0 sc1
  buffer_load_dwordx4 v[68:71], v28, s[4:7], s23 offen offset:2048 sc1
  s_add_u32 s23, s23, 4096
  buffer_load_dwordx4 v[72:75], v28, s[4:7], s23 offen offset:0 sc1
  buffer_load_dwordx4 v[76:79], v28, s[4:7], s23 offen offset:2048 sc1
  s_add_u32 s23, s23, 4096
  buffer_load_dwordx4 v[80:83], v28, s[4:7], s23 offen offset:0 sc1
  buffer_load_dwordx4 v[84:87], v28, s[4:7], s23 offen offset:2048 sc1
  s_add_u32 s23, s23, 4096
  buffer_load_dwordx4 v[88:91], v28, s[4:7], s23 offen offset:0 sc1
  buffer_load_dwordx4 v[92:95], v28, s[4:7], s23 offen offset:2048 sc1
  s_add_u32 s23, s23, 4096
  buffer_load_dwordx4 v[96:99], v28, s[4:7], s23 offen offset:0 sc1
  buffer_load_dwordx4 v[100:103], v28, s[4:7], s23 offen offset:2048 sc1
  s_add_u32 s23, s23, 4096
  buffer_load_dwordx4 v[104:107], v28, s[4:7], s23 offen offset:0 sc1
  buffer_load_dwordx4 v[108:111], v28, s[4:7], s23 offen offset:2048 sc1
  s_add_u32 s23, s23, 4096
  buffer_load_dwordx4 v[112:115], v28, s[4:7], s23 offen offset:0 sc1
  buffer_load_dwordx4 v[116:119], v28, s[4:7], s23 offen offset:2048 sc1
  s_add_u32 s23, s23, 4096
  buffer_load_dwordx4 v[120:123], v28, s[4:7], s23 offen offset:0 sc1
  buffer_load_dwordx4 v[124:127], v28, s[4:7], s23 offen offset:2048 sc1
  s_add_u32 s23, s23, 4096
  buffer_load_dwordx4 v[128:131], v28, s[4:7], s23 offen offset:0 sc1
  buffer_load_dwordx4 v[132:135], v28, s[4:7], s23 offen offset:2048 sc1
  s_add_u32 s23, s23, 4096
  buffer_load_dwordx4 v[136:139], v28, s[4:7], s23 offen offset:0 sc1
  buffer_load_dwordx4 v[140:143], v28, s[4:7], s23 offen offset:2048 sc1
  s_add_u32 s23, s23, 4096
  buffer_load_dwordx4 v[144:147], v28, s[4:7], s23 offen offset:0 sc1
  buffer_load_dwordx4 v[148:151], v28, s[4:7], s23 offen offset:2048 sc1
  s_add_u32 s23, s23, 4096
  buffer_load_dwordx4 v[152:155], v28, s[4:7], s23 offen offset:0 sc1
  buffer_load_dwordx4 v[156:159], v28, s[4:7], s23 offen offset:2048 sc1
OGO_27:
  s_cmp_ge_u32 s22, 0
  s_cselect_b32 s27, 2, 1
  s_add_u32 s27, s27, s22
  s_cmp_ge_u32 s27, 0
  s_cselect_b32 s30, 2, 1
  s_add_u32 s30, s30, s27
  s_lshl_b32 s30, s30, 7
  s_add_u32 s30, s30, 937984
  s_lshl_b32 s23, s27, 18
  s_lshl_b32 s36, s13, 16
  s_add_u32 s23, s23, s36
  s_add_u32 s23, s23, 50331648
  s_waitcnt vmcnt(32)
  v_cmp_eq_u32 vcc, 0, v15
  s_cmp_ge_u32 s27, 64
  s_cbranch_scc1 OPL_28
  s_cbranch_vccnz OPL_28
  buffer_load_dword v15, v13, s[4:7], s30 offen sc1
  s_waitcnt vmcnt(32)
  v_mfma_f32_16x16x32_bf16 v[16:19], a[0:3], v[32:35], 0
  v_mfma_f32_16x16x32_bf16 v[20:23], a[4:7], v[32:35], 0
  buffer_load_dwordx4 v[32:35], v28, s[4:7], s23 offen offset:0 sc1
  s_waitcnt vmcnt(32)
  v_mfma_f32_16x16x32_bf16 v[16:19], a[8:11], v[36:39], v[16:19]
  v_mfma_f32_16x16x32_bf16 v[20:23], a[12:15], v[36:39], v[20:23]
  buffer_load_dwordx4 v[36:39], v28, s[4:7], s23 offen offset:2048 sc1
  s_add_u32 s23, s23, 4096
  s_waitcnt vmcnt(32)
  v_mfma_f32_16x16x32_bf16 v[16:19], a[16:19], v[40:43], v[16:19]
  v_mfma_f32_16x16x32_bf16 v[20:23], a[20:23], v[40:43], v[20:23]
  buffer_load_dwordx4 v[40:43], v28, s[4:7], s23 offen offset:0 sc1
  s_waitcnt vmcnt(32)
  v_mfma_f32_16x16x32_bf16 v[16:19], a[24:27], v[44:47], v[16:19]
  v_mfma_f32_16x16x32_bf16 v[20:23], a[28:31], v[44:47], v[20:23]
  buffer_load_dwordx4 v[44:47], v28, s[4:7], s23 offen offset:2048 sc1
  s_add_u32 s23, s23, 4096
  s_waitcnt vmcnt(32)
  v_mfma_f32_16x16x32_bf16 v[16:19], a[32:35], v[48:51], v[16:19]
  v_mfma_f32_16x16x32_bf16 v[20:23], a[36:39], v[48:51], v[20:23]
  buffer_load_dwordx4 v[48:51], v28, s[4:7], s23 offen offset:0 sc1
  s_waitcnt vmcnt(32)
  v_mfma_f32_16x16x32_bf16 v[16:19], a[40:43], v[52:55], v[16:19]
  v_mfma_f32_16x16x32_bf16 v[20:23], a[44:47], v[52:55], v[20:23]
  buffer_load_dwordx4 v[52:55], v28, s[4:7], s23 offen offset:2048 sc1
  s_add_u32 s23, s23, 4096
  s_waitcnt vmcnt(32)
  v_mfma_f32_16x16x32_bf16 v[16:19], a[48:51], v[56:59], v[16:19]
  v_mfma_f32_16x16x32_bf16 v[20:23], a[52:55], v[56:59], v[20:23]
  buffer_load_dwordx4 v[56:59], v28, s[4:7], s23 offen offset:0 sc1
  s_waitcnt vmcnt(32)
  v_mfma_f32_16x16x32_bf16 v[16:19], a[56:59], v[60:63], v[16:19]
  v_mfma_f32_16x16x32_bf16 v[20:23], a[60:63], v[60:63], v[20:23]
  buffer_load_dwordx4 v[60:63], v28, s[4:7], s23 offen offset:2048 sc1
  s_add_u32 s23, s23, 4096
  s_waitcnt vmcnt(32)
  v_mfma_f32_16x16x32_bf16 v[16:19], a[64:67], v[64:67], v[16:19]
  v_mfma_f32_16x16x32_bf16 v[20:23], a[68:71], v[64:67], v[20:23]
  buffer_load_dwordx4 v[64:67], v28, s[4:7], s23 offen offset:0 sc1
  s_waitcnt vmcnt(32)
  v_mfma_f32_16x16x32_bf16 v[16:19], a[72:75], v[68:71], v[16:19]
  v_mfma_f32_16x16x32_bf16 v[20:23], a[76:79], v[68:71], v[20:23]
  buffer_load_dwordx4 v[68:71], v28, s[4:7], s23 offen offset:2048 sc1
  s_add_u32 s23, s23, 4096
  s_waitcnt vmcnt(32)
  v_mfma_f32_16x16x32_bf16 v[16:19], a[80:83], v[72:75], v[16:19]
  v_mfma_f32_16x16x32_bf16 v[20:23], a[84:87], v[72:75], v[20:23]
  buffer_load_dwordx4 v[72:75], v28, s[4:7], s23 offen offset:0 sc1
  s_waitcnt vmcnt(32)
  v_mfma_f32_16x16x32_bf16 v[16:19], a[88:91], v[76:79], v[16:19]
  v_mfma_f32_16x16x32_bf16 v[20:23], a[92:95], v[76:79], v[20:23]
  buffer_load_dwordx4 v[76:79], v28, s[4:7], s23 offen offset:2048 sc1
  s_add_u32 s23, s23, 4096
  s_waitcnt vmcnt(32)
  v_mfma_f32_16x16x32_bf16 v[16:19], a[96:99], v[80:83], v[16:19]
  v_mfma_f32_16x16x32_bf16 v[20:23], a[100:103], v[80:83], v[20:23]
  buffer_load_dwordx4 v[80:83], v28, s[4:7], s23 offen offset:0 sc1
  s_waitcnt vmcnt(32)
  v_mfma_f32_16x16x32_bf16 v[16:19], a[104:107], v[84:87], v[16:19]
  v_mfma_f32_16x16x32_bf16 v[20:23], a[108:111], v[84:87], v[20:23]
  buffer_load_dwordx4 v[84:87], v28, s[4:7], s23 offen offset:2048 sc1
  s_add_u32 s23, s23, 4096
  s_waitcnt vmcnt(32)
  v_mfma_f32_16x16x32_bf16 v[16:19], a[112:115], v[88:91], v[16:19]
  v_mfma_f32_16x16x32_bf16 v[20:23], a[116:119], v[88:91], v[20:23]
  buffer_load_dwordx4 v[88:91], v28, s[4:7], s23 offen offset:0 sc1
  s_waitcnt vmcnt(32)
  v_mfma_f32_16x16x32_bf16 v[16:19], a[120:123], v[92:95], v[16:19]
  v_mfma_f32_16x16x32_bf16 v[20:23], a[124:127], v[92:95], v[20:23]
  buffer_load_dwordx4 v[92:95], v28, s[4:7], s23 offen offset:2048 sc1
  s_add_u32 s23, s23, 4096
  s_waitcnt vmcnt(32)
  v_mfma_f32_16x16x32_bf16 v[16:19], a[128:131], v[96:99], v[16:19]
  v_mfma_f32_16x16x32_bf16 v[20:23], a[132:135], v[96:99], v[20:23]
  buffer_load_dwordx4 v[96:99], v28, s[4:7], s23 offen offset:0 sc1
  s_waitcnt vmcnt(32)
  v_mfma_f32_16x16x32_bf16 v[16:19], a[136:139], v[100:103], v[16:19]
  v_mfma_f32_16x16x32_bf16 v[20:23], a[140:143], v[100:103], v[20:23]
  buffer_load_dwordx4 v[100:103], v28, s[4:7], s23 offen offset:2048 sc1
  s_add_u32 s23, s23, 4096
  s_waitcnt vmcnt(32)
  v_mfma_f32_16x16x32_bf16 v[16:19], a[144:147], v[104:107], v[16:19]
  v_mfma_f32_16x16x32_bf16 v[20:23], a[148:151], v[104:107], v[20:23]
  buffer_load_dwordx4 v[104:107], v28, s[4:7], s23 offen offset:0 sc1
  s_waitcnt vmcnt(32)
  v_mfma_f32_16x16x32_bf16 v[16:19], a[152:155], v[108:111], v[16:19]
  v_mfma_f32_16x16x32_bf16 v[20:23], a[156:159], v[108:111], v[20:23]
  buffer_load_dwordx4 v[108:111], v28, s[4:7], s23 offen offset:2048 sc1
  s_add_u32 s23, s23, 4096
  s_waitcnt vmcnt(32)
  v_mfma_f32_16x16x32_bf16 v[16:19], a[160:163], v[112:115], v[16:19]
  v_mfma_f32_16x16x32_bf16 v[20:23], a[164:167], v[112:115], v[20:23]
  buffer_load_dwordx4 v[112:115], v28, s[4:7], s23 offen offset:0 sc1
  s_waitcnt vmcnt(32)
  v_mfma_f32_16x16x32_bf16 v[16:19], a[168:171], v[116:119], v[16:19]
  v_mfma_f32_16x16x32_bf16 v[20:23], a[172:175], v[116:119], v[20:23]
  buffer_load_dwordx4 v[116:119], v28, s[4:7], s23 offen offset:2048 sc1
  s_add_u32 s23, s23, 4096
  s_waitcnt vmcnt(32)
  v_mfma_f32_16x16x32_bf16 v[16:19], a[176:179], v[120:123], v[16:19]
  v_mfma_f32_16x16x32_bf16 v[20:23], a[180:183], v[120:123], v[20:23]
  buffer_load_dwordx4 v[120:123], v28, s[4:7], s23 offen offset:0 sc1
  s_waitcnt vmcnt(32)
  v_mfma_f32_16x16x32_bf16 v[16:19], a[184:187], v[124:127], v[16:19]
  v_mfma_f32_16x16x32_bf16 v[20:23], a[188:191], v[124:127], v[20:23]
  buffer_load_dwordx4 v[124:127], v28, s[4:7], s23 offen offset:2048 sc1
  s_add_u32 s23, s23, 4096
  s_waitcnt vmcnt(32)
  v_mfma_f32_16x16x32_bf16 v[16:19], a[192:195], v[128:131], v[16:19]
  v_mfma_f32_16x16x32_bf16 v[20:23], a[196:199], v[128:131], v[20:23]
  buffer_load_dwordx4 v[128:131], v28, s[4:7], s23 offen offset:0 sc1
  s_waitcnt vmcnt(32)
  v_mfma_f32_16x16x32_bf16 v[16:19], a[200:203], v[132:135], v[16:19]
  v_mfma_f32_16x16x32_bf16 v[20:23], a[204:207], v[132:135], v[20:23]
  buffer_load_dwordx4 v[132:135], v28, s[4:7], s23 offen offset:2048 sc1
  s_add_u32 s23, s23, 4096
  s_waitcnt vmcnt(32)
  v_mfma_f32_16x16x32_bf16 v[16:19], a[208:211], v[136:139], v[16:19]
  v_mfma_f32_16x16x32_bf16 v[20:23], a[212:215], v[136:139], v[20:23]
  buffer_load_dwordx4 v[136:139], v28, s[4:7], s23 offen offset:0 sc1
  s_waitcnt vmcnt(32)
  v_mfma_f32_16x16x32_bf16 v[16:19], a[216:219], v[140:143], v[16:19]
  v_mfma_f32_16x16x32_bf16 v[20:23], a[220:223], v[140:143], v[20:23]
  buffer_load_dwordx4 v[140:143], v28, s[4:7], s23 offen offset:2048 sc1
  s_add_u32 s23, s23, 4096
  s_waitcnt vmcnt(32)
  v_mfma_f32_16x16x32_bf16 v[16:19], a[224:227], v[144:147], v[16:19]
  v_mfma_f32_16x16x32_bf16 v[20:23], a[228:231], v[144:147], v[20:23]
  buffer_load_dwordx4 v[144:147], v28, s[4:7], s23 offen offset:0 sc1
  s_waitcnt vmcnt(32)
  v_mfma_f32_16x16x32_bf16 v[16:19], a[232:235], v[148:151], v[16:19]
  v_mfma_f32_16x16x32_bf16 v[20:23], a[236:239], v[148:151], v[20:23]
  buffer_load_dwordx4 v[148:151], v28, s[4:7], s23 offen offset:2048 sc1
  s_add_u32 s23, s23, 4096
  s_waitcnt vmcnt(32)
  v_mfma_f32_16x16x32_bf16 v[16:19], a[240:243], v[152:155], v[16:19]
  v_mfma_f32_16x16x32_bf16 v[20:23], a[244:247], v[152:155], v[20:23]
  buffer_load_dwordx4 v[152:155], v28, s[4:7], s23 offen offset:0 sc1
  s_waitcnt vmcnt(32)
  v_mfma_f32_16x16x32_bf16 v[16:19], a[248:251], v[156:159], v[16:19]
  v_mfma_f32_16x16x32_bf16 v[20:23], a[252:255], v[156:159], v[20:23]
  buffer_load_dwordx4 v[156:159], v28, s[4:7], s23 offen offset:2048 sc1
  s_nop 5
  ds_write_b128 v11, v[16:19] offset:0
  ds_write_b128 v11, v[20:23] offset:1024
  s_waitcnt lgkmcnt(0)
  s_barrier
  ds_read_b64 v[160:161], v12 offset:0
  ds_read_b64 v[162:163], v12 offset:2048
  ds_read_b64 v[164:165], v12 offset:4096
  ds_read_b64 v[166:167], v12 offset:6144
  s_waitcnt lgkmcnt(2)
  v_add_f32 v160, v160, v162
  v_add_f32 v161, v161, v163
  s_waitcnt lgkmcnt(1)
  v_add_f32 v160, v160, v164
  v_add_f32 v161, v161, v165
  s_waitcnt lgkmcnt(0)
  v_add_f32 v160, v160, v166
  v_add_f32 v161, v161, v167
  v_cvt_pk_bf16_f32 v160, v160, v161
  s_mul_i32 s36, s22, 73728
  buffer_store_dword v160, v10, s[16:19], s36 offen
  v_xor_b32 v11, 8192, v11
  v_xor_b32 v12, 8192, v12
  s_mov_b32 s22, s27
  s_branch OGO_27
OPL_28:
  s_waitcnt vmcnt(31)
  v_mfma_f32_16x16x32_bf16 v[16:19], a[0:3], v[32:35], 0
  v_mfma_f32_16x16x32_bf16 v[20:23], a[4:7], v[32:35], 0
  s_waitcnt vmcnt(30)
  v_mfma_f32_16x16x32_bf16 v[16:19], a[8:11], v[36:39], v[16:19]
  v_mfma_f32_16x16x32_bf16 v[20:23], a[12:15], v[36:39], v[20:23]
  s_waitcnt vmcnt(29)
  v_mfma_f32_16x16x32_bf16 v[16:19], a[16:19], v[40:43], v[16:19]
  v_mfma_f32_16x16x32_bf16 v[20:23], a[20:23], v[40:43], v[20:23]
  s_waitcnt vmcnt(28)
  v_mfma_f32_16x16x32_bf16 v[16:19], a[24:27], v[44:47], v[16:19]
  v_mfma_f32_16x16x32_bf16 v[20:23], a[28:31], v[44:47], v[20:23]
  s_waitcnt vmcnt(27)
  v_mfma_f32_16x16x32_bf16 v[16:19], a[32:35], v[48:51], v[16:19]
  v_mfma_f32_16x16x32_bf16 v[20:23], a[36:39], v[48:51], v[20:23]
  s_waitcnt vmcnt(26)
  v_mfma_f32_16x16x32_bf16 v[16:19], a[40:43], v[52:55], v[16:19]
  v_mfma_f32_16x16x32_bf16 v[20:23], a[44:47], v[52:55], v[20:23]
  s_waitcnt vmcnt(25)
  v_mfma_f32_16x16x32_bf16 v[16:19], a[48:51], v[56:59], v[16:19]
  v_mfma_f32_16x16x32_bf16 v[20:23], a[52:55], v[56:59], v[20:23]
  s_waitcnt vmcnt(24)
  v_mfma_f32_16x16x32_bf16 v[16:19], a[56:59], v[60:63], v[16:19]
  v_mfma_f32_16x16x32_bf16 v[20:23], a[60:63], v[60:63], v[20:23]
  s_waitcnt vmcnt(23)
  v_mfma_f32_16x16x32_bf16 v[16:19], a[64:67], v[64:67], v[16:19]
  v_mfma_f32_16x16x32_bf16 v[20:23], a[68:71], v[64:67], v[20:23]
  s_waitcnt vmcnt(22)
  v_mfma_f32_16x16x32_bf16 v[16:19], a[72:75], v[68:71], v[16:19]
  v_mfma_f32_16x16x32_bf16 v[20:23], a[76:79], v[68:71], v[20:23]
  s_waitcnt vmcnt(21)
  v_mfma_f32_16x16x32_bf16 v[16:19], a[80:83], v[72:75], v[16:19]
  v_mfma_f32_16x16x32_bf16 v[20:23], a[84:87], v[72:75], v[20:23]
  s_waitcnt vmcnt(20)
  v_mfma_f32_16x16x32_bf16 v[16:19], a[88:91], v[76:79], v[16:19]
  v_mfma_f32_16x16x32_bf16 v[20:23], a[92:95], v[76:79], v[20:23]
  s_waitcnt vmcnt(19)
  v_mfma_f32_16x16x32_bf16 v[16:19], a[96:99], v[80:83], v[16:19]
  v_mfma_f32_16x16x32_bf16 v[20:23], a[100:103], v[80:83], v[20:23]
  s_waitcnt vmcnt(18)
  v_mfma_f32_16x16x32_bf16 v[16:19], a[104:107], v[84:87], v[16:19]
  v_mfma_f32_16x16x32_bf16 v[20:23], a[108:111], v[84:87], v[20:23]
  s_waitcnt vmcnt(17)
  v_mfma_f32_16x16x32_bf16 v[16:19], a[112:115], v[88:91], v[16:19]
  v_mfma_f32_16x16x32_bf16 v[20:23], a[116:119], v[88:91], v[20:23]
  s_waitcnt vmcnt(16)
  v_mfma_f32_16x16x32_bf16 v[16:19], a[120:123], v[92:95], v[16:19]
  v_mfma_f32_16x16x32_bf16 v[20:23], a[124:127], v[92:95], v[20:23]
  s_waitcnt vmcnt(15)
  v_mfma_f32_16x16x32_bf16 v[16:19], a[128:131], v[96:99], v[16:19]
  v_mfma_f32_16x16x32_bf16 v[20:23], a[132:135], v[96:99], v[20:23]
  s_waitcnt vmcnt(14)
  v_mfma_f32_16x16x32_bf16 v[16:19], a[136:139], v[100:103], v[16:19]
  v_mfma_f32_16x16x32_bf16 v[20:23], a[140:143], v[100:103], v[20:23]
  s_waitcnt vmcnt(13)
  v_mfma_f32_16x16x32_bf16 v[16:19], a[144:147], v[104:107], v[16:19]
  v_mfma_f32_16x16x32_bf16 v[20:23], a[148:151], v[104:107], v[20:23]
  s_waitcnt vmcnt(12)
  v_mfma_f32_16x16x32_bf16 v[16:19], a[152:155], v[108:111], v[16:19]
  v_mfma_f32_16x16x32_bf16 v[20:23], a[156:159], v[108:111], v[20:23]
  s_waitcnt vmcnt(11)
  v_mfma_f32_16x16x32_bf16 v[16:19], a[160:163], v[112:115], v[16:19]
  v_mfma_f32_16x16x32_bf16 v[20:23], a[164:167], v[112:115], v[20:23]
  s_waitcnt vmcnt(10)
  v_mfma_f32_16x16x32_bf16 v[16:19], a[168:171], v[116:119], v[16:19]
  v_mfma_f32_16x16x32_bf16 v[20:23], a[172:175], v[116:119], v[20:23]
  s_waitcnt vmcnt(9)
  v_mfma_f32_16x16x32_bf16 v[16:19], a[176:179], v[120:123], v[16:19]
  v_mfma_f32_16x16x32_bf16 v[20:23], a[180:183], v[120:123], v[20:23]
  s_waitcnt vmcnt(8)
  v_mfma_f32_16x16x32_bf16 v[16:19], a[184:187], v[124:127], v[16:19]
  v_mfma_f32_16x16x32_bf16 v[20:23], a[188:191], v[124:127], v[20:23]
  s_waitcnt vmcnt(7)
  v_mfma_f32_16x16x32_bf16 v[16:19], a[192:195], v[128:131], v[16:19]
  v_mfma_f32_16x16x32_bf16 v[20:23], a[196:199], v[128:131], v[20:23]
  s_waitcnt vmcnt(6)
  v_mfma_f32_16x16x32_bf16 v[16:19], a[200:203], v[132:135], v[16:19]
  v_mfma_f32_16x16x32_bf16 v[20:23], a[204:207], v[132:135], v[20:23]
  s_waitcnt vmcnt(5)
  v_mfma_f32_16x16x32_bf16 v[16:19], a[208:211], v[136:139], v[16:19]
  v_mfma_f32_16x16x32_bf16 v[20:23], a[212:215], v[136:139], v[20:23]
  s_waitcnt vmcnt(4)
  v_mfma_f32_16x16x32_bf16 v[16:19], a[216:219], v[140:143], v[16:19]
  v_mfma_f32_16x16x32_bf16 v[20:23], a[220:223], v[140:143], v[20:23]
  s_waitcnt vmcnt(3)
  v_mfma_f32_16x16x32_bf16 v[16:19], a[224:227], v[144:147], v[16:19]
  v_mfma_f32_16x16x32_bf16 v[20:23], a[228:231], v[144:147], v[20:23]
  s_waitcnt vmcnt(2)
  v_mfma_f32_16x16x32_bf16 v[16:19], a[232:235], v[148:151], v[16:19]
  v_mfma_f32_16x16x32_bf16 v[20:23], a[236:239], v[148:151], v[20:23]
  s_waitcnt vmcnt(1)
  v_mfma_f32_16x16x32_bf16 v[16:19], a[240:243], v[152:155], v[16:19]
  v_mfma_f32_16x16x32_bf16 v[20:23], a[244:247], v[152:155], v[20:23]
  s_waitcnt vmcnt(0)
  v_mfma_f32_16x16x32_bf16 v[16:19], a[248:251], v[156:159], v[16:19]
  v_mfma_f32_16x16x32_bf16 v[20:23], a[252:255], v[156:159], v[20:23]
  s_nop 6
  ds_write_b128 v11, v[16:19] offset:0
  ds_write_b128 v11, v[20:23] offset:1024
  s_waitcnt lgkmcnt(0)
  s_barrier
  ds_read_b64 v[160:161], v12 offset:0
  ds_read_b64 v[162:163], v12 offset:2048
  ds_read_b64 v[164:165], v12 offset:4096
  ds_read_b64 v[166:167], v12 offset:6144
  s_waitcnt lgkmcnt(2)
  v_add_f32 v160, v160, v162
  v_add_f32 v161, v161, v163
  s_waitcnt lgkmcnt(1)
  v_add_f32 v160, v160, v164
  v_add_f32 v161, v161, v165
  s_waitcnt lgkmcnt(0)
  v_add_f32 v160, v160, v166
  v_add_f32 v161, v161, v167
  v_cvt_pk_bf16_f32 v160, v160, v161
  s_mul_i32 s36, s22, 73728
  buffer_store_dword v160, v10, s[16:19], s36 offen
  v_xor_b32 v11, 8192, v11
  v_xor_b32 v12, 8192, v12
  s_mov_b32 s22, s27
  s_cmp_lt_u32 s22, 64
  s_cbranch_scc1 OSEG_24
  s_branch L_end
L_blk_A:
L_a:
  s_load_dwordx2 s[4:5], s[0:1], 112
  s_load_dwordx2 s[8:9], s[0:1], 8
  s_load_dwordx2 s[16:17], s[0:1], 0
  s_load_dwordx2 s[20:21], s[0:1], 16
  s_load_dwordx2 s[24:25], s[0:1], 24
  s_load_dwordx2 s[44:45], s[0:1], 32
  s_load_dwordx2 s[48:49], s[0:1], 96
  s_load_dwordx2 s[66:67], s[0:1], 104
  v_and_b32 v1, 63, v0
  v_lshlrev_b32 v2, 4, v1
  v_and_b32 v3, 31, v1
  s_waitcnt vmcnt(0)
  v_lshrrev_b32 v4, 5, v1
  v_bfe_u32 v5, v1, 4, 1
  v_bfe_u32 v6, v1, 2, 2
  v_and_b32 v7, 3, v1
  v_mul_u32_u24 v8, 1152, v3
  v_lshl_add_u32 v8, v4, 4, v8
  s_mul_i32 s31, s13, 40960
  s_mul_i32 s32, s13, 288
  s_cmp_eq_u32 s13, 3
  s_cselect_b32 s32, 832, s32
  v_lshl_add_u32 v9, v4, 3, v6
  v_mul_u32_u24 v9, 320, v9
  v_lshl_add_u32 v9, v5, 5, v9
  v_lshl_add_u32 v9, v7, 3, v9
  v_add_u32 v165, s31, v9
  v_add_u32 v9, 0, v1
  v_mul_u32_u24 v10, 3277, v9
  v_lshrrev_b32 v10, 16, v10
  v_mul_u32_u24 v11, 20, v10
  v_sub_u32 v11, v9, v11
  v_mul_u32_u24 v10, 1152, v10
  v_lshl_add_u32 v10, v11, 4, v10
  v_add_u32 v160, s32, v10
  v_add_u32 v9, 64, v1
  v_mul_u32_u24 v10, 3277, v9
  v_lshrrev_b32 v10, 16, v10
  v_mul_u32_u24 v11, 20, v10
  v_sub_u32 v11, v9, v11
  v_mul_u32_u24 v10, 1152, v10
  v_lshl_add_u32 v10, v11, 4, v10
  v_add_u32 v161, s32, v10
  v_add_u32 v9, 128, v1
  v_mul_u32_u24 v10, 3277, v9
  v_lshrrev_b32 v10, 16, v10
  v_mul_u32_u24 v11, 20, v10
  v_sub_u32 v11, v9, v11
  v_mul_u32_u24 v10, 1152, v10
  v_lshl_add_u32 v10, v11, 4, v10
  v_add_u32 v162, s32, v10
  v_add_u32 v9, 192, v1
  v_mul_u32_u24 v10, 3277, v9
  v_lshrrev_b32 v10, 16, v10
  v_mul_u32_u24 v11, 20, v10
  v_sub_u32 v11, v9, v11
  v_mul_u32_u24 v10, 1152, v10
  v_lshl_add_u32 v10, v11, 4, v10
  v_add_u32 v163, s32, v10
  v_add_u32 v9, 256, v1
  v_mul_u32_u24 v10, 3277, v9
  v_lshrrev_b32 v10, 16, v10
  v_mul_u32_u24 v11, 20, v10
  v_sub_u32 v11, v9, v11
  v_mul_u32_u24 v10, 1152, v10
  v_lshl_add_u32 v10, v11, 4, v10
  v_add_u32 v164, s32, v10
  s_waitcnt lgkmcnt(0)
  s_mov_b32 s6, 268435456
  s_mov_b32 s7, 0x20000
  s_mov_b32 s10, 663552
  s_mov_b32 s11, 0x20000
  s_mov_b32 s18, 2359296
  s_mov_b32 s19, 0x20000
  s_mov_b32 s22, 20736
  s_mov_b32 s23, 0x20000
  s_mov_b32 s26, 20736
  s_mov_b32 s27, 0x20000
  s_mov_b32 s46, 663552
  s_mov_b32 s47, 0x20000
  s_mov_b32 s50, 4718592
  s_mov_b32 s51, 0x20000
  s_mul_i32 s36, s12, 36864
  buffer_load_dwordx4 v[16:19], v8, s[16:19], s36 offen offset:0
  buffer_load_dwordx4 v[20:23], v8, s[16:19], s36 offen offset:32
  buffer_load_dwordx4 v[24:27], v8, s[16:19], s36 offen offset:64
  buffer_load_dwordx4 v[28:31], v8, s[16:19], s36 offen offset:96
  buffer_load_dwordx4 v[32:35], v8, s[16:19], s36 offen offset:128
  buffer_load_dwordx4 v[36:39], v8, s[16:19], s36 offen offset:160
  buffer_load_dwordx4 v[40:43], v8, s[16:19], s36 offen offset:192
  buffer_load_dwordx4 v[44:47], v8, s[16:19], s36 offen offset:224
  buffer_load_dwordx4 v[48:51], v8, s[16:19], s36 offen offset:256
  buffer_load_dwordx4 v[52:55], v8, s[16:19], s36 offen offset:288
  buffer_load_dwordx4 v[56:59], v8, s[16:19], s36 offen offset:320
  buffer_load_dwordx4 v[60:63], v8, s[16:19], s36 offen offset:352
  buffer_load_dwordx4 v[64:67], v8, s[16:19], s36 offen offset:384
  buffer_load_dwordx4 v[68:71], v8, s[16:19], s36 offen offset:416
  buffer_load_dwordx4 v[72:75], v8, s[16:19], s36 offen offset:448
  buffer_load_dwordx4 v[76:79], v8, s[16:19], s36 offen offset:480
  buffer_load_dwordx4 v[80:83], v8, s[16:19], s36 offen offset:512
  buffer_load_dwordx4 v[84:87], v8, s[16:19], s36 offen offset:544
  buffer_load_dwordx4 v[88:91], v8, s[16:19], s36 offen offset:576
  buffer_load_dwordx4 v[92:95], v8, s[16:19], s36 offen offset:608
  buffer_load_dwordx4 v[96:99], v8, s[16:19], s36 offen offset:640
  buffer_load_dwordx4 v[100:103], v8, s[16:19], s36 offen offset:672
  buffer_load_dwordx4 v[104:107], v8, s[16:19], s36 offen offset:704
  buffer_load_dwordx4 v[108:111], v8, s[16:19], s36 offen offset:736
  buffer_load_dwordx4 v[112:115], v8, s[16:19], s36 offen offset:768
  buffer_load_dwordx4 v[116:119], v8, s[16:19], s36 offen offset:800
  buffer_load_dwordx4 v[120:123], v8, s[16:19], s36 offen offset:832
  buffer_load_dwordx4 v[124:127], v8, s[16:19], s36 offen offset:864
  buffer_load_dwordx4 v[128:131], v8, s[16:19], s36 offen offset:896
  buffer_load_dwordx4 v[132:135], v8, s[16:19], s36 offen offset:928
  buffer_load_dwordx4 v[136:139], v8, s[16:19], s36 offen offset:960
  buffer_load_dwordx4 v[140:143], v8, s[16:19], s36 offen offset:992
  buffer_load_dwordx4 v[144:147], v8, s[16:19], s36 offen offset:1024
  buffer_load_dwordx4 v[148:151], v8, s[16:19], s36 offen offset:1056
  buffer_load_dwordx4 v[152:155], v8, s[16:19], s36 offen offset:1088
  buffer_load_dwordx4 v[156:159], v8, s[16:19], s36 offen offset:1120
  v_mov_b32 v168, 0
  v_mov_b32 v169, 0
  v_mov_b32 v170, 0
  v_mov_b32 v171, 0
  v_lshlrev_b32 v9, 4, v0
  ds_write_b128 v9, v[168:171] offset:0
  ds_write_b128 v9, v[168:171] offset:4096
  ds_write_b128 v9, v[168:171] offset:8192
  ds_write_b128 v9, v[168:171] offset:12288
  ds_write_b128 v9, v[168:171] offset:16384
  ds_write_b128 v9, v[168:171] offset:20480
  ds_write_b128 v9, v[168:171] offset:24576
  ds_write_b128 v9, v[168:171] offset:28672
  ds_write_b128 v9, v[168:171] offset:32768
  ds_write_b128 v9, v[168:171] offset:36864
  ds_write_b128 v9, v[168:171] offset:40960
  ds_write_b128 v9, v[168:171] offset:45056
  ds_write_b128 v9, v[168:171] offset:49152
  ds_write_b128 v9, v[168:171] offset:53248
  ds_write_b128 v9, v[168:171] offset:57344
  ds_write_b128 v9, v[168:171] offset:61440
  v_add_u32 v10, 65536, v9
  ds_write_b128 v10, v[168:171] offset:0
  ds_write_b128 v10, v[168:171] offset:4096
  v_add_u32 v9, 0, v0
  v_lshlrev_b32 v10, 2, v9
  buffer_load_dword v172, v10, s[20:23], 0 offen
  buffer_load_dword v173, v10, s[24:27], 0 offen
  v_add_u32 v9, 256, v0
  v_lshlrev_b32 v10, 2, v9
  buffer_load_dword v174, v10, s[20:23], 0 offen
  buffer_load_dword v175, v10, s[24:27], 0 offen
  v_add_u32 v9, 512, v0
  v_lshlrev_b32 v10, 2, v9
  buffer_load_dword v176, v10, s[20:23], 0 offen
  buffer_load_dword v177, v10, s[24:27], 0 offen
  v_add_u32 v9, 768, v0
  v_lshlrev_b32 v10, 2, v9
  buffer_load_dword v178, v10, s[20:23], 0 offen
  buffer_load_dword v179, v10, s[24:27], 0 offen
  v_add_u32 v9, 1024, v0
  v_lshlrev_b32 v10, 2, v9
  buffer_load_dword v180, v10, s[20:23], 0 offen
  buffer_load_dword v181, v10, s[24:27], 0 offen
  v_add_u32 v9, 1280, v0
  v_lshlrev_b32 v10, 2, v9
  buffer_load_dword v182, v10, s[20:23], 0 offen
  buffer_load_dword v183, v10, s[24:27], 0 offen
  v_add_u32 v9, 1536, v0
  v_lshlrev_b32 v10, 2, v9
  buffer_load_dword v184, v10, s[20:23], 0 offen
  buffer_load_dword v185, v10, s[24:27], 0 offen
  v_add_u32 v9, 1792, v0
  v_lshlrev_b32 v10, 2, v9
  buffer_load_dword v186, v10, s[20:23], 0 offen
  buffer_load_dword v187, v10, s[24:27], 0 offen
  v_add_u32 v9, 2048, v0
  v_lshlrev_b32 v10, 2, v9
  buffer_load_dword v188, v10, s[20:23], 0 offen
  buffer_load_dword v189, v10, s[24:27], 0 offen
  v_add_u32 v9, 2304, v0
  v_lshlrev_b32 v10, 2, v9
  buffer_load_dword v190, v10, s[20:23], 0 offen
  buffer_load_dword v191, v10, s[24:27], 0 offen
  v_add_u32 v9, 2560, v0
  v_lshlrev_b32 v10, 2, v9
  buffer_load_dword v192, v10, s[20:23], 0 offen
  buffer_load_dword v193, v10, s[24:27], 0 offen
  v_add_u32 v9, 2816, v0
  v_lshlrev_b32 v10, 2, v9
  buffer_load_dword v194, v10, s[20:23], 0 offen
  buffer_load_dword v195, v10, s[24:27], 0 offen
  v_add_u32 v9, 3072, v0
  v_lshlrev_b32 v10, 2, v9
  buffer_load_dword v196, v10, s[20:23], 0 offen
  buffer_load_dword v197, v10, s[24:27], 0 offen
  v_add_u32 v9, 3328, v0
  v_lshlrev_b32 v10, 2, v9
  buffer_load_dword v198, v10, s[20:23], 0 offen
  buffer_load_dword v199, v10, s[24:27], 0 offen
  v_add_u32 v9, 3584, v0
  v_lshlrev_b32 v10, 2, v9
  buffer_load_dword v200, v10, s[20:23], 0 offen
  buffer_load_dword v201, v10, s[24:27], 0 offen
  v_add_u32 v9, 3840, v0
  v_lshlrev_b32 v10, 2, v9
  buffer_load_dword v202, v10, s[20:23], 0 offen
  buffer_load_dword v203, v10, s[24:27], 0 offen
  v_add_u32 v9, 4096, v0
  v_lshlrev_b32 v10, 2, v9
  buffer_load_dword v204, v10, s[20:23], 0 offen
  buffer_load_dword v205, v10, s[24:27], 0 offen
  v_add_u32 v9, 4352, v0
  v_lshlrev_b32 v10, 2, v9
  buffer_load_dword v206, v10, s[20:23], 0 offen
  buffer_load_dword v207, v10, s[24:27], 0 offen
  v_add_u32 v9, 4608, v0
  v_lshlrev_b32 v10, 2, v9
  buffer_load_dword v208, v10, s[20:23], 0 offen
  buffer_load_dword v209, v10, s[24:27], 0 offen
  v_add_u32 v9, 4864, v0
  v_lshlrev_b32 v10, 2, v9
  buffer_load_dword v210, v10, s[20:23], 0 offen
  buffer_load_dword v211, v10, s[24:27], 0 offen
  v_add_u32 v9, 5120, v0
  v_lshlrev_b32 v10, 2, v9
  buffer_load_dword v212, v10, s[20:23], 0 offen
  buffer_load_dword v213, v10, s[24:27], 0 offen
  s_waitcnt lgkmcnt(0)
  s_barrier
  s_mov_b32 s28, 58255
  v_add_u32 v9, 0, v0
  v_mul_u32_u24 v10, s28, v9
  v_lshrrev_b32 v10, 19, v10
  v_mul_u32_u24 v11, 9, v10
  v_sub_u32 v11, v9, v11
  v_lshlrev_b32 v10, 6, v10
  v_lshl_add_u32 v10, v11, 2, v10
  s_waitcnt vmcnt(41)
  ds_write_b32 v10, v172
  s_waitcnt vmcnt(40)
  ds_write_b32 v10, v173 offset:36864
  v_add_u32 v9, 256, v0
  v_mul_u32_u24 v10, s28, v9
  v_lshrrev_b32 v10, 19, v10
  v_mul_u32_u24 v11, 9, v10
  v_sub_u32 v11, v9, v11
  v_lshlrev_b32 v10, 6, v10
  v_lshl_add_u32 v10, v11, 2, v10
  s_waitcnt vmcnt(39)
  ds_write_b32 v10, v174
  s_waitcnt vmcnt(38)
  ds_write_b32 v10, v175 offset:36864
  v_add_u32 v9, 512, v0
  v_mul_u32_u24 v10, s28, v9
  v_lshrrev_b32 v10, 19, v10
  v_mul_u32_u24 v11, 9, v10
  v_sub_u32 v11, v9, v11
  v_lshlrev_b32 v10, 6, v10
  v_lshl_add_u32 v10, v11, 2, v10
  s_waitcnt vmcnt(37)
  ds_write_b32 v10, v176
  s_waitcnt vmcnt(36)
  ds_write_b32 v10, v177 offset:36864
  v_add_u32 v9, 768, v0
  v_mul_u32_u24 v10, s28, v9
  v_lshrrev_b32 v10, 19, v10
  v_mul_u32_u24 v11, 9, v10
  v_sub_u32 v11, v9, v11
  v_lshlrev_b32 v10, 6, v10
  v_lshl_add_u32 v10, v11, 2, v10
  s_waitcnt vmcnt(35)
  ds_write_b32 v10, v178
  s_waitcnt vmcnt(34)
  ds_write_b32 v10, v179 offset:36864
  v_add_u32 v9, 1024, v0
  v_mul_u32_u24 v10, s28, v9
  v_lshrrev_b32 v10, 19, v10
  v_mul_u32_u24 v11, 9, v10
  v_sub_u32 v11, v9, v11
  v_lshlrev_b32 v10, 6, v10
  v_lshl_add_u32 v10, v11, 2, v10
  s_waitcnt vmcnt(33)
  ds_write_b32 v10, v180
  s_waitcnt vmcnt(32)
  ds_write_b32 v10, v181 offset:36864
  v_add_u32 v9, 1280, v0
  v_mul_u32_u24 v10, s28, v9
  v_lshrrev_b32 v10, 19, v10
  v_mul_u32_u24 v11, 9, v10
  v_sub_u32 v11, v9, v11
  v_lshlrev_b32 v10, 6, v10
  v_lshl_add_u32 v10, v11, 2, v10
  s_waitcnt vmcnt(31)
  ds_write_b32 v10, v182
  s_waitcnt vmcnt(30)
  ds_write_b32 v10, v183 offset:36864
  v_add_u32 v9, 1536, v0
  v_mul_u32_u24 v10, s28, v9
  v_lshrrev_b32 v10, 19, v10
  v_mul_u32_u24 v11, 9, v10
  v_sub_u32 v11, v9, v11
  v_lshlrev_b32 v10, 6, v10
  v_lshl_add_u32 v10, v11, 2, v10
  s_waitcnt vmcnt(29)
  ds_write_b32 v10, v184
  s_waitcnt vmcnt(28)
  ds_write_b32 v10, v185 offset:36864
  v_add_u32 v9, 1792, v0
  v_mul_u32_u24 v10, s28, v9
  v_lshrrev_b32 v10, 19, v10
  v_mul_u32_u24 v11, 9, v10
  v_sub_u32 v11, v9, v11
  v_lshlrev_b32 v10, 6, v10
  v_lshl_add_u32 v10, v11, 2, v10
  s_waitcnt vmcnt(27)
  ds_write_b32 v10, v186
  s_waitcnt vmcnt(26)
  ds_write_b32 v10, v187 offset:36864
  v_add_u32 v9, 2048, v0
  v_mul_u32_u24 v10, s28, v9
  v_lshrrev_b32 v10, 19, v10
  v_mul_u32_u24 v11, 9, v10
  v_sub_u32 v11, v9, v11
  v_lshlrev_b32 v10, 6, v10
  v_lshl_add_u32 v10, v11, 2, v10
  s_waitcnt vmcnt(25)
  ds_write_b32 v10, v188
  s_waitcnt vmcnt(24)
  ds_write_b32 v10, v189 offset:36864
  v_add_u32 v9, 2304, v0
  v_mul_u32_u24 v10, s28, v9
  v_lshrrev_b32 v10, 19, v10
  v_mul_u32_u24 v11, 9, v10
  v_sub_u32 v11, v9, v11
  v_lshlrev_b32 v10, 6, v10
  v_lshl_add_u32 v10, v11, 2, v10
  s_waitcnt vmcnt(23)
  ds_write_b32 v10, v190
  s_waitcnt vmcnt(22)
  ds_write_b32 v10, v191 offset:36864
  v_add_u32 v9, 2560, v0
  v_mul_u32_u24 v10, s28, v9
  v_lshrrev_b32 v10, 19, v10
  v_mul_u32_u24 v11, 9, v10
  v_sub_u32 v11, v9, v11
  v_lshlrev_b32 v10, 6, v10
  v_lshl_add_u32 v10, v11, 2, v10
  s_waitcnt vmcnt(21)
  ds_write_b32 v10, v192
  s_waitcnt vmcnt(20)
  ds_write_b32 v10, v193 offset:36864
  v_add_u32 v9, 2816, v0
  v_mul_u32_u24 v10, s28, v9
  v_lshrrev_b32 v10, 19, v10
  v_mul_u32_u24 v11, 9, v10
  v_sub_u32 v11, v9, v11
  v_lshlrev_b32 v10, 6, v10
  v_lshl_add_u32 v10, v11, 2, v10
  s_waitcnt vmcnt(19)
  ds_write_b32 v10, v194
  s_waitcnt vmcnt(18)
  ds_write_b32 v10, v195 offset:36864
  v_add_u32 v9, 3072, v0
  v_mul_u32_u24 v10, s28, v9
  v_lshrrev_b32 v10, 19, v10
  v_mul_u32_u24 v11, 9, v10
  v_sub_u32 v11, v9, v11
  v_lshlrev_b32 v10, 6, v10
  v_lshl_add_u32 v10, v11, 2, v10
  s_waitcnt vmcnt(17)
  ds_write_b32 v10, v196
  s_waitcnt vmcnt(16)
  ds_write_b32 v10, v197 offset:36864
  v_add_u32 v9, 3328, v0
  v_mul_u32_u24 v10, s28, v9
  v_lshrrev_b32 v10, 19, v10
  v_mul_u32_u24 v11, 9, v10
  v_sub_u32 v11, v9, v11
  v_lshlrev_b32 v10, 6, v10
  v_lshl_add_u32 v10, v11, 2, v10
  s_waitcnt vmcnt(15)
  ds_write_b32 v10, v198
  s_waitcnt vmcnt(14)
  ds_write_b32 v10, v199 offset:36864
  v_add_u32 v9, 3584, v0
  v_mul_u32_u24 v10, s28, v9
  v_lshrrev_b32 v10, 19, v10
  v_mul_u32_u24 v11, 9, v10
  v_sub_u32 v11, v9, v11
  v_lshlrev_b32 v10, 6, v10
  v_lshl_add_u32 v10, v11, 2, v10
  s_waitcnt vmcnt(13)
  ds_write_b32 v10, v200
  s_waitcnt vmcnt(12)
  ds_write_b32 v10, v201 offset:36864
  v_add_u32 v9, 3840, v0
  v_mul_u32_u24 v10, s28, v9
  v_lshrrev_b32 v10, 19, v10
  v_mul_u32_u24 v11, 9, v10
  v_sub_u32 v11, v9, v11
  v_lshlrev_b32 v10, 6, v10
  v_lshl_add_u32 v10, v11, 2, v10
  s_waitcnt vmcnt(11)
  ds_write_b32 v10, v202
  s_waitcnt vmcnt(10)
  ds_write_b32 v10, v203 offset:36864
  v_add_u32 v9, 4096, v0
  v_mul_u32_u24 v10, s28, v9
  v_lshrrev_b32 v10, 19, v10
  v_mul_u32_u24 v11, 9, v10
  v_sub_u32 v11, v9, v11
  v_lshlrev_b32 v10, 6, v10
  v_lshl_add_u32 v10, v11, 2, v10
  s_waitcnt vmcnt(9)
  ds_write_b32 v10, v204
  s_waitcnt vmcnt(8)
  ds_write_b32 v10, v205 offset:36864
  v_add_u32 v9, 4352, v0
  v_mul_u32_u24 v10, s28, v9
  v_lshrrev_b32 v10, 19, v10
  v_mul_u32_u24 v11, 9, v10
  v_sub_u32 v11, v9, v11
  v_lshlrev_b32 v10, 6, v10
  v_lshl_add_u32 v10, v11, 2, v10
  s_waitcnt vmcnt(7)
  ds_write_b32 v10, v206
  s_waitcnt vmcnt(6)
  ds_write_b32 v10, v207 offset:36864
  v_add_u32 v9, 4608, v0
  v_mul_u32_u24 v10, s28, v9
  v_lshrrev_b32 v10, 19, v10
  v_mul_u32_u24 v11, 9, v10
  v_sub_u32 v11, v9, v11
  v_lshlrev_b32 v10, 6, v10
  v_lshl_add_u32 v10, v11, 2, v10
  s_waitcnt vmcnt(5)
  ds_write_b32 v10, v208
  s_waitcnt vmcnt(4)
  ds_write_b32 v10, v209 offset:36864
  v_add_u32 v9, 4864, v0
  v_mul_u32_u24 v10, s28, v9
  v_lshrrev_b32 v10, 19, v10
  v_mul_u32_u24 v11, 9, v10
  v_sub_u32 v11, v9, v11
  v_lshlrev_b32 v10, 6, v10
  v_lshl_add_u32 v10, v11, 2, v10
  s_waitcnt vmcnt(3)
  ds_write_b32 v10, v210
  s_waitcnt vmcnt(2)
  ds_write_b32 v10, v211 offset:36864
  s_mov_b64 exec, 0
  s_cmp_eq_u32 s13, 0
  s_cselect_b64 exec, -1, 0
  v_add_u32 v9, 5120, v0
  v_mul_u32_u24 v10, s28, v9
  v_lshrrev_b32 v10, 19, v10
  v_mul_u32_u24 v11, 9, v10
  v_sub_u32 v11, v9, v11
  v_lshlrev_b32 v10, 6, v10
  v_lshl_add_u32 v10, v11, 2, v10
  s_waitcnt vmcnt(1)
  ds_write_b32 v10, v212
  s_waitcnt vmcnt(0)
  ds_write_b32 v10, v213 offset:36864
  s_mov_b64 exec, -1
  s_waitcnt lgkmcnt(0)
  s_barrier
  v_lshl_add_u32 v9, v4, 3, v6
  v_lshlrev_b32 v9, 6, v9
  v_lshl_add_u32 v9, v5, 5, v9
  v_lshl_add_u32 v9, v7, 3, v9
  s_cmp_ge_u32 s13, 2
  s_cbranch_scc1 AKVD_29
  s_cmp_eq_u32 s13, 1
  s_cbranch_scc1 AV_30
  ds_read_b64_tr_b16 v[200:201], v9 offset:0
  ds_read_b64_tr_b16 v[202:203], v9 offset:256
  ds_read_b64_tr_b16 v[204:205], v9 offset:1024
  ds_read_b64_tr_b16 v[206:207], v9 offset:1280
  ds_read_b64_tr_b16 v[208:209], v9 offset:2048
  ds_read_b64_tr_b16 v[210:211], v9 offset:2304
  ds_read_b64_tr_b16 v[212:213], v9 offset:3072
  ds_read_b64_tr_b16 v[214:215], v9 offset:3328
  ds_read_b64_tr_b16 v[216:217], v9 offset:4096
  ds_read_b64_tr_b16 v[218:219], v9 offset:4352
  s_waitcnt lgkmcnt(8)
  v_mfma_f32_32x32x16_bf16 v[168:183], v[200:203], v[16:19], 0
  ds_read_b64_tr_b16 v[220:221], v9 offset:5120
  ds_read_b64_tr_b16 v[222:223], v9 offset:5376
  s_waitcnt lgkmcnt(8)
  v_mfma_f32_32x32x16_bf16 v[168:183], v[204:207], v[20:23], v[168:183]
  ds_read_b64_tr_b16 v[224:225], v9 offset:6144
  ds_read_b64_tr_b16 v[226:227], v9 offset:6400
  s_waitcnt lgkmcnt(8)
  v_mfma_f32_32x32x16_bf16 v[168:183], v[208:211], v[24:27], v[168:183]
  ds_read_b64_tr_b16 v[228:229], v9 offset:7168
  ds_read_b64_tr_b16 v[230:231], v9 offset:7424
  s_waitcnt lgkmcnt(8)
  v_mfma_f32_32x32x16_bf16 v[168:183], v[212:215], v[28:31], v[168:183]
  ds_read_b64_tr_b16 v[200:201], v9 offset:8192
  ds_read_b64_tr_b16 v[202:203], v9 offset:8448
  s_waitcnt lgkmcnt(8)
  v_mfma_f32_32x32x16_bf16 v[168:183], v[216:219], v[32:35], v[168:183]
  ds_read_b64_tr_b16 v[204:205], v9 offset:9216
  ds_read_b64_tr_b16 v[206:207], v9 offset:9472
  s_waitcnt lgkmcnt(8)
  v_mfma_f32_32x32x16_bf16 v[168:183], v[220:223], v[36:39], v[168:183]
  ds_read_b64_tr_b16 v[208:209], v9 offset:10240
  ds_read_b64_tr_b16 v[210:211], v9 offset:10496
  s_waitcnt lgkmcnt(8)
  v_mfma_f32_32x32x16_bf16 v[168:183], v[224:227], v[40:43], v[168:183]
  ds_read_b64_tr_b16 v[212:213], v9 offset:11264
  ds_read_b64_tr_b16 v[214:215], v9 offset:11520
  s_waitcnt lgkmcnt(8)
  v_mfma_f32_32x32x16_bf16 v[168:183], v[228:231], v[44:47], v[168:183]
  ds_read_b64_tr_b16 v[216:217], v9 offset:12288
  ds_read_b64_tr_b16 v[218:219], v9 offset:12544
  s_waitcnt lgkmcnt(8)
  v_mfma_f32_32x32x16_bf16 v[168:183], v[200:203], v[48:51], v[168:183]
  ds_read_b64_tr_b16 v[220:221], v9 offset:13312
  ds_read_b64_tr_b16 v[222:223], v9 offset:13568
  s_waitcnt lgkmcnt(8)
  v_mfma_f32_32x32x16_bf16 v[168:183], v[204:207], v[52:55], v[168:183]
  ds_read_b64_tr_b16 v[224:225], v9 offset:14336
  ds_read_b64_tr_b16 v[226:227], v9 offset:14592
  s_waitcnt lgkmcnt(8)
  v_mfma_f32_32x32x16_bf16 v[168:183], v[208:211], v[56:59], v[168:183]
  ds_read_b64_tr_b16 v[228:229], v9 offset:15360
  ds_read_b64_tr_b16 v[230:231], v9 offset:15616
  s_waitcnt lgkmcnt(8)
  v_mfma_f32_32x32x16_bf16 v[168:183], v[212:215], v[60:63], v[168:183]
  ds_read_b64_tr_b16 v[200:201], v9 offset:16384
  ds_read_b64_tr_b16 v[202:203], v9 offset:16640
  s_waitcnt lgkmcnt(8)
  v_mfma_f32_32x32x16_bf16 v[168:183], v[216:219], v[64:67], v[168:183]
  ds_read_b64_tr_b16 v[204:205], v9 offset:17408
  ds_read_b64_tr_b16 v[206:207], v9 offset:17664
  s_waitcnt lgkmcnt(8)
  v_mfma_f32_32x32x16_bf16 v[168:183], v[220:223], v[68:71], v[168:183]
  ds_read_b64_tr_b16 v[208:209], v9 offset:18432
  ds_read_b64_tr_b16 v[210:211], v9 offset:18688
  s_waitcnt lgkmcnt(8)
  v_mfma_f32_32x32x16_bf16 v[168:183], v[224:227], v[72:75], v[168:183]
  ds_read_b64_tr_b16 v[212:213], v9 offset:19456
  ds_read_b64_tr_b16 v[214:215], v9 offset:19712
  s_waitcnt lgkmcnt(8)
  v_mfma_f32_32x32x16_bf16 v[168:183], v[228:231], v[76:79], v[168:183]
  ds_read_b64_tr_b16 v[216:217], v9 offset:20480
  ds_read_b64_tr_b16 v[218:219], v9 offset:20736
  s_waitcnt lgkmcnt(8)
  v_mfma_f32_32x32x16_bf16 v[168:183], v[200:203], v[80:83], v[168:183]
  ds_read_b64_tr_b16 v[220:221], v9 offset:21504
  ds_read_b64_tr_b16 v[222:223], v9 offset:21760
  s_waitcnt lgkmcnt(8)
  v_mfma_f32_32x32x16_bf16 v[168:183], v[204:207], v[84:87], v[168:183]
  ds_read_b64_tr_b16 v[224:225], v9 offset:22528
  ds_read_b64_tr_b16 v[226:227], v9 offset:22784
  s_waitcnt lgkmcnt(8)
  v_mfma_f32_32x32x16_bf16 v[168:183], v[208:211], v[88:91], v[168:183]
  ds_read_b64_tr_b16 v[228:229], v9 offset:23552
  ds_read_b64_tr_b16 v[230:231], v9 offset:23808
  s_waitcnt lgkmcnt(8)
  v_mfma_f32_32x32x16_bf16 v[168:183], v[212:215], v[92:95], v[168:183]
  ds_read_b64_tr_b16 v[200:201], v9 offset:24576
  ds_read_b64_tr_b16 v[202:203], v9 offset:24832
  s_waitcnt lgkmcnt(8)
  v_mfma_f32_32x32x16_bf16 v[168:183], v[216:219], v[96:99], v[168:183]
  ds_read_b64_tr_b16 v[204:205], v9 offset:25600
  ds_read_b64_tr_b16 v[206:207], v9 offset:25856
  s_waitcnt lgkmcnt(8)
  v_mfma_f32_32x32x16_bf16 v[168:183], v[220:223], v[100:103], v[168:183]
  ds_read_b64_tr_b16 v[208:209], v9 offset:26624
  ds_read_b64_tr_b16 v[210:211], v9 offset:26880
  s_waitcnt lgkmcnt(8)
  v_mfma_f32_32x32x16_bf16 v[168:183], v[224:227], v[104:107], v[168:183]
  ds_read_b64_tr_b16 v[212:213], v9 offset:27648
  ds_read_b64_tr_b16 v[214:215], v9 offset:27904
  s_waitcnt lgkmcnt(8)
  v_mfma_f32_32x32x16_bf16 v[168:183], v[228:231], v[108:111], v[168:183]
  ds_read_b64_tr_b16 v[216:217], v9 offset:28672
  ds_read_b64_tr_b16 v[218:219], v9 offset:28928
  s_waitcnt lgkmcnt(8)
  v_mfma_f32_32x32x16_bf16 v[168:183], v[200:203], v[112:115], v[168:183]
  ds_read_b64_tr_b16 v[220:221], v9 offset:29696
  ds_read_b64_tr_b16 v[222:223], v9 offset:29952
  s_waitcnt lgkmcnt(8)
  v_mfma_f32_32x32x16_bf16 v[168:183], v[204:207], v[116:119], v[168:183]
  ds_read_b64_tr_b16 v[224:225], v9 offset:30720
  ds_read_b64_tr_b16 v[226:227], v9 offset:30976
  s_waitcnt lgkmcnt(8)
  v_mfma_f32_32x32x16_bf16 v[168:183], v[208:211], v[120:123], v[168:183]
  ds_read_b64_tr_b16 v[228:229], v9 offset:31744
  ds_read_b64_tr_b16 v[230:231], v9 offset:32000
  s_waitcnt lgkmcnt(8)
  v_mfma_f32_32x32x16_bf16 v[168:183], v[212:215], v[124:127], v[168:183]
  ds_read_b64_tr_b16 v[200:201], v9 offset:32768
  ds_read_b64_tr_b16 v[202:203], v9 offset:33024
  s_waitcnt lgkmcnt(8)
  v_mfma_f32_32x32x16_bf16 v[168:183], v[216:219], v[128:131], v[168:183]
  ds_read_b64_tr_b16 v[204:205], v9 offset:33792
  ds_read_b64_tr_b16 v[206:207], v9 offset:34048
  s_waitcnt lgkmcnt(8)
  v_mfma_f32_32x32x16_bf16 v[168:183], v[220:223], v[132:135], v[168:183]
  ds_read_b64_tr_b16 v[208:209], v9 offset:34816
  ds_read_b64_tr_b16 v[210:211], v9 offset:35072
  s_waitcnt lgkmcnt(8)
  v_mfma_f32_32x32x16_bf16 v[168:183], v[224:227], v[136:139], v[168:183]
  ds_read_b64_tr_b16 v[212:213], v9 offset:35840
  ds_read_b64_tr_b16 v[214:215], v9 offset:36096
  s_waitcnt lgkmcnt(8)
  v_mfma_f32_32x32x16_bf16 v[168:183], v[228:231], v[140:143], v[168:183]
  s_waitcnt lgkmcnt(6)
  v_mfma_f32_32x32x16_bf16 v[168:183], v[200:203], v[144:147], v[168:183]
  s_waitcnt lgkmcnt(4)
  v_mfma_f32_32x32x16_bf16 v[168:183], v[204:207], v[148:151], v[168:183]
  s_waitcnt lgkmcnt(2)
  v_mfma_f32_32x32x16_bf16 v[168:183], v[208:211], v[152:155], v[168:183]
  s_waitcnt lgkmcnt(0)
  v_mfma_f32_32x32x16_bf16 v[168:183], v[212:215], v[156:159], v[168:183]
  s_nop 11
  v_cvt_pk_bf16_f32 v184, v168, v169
  v_cvt_pk_bf16_f32 v185, v170, v171
  v_cvt_pk_bf16_f32 v186, v172, v173
  v_cvt_pk_bf16_f32 v187, v174, v175
  v_cvt_pk_bf16_f32 v188, v176, v177
  s_lshl_b32 s36, s12, 10
  s_add_u32 s36, s36, 67108864
  buffer_store_dwordx4 v[184:187], v2, s[4:7], s36 offen sc1
  s_lshl_b32 s36, s12, 7
  s_add_u32 s36, s36, 67174400
  v_lshlrev_b32 v10, 2, v3
  s_mov_b64 exec, 0xffffffff
  buffer_store_dword v188, v10, s[4:7], s36 offen sc1
  s_mov_b64 exec, -1
  s_branch AKVD_29
AV_30:
  v_add_u32 v9, 36864, v9
  ds_read_b64_tr_b16 v[200:201], v9 offset:0
  ds_read_b64_tr_b16 v[202:203], v9 offset:256
  ds_read_b64_tr_b16 v[204:205], v9 offset:1024
  ds_read_b64_tr_b16 v[206:207], v9 offset:1280
  ds_read_b64_tr_b16 v[208:209], v9 offset:2048
  ds_read_b64_tr_b16 v[210:211], v9 offset:2304
  ds_read_b64_tr_b16 v[212:213], v9 offset:3072
  ds_read_b64_tr_b16 v[214:215], v9 offset:3328
  ds_read_b64_tr_b16 v[216:217], v9 offset:4096
  ds_read_b64_tr_b16 v[218:219], v9 offset:4352
  s_waitcnt lgkmcnt(8)
  v_mfma_f32_32x32x16_bf16 v[168:183], v[16:19], v[200:203], 0
  ds_read_b64_tr_b16 v[220:221], v9 offset:5120
  ds_read_b64_tr_b16 v[222:223], v9 offset:5376
  s_waitcnt lgkmcnt(8)
  v_mfma_f32_32x32x16_bf16 v[168:183], v[20:23], v[204:207], v[168:183]
  ds_read_b64_tr_b16 v[224:225], v9 offset:6144
  ds_read_b64_tr_b16 v[226:227], v9 offset:6400
  s_waitcnt lgkmcnt(8)
  v_mfma_f32_32x32x16_bf16 v[168:183], v[24:27], v[208:211], v[168:183]
  ds_read_b64_tr_b16 v[228:229], v9 offset:7168
  ds_read_b64_tr_b16 v[230:231], v9 offset:7424
  s_waitcnt lgkmcnt(8)
  v_mfma_f32_32x32x16_bf16 v[168:183], v[28:31], v[212:215], v[168:183]
  ds_read_b64_tr_b16 v[200:201], v9 offset:8192
  ds_read_b64_tr_b16 v[202:203], v9 offset:8448
  s_waitcnt lgkmcnt(8)
  v_mfma_f32_32x32x16_bf16 v[168:183], v[32:35], v[216:219], v[168:183]
  ds_read_b64_tr_b16 v[204:205], v9 offset:9216
  ds_read_b64_tr_b16 v[206:207], v9 offset:9472
  s_waitcnt lgkmcnt(8)
  v_mfma_f32_32x32x16_bf16 v[168:183], v[36:39], v[220:223], v[168:183]
  ds_read_b64_tr_b16 v[208:209], v9 offset:10240
  ds_read_b64_tr_b16 v[210:211], v9 offset:10496
  s_waitcnt lgkmcnt(8)
  v_mfma_f32_32x32x16_bf16 v[168:183], v[40:43], v[224:227], v[168:183]
  ds_read_b64_tr_b16 v[212:213], v9 offset:11264
  ds_read_b64_tr_b16 v[214:215], v9 offset:11520
  s_waitcnt lgkmcnt(8)
  v_mfma_f32_32x32x16_bf16 v[168:183], v[44:47], v[228:231], v[168:183]
  ds_read_b64_tr_b16 v[216:217], v9 offset:12288
  ds_read_b64_tr_b16 v[218:219], v9 offset:12544
  s_waitcnt lgkmcnt(8)
  v_mfma_f32_32x32x16_bf16 v[168:183], v[48:51], v[200:203], v[168:183]
  ds_read_b64_tr_b16 v[220:221], v9 offset:13312
  ds_read_b64_tr_b16 v[222:223], v9 offset:13568
  s_waitcnt lgkmcnt(8)
  v_mfma_f32_32x32x16_bf16 v[168:183], v[52:55], v[204:207], v[168:183]
  ds_read_b64_tr_b16 v[224:225], v9 offset:14336
  ds_read_b64_tr_b16 v[226:227], v9 offset:14592
  s_waitcnt lgkmcnt(8)
  v_mfma_f32_32x32x16_bf16 v[168:183], v[56:59], v[208:211], v[168:183]
  ds_read_b64_tr_b16 v[228:229], v9 offset:15360
  ds_read_b64_tr_b16 v[230:231], v9 offset:15616
  s_waitcnt lgkmcnt(8)
  v_mfma_f32_32x32x16_bf16 v[168:183], v[60:63], v[212:215], v[168:183]
  ds_read_b64_tr_b16 v[200:201], v9 offset:16384
  ds_read_b64_tr_b16 v[202:203], v9 offset:16640
  s_waitcnt lgkmcnt(8)
  v_mfma_f32_32x32x16_bf16 v[168:183], v[64:67], v[216:219], v[168:183]
  ds_read_b64_tr_b16 v[204:205], v9 offset:17408
  ds_read_b64_tr_b16 v[206:207], v9 offset:17664
  s_waitcnt lgkmcnt(8)
  v_mfma_f32_32x32x16_bf16 v[168:183], v[68:71], v[220:223], v[168:183]
  ds_read_b64_tr_b16 v[208:209], v9 offset:18432
  ds_read_b64_tr_b16 v[210:211], v9 offset:18688
  s_waitcnt lgkmcnt(8)
  v_mfma_f32_32x32x16_bf16 v[168:183], v[72:75], v[224:227], v[168:183]
  ds_read_b64_tr_b16 v[212:213], v9 offset:19456
  ds_read_b64_tr_b16 v[214:215], v9 offset:19712
  s_waitcnt lgkmcnt(8)
  v_mfma_f32_32x32x16_bf16 v[168:183], v[76:79], v[228:231], v[168:183]
  ds_read_b64_tr_b16 v[216:217], v9 offset:20480
  ds_read_b64_tr_b16 v[218:219], v9 offset:20736
  s_waitcnt lgkmcnt(8)
  v_mfma_f32_32x32x16_bf16 v[168:183], v[80:83], v[200:203], v[168:183]
  ds_read_b64_tr_b16 v[220:221], v9 offset:21504
  ds_read_b64_tr_b16 v[222:223], v9 offset:21760
  s_waitcnt lgkmcnt(8)
  v_mfma_f32_32x32x16_bf16 v[168:183], v[84:87], v[204:207], v[168:183]
  ds_read_b64_tr_b16 v[224:225], v9 offset:22528
  ds_read_b64_tr_b16 v[226:227], v9 offset:22784
  s_waitcnt lgkmcnt(8)
  v_mfma_f32_32x32x16_bf16 v[168:183], v[88:91], v[208:211], v[168:183]
  ds_read_b64_tr_b16 v[228:229], v9 offset:23552
  ds_read_b64_tr_b16 v[230:231], v9 offset:23808
  s_waitcnt lgkmcnt(8)
  v_mfma_f32_32x32x16_bf16 v[168:183], v[92:95], v[212:215], v[168:183]
  ds_read_b64_tr_b16 v[200:201], v9 offset:24576
  ds_read_b64_tr_b16 v[202:203], v9 offset:24832
  s_waitcnt lgkmcnt(8)
  v_mfma_f32_32x32x16_bf16 v[168:183], v[96:99], v[216:219], v[168:183]
  ds_read_b64_tr_b16 v[204:205], v9 offset:25600
  ds_read_b64_tr_b16 v[206:207], v9 offset:25856
  s_waitcnt lgkmcnt(8)
  v_mfma_f32_32x32x16_bf16 v[168:183], v[100:103], v[220:223], v[168:183]
  ds_read_b64_tr_b16 v[208:209], v9 offset:26624
  ds_read_b64_tr_b16 v[210:211], v9 offset:26880
  s_waitcnt lgkmcnt(8)
  v_mfma_f32_32x32x16_bf16 v[168:183], v[104:107], v[224:227], v[168:183]
  ds_read_b64_tr_b16 v[212:213], v9 offset:27648
  ds_read_b64_tr_b16 v[214:215], v9 offset:27904
  s_waitcnt lgkmcnt(8)
  v_mfma_f32_32x32x16_bf16 v[168:183], v[108:111], v[228:231], v[168:183]
  ds_read_b64_tr_b16 v[216:217], v9 offset:28672
  ds_read_b64_tr_b16 v[218:219], v9 offset:28928
  s_waitcnt lgkmcnt(8)
  v_mfma_f32_32x32x16_bf16 v[168:183], v[112:115], v[200:203], v[168:183]
  ds_read_b64_tr_b16 v[220:221], v9 offset:29696
  ds_read_b64_tr_b16 v[222:223], v9 offset:29952
  s_waitcnt lgkmcnt(8)
  v_mfma_f32_32x32x16_bf16 v[168:183], v[116:119], v[204:207], v[168:183]
  ds_read_b64_tr_b16 v[224:225], v9 offset:30720
  ds_read_b64_tr_b16 v[226:227], v9 offset:30976
  s_waitcnt lgkmcnt(8)
  v_mfma_f32_32x32x16_bf16 v[168:183], v[120:123], v[208:211], v[168:183]
  ds_read_b64_tr_b16 v[228:229], v9 offset:31744
  ds_read_b64_tr_b16 v[230:231], v9 offset:32000
  s_waitcnt lgkmcnt(8)
  v_mfma_f32_32x32x16_bf16 v[168:183], v[124:127], v[212:215], v[168:183]
  ds_read_b64_tr_b16 v[200:201], v9 offset:32768
  ds_read_b64_tr_b16 v[202:203], v9 offset:33024
  s_waitcnt lgkmcnt(8)
  v_mfma_f32_32x32x16_bf16 v[168:183], v[128:131], v[216:219], v[168:183]
  ds_read_b64_tr_b16 v[204:205], v9 offset:33792
  ds_read_b64_tr_b16 v[206:207], v9 offset:34048
  s_waitcnt lgkmcnt(8)
  v_mfma_f32_32x32x16_bf16 v[168:183], v[132:135], v[220:223], v[168:183]
  ds_read_b64_tr_b16 v[208:209], v9 offset:34816
  ds_read_b64_tr_b16 v[210:211], v9 offset:35072
  s_waitcnt lgkmcnt(8)
  v_mfma_f32_32x32x16_bf16 v[168:183], v[136:139], v[224:227], v[168:183]
  ds_read_b64_tr_b16 v[212:213], v9 offset:35840
  ds_read_b64_tr_b16 v[214:215], v9 offset:36096
  s_waitcnt lgkmcnt(8)
  v_mfma_f32_32x32x16_bf16 v[168:183], v[140:143], v[228:231], v[168:183]
  s_waitcnt lgkmcnt(6)
  v_mfma_f32_32x32x16_bf16 v[168:183], v[144:147], v[200:203], v[168:183]
  s_waitcnt lgkmcnt(4)
  v_mfma_f32_32x32x16_bf16 v[168:183], v[148:151], v[204:207], v[168:183]
  s_waitcnt lgkmcnt(2)
  v_mfma_f32_32x32x16_bf16 v[168:183], v[152:155], v[208:211], v[168:183]
  s_waitcnt lgkmcnt(0)
  v_mfma_f32_32x32x16_bf16 v[168:183], v[156:159], v[212:215], v[168:183]
  v_cmp_eq_u32 vcc, 18, v3
  v_mov_b32 v11, 0x3f803f80
  s_nop 9
  v_cvt_pk_bf16_f32 v184, v168, v169
  v_cndmask_b32 v184, v184, v11, vcc
  v_cvt_pk_bf16_f32 v185, v170, v171
  v_cndmask_b32 v185, v185, v11, vcc
  v_cvt_pk_bf16_f32 v186, v176, v177
  v_cndmask_b32 v186, v186, v11, vcc
  v_cvt_pk_bf16_f32 v187, v178, v179
  v_cndmask_b32 v187, v187, v11, vcc
  v_cvt_pk_bf16_f32 v188, v172, v173
  v_cndmask_b32 v188, v188, v11, vcc
  v_cvt_pk_bf16_f32 v189, v174, v175
  v_cndmask_b32 v189, v189, v11, vcc
  v_cvt_pk_bf16_f32 v190, v180, v181
  v_cndmask_b32 v190, v190, v11, vcc
  v_cvt_pk_bf16_f32 v191, v182, v183
  v_cndmask_b32 v191, v191, v11, vcc
  v_mul_u32_u24 v10, 320, v4
  v_lshl_add_u32 v10, v3, 4, v10
  s_mul_i32 s36, s12, 1280
  s_add_u32 s36, s36, 67182592
  s_mov_b32 exec_lo, 0xfffff
  s_mov_b32 exec_hi, 0xfffff
  buffer_store_dwordx4 v[184:187], v10, s[4:7], s36 offen sc1
  buffer_store_dwordx4 v[188:191], v10, s[4:7], s36 offen offset:640 sc1
  s_mov_b64 exec, -1
AKVD_29:
  s_waitcnt vmcnt(0)
  s_barrier
  s_cmp_lg_u32 s13, 0
  s_cbranch_scc1 ANA_31
  s_mov_b64 exec, 1
  v_mov_b32 v9, 0
  v_mov_b32 v10, 1
  global_atomic_add v9, v10, s[66:67] offset:224
  s_mov_b64 exec, -1
ANA_31:
  s_mov_b32 s30, 0
  s_add_u32 m0, s31, 0
  s_nop 0
  buffer_load_dwordx4 v160, s[8:11], s30 offen offset:0 lds
  s_add_u32 m0, m0, 1024
  s_nop 0
  buffer_load_dwordx4 v161, s[8:11], s30 offen offset:0 lds
  s_add_u32 m0, m0, 1024
  s_nop 0
  buffer_load_dwordx4 v162, s[8:11], s30 offen offset:0 lds
  s_add_u32 m0, m0, 1024
  s_nop 0
  buffer_load_dwordx4 v163, s[8:11], s30 offen offset:0 lds
  s_add_u32 m0, m0, 1024
  s_nop 0
  buffer_load_dwordx4 v164, s[8:11], s30 offen offset:0 lds
  s_add_u32 s30, s30, 18432
  s_add_u32 m0, s31, 5120
  s_nop 0
  buffer_load_dwordx4 v160, s[8:11], s30 offen offset:0 lds
  s_add_u32 m0, m0, 1024
  s_nop 0
  buffer_load_dwordx4 v161, s[8:11], s30 offen offset:0 lds
  s_add_u32 m0, m0, 1024
  s_nop 0
  buffer_load_dwordx4 v162, s[8:11], s30 offen offset:0 lds
  s_add_u32 m0, m0, 1024
  s_nop 0
  buffer_load_dwordx4 v163, s[8:11], s30 offen offset:0 lds
  s_add_u32 m0, m0, 1024
  s_nop 0
  buffer_load_dwordx4 v164, s[8:11], s30 offen offset:0 lds
  s_add_u32 s30, s30, 18432
  s_add_u32 m0, s31, 10240
  s_nop 0
  buffer_load_dwordx4 v160, s[8:11], s30 offen offset:0 lds
  s_add_u32 m0, m0, 1024
  s_nop 0
  buffer_load_dwordx4 v161, s[8:11], s30 offen offset:0 lds
  s_add_u32 m0, m0, 1024
  s_nop 0
  buffer_load_dwordx4 v162, s[8:11], s30 offen offset:0 lds
  s_add_u32 m0, m0, 1024
  s_nop 0
  buffer_load_dwordx4 v163, s[8:11], s30 offen offset:0 lds
  s_add_u32 m0, m0, 1024
  s_nop 0
  buffer_load_dwordx4 v164, s[8:11], s30 offen offset:0 lds
  s_add_u32 s30, s30, 18432
  s_add_u32 m0, s31, 15360
  s_nop 0
  buffer_load_dwordx4 v160, s[8:11], s30 offen offset:0 lds
  s_add_u32 m0, m0, 1024
  s_nop 0
  buffer_load_dwordx4 v161, s[8:11], s30 offen offset:0 lds
  s_add_u32 m0, m0, 1024
  s_nop 0
  buffer_load_dwordx4 v162, s[8:11], s30 offen offset:0 lds
  s_add_u32 m0, m0, 1024
  s_nop 0
  buffer_load_dwordx4 v163, s[8:11], s30 offen offset:0 lds
  s_add_u32 m0, m0, 1024
  s_nop 0
  buffer_load_dwordx4 v164, s[8:11], s30 offen offset:0 lds
  s_add_u32 s30, s30, 18432
  s_add_u32 m0, s31, 20480
  s_nop 0
  buffer_load_dwordx4 v160, s[8:11], s30 offen offset:0 lds
  s_add_u32 m0, m0, 1024
  s_nop 0
  buffer_load_dwordx4 v161, s[8:11], s30 offen offset:0 lds
  s_add_u32 m0, m0, 1024
  s_nop 0
  buffer_load_dwordx4 v162, s[8:11], s30 offen offset:0 lds
  s_add_u32 m0, m0, 1024
  s_nop 0
  buffer_load_dwordx4 v163, s[8:11], s30 offen offset:0 lds
  s_add_u32 m0, m0, 1024
  s_nop 0
  buffer_load_dwordx4 v164, s[8:11], s30 offen offset:0 lds
  s_add_u32 s30, s30, 18432
  s_add_u32 m0, s31, 25600
  s_nop 0
  buffer_load_dwordx4 v160, s[8:11], s30 offen offset:0 lds
  s_add_u32 m0, m0, 1024
  s_nop 0
  buffer_load_dwordx4 v161, s[8:11], s30 offen offset:0 lds
  s_add_u32 m0, m0, 1024
  s_nop 0
  buffer_load_dwordx4 v162, s[8:11], s30 offen offset:0 lds
  s_add_u32 m0, m0, 1024
  s_nop 0
  buffer_load_dwordx4 v163, s[8:11], s30 offen offset:0 lds
  s_add_u32 m0, m0, 1024
  s_nop 0
  buffer_load_dwordx4 v164, s[8:11], s30 offen offset:0 lds
  s_add_u32 s30, s30, 18432
  s_add_u32 m0, s31, 30720
  s_nop 0
  buffer_load_dwordx4 v160, s[8:11], s30 offen offset:0 lds
  s_add_u32 m0, m0, 1024
  s_nop 0
  buffer_load_dwordx4 v161, s[8:11], s30 offen offset:0 lds
  s_add_u32 m0, m0, 1024
  s_nop 0
  buffer_load_dwordx4 v162, s[8:11], s30 offen offset:0 lds
  s_add_u32 m0, m0, 1024
  s_nop 0
  buffer_load_dwordx4 v163, s[8:11], s30 offen offset:0 lds
  s_add_u32 m0, m0, 1024
  s_nop 0
  buffer_load_dwordx4 v164, s[8:11], s30 offen offset:0 lds
  s_add_u32 s30, s30, 18432
  s_add_u32 m0, s31, 35840
  s_nop 0
  buffer_load_dwordx4 v160, s[8:11], s30 offen offset:0 lds
  s_add_u32 m0, m0, 1024
  s_nop 0
  buffer_load_dwordx4 v161, s[8:11], s30 offen offset:0 lds
  s_add_u32 m0, m0, 1024
  s_nop 0
  buffer_load_dwordx4 v162, s[8:11], s30 offen offset:0 lds
  s_add_u32 m0, m0, 1024
  s_nop 0
  buffer_load_dwordx4 v163, s[8:11], s30 offen offset:0 lds
  s_add_u32 m0, m0, 1024
  s_nop 0
  buffer_load_dwordx4 v164, s[8:11], s30 offen offset:0 lds
  s_add_u32 s30, s30, 18432
  s_waitcnt vmcnt(35)
  ds_read_b64_tr_b16 v[200:201], v165 offset:0
  ds_read_b64_tr_b16 v[202:203], v165 offset:1280
  ds_read_b64_tr_b16 v[204:205], v165 offset:64
  ds_read_b64_tr_b16 v[206:207], v165 offset:1344
  ds_read_b64_tr_b16 v[208:209], v165 offset:128
  ds_read_b64_tr_b16 v[210:211], v165 offset:1408
  ds_read_b64_tr_b16 v[212:213], v165 offset:192
  ds_read_b64_tr_b16 v[214:215], v165 offset:1472
  ds_read_b64_tr_b16 v[216:217], v165 offset:256
  ds_read_b64_tr_b16 v[218:219], v165 offset:1536
  s_waitcnt vmcnt(30)
  ds_read_b64_tr_b16 v[220:221], v165 offset:5120
  ds_read_b64_tr_b16 v[222:223], v165 offset:6400
  ds_read_b64_tr_b16 v[224:225], v165 offset:5184
  ds_read_b64_tr_b16 v[226:227], v165 offset:6464
  ds_read_b64_tr_b16 v[228:229], v165 offset:5248
  ds_read_b64_tr_b16 v[230:231], v165 offset:6528
  ds_read_b64_tr_b16 v[232:233], v165 offset:5312
  ds_read_b64_tr_b16 v[234:235], v165 offset:6592
  ds_read_b64_tr_b16 v[236:237], v165 offset:5376
  ds_read_b64_tr_b16 v[238:239], v165 offset:6656
  s_waitcnt lgkmcnt(15)
  v_mfma_f32_32x32x16_bf16 a[0:15], v[200:203], v[16:19], 0
  v_mfma_f32_32x32x16_bf16 a[16:31], v[204:207], v[16:19], 0
  s_waitcnt lgkmcnt(14)
  v_mfma_f32_32x32x16_bf16 a[32:47], v[208:211], v[16:19], 0
  s_waitcnt lgkmcnt(12)
  v_mfma_f32_32x32x16_bf16 a[48:63], v[212:215], v[16:19], 0
  s_waitcnt lgkmcnt(10)
  v_mfma_f32_32x32x16_bf16 a[64:79], v[216:219], v[16:19], 0
  s_add_u32 m0, s31, 0
  s_nop 0
  buffer_load_dwordx4 v160, s[8:11], s30 offen offset:0 lds
  s_add_u32 m0, m0, 1024
  s_nop 0
  buffer_load_dwordx4 v161, s[8:11], s30 offen offset:0 lds
  s_add_u32 m0, m0, 1024
  s_nop 0
  buffer_load_dwordx4 v162, s[8:11], s30 offen offset:0 lds
  s_add_u32 m0, m0, 1024
  s_nop 0
  buffer_load_dwordx4 v163, s[8:11], s30 offen offset:0 lds
  s_add_u32 m0, m0, 1024
  s_nop 0
  buffer_load_dwordx4 v164, s[8:11], s30 offen offset:0 lds
  s_add_u32 s30, s30, 18432
  s_waitcnt vmcnt(30)
  ds_read_b64_tr_b16 v[200:201], v165 offset:10240
  ds_read_b64_tr_b16 v[202:203], v165 offset:11520
  ds_read_b64_tr_b16 v[204:205], v165 offset:10304
  ds_read_b64_tr_b16 v[206:207], v165 offset:11584
  ds_read_b64_tr_b16 v[208:209], v165 offset:10368
  ds_read_b64_tr_b16 v[210:211], v165 offset:11648
  ds_read_b64_tr_b16 v[212:213], v165 offset:10432
  ds_read_b64_tr_b16 v[214:215], v165 offset:11712
  ds_read_b64_tr_b16 v[216:217], v165 offset:10496
  ds_read_b64_tr_b16 v[218:219], v165 offset:11776
  s_waitcnt lgkmcnt(15)
  v_mfma_f32_32x32x16_bf16 a[0:15], v[220:223], v[20:23], a[0:15]
  v_mfma_f32_32x32x16_bf16 a[16:31], v[224:227], v[20:23], a[16:31]
  s_waitcnt lgkmcnt(14)
  v_mfma_f32_32x32x16_bf16 a[32:47], v[228:231], v[20:23], a[32:47]
  s_waitcnt lgkmcnt(12)
  v_mfma_f32_32x32x16_bf16 a[48:63], v[232:235], v[20:23], a[48:63]
  s_waitcnt lgkmcnt(10)
  v_mfma_f32_32x32x16_bf16 a[64:79], v[236:239], v[20:23], a[64:79]
  s_add_u32 m0, s31, 5120
  s_nop 0
  buffer_load_dwordx4 v160, s[8:11], s30 offen offset:0 lds
  s_add_u32 m0, m0, 1024
  s_nop 0
  buffer_load_dwordx4 v161, s[8:11], s30 offen offset:0 lds
  s_add_u32 m0, m0, 1024
  s_nop 0
  buffer_load_dwordx4 v162, s[8:11], s30 offen offset:0 lds
  s_add_u32 m0, m0, 1024
  s_nop 0
  buffer_load_dwordx4 v163, s[8:11], s30 offen offset:0 lds
  s_add_u32 m0, m0, 1024
  s_nop 0
  buffer_load_dwordx4 v164, s[8:11], s30 offen offset:0 lds
  s_add_u32 s30, s30, 18432
  s_waitcnt vmcnt(30)
  ds_read_b64_tr_b16 v[220:221], v165 offset:15360
  ds_read_b64_tr_b16 v[222:223], v165 offset:16640
  ds_read_b64_tr_b16 v[224:225], v165 offset:15424
  ds_read_b64_tr_b16 v[226:227], v165 offset:16704
  ds_read_b64_tr_b16 v[228:229], v165 offset:15488
  ds_read_b64_tr_b16 v[230:231], v165 offset:16768
  ds_read_b64_tr_b16 v[232:233], v165 offset:15552
  ds_read_b64_tr_b16 v[234:235], v165 offset:16832
  ds_read_b64_tr_b16 v[236:237], v165 offset:15616
  ds_read_b64_tr_b16 v[238:239], v165 offset:16896
  s_waitcnt lgkmcnt(15)
  v_mfma_f32_32x32x16_bf16 a[0:15], v[200:203], v[24:27], a[0:15]
  v_mfma_f32_32x32x16_bf16 a[16:31], v[204:207], v[24:27], a[16:31]
  s_waitcnt lgkmcnt(14)
  v_mfma_f32_32x32x16_bf16 a[32:47], v[208:211], v[24:27], a[32:47]
  s_waitcnt lgkmcnt(12)
  v_mfma_f32_32x32x16_bf16 a[48:63], v[212:215], v[24:27], a[48:63]
  s_waitcnt lgkmcnt(10)
  v_mfma_f32_32x32x16_bf16 a[64:79], v[216:219], v[24:27], a[64:79]
  s_add_u32 m0, s31, 10240
  s_nop 0
  buffer_load_dwordx4 v160, s[8:11], s30 offen offset:0 lds
  s_add_u32 m0, m0, 1024
  s_nop 0
  buffer_load_dwordx4 v161, s[8:11], s30 offen offset:0 lds
  s_add_u32 m0, m0, 1024
  s_nop 0
  buffer_load_dwordx4 v162, s[8:11], s30 offen offset:0 lds
  s_add_u32 m0, m0, 1024
  s_nop 0
  buffer_load_dwordx4 v163, s[8:11], s30 offen offset:0 lds
  s_add_u32 m0, m0, 1024
  s_nop 0
  buffer_load_dwordx4 v164, s[8:11], s30 offen offset:0 lds
  s_add_u32 s30, s30, 18432
  s_waitcnt vmcnt(30)
  ds_read_b64_tr_b16 v[200:201], v165 offset:20480
  ds_read_b64_tr_b16 v[202:203], v165 offset:21760
  ds_read_b64_tr_b16 v[204:205], v165 offset:20544
  ds_read_b64_tr_b16 v[206:207], v165 offset:21824
  ds_read_b64_tr_b16 v[208:209], v165 offset:20608
  ds_read_b64_tr_b16 v[210:211], v165 offset:21888
  ds_read_b64_tr_b16 v[212:213], v165 offset:20672
  ds_read_b64_tr_b16 v[214:215], v165 offset:21952
  ds_read_b64_tr_b16 v[216:217], v165 offset:20736
  ds_read_b64_tr_b16 v[218:219], v165 offset:22016
  s_waitcnt lgkmcnt(15)
  v_mfma_f32_32x32x16_bf16 a[0:15], v[220:223], v[28:31], a[0:15]
  v_mfma_f32_32x32x16_bf16 a[16:31], v[224:227], v[28:31], a[16:31]
  s_waitcnt lgkmcnt(14)
  v_mfma_f32_32x32x16_bf16 a[32:47], v[228:231], v[28:31], a[32:47]
  s_waitcnt lgkmcnt(12)
  v_mfma_f32_32x32x16_bf16 a[48:63], v[232:235], v[28:31], a[48:63]
  s_waitcnt lgkmcnt(10)
  v_mfma_f32_32x32x16_bf16 a[64:79], v[236:239], v[28:31], a[64:79]
  s_add_u32 m0, s31, 15360
  s_nop 0
  buffer_load_dwordx4 v160, s[8:11], s30 offen offset:0 lds
  s_add_u32 m0, m0, 1024
  s_nop 0
  buffer_load_dwordx4 v161, s[8:11], s30 offen offset:0 lds
  s_add_u32 m0, m0, 1024
  s_nop 0
  buffer_load_dwordx4 v162, s[8:11], s30 offen offset:0 lds
  s_add_u32 m0, m0, 1024
  s_nop 0
  buffer_load_dwordx4 v163, s[8:11], s30 offen offset:0 lds
  s_add_u32 m0, m0, 1024
  s_nop 0
  buffer_load_dwordx4 v164, s[8:11], s30 offen offset:0 lds
  s_add_u32 s30, s30, 18432
  s_waitcnt vmcnt(30)
  ds_read_b64_tr_b16 v[220:221], v165 offset:25600
  ds_read_b64_tr_b16 v[222:223], v165 offset:26880
  ds_read_b64_tr_b16 v[224:225], v165 offset:25664
  ds_read_b64_tr_b16 v[226:227], v165 offset:26944
  ds_read_b64_tr_b16 v[228:229], v165 offset:25728
  ds_read_b64_tr_b16 v[230:231], v165 offset:27008
  ds_read_b64_tr_b16 v[232:233], v165 offset:25792
  ds_read_b64_tr_b16 v[234:235], v165 offset:27072
  ds_read_b64_tr_b16 v[236:237], v165 offset:25856
  ds_read_b64_tr_b16 v[238:239], v165 offset:27136
  s_waitcnt lgkmcnt(15)
  v_mfma_f32_32x32x16_bf16 a[0:15], v[200:203], v[32:35], a[0:15]
  v_mfma_f32_32x32x16_bf16 a[16:31], v[204:207], v[32:35], a[16:31]
  s_waitcnt lgkmcnt(14)
  v_mfma_f32_32x32x16_bf16 a[32:47], v[208:211], v[32:35], a[32:47]
  s_waitcnt lgkmcnt(12)
  v_mfma_f32_32x32x16_bf16 a[48:63], v[212:215], v[32:35], a[48:63]
  s_waitcnt lgkmcnt(10)
  v_mfma_f32_32x32x16_bf16 a[64:79], v[216:219], v[32:35], a[64:79]
  s_add_u32 m0, s31, 20480
  s_nop 0
  buffer_load_dwordx4 v160, s[8:11], s30 offen offset:0 lds
  s_add_u32 m0, m0, 1024
  s_nop 0
  buffer_load_dwordx4 v161, s[8:11], s30 offen offset:0 lds
  s_add_u32 m0, m0, 1024
  s_nop 0
  buffer_load_dwordx4 v162, s[8:11], s30 offen offset:0 lds
  s_add_u32 m0, m0, 1024
  s_nop 0
  buffer_load_dwordx4 v163, s[8:11], s30 offen offset:0 lds
  s_add_u32 m0, m0, 1024
  s_nop 0
  buffer_load_dwordx4 v164, s[8:11], s30 offen offset:0 lds
  s_add_u32 s30, s30, 18432
  s_waitcnt vmcnt(30)
  ds_read_b64_tr_b16 v[200:201], v165 offset:30720
  ds_read_b64_tr_b16 v[202:203], v165 offset:32000
  ds_read_b64_tr_b16 v[204:205], v165 offset:30784
  ds_read_b64_tr_b16 v[206:207], v165 offset:32064
  ds_read_b64_tr_b16 v[208:209], v165 offset:30848
  ds_read_b64_tr_b16 v[210:211], v165 offset:32128
  ds_read_b64_tr_b16 v[212:213], v165 offset:30912
  ds_read_b64_tr_b16 v[214:215], v165 offset:32192
  ds_read_b64_tr_b16 v[216:217], v165 offset:30976
  ds_read_b64_tr_b16 v[218:219], v165 offset:32256
  s_waitcnt lgkmcnt(15)
  v_mfma_f32_32x32x16_bf16 a[0:15], v[220:223], v[36:39], a[0:15]
  v_mfma_f32_32x32x16_bf16 a[16:31], v[224:227], v[36:39], a[16:31]
  s_waitcnt lgkmcnt(14)
  v_mfma_f32_32x32x16_bf16 a[32:47], v[228:231], v[36:39], a[32:47]
  s_waitcnt lgkmcnt(12)
  v_mfma_f32_32x32x16_bf16 a[48:63], v[232:235], v[36:39], a[48:63]
  s_waitcnt lgkmcnt(10)
  v_mfma_f32_32x32x16_bf16 a[64:79], v[236:239], v[36:39], a[64:79]
  s_add_u32 m0, s31, 25600
  s_nop 0
  buffer_load_dwordx4 v160, s[8:11], s30 offen offset:0 lds
  s_add_u32 m0, m0, 1024
  s_nop 0
  buffer_load_dwordx4 v161, s[8:11], s30 offen offset:0 lds
  s_add_u32 m0, m0, 1024
  s_nop 0
  buffer_load_dwordx4 v162, s[8:11], s30 offen offset:0 lds
  s_add_u32 m0, m0, 1024
  s_nop 0
  buffer_load_dwordx4 v163, s[8:11], s30 offen offset:0 lds
  s_add_u32 m0, m0, 1024
  s_nop 0
  buffer_load_dwordx4 v164, s[8:11], s30 offen offset:0 lds
  s_add_u32 s30, s30, 18432
  s_waitcnt vmcnt(30)
  ds_read_b64_tr_b16 v[220:221], v165 offset:35840
  ds_read_b64_tr_b16 v[222:223], v165 offset:37120
  ds_read_b64_tr_b16 v[224:225], v165 offset:35904
  ds_read_b64_tr_b16 v[226:227], v165 offset:37184
  ds_read_b64_tr_b16 v[228:229], v165 offset:35968
  ds_read_b64_tr_b16 v[230:231], v165 offset:37248
  ds_read_b64_tr_b16 v[232:233], v165 offset:36032
  ds_read_b64_tr_b16 v[234:235], v165 offset:37312
  ds_read_b64_tr_b16 v[236:237], v165 offset:36096
  ds_read_b64_tr_b16 v[238:239], v165 offset:37376
  s_waitcnt lgkmcnt(15)
  v_mfma_f32_32x32x16_bf16 a[0:15], v[200:203], v[40:43], a[0:15]
  v_mfma_f32_32x32x16_bf16 a[16:31], v[204:207], v[40:43], a[16:31]
  s_waitcnt lgkmcnt(14)
  v_mfma_f32_32x32x16_bf16 a[32:47], v[208:211], v[40:43], a[32:47]
  s_waitcnt lgkmcnt(12)
  v_mfma_f32_32x32x16_bf16 a[48:63], v[212:215], v[40:43], a[48:63]
  s_waitcnt lgkmcnt(10)
  v_mfma_f32_32x32x16_bf16 a[64:79], v[216:219], v[40:43], a[64:79]
  s_add_u32 m0, s31, 30720
  s_nop 0
  buffer_load_dwordx4 v160, s[8:11], s30 offen offset:0 lds
  s_add_u32 m0, m0, 1024
  s_nop 0
  buffer_load_dwordx4 v161, s[8:11], s30 offen offset:0 lds
  s_add_u32 m0, m0, 1024
  s_nop 0
  buffer_load_dwordx4 v162, s[8:11], s30 offen offset:0 lds
  s_add_u32 m0, m0, 1024
  s_nop 0
  buffer_load_dwordx4 v163, s[8:11], s30 offen offset:0 lds
  s_add_u32 m0, m0, 1024
  s_nop 0
  buffer_load_dwordx4 v164, s[8:11], s30 offen offset:0 lds
  s_add_u32 s30, s30, 18432
  s_waitcnt vmcnt(30)
  ds_read_b64_tr_b16 v[200:201], v165 offset:0
  ds_read_b64_tr_b16 v[202:203], v165 offset:1280
  ds_read_b64_tr_b16 v[204:205], v165 offset:64
  ds_read_b64_tr_b16 v[206:207], v165 offset:1344
  ds_read_b64_tr_b16 v[208:209], v165 offset:128
  ds_read_b64_tr_b16 v[210:211], v165 offset:1408
  ds_read_b64_tr_b16 v[212:213], v165 offset:192
  ds_read_b64_tr_b16 v[214:215], v165 offset:1472
  ds_read_b64_tr_b16 v[216:217], v165 offset:256
  ds_read_b64_tr_b16 v[218:219], v165 offset:1536
  s_waitcnt lgkmcnt(15)
  v_mfma_f32_32x32x16_bf16 a[0:15], v[220:223], v[44:47], a[0:15]
  v_mfma_f32_32x32x16_bf16 a[16:31], v[224:227], v[44:47], a[16:31]
  s_waitcnt lgkmcnt(14)
  v_mfma_f32_32x32x16_bf16 a[32:47], v[228:231], v[44:47], a[32:47]
  s_waitcnt lgkmcnt(12)
  v_mfma_f32_32x32x16_bf16 a[48:63], v[232:235], v[44:47], a[48:63]
  s_waitcnt lgkmcnt(10)
  v_mfma_f32_32x32x16_bf16 a[64:79], v[236:239], v[44:47], a[64:79]
  s_add_u32 m0, s31, 35840
  s_nop 0
  buffer_load_dwordx4 v160, s[8:11], s30 offen offset:0 lds
  s_add_u32 m0, m0, 1024
  s_nop 0
  buffer_load_dwordx4 v161, s[8:11], s30 offen offset:0 lds
  s_add_u32 m0, m0, 1024
  s_nop 0
  buffer_load_dwordx4 v162, s[8:11], s30 offen offset:0 lds
  s_add_u32 m0, m0, 1024
  s_nop 0
  buffer_load_dwordx4 v163, s[8:11], s30 offen offset:0 lds
  s_add_u32 m0, m0, 1024
  s_nop 0
  buffer_load_dwordx4 v164, s[8:11], s30 offen offset:0 lds
  s_add_u32 s30, s30, 18432
  s_waitcnt vmcnt(30)
  ds_read_b64_tr_b16 v[220:221], v165 offset:5120
  ds_read_b64_tr_b16 v[222:223], v165 offset:6400
  ds_read_b64_tr_b16 v[224:225], v165 offset:5184
  ds_read_b64_tr_b16 v[226:227], v165 offset:6464
  ds_read_b64_tr_b16 v[228:229], v165 offset:5248
  ds_read_b64_tr_b16 v[230:231], v165 offset:6528
  ds_read_b64_tr_b16 v[232:233], v165 offset:5312
  ds_read_b64_tr_b16 v[234:235], v165 offset:6592
  ds_read_b64_tr_b16 v[236:237], v165 offset:5376
  ds_read_b64_tr_b16 v[238:239], v165 offset:6656
  s_waitcnt lgkmcnt(15)
  v_mfma_f32_32x32x16_bf16 a[0:15], v[200:203], v[48:51], a[0:15]
  v_mfma_f32_32x32x16_bf16 a[16:31], v[204:207], v[48:51], a[16:31]
  s_waitcnt lgkmcnt(14)
  v_mfma_f32_32x32x16_bf16 a[32:47], v[208:211], v[48:51], a[32:47]
  s_waitcnt lgkmcnt(12)
  v_mfma_f32_32x32x16_bf16 a[48:63], v[212:215], v[48:51], a[48:63]
  s_waitcnt lgkmcnt(10)
  v_mfma_f32_32x32x16_bf16 a[64:79], v[216:219], v[48:51], a[64:79]
  s_add_u32 m0, s31, 0
  s_nop 0
  buffer_load_dwordx4 v160, s[8:11], s30 offen offset:0 lds
  s_add_u32 m0, m0, 1024
  s_nop 0
  buffer_load_dwordx4 v161, s[8:11], s30 offen offset:0 lds
  s_add_u32 m0, m0, 1024
  s_nop 0
  buffer_load_dwordx4 v162, s[8:11], s30 offen offset:0 lds
  s_add_u32 m0, m0, 1024
  s_nop 0
  buffer_load_dwordx4 v163, s[8:11], s30 offen offset:0 lds
  s_add_u32 m0, m0, 1024
  s_nop 0
  buffer_load_dwordx4 v164, s[8:11], s30 offen offset:0 lds
  s_add_u32 s30, s30, 18432
  s_waitcnt vmcnt(30)
  ds_read_b64_tr_b16 v[200:201], v165 offset:10240
  ds_read_b64_tr_b16 v[202:203], v165 offset:11520
  ds_read_b64_tr_b16 v[204:205], v165 offset:10304
  ds_read_b64_tr_b16 v[206:207], v165 offset:11584
  ds_read_b64_tr_b16 v[208:209], v165 offset:10368
  ds_read_b64_tr_b16 v[210:211], v165 offset:11648
  ds_read_b64_tr_b16 v[212:213], v165 offset:10432
  ds_read_b64_tr_b16 v[214:215], v165 offset:11712
  ds_read_b64_tr_b16 v[216:217], v165 offset:10496
  ds_read_b64_tr_b16 v[218:219], v165 offset:11776
  s_waitcnt lgkmcnt(15)
  v_mfma_f32_32x32x16_bf16 a[0:15], v[220:223], v[52:55], a[0:15]
  v_mfma_f32_32x32x16_bf16 a[16:31], v[224:227], v[52:55], a[16:31]
  s_waitcnt lgkmcnt(14)
  v_mfma_f32_32x32x16_bf16 a[32:47], v[228:231], v[52:55], a[32:47]
  s_waitcnt lgkmcnt(12)
  v_mfma_f32_32x32x16_bf16 a[48:63], v[232:235], v[52:55], a[48:63]
  s_waitcnt lgkmcnt(10)
  v_mfma_f32_32x32x16_bf16 a[64:79], v[236:239], v[52:55], a[64:79]
  s_add_u32 m0, s31, 5120
  s_nop 0
  buffer_load_dwordx4 v160, s[8:11], s30 offen offset:0 lds
  s_add_u32 m0, m0, 1024
  s_nop 0
  buffer_load_dwordx4 v161, s[8:11], s30 offen offset:0 lds
  s_add_u32 m0, m0, 1024
  s_nop 0
  buffer_load_dwordx4 v162, s[8:11], s30 offen offset:0 lds
  s_add_u32 m0, m0, 1024
  s_nop 0
  buffer_load_dwordx4 v163, s[8:11], s30 offen offset:0 lds
  s_add_u32 m0, m0, 1024
  s_nop 0
  buffer_load_dwordx4 v164, s[8:11], s30 offen offset:0 lds
  s_add_u32 s30, s30, 18432
  s_waitcnt vmcnt(30)
  ds_read_b64_tr_b16 v[220:221], v165 offset:15360
  ds_read_b64_tr_b16 v[222:223], v165 offset:16640
  ds_read_b64_tr_b16 v[224:225], v165 offset:15424
  ds_read_b64_tr_b16 v[226:227], v165 offset:16704
  ds_read_b64_tr_b16 v[228:229], v165 offset:15488
  ds_read_b64_tr_b16 v[230:231], v165 offset:16768
  ds_read_b64_tr_b16 v[232:233], v165 offset:15552
  ds_read_b64_tr_b16 v[234:235], v165 offset:16832
  ds_read_b64_tr_b16 v[236:237], v165 offset:15616
  ds_read_b64_tr_b16 v[238:239], v165 offset:16896
  s_waitcnt lgkmcnt(15)
  v_mfma_f32_32x32x16_bf16 a[0:15], v[200:203], v[56:59], a[0:15]
  v_mfma_f32_32x32x16_bf16 a[16:31], v[204:207], v[56:59], a[16:31]
  s_waitcnt lgkmcnt(14)
  v_mfma_f32_32x32x16_bf16 a[32:47], v[208:211], v[56:59], a[32:47]
  s_waitcnt lgkmcnt(12)
  v_mfma_f32_32x32x16_bf16 a[48:63], v[212:215], v[56:59], a[48:63]
  s_waitcnt lgkmcnt(10)
  v_mfma_f32_32x32x16_bf16 a[64:79], v[216:219], v[56:59], a[64:79]
  s_add_u32 m0, s31, 10240
  s_nop 0
  buffer_load_dwordx4 v160, s[8:11], s30 offen offset:0 lds
  s_add_u32 m0, m0, 1024
  s_nop 0
  buffer_load_dwordx4 v161, s[8:11], s30 offen offset:0 lds
  s_add_u32 m0, m0, 1024
  s_nop 0
  buffer_load_dwordx4 v162, s[8:11], s30 offen offset:0 lds
  s_add_u32 m0, m0, 1024
  s_nop 0
  buffer_load_dwordx4 v163, s[8:11], s30 offen offset:0 lds
  s_add_u32 m0, m0, 1024
  s_nop 0
  buffer_load_dwordx4 v164, s[8:11], s30 offen offset:0 lds
  s_add_u32 s30, s30, 18432
  s_waitcnt vmcnt(30)
  ds_read_b64_tr_b16 v[200:201], v165 offset:20480
  ds_read_b64_tr_b16 v[202:203], v165 offset:21760
  ds_read_b64_tr_b16 v[204:205], v165 offset:20544
  ds_read_b64_tr_b16 v[206:207], v165 offset:21824
  ds_read_b64_tr_b16 v[208:209], v165 offset:20608
  ds_read_b64_tr_b16 v[210:211], v165 offset:21888
  ds_read_b64_tr_b16 v[212:213], v165 offset:20672
  ds_read_b64_tr_b16 v[214:215], v165 offset:21952
  ds_read_b64_tr_b16 v[216:217], v165 offset:20736
  ds_read_b64_tr_b16 v[218:219], v165 offset:22016
  s_waitcnt lgkmcnt(15)
  v_mfma_f32_32x32x16_bf16 a[0:15], v[220:223], v[60:63], a[0:15]
  v_mfma_f32_32x32x16_bf16 a[16:31], v[224:227], v[60:63], a[16:31]
  s_waitcnt lgkmcnt(14)
  v_mfma_f32_32x32x16_bf16 a[32:47], v[228:231], v[60:63], a[32:47]
  s_waitcnt lgkmcnt(12)
  v_mfma_f32_32x32x16_bf16 a[48:63], v[232:235], v[60:63], a[48:63]
  s_waitcnt lgkmcnt(10)
  v_mfma_f32_32x32x16_bf16 a[64:79], v[236:239], v[60:63], a[64:79]
  s_add_u32 m0, s31, 15360
  s_nop 0
  buffer_load_dwordx4 v160, s[8:11], s30 offen offset:0 lds
  s_add_u32 m0, m0, 1024
  s_nop 0
  buffer_load_dwordx4 v161, s[8:11], s30 offen offset:0 lds
  s_add_u32 m0, m0, 1024
  s_nop 0
  buffer_load_dwordx4 v162, s[8:11], s30 offen offset:0 lds
  s_add_u32 m0, m0, 1024
  s_nop 0
  buffer_load_dwordx4 v163, s[8:11], s30 offen offset:0 lds
  s_add_u32 m0, m0, 1024
  s_nop 0
  buffer_load_dwordx4 v164, s[8:11], s30 offen offset:0 lds
  s_add_u32 s30, s30, 18432
  s_waitcnt vmcnt(30)
  ds_read_b64_tr_b16 v[220:221], v165 offset:25600
  ds_read_b64_tr_b16 v[222:223], v165 offset:26880
  ds_read_b64_tr_b16 v[224:225], v165 offset:25664
  ds_read_b64_tr_b16 v[226:227], v165 offset:26944
  ds_read_b64_tr_b16 v[228:229], v165 offset:25728
  ds_read_b64_tr_b16 v[230:231], v165 offset:27008
  ds_read_b64_tr_b16 v[232:233], v165 offset:25792
  ds_read_b64_tr_b16 v[234:235], v165 offset:27072
  ds_read_b64_tr_b16 v[236:237], v165 offset:25856
  ds_read_b64_tr_b16 v[238:239], v165 offset:27136
  s_waitcnt lgkmcnt(15)
  v_mfma_f32_32x32x16_bf16 a[0:15], v[200:203], v[64:67], a[0:15]
  v_mfma_f32_32x32x16_bf16 a[16:31], v[204:207], v[64:67], a[16:31]
  s_waitcnt lgkmcnt(14)
  v_mfma_f32_32x32x16_bf16 a[32:47], v[208:211], v[64:67], a[32:47]
  s_waitcnt lgkmcnt(12)
  v_mfma_f32_32x32x16_bf16 a[48:63], v[212:215], v[64:67], a[48:63]
  s_waitcnt lgkmcnt(10)
  v_mfma_f32_32x32x16_bf16 a[64:79], v[216:219], v[64:67], a[64:79]
  s_add_u32 m0, s31, 20480
  s_nop 0
  buffer_load_dwordx4 v160, s[8:11], s30 offen offset:0 lds
  s_add_u32 m0, m0, 1024
  s_nop 0
  buffer_load_dwordx4 v161, s[8:11], s30 offen offset:0 lds
  s_add_u32 m0, m0, 1024
  s_nop 0
  buffer_load_dwordx4 v162, s[8:11], s30 offen offset:0 lds
  s_add_u32 m0, m0, 1024
  s_nop 0
  buffer_load_dwordx4 v163, s[8:11], s30 offen offset:0 lds
  s_add_u32 m0, m0, 1024
  s_nop 0
  buffer_load_dwordx4 v164, s[8:11], s30 offen offset:0 lds
  s_add_u32 s30, s30, 18432
  s_waitcnt vmcnt(30)
  ds_read_b64_tr_b16 v[200:201], v165 offset:30720
  ds_read_b64_tr_b16 v[202:203], v165 offset:32000
  ds_read_b64_tr_b16 v[204:205], v165 offset:30784
  ds_read_b64_tr_b16 v[206:207], v165 offset:32064
  ds_read_b64_tr_b16 v[208:209], v165 offset:30848
  ds_read_b64_tr_b16 v[210:211], v165 offset:32128
  ds_read_b64_tr_b16 v[212:213], v165 offset:30912
  ds_read_b64_tr_b16 v[214:215], v165 offset:32192
  ds_read_b64_tr_b16 v[216:217], v165 offset:30976
  ds_read_b64_tr_b16 v[218:219], v165 offset:32256
  s_waitcnt lgkmcnt(15)
  v_mfma_f32_32x32x16_bf16 a[0:15], v[220:223], v[68:71], a[0:15]
  v_mfma_f32_32x32x16_bf16 a[16:31], v[224:227], v[68:71], a[16:31]
  s_waitcnt lgkmcnt(14)
  v_mfma_f32_32x32x16_bf16 a[32:47], v[228:231], v[68:71], a[32:47]
  s_waitcnt lgkmcnt(12)
  v_mfma_f32_32x32x16_bf16 a[48:63], v[232:235], v[68:71], a[48:63]
  s_waitcnt lgkmcnt(10)
  v_mfma_f32_32x32x16_bf16 a[64:79], v[236:239], v[68:71], a[64:79]
  s_add_u32 m0, s31, 25600
  s_nop 0
  buffer_load_dwordx4 v160, s[8:11], s30 offen offset:0 lds
  s_add_u32 m0, m0, 1024
  s_nop 0
  buffer_load_dwordx4 v161, s[8:11], s30 offen offset:0 lds
  s_add_u32 m0, m0, 1024
  s_nop 0
  buffer_load_dwordx4 v162, s[8:11], s30 offen offset:0 lds
  s_add_u32 m0, m0, 1024
  s_nop 0
  buffer_load_dwordx4 v163, s[8:11], s30 offen offset:0 lds
  s_add_u32 m0, m0, 1024
  s_nop 0
  buffer_load_dwordx4 v164, s[8:11], s30 offen offset:0 lds
  s_add_u32 s30, s30, 18432
  s_waitcnt vmcnt(30)
  ds_read_b64_tr_b16 v[220:221], v165 offset:35840
  ds_read_b64_tr_b16 v[222:223], v165 offset:37120
  ds_read_b64_tr_b16 v[224:225], v165 offset:35904
  ds_read_b64_tr_b16 v[226:227], v165 offset:37184
  ds_read_b64_tr_b16 v[228:229], v165 offset:35968
  ds_read_b64_tr_b16 v[230:231], v165 offset:37248
  ds_read_b64_tr_b16 v[232:233], v165 offset:36032
  ds_read_b64_tr_b16 v[234:235], v165 offset:37312
  ds_read_b64_tr_b16 v[236:237], v165 offset:36096
  ds_read_b64_tr_b16 v[238:239], v165 offset:37376
  s_waitcnt lgkmcnt(15)
  v_mfma_f32_32x32x16_bf16 a[0:15], v[200:203], v[72:75], a[0:15]
  v_mfma_f32_32x32x16_bf16 a[16:31], v[204:207], v[72:75], a[16:31]
  s_waitcnt lgkmcnt(14)
  v_mfma_f32_32x32x16_bf16 a[32:47], v[208:211], v[72:75], a[32:47]
  s_waitcnt lgkmcnt(12)
  v_mfma_f32_32x32x16_bf16 a[48:63], v[212:215], v[72:75], a[48:63]
  s_waitcnt lgkmcnt(10)
  v_mfma_f32_32x32x16_bf16 a[64:79], v[216:219], v[72:75], a[64:79]
  s_add_u32 m0, s31, 30720
  s_nop 0
  buffer_load_dwordx4 v160, s[8:11], s30 offen offset:0 lds
  s_add_u32 m0, m0, 1024
  s_nop 0
  buffer_load_dwordx4 v161, s[8:11], s30 offen offset:0 lds
  s_add_u32 m0, m0, 1024
  s_nop 0
  buffer_load_dwordx4 v162, s[8:11], s30 offen offset:0 lds
  s_add_u32 m0, m0, 1024
  s_nop 0
  buffer_load_dwordx4 v163, s[8:11], s30 offen offset:0 lds
  s_add_u32 m0, m0, 1024
  s_nop 0
  buffer_load_dwordx4 v164, s[8:11], s30 offen offset:0 lds
  s_add_u32 s30, s30, 18432
  s_waitcnt vmcnt(30)
  ds_read_b64_tr_b16 v[200:201], v165 offset:0
  ds_read_b64_tr_b16 v[202:203], v165 offset:1280
  ds_read_b64_tr_b16 v[204:205], v165 offset:64
  ds_read_b64_tr_b16 v[206:207], v165 offset:1344
  ds_read_b64_tr_b16 v[208:209], v165 offset:128
  ds_read_b64_tr_b16 v[210:211], v165 offset:1408
  ds_read_b64_tr_b16 v[212:213], v165 offset:192
  ds_read_b64_tr_b16 v[214:215], v165 offset:1472
  ds_read_b64_tr_b16 v[216:217], v165 offset:256
  ds_read_b64_tr_b16 v[218:219], v165 offset:1536
  s_waitcnt lgkmcnt(15)
  v_mfma_f32_32x32x16_bf16 a[0:15], v[220:223], v[76:79], a[0:15]
  v_mfma_f32_32x32x16_bf16 a[16:31], v[224:227], v[76:79], a[16:31]
  s_waitcnt lgkmcnt(14)
  v_mfma_f32_32x32x16_bf16 a[32:47], v[228:231], v[76:79], a[32:47]
  s_waitcnt lgkmcnt(12)
  v_mfma_f32_32x32x16_bf16 a[48:63], v[232:235], v[76:79], a[48:63]
  s_waitcnt lgkmcnt(10)
  v_mfma_f32_32x32x16_bf16 a[64:79], v[236:239], v[76:79], a[64:79]
  s_add_u32 m0, s31, 35840
  s_nop 0
  buffer_load_dwordx4 v160, s[8:11], s30 offen offset:0 lds
  s_add_u32 m0, m0, 1024
  s_nop 0
  buffer_load_dwordx4 v161, s[8:11], s30 offen offset:0 lds
  s_add_u32 m0, m0, 1024
  s_nop 0
  buffer_load_dwordx4 v162, s[8:11], s30 offen offset:0 lds
  s_add_u32 m0, m0, 1024
  s_nop 0
  buffer_load_dwordx4 v163, s[8:11], s30 offen offset:0 lds
  s_add_u32 m0, m0, 1024
  s_nop 0
  buffer_load_dwordx4 v164, s[8:11], s30 offen offset:0 lds
  s_add_u32 s30, s30, 18432
  s_waitcnt vmcnt(30)
  ds_read_b64_tr_b16 v[220:221], v165 offset:5120
  ds_read_b64_tr_b16 v[222:223], v165 offset:6400
  ds_read_b64_tr_b16 v[224:225], v165 offset:5184
  ds_read_b64_tr_b16 v[226:227], v165 offset:6464
  ds_read_b64_tr_b16 v[228:229], v165 offset:5248
  ds_read_b64_tr_b16 v[230:231], v165 offset:6528
  ds_read_b64_tr_b16 v[232:233], v165 offset:5312
  ds_read_b64_tr_b16 v[234:235], v165 offset:6592
  ds_read_b64_tr_b16 v[236:237], v165 offset:5376
  ds_read_b64_tr_b16 v[238:239], v165 offset:6656
  s_waitcnt lgkmcnt(15)
  v_mfma_f32_32x32x16_bf16 a[0:15], v[200:203], v[80:83], a[0:15]
  v_mfma_f32_32x32x16_bf16 a[16:31], v[204:207], v[80:83], a[16:31]
  s_waitcnt lgkmcnt(14)
  v_mfma_f32_32x32x16_bf16 a[32:47], v[208:211], v[80:83], a[32:47]
  s_waitcnt lgkmcnt(12)
  v_mfma_f32_32x32x16_bf16 a[48:63], v[212:215], v[80:83], a[48:63]
  s_waitcnt lgkmcnt(10)
  v_mfma_f32_32x32x16_bf16 a[64:79], v[216:219], v[80:83], a[64:79]
  s_add_u32 m0, s31, 0
  s_nop 0
  buffer_load_dwordx4 v160, s[8:11], s30 offen offset:0 lds
  s_add_u32 m0, m0, 1024
  s_nop 0
  buffer_load_dwordx4 v161, s[8:11], s30 offen offset:0 lds
  s_add_u32 m0, m0, 1024
  s_nop 0
  buffer_load_dwordx4 v162, s[8:11], s30 offen offset:0 lds
  s_add_u32 m0, m0, 1024
  s_nop 0
  buffer_load_dwordx4 v163, s[8:11], s30 offen offset:0 lds
  s_add_u32 m0, m0, 1024
  s_nop 0
  buffer_load_dwordx4 v164, s[8:11], s30 offen offset:0 lds
  s_add_u32 s30, s30, 18432
  s_waitcnt vmcnt(30)
  ds_read_b64_tr_b16 v[200:201], v165 offset:10240
  ds_read_b64_tr_b16 v[202:203], v165 offset:11520
  ds_read_b64_tr_b16 v[204:205], v165 offset:10304
  ds_read_b64_tr_b16 v[206:207], v165 offset:11584
  ds_read_b64_tr_b16 v[208:209], v165 offset:10368
  ds_read_b64_tr_b16 v[210:211], v165 offset:11648
  ds_read_b64_tr_b16 v[212:213], v165 offset:10432
  ds_read_b64_tr_b16 v[214:215], v165 offset:11712
  ds_read_b64_tr_b16 v[216:217], v165 offset:10496
  ds_read_b64_tr_b16 v[218:219], v165 offset:11776
  s_waitcnt lgkmcnt(15)
  v_mfma_f32_32x32x16_bf16 a[0:15], v[220:223], v[84:87], a[0:15]
  v_mfma_f32_32x32x16_bf16 a[16:31], v[224:227], v[84:87], a[16:31]
  s_waitcnt lgkmcnt(14)
  v_mfma_f32_32x32x16_bf16 a[32:47], v[228:231], v[84:87], a[32:47]
  s_waitcnt lgkmcnt(12)
  v_mfma_f32_32x32x16_bf16 a[48:63], v[232:235], v[84:87], a[48:63]
  s_waitcnt lgkmcnt(10)
  v_mfma_f32_32x32x16_bf16 a[64:79], v[236:239], v[84:87], a[64:79]
  s_add_u32 m0, s31, 5120
  s_nop 0
  buffer_load_dwordx4 v160, s[8:11], s30 offen offset:0 lds
  s_add_u32 m0, m0, 1024
  s_nop 0
  buffer_load_dwordx4 v161, s[8:11], s30 offen offset:0 lds
  s_add_u32 m0, m0, 1024
  s_nop 0
  buffer_load_dwordx4 v162, s[8:11], s30 offen offset:0 lds
  s_add_u32 m0, m0, 1024
  s_nop 0
  buffer_load_dwordx4 v163, s[8:11], s30 offen offset:0 lds
  s_add_u32 m0, m0, 1024
  s_nop 0
  buffer_load_dwordx4 v164, s[8:11], s30 offen offset:0 lds
  s_add_u32 s30, s30, 18432
  s_waitcnt vmcnt(30)
  ds_read_b64_tr_b16 v[220:221], v165 offset:15360
  ds_read_b64_tr_b16 v[222:223], v165 offset:16640
  ds_read_b64_tr_b16 v[224:225], v165 offset:15424
  ds_read_b64_tr_b16 v[226:227], v165 offset:16704
  ds_read_b64_tr_b16 v[228:229], v165 offset:15488
  ds_read_b64_tr_b16 v[230:231], v165 offset:16768
  ds_read_b64_tr_b16 v[232:233], v165 offset:15552
  ds_read_b64_tr_b16 v[234:235], v165 offset:16832
  ds_read_b64_tr_b16 v[236:237], v165 offset:15616
  ds_read_b64_tr_b16 v[238:239], v165 offset:16896
  s_waitcnt lgkmcnt(15)
  v_mfma_f32_32x32x16_bf16 a[0:15], v[200:203], v[88:91], a[0:15]
  v_mfma_f32_32x32x16_bf16 a[16:31], v[204:207], v[88:91], a[16:31]
  s_waitcnt lgkmcnt(14)
  v_mfma_f32_32x32x16_bf16 a[32:47], v[208:211], v[88:91], a[32:47]
  s_waitcnt lgkmcnt(12)
  v_mfma_f32_32x32x16_bf16 a[48:63], v[212:215], v[88:91], a[48:63]
  s_waitcnt lgkmcnt(10)
  v_mfma_f32_32x32x16_bf16 a[64:79], v[216:219], v[88:91], a[64:79]
  s_add_u32 m0, s31, 10240
  s_nop 0
  buffer_load_dwordx4 v160, s[8:11], s30 offen offset:0 lds
  s_add_u32 m0, m0, 1024
  s_nop 0
  buffer_load_dwordx4 v161, s[8:11], s30 offen offset:0 lds
  s_add_u32 m0, m0, 1024
  s_nop 0
  buffer_load_dwordx4 v162, s[8:11], s30 offen offset:0 lds
  s_add_u32 m0, m0, 1024
  s_nop 0
  buffer_load_dwordx4 v163, s[8:11], s30 offen offset:0 lds
  s_add_u32 m0, m0, 1024
  s_nop 0
  buffer_load_dwordx4 v164, s[8:11], s30 offen offset:0 lds
  s_add_u32 s30, s30, 18432
  s_waitcnt vmcnt(30)
  ds_read_b64_tr_b16 v[200:201], v165 offset:20480
  ds_read_b64_tr_b16 v[202:203], v165 offset:21760
  ds_read_b64_tr_b16 v[204:205], v165 offset:20544
  ds_read_b64_tr_b16 v[206:207], v165 offset:21824
  ds_read_b64_tr_b16 v[208:209], v165 offset:20608
  ds_read_b64_tr_b16 v[210:211], v165 offset:21888
  ds_read_b64_tr_b16 v[212:213], v165 offset:20672
  ds_read_b64_tr_b16 v[214:215], v165 offset:21952
  ds_read_b64_tr_b16 v[216:217], v165 offset:20736
  ds_read_b64_tr_b16 v[218:219], v165 offset:22016
  s_waitcnt lgkmcnt(15)
  v_mfma_f32_32x32x16_bf16 a[0:15], v[220:223], v[92:95], a[0:15]
  v_mfma_f32_32x32x16_bf16 a[16:31], v[224:227], v[92:95], a[16:31]
  s_waitcnt lgkmcnt(14)
  v_mfma_f32_32x32x16_bf16 a[32:47], v[228:231], v[92:95], a[32:47]
  s_waitcnt lgkmcnt(12)
  v_mfma_f32_32x32x16_bf16 a[48:63], v[232:235], v[92:95], a[48:63]
  s_waitcnt lgkmcnt(10)
  v_mfma_f32_32x32x16_bf16 a[64:79], v[236:239], v[92:95], a[64:79]
  s_add_u32 m0, s31, 15360
  s_nop 0
  buffer_load_dwordx4 v160, s[8:11], s30 offen offset:0 lds
  s_add_u32 m0, m0, 1024
  s_nop 0
  buffer_load_dwordx4 v161, s[8:11], s30 offen offset:0 lds
  s_add_u32 m0, m0, 1024
  s_nop 0
  buffer_load_dwordx4 v162, s[8:11], s30 offen offset:0 lds
  s_add_u32 m0, m0, 1024
  s_nop 0
  buffer_load_dwordx4 v163, s[8:11], s30 offen offset:0 lds
  s_add_u32 m0, m0, 1024
  s_nop 0
  buffer_load_dwordx4 v164, s[8:11], s30 offen offset:0 lds
  s_add_u32 s30, s30, 18432
  s_waitcnt vmcnt(30)
  ds_read_b64_tr_b16 v[220:221], v165 offset:25600
  ds_read_b64_tr_b16 v[222:223], v165 offset:26880
  ds_read_b64_tr_b16 v[224:225], v165 offset:25664
  ds_read_b64_tr_b16 v[226:227], v165 offset:26944
  ds_read_b64_tr_b16 v[228:229], v165 offset:25728
  ds_read_b64_tr_b16 v[230:231], v165 offset:27008
  ds_read_b64_tr_b16 v[232:233], v165 offset:25792
  ds_read_b64_tr_b16 v[234:235], v165 offset:27072
  ds_read_b64_tr_b16 v[236:237], v165 offset:25856
  ds_read_b64_tr_b16 v[238:239], v165 offset:27136
  s_waitcnt lgkmcnt(15)
  v_mfma_f32_32x32x16_bf16 a[0:15], v[200:203], v[96:99], a[0:15]
  v_mfma_f32_32x32x16_bf16 a[16:31], v[204:207], v[96:99], a[16:31]
  s_waitcnt lgkmcnt(14)
  v_mfma_f32_32x32x16_bf16 a[32:47], v[208:211], v[96:99], a[32:47]
  s_waitcnt lgkmcnt(12)
  v_mfma_f32_32x32x16_bf16 a[48:63], v[212:215], v[96:99], a[48:63]
  s_waitcnt lgkmcnt(10)
  v_mfma_f32_32x32x16_bf16 a[64:79], v[216:219], v[96:99], a[64:79]
  s_add_u32 m0, s31, 20480
  s_nop 0
  buffer_load_dwordx4 v160, s[8:11], s30 offen offset:0 lds
  s_add_u32 m0, m0, 1024
  s_nop 0
  buffer_load_dwordx4 v161, s[8:11], s30 offen offset:0 lds
  s_add_u32 m0, m0, 1024
  s_nop 0
  buffer_load_dwordx4 v162, s[8:11], s30 offen offset:0 lds
  s_add_u32 m0, m0, 1024
  s_nop 0
  buffer_load_dwordx4 v163, s[8:11], s30 offen offset:0 lds
  s_add_u32 m0, m0, 1024
  s_nop 0
  buffer_load_dwordx4 v164, s[8:11], s30 offen offset:0 lds
  s_add_u32 s30, s30, 18432
  s_waitcnt vmcnt(30)
  ds_read_b64_tr_b16 v[200:201], v165 offset:30720
  ds_read_b64_tr_b16 v[202:203], v165 offset:32000
  ds_read_b64_tr_b16 v[204:205], v165 offset:30784
  ds_read_b64_tr_b16 v[206:207], v165 offset:32064
  ds_read_b64_tr_b16 v[208:209], v165 offset:30848
  ds_read_b64_tr_b16 v[210:211], v165 offset:32128
  ds_read_b64_tr_b16 v[212:213], v165 offset:30912
  ds_read_b64_tr_b16 v[214:215], v165 offset:32192
  ds_read_b64_tr_b16 v[216:217], v165 offset:30976
  ds_read_b64_tr_b16 v[218:219], v165 offset:32256
  s_waitcnt lgkmcnt(15)
  v_mfma_f32_32x32x16_bf16 a[0:15], v[220:223], v[100:103], a[0:15]
  v_mfma_f32_32x32x16_bf16 a[16:31], v[224:227], v[100:103], a[16:31]
  s_waitcnt lgkmcnt(14)
  v_mfma_f32_32x32x16_bf16 a[32:47], v[228:231], v[100:103], a[32:47]
  s_waitcnt lgkmcnt(12)
  v_mfma_f32_32x32x16_bf16 a[48:63], v[232:235], v[100:103], a[48:63]
  s_waitcnt lgkmcnt(10)
  v_mfma_f32_32x32x16_bf16 a[64:79], v[236:239], v[100:103], a[64:79]
  s_add_u32 m0, s31, 25600
  s_nop 0
  buffer_load_dwordx4 v160, s[8:11], s30 offen offset:0 lds
  s_add_u32 m0, m0, 1024
  s_nop 0
  buffer_load_dwordx4 v161, s[8:11], s30 offen offset:0 lds
  s_add_u32 m0, m0, 1024
  s_nop 0
  buffer_load_dwordx4 v162, s[8:11], s30 offen offset:0 lds
  s_add_u32 m0, m0, 1024
  s_nop 0
  buffer_load_dwordx4 v163, s[8:11], s30 offen offset:0 lds
  s_add_u32 m0, m0, 1024
  s_nop 0
  buffer_load_dwordx4 v164, s[8:11], s30 offen offset:0 lds
  s_add_u32 s30, s30, 18432
  s_waitcnt vmcnt(30)
  ds_read_b64_tr_b16 v[220:221], v165 offset:35840
  ds_read_b64_tr_b16 v[222:223], v165 offset:37120
  ds_read_b64_tr_b16 v[224:225], v165 offset:35904
  ds_read_b64_tr_b16 v[226:227], v165 offset:37184
  ds_read_b64_tr_b16 v[228:229], v165 offset:35968
  ds_read_b64_tr_b16 v[230:231], v165 offset:37248
  ds_read_b64_tr_b16 v[232:233], v165 offset:36032
  ds_read_b64_tr_b16 v[234:235], v165 offset:37312
  ds_read_b64_tr_b16 v[236:237], v165 offset:36096
  ds_read_b64_tr_b16 v[238:239], v165 offset:37376
  s_waitcnt lgkmcnt(15)
  v_mfma_f32_32x32x16_bf16 a[0:15], v[200:203], v[104:107], a[0:15]
  v_mfma_f32_32x32x16_bf16 a[16:31], v[204:207], v[104:107], a[16:31]
  s_waitcnt lgkmcnt(14)
  v_mfma_f32_32x32x16_bf16 a[32:47], v[208:211], v[104:107], a[32:47]
  s_waitcnt lgkmcnt(12)
  v_mfma_f32_32x32x16_bf16 a[48:63], v[212:215], v[104:107], a[48:63]
  s_waitcnt lgkmcnt(10)
  v_mfma_f32_32x32x16_bf16 a[64:79], v[216:219], v[104:107], a[64:79]
  s_add_u32 m0, s31, 30720
  s_nop 0
  buffer_load_dwordx4 v160, s[8:11], s30 offen offset:0 lds
  s_add_u32 m0, m0, 1024
  s_nop 0
  buffer_load_dwordx4 v161, s[8:11], s30 offen offset:0 lds
  s_add_u32 m0, m0, 1024
  s_nop 0
  buffer_load_dwordx4 v162, s[8:11], s30 offen offset:0 lds
  s_add_u32 m0, m0, 1024
  s_nop 0
  buffer_load_dwordx4 v163, s[8:11], s30 offen offset:0 lds
  s_add_u32 m0, m0, 1024
  s_nop 0
  buffer_load_dwordx4 v164, s[8:11], s30 offen offset:0 lds
  s_add_u32 s30, s30, 18432
  s_waitcnt vmcnt(30)
  ds_read_b64_tr_b16 v[200:201], v165 offset:0
  ds_read_b64_tr_b16 v[202:203], v165 offset:1280
  ds_read_b64_tr_b16 v[204:205], v165 offset:64
  ds_read_b64_tr_b16 v[206:207], v165 offset:1344
  ds_read_b64_tr_b16 v[208:209], v165 offset:128
  ds_read_b64_tr_b16 v[210:211], v165 offset:1408
  ds_read_b64_tr_b16 v[212:213], v165 offset:192
  ds_read_b64_tr_b16 v[214:215], v165 offset:1472
  ds_read_b64_tr_b16 v[216:217], v165 offset:256
  ds_read_b64_tr_b16 v[218:219], v165 offset:1536
  s_waitcnt lgkmcnt(15)
  v_mfma_f32_32x32x16_bf16 a[0:15], v[220:223], v[108:111], a[0:15]
  v_mfma_f32_32x32x16_bf16 a[16:31], v[224:227], v[108:111], a[16:31]
  s_waitcnt lgkmcnt(14)
  v_mfma_f32_32x32x16_bf16 a[32:47], v[228:231], v[108:111], a[32:47]
  s_waitcnt lgkmcnt(12)
  v_mfma_f32_32x32x16_bf16 a[48:63], v[232:235], v[108:111], a[48:63]
  s_waitcnt lgkmcnt(10)
  v_mfma_f32_32x32x16_bf16 a[64:79], v[236:239], v[108:111], a[64:79]
  s_add_u32 m0, s31, 35840
  s_nop 0
  buffer_load_dwordx4 v160, s[8:11], s30 offen offset:0 lds
  s_add_u32 m0, m0, 1024
  s_nop 0
  buffer_load_dwordx4 v161, s[8:11], s30 offen offset:0 lds
  s_add_u32 m0, m0, 1024
  s_nop 0
  buffer_load_dwordx4 v162, s[8:11], s30 offen offset:0 lds
  s_add_u32 m0, m0, 1024
  s_nop 0
  buffer_load_dwordx4 v163, s[8:11], s30 offen offset:0 lds
  s_add_u32 m0, m0, 1024
  s_nop 0
  buffer_load_dwordx4 v164, s[8:11], s30 offen offset:0 lds
  s_add_u32 s30, s30, 18432
  s_waitcnt vmcnt(30)
  ds_read_b64_tr_b16 v[220:221], v165 offset:5120
  ds_read_b64_tr_b16 v[222:223], v165 offset:6400
  ds_read_b64_tr_b16 v[224:225], v165 offset:5184
  ds_read_b64_tr_b16 v[226:227], v165 offset:6464
  ds_read_b64_tr_b16 v[228:229], v165 offset:5248
  ds_read_b64_tr_b16 v[230:231], v165 offset:6528
  ds_read_b64_tr_b16 v[232:233], v165 offset:5312
  ds_read_b64_tr_b16 v[234:235], v165 offset:6592
  ds_read_b64_tr_b16 v[236:237], v165 offset:5376
  ds_read_b64_tr_b16 v[238:239], v165 offset:6656
  s_waitcnt lgkmcnt(15)
  v_mfma_f32_32x32x16_bf16 a[0:15], v[200:203], v[112:115], a[0:15]
  v_mfma_f32_32x32x16_bf16 a[16:31], v[204:207], v[112:115], a[16:31]
  s_waitcnt lgkmcnt(14)
  v_mfma_f32_32x32x16_bf16 a[32:47], v[208:211], v[112:115], a[32:47]
  s_waitcnt lgkmcnt(12)
  v_mfma_f32_32x32x16_bf16 a[48:63], v[212:215], v[112:115], a[48:63]
  s_waitcnt lgkmcnt(10)
  v_mfma_f32_32x32x16_bf16 a[64:79], v[216:219], v[112:115], a[64:79]
  s_add_u32 m0, s31, 0
  s_nop 0
  buffer_load_dwordx4 v160, s[8:11], s30 offen offset:0 lds
  s_add_u32 m0, m0, 1024
  s_nop 0
  buffer_load_dwordx4 v161, s[8:11], s30 offen offset:0 lds
  s_add_u32 m0, m0, 1024
  s_nop 0
  buffer_load_dwordx4 v162, s[8:11], s30 offen offset:0 lds
  s_add_u32 m0, m0, 1024
  s_nop 0
  buffer_load_dwordx4 v163, s[8:11], s30 offen offset:0 lds
  s_add_u32 m0, m0, 1024
  s_nop 0
  buffer_load_dwordx4 v164, s[8:11], s30 offen offset:0 lds
  s_add_u32 s30, s30, 18432
  s_waitcnt vmcnt(30)
  ds_read_b64_tr_b16 v[200:201], v165 offset:10240
  ds_read_b64_tr_b16 v[202:203], v165 offset:11520
  ds_read_b64_tr_b16 v[204:205], v165 offset:10304
  ds_read_b64_tr_b16 v[206:207], v165 offset:11584
  ds_read_b64_tr_b16 v[208:209], v165 offset:10368
  ds_read_b64_tr_b16 v[210:211], v165 offset:11648
  ds_read_b64_tr_b16 v[212:213], v165 offset:10432
  ds_read_b64_tr_b16 v[214:215], v165 offset:11712
  ds_read_b64_tr_b16 v[216:217], v165 offset:10496
  ds_read_b64_tr_b16 v[218:219], v165 offset:11776
  s_waitcnt lgkmcnt(15)
  v_mfma_f32_32x32x16_bf16 a[0:15], v[220:223], v[116:119], a[0:15]
  v_mfma_f32_32x32x16_bf16 a[16:31], v[224:227], v[116:119], a[16:31]
  s_waitcnt lgkmcnt(14)
  v_mfma_f32_32x32x16_bf16 a[32:47], v[228:231], v[116:119], a[32:47]
  s_waitcnt lgkmcnt(12)
  v_mfma_f32_32x32x16_bf16 a[48:63], v[232:235], v[116:119], a[48:63]
  s_waitcnt lgkmcnt(10)
  v_mfma_f32_32x32x16_bf16 a[64:79], v[236:239], v[116:119], a[64:79]
  s_add_u32 m0, s31, 5120
  s_nop 0
  buffer_load_dwordx4 v160, s[8:11], s30 offen offset:0 lds
  s_add_u32 m0, m0, 1024
  s_nop 0
  buffer_load_dwordx4 v161, s[8:11], s30 offen offset:0 lds
  s_add_u32 m0, m0, 1024
  s_nop 0
  buffer_load_dwordx4 v162, s[8:11], s30 offen offset:0 lds
  s_add_u32 m0, m0, 1024
  s_nop 0
  buffer_load_dwordx4 v163, s[8:11], s30 offen offset:0 lds
  s_add_u32 m0, m0, 1024
  s_nop 0
  buffer_load_dwordx4 v164, s[8:11], s30 offen offset:0 lds
  s_add_u32 s30, s30, 18432
  s_waitcnt vmcnt(30)
  ds_read_b64_tr_b16 v[220:221], v165 offset:15360
  ds_read_b64_tr_b16 v[222:223], v165 offset:16640
  ds_read_b64_tr_b16 v[224:225], v165 offset:15424
  ds_read_b64_tr_b16 v[226:227], v165 offset:16704
  ds_read_b64_tr_b16 v[228:229], v165 offset:15488
  ds_read_b64_tr_b16 v[230:231], v165 offset:16768
  ds_read_b64_tr_b16 v[232:233], v165 offset:15552
  ds_read_b64_tr_b16 v[234:235], v165 offset:16832
  ds_read_b64_tr_b16 v[236:237], v165 offset:15616
  ds_read_b64_tr_b16 v[238:239], v165 offset:16896
  s_waitcnt lgkmcnt(15)
  v_mfma_f32_32x32x16_bf16 a[0:15], v[200:203], v[120:123], a[0:15]
  v_mfma_f32_32x32x16_bf16 a[16:31], v[204:207], v[120:123], a[16:31]
  s_waitcnt lgkmcnt(14)
  v_mfma_f32_32x32x16_bf16 a[32:47], v[208:211], v[120:123], a[32:47]
  s_waitcnt lgkmcnt(12)
  v_mfma_f32_32x32x16_bf16 a[48:63], v[212:215], v[120:123], a[48:63]
  s_waitcnt lgkmcnt(10)
  v_mfma_f32_32x32x16_bf16 a[64:79], v[216:219], v[120:123], a[64:79]
  s_add_u32 m0, s31, 10240
  s_nop 0
  buffer_load_dwordx4 v160, s[8:11], s30 offen offset:0 lds
  s_add_u32 m0, m0, 1024
  s_nop 0
  buffer_load_dwordx4 v161, s[8:11], s30 offen offset:0 lds
  s_add_u32 m0, m0, 1024
  s_nop 0
  buffer_load_dwordx4 v162, s[8:11], s30 offen offset:0 lds
  s_add_u32 m0, m0, 1024
  s_nop 0
  buffer_load_dwordx4 v163, s[8:11], s30 offen offset:0 lds
  s_add_u32 m0, m0, 1024
  s_nop 0
  buffer_load_dwordx4 v164, s[8:11], s30 offen offset:0 lds
  s_add_u32 s30, s30, 18432
  s_waitcnt vmcnt(30)
  ds_read_b64_tr_b16 v[200:201], v165 offset:20480
  ds_read_b64_tr_b16 v[202:203], v165 offset:21760
  ds_read_b64_tr_b16 v[204:205], v165 offset:20544
  ds_read_b64_tr_b16 v[206:207], v165 offset:21824
  ds_read_b64_tr_b16 v[208:209], v165 offset:20608
  ds_read_b64_tr_b16 v[210:211], v165 offset:21888
  ds_read_b64_tr_b16 v[212:213], v165 offset:20672
  ds_read_b64_tr_b16 v[214:215], v165 offset:21952
  ds_read_b64_tr_b16 v[216:217], v165 offset:20736
  ds_read_b64_tr_b16 v[218:219], v165 offset:22016
  s_waitcnt lgkmcnt(15)
  v_mfma_f32_32x32x16_bf16 a[0:15], v[220:223], v[124:127], a[0:15]
  v_mfma_f32_32x32x16_bf16 a[16:31], v[224:227], v[124:127], a[16:31]
  s_waitcnt lgkmcnt(14)
  v_mfma_f32_32x32x16_bf16 a[32:47], v[228:231], v[124:127], a[32:47]
  s_waitcnt lgkmcnt(12)
  v_mfma_f32_32x32x16_bf16 a[48:63], v[232:235], v[124:127], a[48:63]
  s_waitcnt lgkmcnt(10)
  v_mfma_f32_32x32x16_bf16 a[64:79], v[236:239], v[124:127], a[64:79]
  s_add_u32 m0, s31, 15360
  s_nop 0
  buffer_load_dwordx4 v160, s[8:11], s30 offen offset:0 lds
  s_add_u32 m0, m0, 1024
  s_nop 0
  buffer_load_dwordx4 v161, s[8:11], s30 offen offset:0 lds
  s_add_u32 m0, m0, 1024
  s_nop 0
  buffer_load_dwordx4 v162, s[8:11], s30 offen offset:0 lds
  s_add_u32 m0, m0, 1024
  s_nop 0
  buffer_load_dwordx4 v163, s[8:11], s30 offen offset:0 lds
  s_add_u32 m0, m0, 1024
  s_nop 0
  buffer_load_dwordx4 v164, s[8:11], s30 offen offset:0 lds
  s_add_u32 s30, s30, 18432
  s_waitcnt vmcnt(30)
  ds_read_b64_tr_b16 v[220:221], v165 offset:25600
  ds_read_b64_tr_b16 v[222:223], v165 offset:26880
  ds_read_b64_tr_b16 v[224:225], v165 offset:25664
  ds_read_b64_tr_b16 v[226:227], v165 offset:26944
  ds_read_b64_tr_b16 v[228:229], v165 offset:25728
  ds_read_b64_tr_b16 v[230:231], v165 offset:27008
  ds_read_b64_tr_b16 v[232:233], v165 offset:25792
  ds_read_b64_tr_b16 v[234:235], v165 offset:27072
  ds_read_b64_tr_b16 v[236:237], v165 offset:25856
  ds_read_b64_tr_b16 v[238:239], v165 offset:27136
  s_waitcnt lgkmcnt(15)
  v_mfma_f32_32x32x16_bf16 a[0:15], v[200:203], v[128:131], a[0:15]
  v_mfma_f32_32x32x16_bf16 a[16:31], v[204:207], v[128:131], a[16:31]
  s_waitcnt lgkmcnt(14)
  v_mfma_f32_32x32x16_bf16 a[32:47], v[208:211], v[128:131], a[32:47]
  s_waitcnt lgkmcnt(12)
  v_mfma_f32_32x32x16_bf16 a[48:63], v[212:215], v[128:131], a[48:63]
  s_waitcnt lgkmcnt(10)
  v_mfma_f32_32x32x16_bf16 a[64:79], v[216:219], v[128:131], a[64:79]
  s_waitcnt vmcnt(25)
  ds_read_b64_tr_b16 v[200:201], v165 offset:30720
  ds_read_b64_tr_b16 v[202:203], v165 offset:32000
  ds_read_b64_tr_b16 v[204:205], v165 offset:30784
  ds_read_b64_tr_b16 v[206:207], v165 offset:32064
  ds_read_b64_tr_b16 v[208:209], v165 offset:30848
  ds_read_b64_tr_b16 v[210:211], v165 offset:32128
  ds_read_b64_tr_b16 v[212:213], v165 offset:30912
  ds_read_b64_tr_b16 v[214:215], v165 offset:32192
  ds_read_b64_tr_b16 v[216:217], v165 offset:30976
  ds_read_b64_tr_b16 v[218:219], v165 offset:32256
  s_waitcnt lgkmcnt(15)
  v_mfma_f32_32x32x16_bf16 a[0:15], v[220:223], v[132:135], a[0:15]
  v_mfma_f32_32x32x16_bf16 a[16:31], v[224:227], v[132:135], a[16:31]
  s_waitcnt lgkmcnt(14)
  v_mfma_f32_32x32x16_bf16 a[32:47], v[228:231], v[132:135], a[32:47]
  s_waitcnt lgkmcnt(12)
  v_mfma_f32_32x32x16_bf16 a[48:63], v[232:235], v[132:135], a[48:63]
  s_waitcnt lgkmcnt(10)
  v_mfma_f32_32x32x16_bf16 a[64:79], v[236:239], v[132:135], a[64:79]
  s_waitcnt vmcnt(20)
  ds_read_b64_tr_b16 v[220:221], v165 offset:35840
  ds_read_b64_tr_b16 v[222:223], v165 offset:37120
  ds_read_b64_tr_b16 v[224:225], v165 offset:35904
  ds_read_b64_tr_b16 v[226:227], v165 offset:37184
  ds_read_b64_tr_b16 v[228:229], v165 offset:35968
  ds_read_b64_tr_b16 v[230:231], v165 offset:37248
  ds_read_b64_tr_b16 v[232:233], v165 offset:36032
  ds_read_b64_tr_b16 v[234:235], v165 offset:37312
  ds_read_b64_tr_b16 v[236:237], v165 offset:36096
  ds_read_b64_tr_b16 v[238:239], v165 offset:37376
  s_waitcnt lgkmcnt(15)
  v_mfma_f32_32x32x16_bf16 a[0:15], v[200:203], v[136:139], a[0:15]
  v_mfma_f32_32x32x16_bf16 a[16:31], v[204:207], v[136:139], a[16:31]
  s_waitcnt lgkmcnt(14)
  v_mfma_f32_32x32x16_bf16 a[32:47], v[208:211], v[136:139], a[32:47]
  s_waitcnt lgkmcnt(12)
  v_mfma_f32_32x32x16_bf16 a[48:63], v[212:215], v[136:139], a[48:63]
  s_waitcnt lgkmcnt(10)
  v_mfma_f32_32x32x16_bf16 a[64:79], v[216:219], v[136:139], a[64:79]
  s_waitcnt vmcnt(15)
  ds_read_b64_tr_b16 v[200:201], v165 offset:0
  ds_read_b64_tr_b16 v[202:203], v165 offset:1280
  ds_read_b64_tr_b16 v[204:205], v165 offset:64
  ds_read_b64_tr_b16 v[206:207], v165 offset:1344
  ds_read_b64_tr_b16 v[208:209], v165 offset:128
  ds_read_b64_tr_b16 v[210:211], v165 offset:1408
  ds_read_b64_tr_b16 v[212:213], v165 offset:192
  ds_read_b64_tr_b16 v[214:215], v165 offset:1472
  ds_read_b64_tr_b16 v[216:217], v165 offset:256
  ds_read_b64_tr_b16 v[218:219], v165 offset:1536
  s_waitcnt lgkmcnt(15)
  v_mfma_f32_32x32x16_bf16 a[0:15], v[220:223], v[140:143], a[0:15]
  v_mfma_f32_32x32x16_bf16 a[16:31], v[224:227], v[140:143], a[16:31]
  s_waitcnt lgkmcnt(14)
  v_mfma_f32_32x32x16_bf16 a[32:47], v[228:231], v[140:143], a[32:47]
  s_waitcnt lgkmcnt(12)
  v_mfma_f32_32x32x16_bf16 a[48:63], v[232:235], v[140:143], a[48:63]
  s_waitcnt lgkmcnt(10)
  v_mfma_f32_32x32x16_bf16 a[64:79], v[236:239], v[140:143], a[64:79]
  s_waitcnt vmcnt(10)
  ds_read_b64_tr_b16 v[220:221], v165 offset:5120
  ds_read_b64_tr_b16 v[222:223], v165 offset:6400
  ds_read_b64_tr_b16 v[224:225], v165 offset:5184
  ds_read_b64_tr_b16 v[226:227], v165 offset:6464
  ds_read_b64_tr_b16 v[228:229], v165 offset:5248
  ds_read_b64_tr_b16 v[230:231], v165 offset:6528
  ds_read_b64_tr_b16 v[232:233], v165 offset:5312
  ds_read_b64_tr_b16 v[234:235], v165 offset:6592
  ds_read_b64_tr_b16 v[236:237], v165 offset:5376
  ds_read_b64_tr_b16 v[238:239], v165 offset:6656
  s_waitcnt lgkmcnt(15)
  v_mfma_f32_32x32x16_bf16 a[0:15], v[200:203], v[144:147], a[0:15]
  v_mfma_f32_32x32x16_bf16 a[16:31], v[204:207], v[144:147], a[16:31]
  s_waitcnt lgkmcnt(14)
  v_mfma_f32_32x32x16_bf16 a[32:47], v[208:211], v[144:147], a[32:47]
  s_waitcnt lgkmcnt(12)
  v_mfma_f32_32x32x16_bf16 a[48:63], v[212:215], v[144:147], a[48:63]
  s_waitcnt lgkmcnt(10)
  v_mfma_f32_32x32x16_bf16 a[64:79], v[216:219], v[144:147], a[64:79]
  s_waitcnt vmcnt(5)
  ds_read_b64_tr_b16 v[200:201], v165 offset:10240
  ds_read_b64_tr_b16 v[202:203], v165 offset:11520
  ds_read_b64_tr_b16 v[204:205], v165 offset:10304
  ds_read_b64_tr_b16 v[206:207], v165 offset:11584
  ds_read_b64_tr_b16 v[208:209], v165 offset:10368
  ds_read_b64_tr_b16 v[210:211], v165 offset:11648
  ds_read_b64_tr_b16 v[212:213], v165 offset:10432
  ds_read_b64_tr_b16 v[214:215], v165 offset:11712
  ds_read_b64_tr_b16 v[216:217], v165 offset:10496
  ds_read_b64_tr_b16 v[218:219], v165 offset:11776
  s_waitcnt lgkmcnt(15)
  v_mfma_f32_32x32x16_bf16 a[0:15], v[220:223], v[148:151], a[0:15]
  v_mfma_f32_32x32x16_bf16 a[16:31], v[224:227], v[148:151], a[16:31]
  s_waitcnt lgkmcnt(14)
  v_mfma_f32_32x32x16_bf16 a[32:47], v[228:231], v[148:151], a[32:47]
  s_waitcnt lgkmcnt(12)
  v_mfma_f32_32x32x16_bf16 a[48:63], v[232:235], v[148:151], a[48:63]
  s_waitcnt lgkmcnt(10)
  v_mfma_f32_32x32x16_bf16 a[64:79], v[236:239], v[148:151], a[64:79]
  s_waitcnt vmcnt(0)
  ds_read_b64_tr_b16 v[220:221], v165 offset:15360
  ds_read_b64_tr_b16 v[222:223], v165 offset:16640
  ds_read_b64_tr_b16 v[224:225], v165 offset:15424
  ds_read_b64_tr_b16 v[226:227], v165 offset:16704
  ds_read_b64_tr_b16 v[228:229], v165 offset:15488
  ds_read_b64_tr_b16 v[230:231], v165 offset:16768
  ds_read_b64_tr_b16 v[232:233], v165 offset:15552
  ds_read_b64_tr_b16 v[234:235], v165 offset:16832
  ds_read_b64_tr_b16 v[236:237], v165 offset:15616
  ds_read_b64_tr_b16 v[238:239], v165 offset:16896
  s_waitcnt lgkmcnt(15)
  v_mfma_f32_32x32x16_bf16 a[0:15], v[200:203], v[152:155], a[0:15]
  v_mfma_f32_32x32x16_bf16 a[16:31], v[204:207], v[152:155], a[16:31]
  s_waitcnt lgkmcnt(14)
  v_mfma_f32_32x32x16_bf16 a[32:47], v[208:211], v[152:155], a[32:47]
  s_waitcnt lgkmcnt(12)
  v_mfma_f32_32x32x16_bf16 a[48:63], v[212:215], v[152:155], a[48:63]
  s_waitcnt lgkmcnt(10)
  v_mfma_f32_32x32x16_bf16 a[64:79], v[216:219], v[152:155], a[64:79]
  s_waitcnt lgkmcnt(8)
  v_mfma_f32_32x32x16_bf16 a[0:15], v[220:223], v[156:159], a[0:15]
  s_waitcnt lgkmcnt(6)
  v_mfma_f32_32x32x16_bf16 a[16:31], v[224:227], v[156:159], a[16:31]
  s_waitcnt lgkmcnt(4)
  v_mfma_f32_32x32x16_bf16 a[32:47], v[228:231], v[156:159], a[32:47]
  s_waitcnt lgkmcnt(2)
  v_mfma_f32_32x32x16_bf16 a[48:63], v[232:235], v[156:159], a[48:63]
  s_waitcnt lgkmcnt(0)
  v_mfma_f32_32x32x16_bf16 a[64:79], v[236:239], v[156:159], a[64:79]
  s_mov_b32 s36, 0x3eae1a93
  v_mul_u32_u24 v9, 336, v3
  v_lshl_add_u32 v9, v4, 3, v9
  v_add_u32 v9, s31, v9
  s_waitcnt lgkmcnt(0)
  v_accvgpr_read_b32 v168, a0
  v_accvgpr_read_b32 v169, a1
  v_accvgpr_read_b32 v170, a2
  v_accvgpr_read_b32 v171, a3
  v_accvgpr_read_b32 v172, a4
  v_accvgpr_read_b32 v173, a5
  v_accvgpr_read_b32 v174, a6
  v_accvgpr_read_b32 v175, a7
  v_accvgpr_read_b32 v176, a8
  v_accvgpr_read_b32 v177, a9
  v_accvgpr_read_b32 v178, a10
  v_accvgpr_read_b32 v179, a11
  v_accvgpr_read_b32 v180, a12
  v_accvgpr_read_b32 v181, a13
  v_accvgpr_read_b32 v182, a14
  v_accvgpr_read_b32 v183, a15
  v_mul_f32 v168, s36, v168
  v_mul_f32 v169, s36, v169
  v_mul_f32 v170, s36, v170
  v_mul_f32 v171, s36, v171
  v_mul_f32 v172, s36, v172
  v_mul_f32 v173, s36, v173
  v_mul_f32 v174, s36, v174
  v_mul_f32 v175, s36, v175
  v_mul_f32 v176, s36, v176
  v_mul_f32 v177, s36, v177
  v_mul_f32 v178, s36, v178
  v_mul_f32 v179, s36, v179
  v_mul_f32 v180, s36, v180
  v_mul_f32 v181, s36, v181
  v_mul_f32 v182, s36, v182
  v_mul_f32 v183, s36, v183
  v_cvt_pk_bf16_f32 v184, v168, v169
  v_cvt_pk_bf16_f32 v185, v170, v171
  ds_write_b64 v9, v[184:185] offset:0
  v_cvt_pk_bf16_f32 v186, v172, v173
  v_cvt_pk_bf16_f32 v187, v174, v175
  ds_write_b64 v9, v[186:187] offset:16
  v_cvt_pk_bf16_f32 v188, v176, v177
  v_cvt_pk_bf16_f32 v189, v178, v179
  ds_write_b64 v9, v[188:189] offset:32
  v_cvt_pk_bf16_f32 v190, v180, v181
  v_cvt_pk_bf16_f32 v191, v182, v183
  ds_write_b64 v9, v[190:191] offset:48
  v_accvgpr_read_b32 v168, a16
  v_accvgpr_read_b32 v169, a17
  v_accvgpr_read_b32 v170, a18
  v_accvgpr_read_b32 v171, a19
  v_accvgpr_read_b32 v172, a20
  v_accvgpr_read_b32 v173, a21
  v_accvgpr_read_b32 v174, a22
  v_accvgpr_read_b32 v175, a23
  v_accvgpr_read_b32 v176, a24
  v_accvgpr_read_b32 v177, a25
  v_accvgpr_read_b32 v178, a26
  v_accvgpr_read_b32 v179, a27
  v_accvgpr_read_b32 v180, a28
  v_accvgpr_read_b32 v181, a29
  v_accvgpr_read_b32 v182, a30
  v_accvgpr_read_b32 v183, a31
  v_mul_f32 v168, s36, v168
  v_mul_f32 v169, s36, v169
  v_mul_f32 v170, s36, v170
  v_mul_f32 v171, s36, v171
  v_mul_f32 v172, s36, v172
  v_mul_f32 v173, s36, v173
  v_mul_f32 v174, s36, v174
  v_mul_f32 v175, s36, v175
  v_mul_f32 v176, s36, v176
  v_mul_f32 v177, s36, v177
  v_mul_f32 v178, s36, v178
  v_mul_f32 v179, s36, v179
  v_mul_f32 v180, s36, v180
  v_mul_f32 v181, s36, v181
  v_mul_f32 v182, s36, v182
  v_mul_f32 v183, s36, v183
  v_cvt_pk_bf16_f32 v184, v168, v169
  v_cvt_pk_bf16_f32 v185, v170, v171
  ds_write_b64 v9, v[184:185] offset:64
  v_cvt_pk_bf16_f32 v186, v172, v173
  v_cvt_pk_bf16_f32 v187, v174, v175
  ds_write_b64 v9, v[186:187] offset:80
  v_cvt_pk_bf16_f32 v188, v176, v177
  v_cvt_pk_bf16_f32 v189, v178, v179
  ds_write_b64 v9, v[188:189] offset:96
  v_cvt_pk_bf16_f32 v190, v180, v181
  v_cvt_pk_bf16_f32 v191, v182, v183
  ds_write_b64 v9, v[190:191] offset:112
  v_accvgpr_read_b32 v168, a32
  v_accvgpr_read_b32 v169, a33
  v_accvgpr_read_b32 v170, a34
  v_accvgpr_read_b32 v171, a35
  v_accvgpr_read_b32 v172, a36
  v_accvgpr_read_b32 v173, a37
  v_accvgpr_read_b32 v174, a38
  v_accvgpr_read_b32 v175, a39
  v_accvgpr_read_b32 v176, a40
  v_accvgpr_read_b32 v177, a41
  v_accvgpr_read_b32 v178, a42
  v_accvgpr_read_b32 v179, a43
  v_accvgpr_read_b32 v180, a44
  v_accvgpr_read_b32 v181, a45
  v_accvgpr_read_b32 v182, a46
  v_accvgpr_read_b32 v183, a47
  v_mul_f32 v168, s36, v168
  v_mul_f32 v169, s36, v169
  v_mul_f32 v170, s36, v170
  v_mul_f32 v171, s36, v171
  v_mul_f32 v172, s36, v172
  v_mul_f32 v173, s36, v173
  v_mul_f32 v174, s36, v174
  v_mul_f32 v175, s36, v175
  v_mul_f32 v176, s36, v176
  v_mul_f32 v177, s36, v177
  v_mul_f32 v178, s36, v178
  v_mul_f32 v179, s36, v179
  v_mul_f32 v180, s36, v180
  v_mul_f32 v181, s36, v181
  v_mul_f32 v182, s36, v182
  v_mul_f32 v183, s36, v183
  v_cvt_pk_bf16_f32 v184, v168, v169
  v_cvt_pk_bf16_f32 v185, v170, v171
  ds_write_b64 v9, v[184:185] offset:128
  v_cvt_pk_bf16_f32 v186, v172, v173
  v_cvt_pk_bf16_f32 v187, v174, v175
  ds_write_b64 v9, v[186:187] offset:144
  v_cvt_pk_bf16_f32 v188, v176, v177
  v_cvt_pk_bf16_f32 v189, v178, v179
  ds_write_b64 v9, v[188:189] offset:160
  v_cvt_pk_bf16_f32 v190, v180, v181
  v_cvt_pk_bf16_f32 v191, v182, v183
  ds_write_b64 v9, v[190:191] offset:176
  v_accvgpr_read_b32 v168, a48
  v_accvgpr_read_b32 v169, a49
  v_accvgpr_read_b32 v170, a50
  v_accvgpr_read_b32 v171, a51
  v_accvgpr_read_b32 v172, a52
  v_accvgpr_read_b32 v173, a53
  v_accvgpr_read_b32 v174, a54
  v_accvgpr_read_b32 v175, a55
  v_accvgpr_read_b32 v176, a56
  v_accvgpr_read_b32 v177, a57
  v_accvgpr_read_b32 v178, a58
  v_accvgpr_read_b32 v179, a59
  v_accvgpr_read_b32 v180, a60
  v_accvgpr_read_b32 v181, a61
  v_accvgpr_read_b32 v182, a62
  v_accvgpr_read_b32 v183, a63
  v_mul_f32 v168, s36, v168
  v_mul_f32 v169, s36, v169
  v_mul_f32 v170, s36, v170
  v_mul_f32 v171, s36, v171
  v_mul_f32 v172, s36, v172
  v_mul_f32 v173, s36, v173
  v_mul_f32 v174, s36, v174
  v_mul_f32 v175, s36, v175
  v_mul_f32 v176, s36, v176
  v_mul_f32 v177, s36, v177
  v_mul_f32 v178, s36, v178
  v_mul_f32 v179, s36, v179
  v_mul_f32 v180, s36, v180
  v_mul_f32 v181, s36, v181
  v_mul_f32 v182, s36, v182
  v_mul_f32 v183, s36, v183
  v_cvt_pk_bf16_f32 v184, v168, v169
  v_cvt_pk_bf16_f32 v185, v170, v171
  ds_write_b64 v9, v[184:185] offset:192
  v_cvt_pk_bf16_f32 v186, v172, v173
  v_cvt_pk_bf16_f32 v187, v174, v175
  ds_write_b64 v9, v[186:187] offset:208
  v_cvt_pk_bf16_f32 v188, v176, v177
  v_cvt_pk_bf16_f32 v189, v178, v179
  ds_write_b64 v9, v[188:189] offset:224
  v_cvt_pk_bf16_f32 v190, v180, v181
  v_cvt_pk_bf16_f32 v191, v182, v183
  ds_write_b64 v9, v[190:191] offset:240
  v_accvgpr_read_b32 v168, a64
  v_accvgpr_read_b32 v169, a65
  v_accvgpr_read_b32 v170, a66
  v_accvgpr_read_b32 v171, a67
  v_accvgpr_read_b32 v172, a68
  v_accvgpr_read_b32 v173, a69
  v_accvgpr_read_b32 v174, a70
  v_accvgpr_read_b32 v175, a71
  v_accvgpr_read_b32 v176, a72
  v_accvgpr_read_b32 v177, a73
  v_accvgpr_read_b32 v178, a74
  v_accvgpr_read_b32 v179, a75
  v_accvgpr_read_b32 v180, a76
  v_accvgpr_read_b32 v181, a77
  v_accvgpr_read_b32 v182, a78
  v_accvgpr_read_b32 v183, a79
  v_mul_f32 v168, s36, v168
  v_mul_f32 v169, s36, v169
  v_mul_f32 v170, s36, v170
  v_mul_f32 v171, s36, v171
  v_mul_f32 v172, s36, v172
  v_mul_f32 v173, s36, v173
  v_mul_f32 v174, s36, v174
  v_mul_f32 v175, s36, v175
  v_mul_f32 v176, s36, v176
  v_mul_f32 v177, s36, v177
  v_mul_f32 v178, s36, v178
  v_mul_f32 v179, s36, v179
  v_mul_f32 v180, s36, v180
  v_mul_f32 v181, s36, v181
  v_mul_f32 v182, s36, v182
  v_mul_f32 v183, s36, v183
  v_cvt_pk_bf16_f32 v184, v168, v169
  v_cvt_pk_bf16_f32 v185, v170, v171
  ds_write_b64 v9, v[184:185] offset:256
  v_cvt_pk_bf16_f32 v186, v172, v173
  v_cvt_pk_bf16_f32 v187, v174, v175
  ds_write_b64 v9, v[186:187] offset:272
  v_cvt_pk_bf16_f32 v188, v176, v177
  v_cvt_pk_bf16_f32 v189, v178, v179
  ds_write_b64 v9, v[188:189] offset:288
  v_cvt_pk_bf16_f32 v190, v180, v181
  v_cvt_pk_bf16_f32 v191, v182, v183
  ds_write_b64 v9, v[190:191] offset:304
  s_mul_i32 s37, s13, 288
  s_sub_u32 s37, s37, s32
  v_add_u32 v9, s37, v9
  v_cmp_eq_u32 s[34:35], 0, v4
  ds_read2_b32 v[16:17], v9 offset0:0 offset1:1
  ds_read2_b32 v[18:19], v9 offset0:4 offset1:5
  ds_read_b32 v20, v9 offset:32
  ds_read2_b32 v[24:25], v9 offset0:9 offset1:10
  ds_read2_b32 v[26:27], v9 offset0:13 offset1:14
  ds_read_b32 v28, v9 offset:68
  ds_read2_b32 v[32:33], v9 offset0:18 offset1:19
  ds_read2_b32 v[34:35], v9 offset0:22 offset1:23
  ds_read_b32 v36, v9 offset:104
  ds_read2_b32 v[40:41], v9 offset0:27 offset1:28
  ds_read2_b32 v[42:43], v9 offset0:31 offset1:32
  ds_read_b32 v44, v9 offset:140
  ds_read2_b32 v[48:49], v9 offset0:36 offset1:37
  ds_read2_b32 v[50:51], v9 offset0:40 offset1:41
  ds_read_b32 v52, v9 offset:176
  ds_read2_b32 v[56:57], v9 offset0:45 offset1:46
  ds_read2_b32 v[58:59], v9 offset0:49 offset1:50
  ds_read_b32 v60, v9 offset:212
  ds_read2_b32 v[64:65], v9 offset0:54 offset1:55
  ds_read2_b32 v[66:67], v9 offset0:58 offset1:59
  ds_read_b32 v68, v9 offset:248
  ds_read2_b32 v[72:73], v9 offset0:63 offset1:64
  ds_read2_b32 v[74:75], v9 offset0:67 offset1:68
  ds_read_b32 v76, v9 offset:284
  s_waitcnt lgkmcnt(15)
  v_cndmask_b32 v20, 0, v20, s[34:35]
  v_mov_b32 v21, 0
  v_mov_b32 v22, 0
  v_mov_b32 v23, 0
  v_cndmask_b32 v28, 0, v28, s[34:35]
  v_mov_b32 v29, 0
  v_mov_b32 v30, 0
  v_mov_b32 v31, 0
  v_cndmask_b32 v36, 0, v36, s[34:35]
  v_mov_b32 v37, 0
  v_mov_b32 v38, 0
  v_mov_b32 v39, 0
  s_waitcnt lgkmcnt(12)
  v_cndmask_b32 v44, 0, v44, s[34:35]
  v_mov_b32 v45, 0
  v_mov_b32 v46, 0
  v_mov_b32 v47, 0
  s_waitcnt lgkmcnt(9)
  v_cndmask_b32 v52, 0, v52, s[34:35]
  v_mov_b32 v53, 0
  v_mov_b32 v54, 0
  v_mov_b32 v55, 0
  s_waitcnt lgkmcnt(6)
  v_cndmask_b32 v60, 0, v60, s[34:35]
  v_mov_b32 v61, 0
  v_mov_b32 v62, 0
  v_mov_b32 v63, 0
  s_waitcnt lgkmcnt(3)
  v_cndmask_b32 v68, 0, v68, s[34:35]
  v_mov_b32 v69, 0
  v_mov_b32 v70, 0
  v_mov_b32 v71, 0
  s_waitcnt lgkmcnt(0)
  v_cndmask_b32 v76, 0, v76, s[34:35]
  v_mov_b32 v77, 0
  v_mov_b32 v78, 0
  v_mov_b32 v79, 0
  s_mov_b32 s40, 0
  v_mov_b32 v9, 0
AW_32:
  global_load_dword v10, v9, s[66:67] offset:224 sc1
  s_add_u32 s40, s40, 1
  s_cmp_gt_u32 s40, 400000
  s_cbranch_scc1 L_fail
  s_waitcnt vmcnt(0)
  v_readfirstlane_b32 s37, v10
  s_nop 0
  s_cmp_ge_u32 s37, 64
  s_cbranch_scc1 AWK_33
  s_sleep 4
  s_branch AW_32
AWK_33:
  s_barrier
  s_mul_i32 s36, s13, 38912
  s_add_u32 s37, s36, 67108864
  s_mov_b32 s38, 0
AD_34:
  s_mov_b32 m0, s36
  s_add_u32 s36, s36, 1024
  buffer_load_dwordx4 v2, s[4:7], s37 offen sc1 lds
  s_add_u32 s37, s37, 1024
  s_add_u32 s38, s38, 1
  s_cmp_lt_u32 s38, 38
  s_cbranch_scc1 AD_34
  v_min_u32 v11, 19, v3
  v_mul_u32_u24 v10, 320, v4
  v_lshl_add_u32 v10, v11, 4, v10
  v_mov_b32 v89, 0x3f80
  v_mov_b32 v90, 0
  v_mov_b32 v91, 0
  v_mov_b32 v93, 0x3f80
  v_mov_b32 v94, 0
  v_mov_b32 v95, 0
  s_waitcnt vmcnt(0)
  s_barrier
  v_mov_b32 v8, v2
  v_lshlrev_b32 v9, 2, v3
  v_add_u32 v9, 65536, v9
  v_mov_b32 v208, 0xff800000
  v_mov_b32 v209, 0xff800000
  v_mov_b32 v210, 0xff800000
  v_mov_b32 v211, 0xff800000
  ds_read_b128 v[80:83], v8 offset:0
  ds_read_b32 v88, v9 offset:0
  s_waitcnt lgkmcnt(1)
  v_mfma_f32_32x32x16_bf16 v[112:127], v[80:83], v[16:19], 0
  s_waitcnt lgkmcnt(0)
  v_mfma_f32_32x32x16_bf16 v[112:127], v[88:91], v[20:23], v[112:127]
  s_mov_b32 s28, 0
.p2align 6
P1L_35:
  ds_read_b128 v[84:87], v8 offset:1024
  ds_read_b32 v92, v9 offset:128
  v_mfma_f32_32x32x16_bf16 v[128:143], v[80:83], v[24:27], 0
  s_nop 7
  v_max3_f32 v208, v208, v112, v113
  v_max3_f32 v208, v208, v114, v115
  v_max3_f32 v208, v208, v116, v117
  v_max3_f32 v208, v208, v118, v119
  v_mfma_f32_32x32x16_bf16 v[128:143], v[88:91], v[28:31], v[128:143]
  v_max3_f32 v208, v208, v120, v121
  v_max3_f32 v208, v208, v122, v123
  v_max3_f32 v208, v208, v124, v125
  v_max3_f32 v208, v208, v126, v127
  v_mfma_f32_32x32x16_bf16 v[112:127], v[80:83], v[32:35], 0
  s_nop 6
  v_max3_f32 v209, v209, v128, v129
  v_max3_f32 v209, v209, v130, v131
  v_max3_f32 v209, v209, v132, v133
  v_max3_f32 v209, v209, v134, v135
  v_mfma_f32_32x32x16_bf16 v[112:127], v[88:91], v[36:39], v[112:127]
  v_max3_f32 v209, v209, v136, v137
  v_max3_f32 v209, v209, v138, v139
  v_max3_f32 v209, v209, v140, v141
  v_max3_f32 v209, v209, v142, v143
  v_mfma_f32_32x32x16_bf16 v[128:143], v[80:83], v[40:43], 0
  s_nop 6
  v_max3_f32 v210, v210, v112, v113
  v_max3_f32 v210, v210, v114, v115
  v_max3_f32 v210, v210, v116, v117
  v_max3_f32 v210, v210, v118, v119
  v_mfma_f32_32x32x16_bf16 v[128:143], v[88:91], v[44:47], v[128:143]
  v_max3_f32 v210, v210, v120, v121
  v_max3_f32 v210, v210, v122, v123
  v_max3_f32 v210, v210, v124, v125
  v_max3_f32 v210, v210, v126, v127
  s_waitcnt lgkmcnt(1)
  v_mfma_f32_32x32x16_bf16 v[112:127], v[84:87], v[16:19], 0
  s_nop 5
  v_max3_f32 v211, v211, v128, v129
  v_max3_f32 v211, v211, v130, v131
  v_max3_f32 v211, v211, v132, v133
  v_max3_f32 v211, v211, v134, v135
  s_waitcnt lgkmcnt(0)
  v_mfma_f32_32x32x16_bf16 v[112:127], v[92:95], v[20:23], v[112:127]
  v_max3_f32 v211, v211, v136, v137
  v_max3_f32 v211, v211, v138, v139
  v_max3_f32 v211, v211, v140, v141
  v_max3_f32 v211, v211, v142, v143
  ds_read_b128 v[80:83], v8 offset:2048
  ds_read_b32 v88, v9 offset:256
  v_mfma_f32_32x32x16_bf16 v[128:143], v[84:87], v[24:27], 0
  s_nop 4
  v_max3_f32 v208, v208, v112, v113
  v_max3_f32 v208, v208, v114, v115
  v_max3_f32 v208, v208, v116, v117
  v_max3_f32 v208, v208, v118, v119
  v_mfma_f32_32x32x16_bf16 v[128:143], v[92:95], v[28:31], v[128:143]
  v_max3_f32 v208, v208, v120, v121
  v_max3_f32 v208, v208, v122, v123
  v_max3_f32 v208, v208, v124, v125
  v_max3_f32 v208, v208, v126, v127
  v_mfma_f32_32x32x16_bf16 v[112:127], v[84:87], v[32:35], 0
  s_nop 6
  v_max3_f32 v209, v209, v128, v129
  v_max3_f32 v209, v209, v130, v131
  v_max3_f32 v209, v209, v132, v133
  v_max3_f32 v209, v209, v134, v135
  v_mfma_f32_32x32x16_bf16 v[112:127], v[92:95], v[36:39], v[112:127]
  v_max3_f32 v209, v209, v136, v137
  v_max3_f32 v209, v209, v138, v139
  v_max3_f32 v209, v209, v140, v141
  v_max3_f32 v209, v209, v142, v143
  v_mfma_f32_32x32x16_bf16 v[128:143], v[84:87], v[40:43], 0
  s_nop 6
  v_max3_f32 v210, v210, v112, v113
  v_max3_f32 v210, v210, v114, v115
  v_max3_f32 v210, v210, v116, v117
  v_max3_f32 v210, v210, v118, v119
  v_mfma_f32_32x32x16_bf16 v[128:143], v[92:95], v[44:47], v[128:143]
  v_max3_f32 v210, v210, v120, v121
  v_max3_f32 v210, v210, v122, v123
  v_max3_f32 v210, v210, v124, v125
  v_max3_f32 v210, v210, v126, v127
  s_waitcnt lgkmcnt(1)
  v_mfma_f32_32x32x16_bf16 v[112:127], v[80:83], v[16:19], 0
  s_nop 5
  v_max3_f32 v211, v211, v128, v129
  v_max3_f32 v211, v211, v130, v131
  v_max3_f32 v211, v211, v132, v133
  v_max3_f32 v211, v211, v134, v135
  s_waitcnt lgkmcnt(0)
  v_mfma_f32_32x32x16_bf16 v[112:127], v[88:91], v[20:23], v[112:127]
  v_max3_f32 v211, v211, v136, v137
  v_max3_f32 v211, v211, v138, v139
  v_max3_f32 v211, v211, v140, v141
  v_max3_f32 v211, v211, v142, v143
  v_add_u32 v8, 2048, v8
  v_add_u32 v9, 256, v9
  s_add_u32 s28, s28, 1
  s_cmp_lt_u32 s28, 32
  s_cbranch_scc1 P1L_35
  v_mov_b32 v212, v208
  s_nop 1
  v_permlane32_swap_b32 v208, v212
  v_max_f32 v208, v208, v212
  v_sub_f32 v208, 0, v208
  v_cvt_pk_bf16_f32 v208, v208, 0
  v_cndmask_b32 v21, 0, v208, s[34:35]
  v_mov_b32 v212, v209
  s_nop 1
  v_permlane32_swap_b32 v209, v212
  v_max_f32 v209, v209, v212
  v_sub_f32 v209, 0, v209
  v_cvt_pk_bf16_f32 v209, v209, 0
  v_cndmask_b32 v29, 0, v209, s[34:35]
  v_mov_b32 v212, v210
  s_nop 1
  v_permlane32_swap_b32 v210, v212
  v_max_f32 v210, v210, v212
  v_sub_f32 v210, 0, v210
  v_cvt_pk_bf16_f32 v210, v210, 0
  v_cndmask_b32 v37, 0, v210, s[34:35]
  v_mov_b32 v212, v211
  s_nop 1
  v_permlane32_swap_b32 v211, v212
  v_max_f32 v211, v211, v212
  v_sub_f32 v211, 0, v211
  v_cvt_pk_bf16_f32 v211, v211, 0
  v_cndmask_b32 v45, 0, v211, s[34:35]
  v_mov_b32 v8, v2
  v_lshlrev_b32 v9, 2, v3
  v_add_u32 v9, 65536, v9
  v_add_u32 v11, 73728, v10
  v_accvgpr_write_b32 a0, 0
  v_accvgpr_write_b32 a1, 0
  v_accvgpr_write_b32 a2, 0
  v_accvgpr_write_b32 a3, 0
  v_accvgpr_write_b32 a4, 0
  v_accvgpr_write_b32 a5, 0
  v_accvgpr_write_b32 a6, 0
  v_accvgpr_write_b32 a7, 0
  v_accvgpr_write_b32 a8, 0
  v_accvgpr_write_b32 a9, 0
  v_accvgpr_write_b32 a10, 0
  v_accvgpr_write_b32 a11, 0
  v_accvgpr_write_b32 a12, 0
  v_accvgpr_write_b32 a13, 0
  v_accvgpr_write_b32 a14, 0
  v_accvgpr_write_b32 a15, 0
  v_accvgpr_write_b32 a16, 0
  v_accvgpr_write_b32 a17, 0
  v_accvgpr_write_b32 a18, 0
  v_accvgpr_write_b32 a19, 0
  v_accvgpr_write_b32 a20, 0
  v_accvgpr_write_b32 a21, 0
  v_accvgpr_write_b32 a22, 0
  v_accvgpr_write_b32 a23, 0
  v_accvgpr_write_b32 a24, 0
  v_accvgpr_write_b32 a25, 0
  v_accvgpr_write_b32 a26, 0
  v_accvgpr_write_b32 a27, 0
  v_accvgpr_write_b32 a28, 0
  v_accvgpr_write_b32 a29, 0
  v_accvgpr_write_b32 a30, 0
  v_accvgpr_write_b32 a31, 0
  v_accvgpr_write_b32 a32, 0
  v_accvgpr_write_b32 a33, 0
  v_accvgpr_write_b32 a34, 0
  v_accvgpr_write_b32 a35, 0
  v_accvgpr_write_b32 a36, 0
  v_accvgpr_write_b32 a37, 0
  v_accvgpr_write_b32 a38, 0
  v_accvgpr_write_b32 a39, 0
  v_accvgpr_write_b32 a40, 0
  v_accvgpr_write_b32 a41, 0
  v_accvgpr_write_b32 a42, 0
  v_accvgpr_write_b32 a43, 0
  v_accvgpr_write_b32 a44, 0
  v_accvgpr_write_b32 a45, 0
  v_accvgpr_write_b32 a46, 0
  v_accvgpr_write_b32 a47, 0
  v_accvgpr_write_b32 a48, 0
  v_accvgpr_write_b32 a49, 0
  v_accvgpr_write_b32 a50, 0
  v_accvgpr_write_b32 a51, 0
  v_accvgpr_write_b32 a52, 0
  v_accvgpr_write_b32 a53, 0
  v_accvgpr_write_b32 a54, 0
  v_accvgpr_write_b32 a55, 0
  v_accvgpr_write_b32 a56, 0
  v_accvgpr_write_b32 a57, 0
  v_accvgpr_write_b32 a58, 0
  v_accvgpr_write_b32 a59, 0
  v_accvgpr_write_b32 a60, 0
  v_accvgpr_write_b32 a61, 0
  v_accvgpr_write_b32 a62, 0
  v_accvgpr_write_b32 a63, 0
  v_mov_b32 v152, 0
  v_mov_b32 v153, 0
  v_mov_b32 v154, 0
  v_mov_b32 v155, 0
  v_mov_b32 v156, 0
  v_mov_b32 v157, 0
  v_mov_b32 v158, 0
  v_mov_b32 v159, 0
  ds_read_b128 v[80:83], v8 offset:0
  ds_read_b32 v88, v9 offset:0
  ds_read_b128 v[104:107], v11 offset:0
  ds_read_b128 v[108:111], v11 offset:640
  s_waitcnt lgkmcnt(3)
  v_mfma_f32_32x32x16_bf16 v[112:127], v[80:83], v[16:19], 0
  s_waitcnt lgkmcnt(2)
  v_mfma_f32_32x32x16_bf16 v[112:127], v[88:91], v[20:23], v[112:127]
  s_mov_b32 s28, 0
.p2align 6
P2L_36:
  ds_read_b128 v[96:99], v11 offset:0
  ds_read_b128 v[100:103], v11 offset:640
  v_mfma_f32_32x32x16_bf16 v[128:143], v[80:83], v[24:27], 0
  s_nop 7
  v_exp_f32 v112, v112
  v_exp_f32 v113, v113
  v_exp_f32 v114, v114
  v_exp_f32 v115, v115
  s_waitcnt lgkmcnt(3)
  v_mfma_f32_32x32x16_bf16 a[48:63], v[104:107], v[152:155], a[48:63]
  v_exp_f32 v116, v116
  v_exp_f32 v117, v117
  v_exp_f32 v118, v118
  v_exp_f32 v119, v119
  v_cvt_pk_bf16_f32 v144, v112, v113
  v_cvt_pk_bf16_f32 v145, v114, v115
  v_mfma_f32_32x32x16_bf16 v[128:143], v[88:91], v[28:31], v[128:143]
  v_exp_f32 v120, v120
  v_exp_f32 v121, v121
  v_exp_f32 v122, v122
  v_exp_f32 v123, v123
  v_cvt_pk_bf16_f32 v148, v116, v117
  v_cvt_pk_bf16_f32 v149, v118, v119
  s_waitcnt lgkmcnt(2)
  v_mfma_f32_32x32x16_bf16 a[48:63], v[108:111], v[156:159], a[48:63]
  v_exp_f32 v124, v124
  v_exp_f32 v125, v125
  v_exp_f32 v126, v126
  v_exp_f32 v127, v127
  v_cvt_pk_bf16_f32 v146, v120, v121
  v_cvt_pk_bf16_f32 v147, v122, v123
  v_cvt_pk_bf16_f32 v150, v124, v125
  v_cvt_pk_bf16_f32 v151, v126, v127
  ds_read_b128 v[84:87], v8 offset:1024
  ds_read_b32 v92, v9 offset:128
  v_mfma_f32_32x32x16_bf16 v[112:127], v[80:83], v[32:35], 0
  v_exp_f32 v128, v128
  v_exp_f32 v129, v129
  v_exp_f32 v130, v130
  v_exp_f32 v131, v131
  s_waitcnt lgkmcnt(3)
  v_mfma_f32_32x32x16_bf16 a[0:15], v[96:99], v[144:147], a[0:15]
  v_exp_f32 v132, v132
  v_exp_f32 v133, v133
  v_exp_f32 v134, v134
  v_exp_f32 v135, v135
  v_cvt_pk_bf16_f32 v152, v128, v129
  v_cvt_pk_bf16_f32 v153, v130, v131
  v_mfma_f32_32x32x16_bf16 v[112:127], v[88:91], v[36:39], v[112:127]
  v_exp_f32 v136, v136
  v_exp_f32 v137, v137
  v_exp_f32 v138, v138
  v_exp_f32 v139, v139
  v_cvt_pk_bf16_f32 v156, v132, v133
  v_cvt_pk_bf16_f32 v157, v134, v135
  s_waitcnt lgkmcnt(2)
  v_mfma_f32_32x32x16_bf16 a[0:15], v[100:103], v[148:151], a[0:15]
  v_exp_f32 v140, v140
  v_exp_f32 v141, v141
  v_exp_f32 v142, v142
  v_exp_f32 v143, v143
  v_cvt_pk_bf16_f32 v154, v136, v137
  v_cvt_pk_bf16_f32 v155, v138, v139
  v_cvt_pk_bf16_f32 v158, v140, v141
  v_cvt_pk_bf16_f32 v159, v142, v143
  v_mfma_f32_32x32x16_bf16 v[128:143], v[80:83], v[40:43], 0
  v_exp_f32 v112, v112
  v_exp_f32 v113, v113
  v_exp_f32 v114, v114
  v_exp_f32 v115, v115
  v_mfma_f32_32x32x16_bf16 a[16:31], v[96:99], v[152:155], a[16:31]
  v_exp_f32 v116, v116
  v_exp_f32 v117, v117
  v_exp_f32 v118, v118
  v_exp_f32 v119, v119
  v_cvt_pk_bf16_f32 v144, v112, v113
  v_cvt_pk_bf16_f32 v145, v114, v115
  v_mfma_f32_32x32x16_bf16 v[128:143], v[88:91], v[44:47], v[128:143]
  v_exp_f32 v120, v120
  v_exp_f32 v121, v121
  v_exp_f32 v122, v122
  v_exp_f32 v123, v123
  v_cvt_pk_bf16_f32 v148, v116, v117
  v_cvt_pk_bf16_f32 v149, v118, v119
  v_mfma_f32_32x32x16_bf16 a[16:31], v[100:103], v[156:159], a[16:31]
  v_exp_f32 v124, v124
  v_exp_f32 v125, v125
  v_exp_f32 v126, v126
  v_exp_f32 v127, v127
  v_cvt_pk_bf16_f32 v146, v120, v121
  v_cvt_pk_bf16_f32 v147, v122, v123
  v_cvt_pk_bf16_f32 v150, v124, v125
  v_cvt_pk_bf16_f32 v151, v126, v127
  s_waitcnt lgkmcnt(1)
  v_mfma_f32_32x32x16_bf16 v[112:127], v[84:87], v[16:19], 0
  v_exp_f32 v128, v128
  v_exp_f32 v129, v129
  v_exp_f32 v130, v130
  v_exp_f32 v131, v131
  v_mfma_f32_32x32x16_bf16 a[32:47], v[96:99], v[144:147], a[32:47]
  v_exp_f32 v132, v132
  v_exp_f32 v133, v133
  v_exp_f32 v134, v134
  v_exp_f32 v135, v135
  v_cvt_pk_bf16_f32 v152, v128, v129
  v_cvt_pk_bf16_f32 v153, v130, v131
  s_waitcnt lgkmcnt(0)
  v_mfma_f32_32x32x16_bf16 v[112:127], v[92:95], v[20:23], v[112:127]
  v_exp_f32 v136, v136
  v_exp_f32 v137, v137
  v_exp_f32 v138, v138
  v_exp_f32 v139, v139
  v_cvt_pk_bf16_f32 v156, v132, v133
  v_cvt_pk_bf16_f32 v157, v134, v135
  v_mfma_f32_32x32x16_bf16 a[32:47], v[100:103], v[148:151], a[32:47]
  v_exp_f32 v140, v140
  v_exp_f32 v141, v141
  v_exp_f32 v142, v142
  v_exp_f32 v143, v143
  v_cvt_pk_bf16_f32 v154, v136, v137
  v_cvt_pk_bf16_f32 v155, v138, v139
  v_cvt_pk_bf16_f32 v158, v140, v141
  v_cvt_pk_bf16_f32 v159, v142, v143
  ds_read_b128 v[104:107], v11 offset:1280
  ds_read_b128 v[108:111], v11 offset:1920
  v_mfma_f32_32x32x16_bf16 v[128:143], v[84:87], v[24:27], 0
  v_exp_f32 v112, v112
  v_exp_f32 v113, v113
  v_exp_f32 v114, v114
  v_exp_f32 v115, v115
  v_mfma_f32_32x32x16_bf16 a[48:63], v[96:99], v[152:155], a[48:63]
  v_exp_f32 v116, v116
  v_exp_f32 v117, v117
  v_exp_f32 v118, v118
  v_exp_f32 v119, v119
  v_cvt_pk_bf16_f32 v144, v112, v113
  v_cvt_pk_bf16_f32 v145, v114, v115
  v_mfma_f32_32x32x16_bf16 v[128:143], v[92:95], v[28:31], v[128:143]
  v_exp_f32 v120, v120
  v_exp_f32 v121, v121
  v_exp_f32 v122, v122
  v_exp_f32 v123, v123
  v_cvt_pk_bf16_f32 v148, v116, v117
  v_cvt_pk_bf16_f32 v149, v118, v119
  v_mfma_f32_32x32x16_bf16 a[48:63], v[100:103], v[156:159], a[48:63]
  v_exp_f32 v124, v124
  v_exp_f32 v125, v125
  v_exp_f32 v126, v126
  v_exp_f32 v127, v127
  v_cvt_pk_bf16_f32 v146, v120, v121
  v_cvt_pk_bf16_f32 v147, v122, v123
  v_cvt_pk_bf16_f32 v150, v124, v125
  v_cvt_pk_bf16_f32 v151, v126, v127
  ds_read_b128 v[80:83], v8 offset:2048
  ds_read_b32 v88, v9 offset:256
  v_mfma_f32_32x32x16_bf16 v[112:127], v[84:87], v[32:35], 0
  v_exp_f32 v128, v128
  v_exp_f32 v129, v129
  v_exp_f32 v130, v130
  v_exp_f32 v131, v131
  s_waitcnt lgkmcnt(3)
  v_mfma_f32_32x32x16_bf16 a[0:15], v[104:107], v[144:147], a[0:15]
  v_exp_f32 v132, v132
  v_exp_f32 v133, v133
  v_exp_f32 v134, v134
  v_exp_f32 v135, v135
  v_cvt_pk_bf16_f32 v152, v128, v129
  v_cvt_pk_bf16_f32 v153, v130, v131
  v_mfma_f32_32x32x16_bf16 v[112:127], v[92:95], v[36:39], v[112:127]
  v_exp_f32 v136, v136
  v_exp_f32 v137, v137
  v_exp_f32 v138, v138
  v_exp_f32 v139, v139
  v_cvt_pk_bf16_f32 v156, v132, v133
  v_cvt_pk_bf16_f32 v157, v134, v135
  s_waitcnt lgkmcnt(2)
  v_mfma_f32_32x32x16_bf16 a[0:15], v[108:111], v[148:151], a[0:15]
  v_exp_f32 v140, v140
  v_exp_f32 v141, v141
  v_exp_f32 v142, v142
  v_exp_f32 v143, v143
  v_cvt_pk_bf16_f32 v154, v136, v137
  v_cvt_pk_bf16_f32 v155, v138, v139
  v_cvt_pk_bf16_f32 v158, v140, v141
  v_cvt_pk_bf16_f32 v159, v142, v143
  v_mfma_f32_32x32x16_bf16 v[128:143], v[84:87], v[40:43], 0
  v_exp_f32 v112, v112
  v_exp_f32 v113, v113
  v_exp_f32 v114, v114
  v_exp_f32 v115, v115
  v_mfma_f32_32x32x16_bf16 a[16:31], v[104:107], v[152:155], a[16:31]
  v_exp_f32 v116, v116
  v_exp_f32 v117, v117
  v_exp_f32 v118, v118
  v_exp_f32 v119, v119
  v_cvt_pk_bf16_f32 v144, v112, v113
  v_cvt_pk_bf16_f32 v145, v114, v115
  v_mfma_f32_32x32x16_bf16 v[128:143], v[92:95], v[44:47], v[128:143]
  v_exp_f32 v120, v120
  v_exp_f32 v121, v121
  v_exp_f32 v122, v122
  v_exp_f32 v123, v123
  v_cvt_pk_bf16_f32 v148, v116, v117
  v_cvt_pk_bf16_f32 v149, v118, v119
  v_mfma_f32_32x32x16_bf16 a[16:31], v[108:111], v[156:159], a[16:31]
  v_exp_f32 v124, v124
  v_exp_f32 v125, v125
  v_exp_f32 v126, v126
  v_exp_f32 v127, v127
  v_cvt_pk_bf16_f32 v146, v120, v121
  v_cvt_pk_bf16_f32 v147, v122, v123
  v_cvt_pk_bf16_f32 v150, v124, v125
  v_cvt_pk_bf16_f32 v151, v126, v127
  s_waitcnt lgkmcnt(1)
  v_mfma_f32_32x32x16_bf16 v[112:127], v[80:83], v[16:19], 0
  v_exp_f32 v128, v128
  v_exp_f32 v129, v129
  v_exp_f32 v130, v130
  v_exp_f32 v131, v131
  v_mfma_f32_32x32x16_bf16 a[32:47], v[104:107], v[144:147], a[32:47]
  v_exp_f32 v132, v132
  v_exp_f32 v133, v133
  v_exp_f32 v134, v134
  v_exp_f32 v135, v135
  v_cvt_pk_bf16_f32 v152, v128, v129
  v_cvt_pk_bf16_f32 v153, v130, v131
  s_waitcnt lgkmcnt(0)
  v_mfma_f32_32x32x16_bf16 v[112:127], v[88:91], v[20:23], v[112:127]
  v_exp_f32 v136, v136
  v_exp_f32 v137, v137
  v_exp_f32 v138, v138
  v_exp_f32 v139, v139
  v_cvt_pk_bf16_f32 v156, v132, v133
  v_cvt_pk_bf16_f32 v157, v134, v135
  v_mfma_f32_32x32x16_bf16 a[32:47], v[108:111], v[148:151], a[32:47]
  v_exp_f32 v140, v140
  v_exp_f32 v141, v141
  v_exp_f32 v142, v142
  v_exp_f32 v143, v143
  v_cvt_pk_bf16_f32 v154, v136, v137
  v_cvt_pk_bf16_f32 v155, v138, v139
  v_cvt_pk_bf16_f32 v158, v140, v141
  v_cvt_pk_bf16_f32 v159, v142, v143
  v_add_u32 v8, 2048, v8
  v_add_u32 v9, 256, v9
  v_add_u32 v11, 2560, v11
  s_add_u32 s28, s28, 1
  s_cmp_lt_u32 s28, 32
  s_cbranch_scc1 P2L_36
  v_mfma_f32_32x32x16_bf16 a[48:63], v[104:107], v[152:155], a[48:63]
  v_mfma_f32_32x32x16_bf16 a[48:63], v[108:111], v[156:159], a[48:63]
  v_accvgpr_read_b32 v112, a0
  v_accvgpr_read_b32 v113, a1
  v_accvgpr_read_b32 v114, a2
  v_accvgpr_read_b32 v115, a3
  v_accvgpr_read_b32 v116, a4
  v_accvgpr_read_b32 v117, a5
  v_accvgpr_read_b32 v118, a6
  v_accvgpr_read_b32 v119, a7
  v_accvgpr_read_b32 v120, a8
  v_accvgpr_read_b32 v121, a9
  v_accvgpr_read_b32 v122, a10
  v_mov_b32 v123, v122
  s_nop 1
  v_permlane32_swap_b32 v122, v123
  v_rcp_f32 v122, v122
  s_nop 0
  v_mul_f32 v112, v122, v112
  v_mul_f32 v113, v122, v113
  v_mul_f32 v114, v122, v114
  v_mul_f32 v115, v122, v115
  v_mul_f32 v116, v122, v116
  v_mul_f32 v117, v122, v117
  v_mul_f32 v118, v122, v118
  v_mul_f32 v119, v122, v119
  v_mul_f32 v120, v122, v120
  v_mul_f32 v121, v122, v121
  v_cvt_pk_bf16_f32 v168, v112, v113
  v_cvt_pk_bf16_f32 v169, v114, v115
  v_cvt_pk_bf16_f32 v170, v116, v117
  v_cvt_pk_bf16_f32 v171, v118, v119
  v_cvt_pk_bf16_f32 v172, v120, v121
  v_accvgpr_read_b32 v112, a16
  v_accvgpr_read_b32 v113, a17
  v_accvgpr_read_b32 v114, a18
  v_accvgpr_read_b32 v115, a19
  v_accvgpr_read_b32 v116, a20
  v_accvgpr_read_b32 v117, a21
  v_accvgpr_read_b32 v118, a22
  v_accvgpr_read_b32 v119, a23
  v_accvgpr_read_b32 v120, a24
  v_accvgpr_read_b32 v121, a25
  v_accvgpr_read_b32 v122, a26
  v_mov_b32 v123, v122
  s_nop 1
  v_permlane32_swap_b32 v122, v123
  v_rcp_f32 v122, v122
  s_nop 0
  v_mul_f32 v112, v122, v112
  v_mul_f32 v113, v122, v113
  v_mul_f32 v114, v122, v114
  v_mul_f32 v115, v122, v115
  v_mul_f32 v116, v122, v116
  v_mul_f32 v117, v122, v117
  v_mul_f32 v118, v122, v118
  v_mul_f32 v119, v122, v119
  v_mul_f32 v120, v122, v120
  v_mul_f32 v121, v122, v121
  v_cvt_pk_bf16_f32 v173, v112, v113
  v_cvt_pk_bf16_f32 v174, v114, v115
  v_cvt_pk_bf16_f32 v175, v116, v117
  v_cvt_pk_bf16_f32 v176, v118, v119
  v_cvt_pk_bf16_f32 v177, v120, v121
  v_accvgpr_read_b32 v112, a32
  v_accvgpr_read_b32 v113, a33
  v_accvgpr_read_b32 v114, a34
  v_accvgpr_read_b32 v115, a35
  v_accvgpr_read_b32 v116, a36
  v_accvgpr_read_b32 v117, a37
  v_accvgpr_read_b32 v118, a38
  v_accvgpr_read_b32 v119, a39
  v_accvgpr_read_b32 v120, a40
  v_accvgpr_read_b32 v121, a41
  v_accvgpr_read_b32 v122, a42
  v_mov_b32 v123, v122
  s_nop 1
  v_permlane32_swap_b32 v122, v123
  v_rcp_f32 v122, v122
  s_nop 0
  v_mul_f32 v112, v122, v112
  v_mul_f32 v113, v122, v113
  v_mul_f32 v114, v122, v114
  v_mul_f32 v115, v122, v115
  v_mul_f32 v116, v122, v116
  v_mul_f32 v117, v122, v117
  v_mul_f32 v118, v122, v118
  v_mul_f32 v119, v122, v119
  v_mul_f32 v120, v122, v120
  v_mul_f32 v121, v122, v121
  v_cvt_pk_bf16_f32 v178, v112, v113
  v_cvt_pk_bf16_f32 v179, v114, v115
  v_cvt_pk_bf16_f32 v180, v116, v117
  v_cvt_pk_bf16_f32 v181, v118, v119
  v_cvt_pk_bf16_f32 v182, v120, v121
  v_accvgpr_read_b32 v112, a48
  v_accvgpr_read_b32 v113, a49
  v_accvgpr_read_b32 v114, a50
  v_accvgpr_read_b32 v115, a51
  v_accvgpr_read_b32 v116, a52
  v_accvgpr_read_b32 v117, a53
  v_accvgpr_read_b32 v118, a54
  v_accvgpr_read_b32 v119, a55
  v_accvgpr_read_b32 v120, a56
  v_accvgpr_read_b32 v121, a57
  v_accvgpr_read_b32 v122, a58
  v_mov_b32 v123, v122
  s_nop 1
  v_permlane32_swap_b32 v122, v123
  v_rcp_f32 v122, v122
  s_nop 0
  v_mul_f32 v112, v122, v112
  v_mul_f32 v113, v122, v113
  v_mul_f32 v114, v122, v114
  v_mul_f32 v115, v122, v115
  v_mul_f32 v116, v122, v116
  v_mul_f32 v117, v122, v117
  v_mul_f32 v118, v122, v118
  v_mul_f32 v119, v122, v119
  v_mul_f32 v120, v122, v120
  v_mul_f32 v121, v122, v121
  v_cvt_pk_bf16_f32 v183, v112, v113
  v_cvt_pk_bf16_f32 v184, v114, v115
  v_cvt_pk_bf16_f32 v185, v116, v117
  v_cvt_pk_bf16_f32 v186, v118, v119
  v_cvt_pk_bf16_f32 v187, v120, v121
  v_mov_b32 v8, v2
  v_lshlrev_b32 v9, 2, v3
  v_add_u32 v9, 65536, v9
  v_mov_b32 v208, 0xff800000
  v_mov_b32 v209, 0xff800000
  v_mov_b32 v210, 0xff800000
  v_mov_b32 v211, 0xff800000
  ds_read_b128 v[80:83], v8 offset:0
  ds_read_b32 v88, v9 offset:0
  s_waitcnt lgkmcnt(1)
  v_mfma_f32_32x32x16_bf16 v[112:127], v[80:83], v[48:51], 0
  s_waitcnt lgkmcnt(0)
  v_mfma_f32_32x32x16_bf16 v[112:127], v[88:91], v[52:55], v[112:127]
  s_mov_b32 s28, 0
.p2align 6
P1L_37:
  ds_read_b128 v[84:87], v8 offset:1024
  ds_read_b32 v92, v9 offset:128
  v_mfma_f32_32x32x16_bf16 v[128:143], v[80:83], v[56:59], 0
  s_nop 7
  v_max3_f32 v208, v208, v112, v113
  v_max3_f32 v208, v208, v114, v115
  v_max3_f32 v208, v208, v116, v117
  v_max3_f32 v208, v208, v118, v119
  v_mfma_f32_32x32x16_bf16 v[128:143], v[88:91], v[60:63], v[128:143]
  v_max3_f32 v208, v208, v120, v121
  v_max3_f32 v208, v208, v122, v123
  v_max3_f32 v208, v208, v124, v125
  v_max3_f32 v208, v208, v126, v127
  v_mfma_f32_32x32x16_bf16 v[112:127], v[80:83], v[64:67], 0
  s_nop 6
  v_max3_f32 v209, v209, v128, v129
  v_max3_f32 v209, v209, v130, v131
  v_max3_f32 v209, v209, v132, v133
  v_max3_f32 v209, v209, v134, v135
  v_mfma_f32_32x32x16_bf16 v[112:127], v[88:91], v[68:71], v[112:127]
  v_max3_f32 v209, v209, v136, v137
  v_max3_f32 v209, v209, v138, v139
  v_max3_f32 v209, v209, v140, v141
  v_max3_f32 v209, v209, v142, v143
  v_mfma_f32_32x32x16_bf16 v[128:143], v[80:83], v[72:75], 0
  s_nop 6
  v_max3_f32 v210, v210, v112, v113
  v_max3_f32 v210, v210, v114, v115
  v_max3_f32 v210, v210, v116, v117
  v_max3_f32 v210, v210, v118, v119
  v_mfma_f32_32x32x16_bf16 v[128:143], v[88:91], v[76:79], v[128:143]
  v_max3_f32 v210, v210, v120, v121
  v_max3_f32 v210, v210, v122, v123
  v_max3_f32 v210, v210, v124, v125
  v_max3_f32 v210, v210, v126, v127
  s_waitcnt lgkmcnt(1)
  v_mfma_f32_32x32x16_bf16 v[112:127], v[84:87], v[48:51], 0
  s_nop 5
  v_max3_f32 v211, v211, v128, v129
  v_max3_f32 v211, v211, v130, v131
  v_max3_f32 v211, v211, v132, v133
  v_max3_f32 v211, v211, v134, v135
  s_waitcnt lgkmcnt(0)
  v_mfma_f32_32x32x16_bf16 v[112:127], v[92:95], v[52:55], v[112:127]
  v_max3_f32 v211, v211, v136, v137
  v_max3_f32 v211, v211, v138, v139
  v_max3_f32 v211, v211, v140, v141
  v_max3_f32 v211, v211, v142, v143
  ds_read_b128 v[80:83], v8 offset:2048
  ds_read_b32 v88, v9 offset:256
  v_mfma_f32_32x32x16_bf16 v[128:143], v[84:87], v[56:59], 0
  s_nop 4
  v_max3_f32 v208, v208, v112, v113
  v_max3_f32 v208, v208, v114, v115
  v_max3_f32 v208, v208, v116, v117
  v_max3_f32 v208, v208, v118, v119
  v_mfma_f32_32x32x16_bf16 v[128:143], v[92:95], v[60:63], v[128:143]
  v_max3_f32 v208, v208, v120, v121
  v_max3_f32 v208, v208, v122, v123
  v_max3_f32 v208, v208, v124, v125
  v_max3_f32 v208, v208, v126, v127
  v_mfma_f32_32x32x16_bf16 v[112:127], v[84:87], v[64:67], 0
  s_nop 6
  v_max3_f32 v209, v209, v128, v129
  v_max3_f32 v209, v209, v130, v131
  v_max3_f32 v209, v209, v132, v133
  v_max3_f32 v209, v209, v134, v135
  v_mfma_f32_32x32x16_bf16 v[112:127], v[92:95], v[68:71], v[112:127]
  v_max3_f32 v209, v209, v136, v137
  v_max3_f32 v209, v209, v138, v139
  v_max3_f32 v209, v209, v140, v141
  v_max3_f32 v209, v209, v142, v143
  v_mfma_f32_32x32x16_bf16 v[128:143], v[84:87], v[72:75], 0
  s_nop 6
  v_max3_f32 v210, v210, v112, v113
  v_max3_f32 v210, v210, v114, v115
  v_max3_f32 v210, v210, v116, v117
  v_max3_f32 v210, v210, v118, v119
  v_mfma_f32_32x32x16_bf16 v[128:143], v[92:95], v[76:79], v[128:143]
  v_max3_f32 v210, v210, v120, v121
  v_max3_f32 v210, v210, v122, v123
  v_max3_f32 v210, v210, v124, v125
  v_max3_f32 v210, v210, v126, v127
  s_waitcnt lgkmcnt(1)
  v_mfma_f32_32x32x16_bf16 v[112:127], v[80:83], v[48:51], 0
  s_nop 5
  v_max3_f32 v211, v211, v128, v129
  v_max3_f32 v211, v211, v130, v131
  v_max3_f32 v211, v211, v132, v133
  v_max3_f32 v211, v211, v134, v135
  s_waitcnt lgkmcnt(0)
  v_mfma_f32_32x32x16_bf16 v[112:127], v[88:91], v[52:55], v[112:127]
  v_max3_f32 v211, v211, v136, v137
  v_max3_f32 v211, v211, v138, v139
  v_max3_f32 v211, v211, v140, v141
  v_max3_f32 v211, v211, v142, v143
  v_add_u32 v8, 2048, v8
  v_add_u32 v9, 256, v9
  s_add_u32 s28, s28, 1
  s_cmp_lt_u32 s28, 32
  s_cbranch_scc1 P1L_37
  v_mov_b32 v212, v208
  s_nop 1
  v_permlane32_swap_b32 v208, v212
  v_max_f32 v208, v208, v212
  v_sub_f32 v208, 0, v208
  v_cvt_pk_bf16_f32 v208, v208, 0
  v_cndmask_b32 v53, 0, v208, s[34:35]
  v_mov_b32 v212, v209
  s_nop 1
  v_permlane32_swap_b32 v209, v212
  v_max_f32 v209, v209, v212
  v_sub_f32 v209, 0, v209
  v_cvt_pk_bf16_f32 v209, v209, 0
  v_cndmask_b32 v61, 0, v209, s[34:35]
  v_mov_b32 v212, v210
  s_nop 1
  v_permlane32_swap_b32 v210, v212
  v_max_f32 v210, v210, v212
  v_sub_f32 v210, 0, v210
  v_cvt_pk_bf16_f32 v210, v210, 0
  v_cndmask_b32 v69, 0, v210, s[34:35]
  v_mov_b32 v212, v211
  s_nop 1
  v_permlane32_swap_b32 v211, v212
  v_max_f32 v211, v211, v212
  v_sub_f32 v211, 0, v211
  v_cvt_pk_bf16_f32 v211, v211, 0
  v_cndmask_b32 v77, 0, v211, s[34:35]
  v_mov_b32 v8, v2
  v_lshlrev_b32 v9, 2, v3
  v_add_u32 v9, 65536, v9
  v_add_u32 v11, 73728, v10
  v_accvgpr_write_b32 a0, 0
  v_accvgpr_write_b32 a1, 0
  v_accvgpr_write_b32 a2, 0
  v_accvgpr_write_b32 a3, 0
  v_accvgpr_write_b32 a4, 0
  v_accvgpr_write_b32 a5, 0
  v_accvgpr_write_b32 a6, 0
  v_accvgpr_write_b32 a7, 0
  v_accvgpr_write_b32 a8, 0
  v_accvgpr_write_b32 a9, 0
  v_accvgpr_write_b32 a10, 0
  v_accvgpr_write_b32 a11, 0
  v_accvgpr_write_b32 a12, 0
  v_accvgpr_write_b32 a13, 0
  v_accvgpr_write_b32 a14, 0
  v_accvgpr_write_b32 a15, 0
  v_accvgpr_write_b32 a16, 0
  v_accvgpr_write_b32 a17, 0
  v_accvgpr_write_b32 a18, 0
  v_accvgpr_write_b32 a19, 0
  v_accvgpr_write_b32 a20, 0
  v_accvgpr_write_b32 a21, 0
  v_accvgpr_write_b32 a22, 0
  v_accvgpr_write_b32 a23, 0
  v_accvgpr_write_b32 a24, 0
  v_accvgpr_write_b32 a25, 0
  v_accvgpr_write_b32 a26, 0
  v_accvgpr_write_b32 a27, 0
  v_accvgpr_write_b32 a28, 0
  v_accvgpr_write_b32 a29, 0
  v_accvgpr_write_b32 a30, 0
  v_accvgpr_write_b32 a31, 0
  v_accvgpr_write_b32 a32, 0
  v_accvgpr_write_b32 a33, 0
  v_accvgpr_write_b32 a34, 0
  v_accvgpr_write_b32 a35, 0
  v_accvgpr_write_b32 a36, 0
  v_accvgpr_write_b32 a37, 0
  v_accvgpr_write_b32 a38, 0
  v_accvgpr_write_b32 a39, 0
  v_accvgpr_write_b32 a40, 0
  v_accvgpr_write_b32 a41, 0
  v_accvgpr_write_b32 a42, 0
  v_accvgpr_write_b32 a43, 0
  v_accvgpr_write_b32 a44, 0
  v_accvgpr_write_b32 a45, 0
  v_accvgpr_write_b32 a46, 0
  v_accvgpr_write_b32 a47, 0
  v_accvgpr_write_b32 a48, 0
  v_accvgpr_write_b32 a49, 0
  v_accvgpr_write_b32 a50, 0
  v_accvgpr_write_b32 a51, 0
  v_accvgpr_write_b32 a52, 0
  v_accvgpr_write_b32 a53, 0
  v_accvgpr_write_b32 a54, 0
  v_accvgpr_write_b32 a55, 0
  v_accvgpr_write_b32 a56, 0
  v_accvgpr_write_b32 a57, 0
  v_accvgpr_write_b32 a58, 0
  v_accvgpr_write_b32 a59, 0
  v_accvgpr_write_b32 a60, 0
  v_accvgpr_write_b32 a61, 0
  v_accvgpr_write_b32 a62, 0
  v_accvgpr_write_b32 a63, 0
  v_mov_b32 v152, 0
  v_mov_b32 v153, 0
  v_mov_b32 v154, 0
  v_mov_b32 v155, 0
  v_mov_b32 v156, 0
  v_mov_b32 v157, 0
  v_mov_b32 v158, 0
  v_mov_b32 v159, 0
  ds_read_b128 v[80:83], v8 offset:0
  ds_read_b32 v88, v9 offset:0
  ds_read_b128 v[104:107], v11 offset:0
  ds_read_b128 v[108:111], v11 offset:640
  s_waitcnt lgkmcnt(3)
  v_mfma_f32_32x32x16_bf16 v[112:127], v[80:83], v[48:51], 0
  s_waitcnt lgkmcnt(2)
  v_mfma_f32_32x32x16_bf16 v[112:127], v[88:91], v[52:55], v[112:127]
  s_mov_b32 s28, 0
.p2align 6
P2L_38:
  ds_read_b128 v[96:99], v11 offset:0
  ds_read_b128 v[100:103], v11 offset:640
  v_mfma_f32_32x32x16_bf16 v[128:143], v[80:83], v[56:59], 0
  s_nop 7
  v_exp_f32 v112, v112
  v_exp_f32 v113, v113
  v_exp_f32 v114, v114
  v_exp_f32 v115, v115
  s_waitcnt lgkmcnt(3)
  v_mfma_f32_32x32x16_bf16 a[48:63], v[104:107], v[152:155], a[48:63]
  v_exp_f32 v116, v116
  v_exp_f32 v117, v117
  v_exp_f32 v118, v118
  v_exp_f32 v119, v119
  v_cvt_pk_bf16_f32 v144, v112, v113
  v_cvt_pk_bf16_f32 v145, v114, v115
  v_mfma_f32_32x32x16_bf16 v[128:143], v[88:91], v[60:63], v[128:143]
  v_exp_f32 v120, v120
  v_exp_f32 v121, v121
  v_exp_f32 v122, v122
  v_exp_f32 v123, v123
  v_cvt_pk_bf16_f32 v148, v116, v117
  v_cvt_pk_bf16_f32 v149, v118, v119
  s_waitcnt lgkmcnt(2)
  v_mfma_f32_32x32x16_bf16 a[48:63], v[108:111], v[156:159], a[48:63]
  v_exp_f32 v124, v124
  v_exp_f32 v125, v125
  v_exp_f32 v126, v126
  v_exp_f32 v127, v127
  v_cvt_pk_bf16_f32 v146, v120, v121
  v_cvt_pk_bf16_f32 v147, v122, v123
  v_cvt_pk_bf16_f32 v150, v124, v125
  v_cvt_pk_bf16_f32 v151, v126, v127
  ds_read_b128 v[84:87], v8 offset:1024
  ds_read_b32 v92, v9 offset:128
  v_mfma_f32_32x32x16_bf16 v[112:127], v[80:83], v[64:67], 0
  v_exp_f32 v128, v128
  v_exp_f32 v129, v129
  v_exp_f32 v130, v130
  v_exp_f32 v131, v131
  s_waitcnt lgkmcnt(3)
  v_mfma_f32_32x32x16_bf16 a[0:15], v[96:99], v[144:147], a[0:15]
  v_exp_f32 v132, v132
  v_exp_f32 v133, v133
  v_exp_f32 v134, v134
  v_exp_f32 v135, v135
  v_cvt_pk_bf16_f32 v152, v128, v129
  v_cvt_pk_bf16_f32 v153, v130, v131
  v_mfma_f32_32x32x16_bf16 v[112:127], v[88:91], v[68:71], v[112:127]
  v_exp_f32 v136, v136
  v_exp_f32 v137, v137
  v_exp_f32 v138, v138
  v_exp_f32 v139, v139
  v_cvt_pk_bf16_f32 v156, v132, v133
  v_cvt_pk_bf16_f32 v157, v134, v135
  s_waitcnt lgkmcnt(2)
  v_mfma_f32_32x32x16_bf16 a[0:15], v[100:103], v[148:151], a[0:15]
  v_exp_f32 v140, v140
  v_exp_f32 v141, v141
  v_exp_f32 v142, v142
  v_exp_f32 v143, v143
  v_cvt_pk_bf16_f32 v154, v136, v137
  v_cvt_pk_bf16_f32 v155, v138, v139
  v_cvt_pk_bf16_f32 v158, v140, v141
  v_cvt_pk_bf16_f32 v159, v142, v143
  v_mfma_f32_32x32x16_bf16 v[128:143], v[80:83], v[72:75], 0
  v_exp_f32 v112, v112
  v_exp_f32 v113, v113
  v_exp_f32 v114, v114
  v_exp_f32 v115, v115
  v_mfma_f32_32x32x16_bf16 a[16:31], v[96:99], v[152:155], a[16:31]
  v_exp_f32 v116, v116
  v_exp_f32 v117, v117
  v_exp_f32 v118, v118
  v_exp_f32 v119, v119
  v_cvt_pk_bf16_f32 v144, v112, v113
  v_cvt_pk_bf16_f32 v145, v114, v115
  v_mfma_f32_32x32x16_bf16 v[128:143], v[88:91], v[76:79], v[128:143]
  v_exp_f32 v120, v120
  v_exp_f32 v121, v121
  v_exp_f32 v122, v122
  v_exp_f32 v123, v123
  v_cvt_pk_bf16_f32 v148, v116, v117
  v_cvt_pk_bf16_f32 v149, v118, v119
  v_mfma_f32_32x32x16_bf16 a[16:31], v[100:103], v[156:159], a[16:31]
  v_exp_f32 v124, v124
  v_exp_f32 v125, v125
  v_exp_f32 v126, v126
  v_exp_f32 v127, v127
  v_cvt_pk_bf16_f32 v146, v120, v121
  v_cvt_pk_bf16_f32 v147, v122, v123
  v_cvt_pk_bf16_f32 v150, v124, v125
  v_cvt_pk_bf16_f32 v151, v126, v127
  s_waitcnt lgkmcnt(1)
  v_mfma_f32_32x32x16_bf16 v[112:127], v[84:87], v[48:51], 0
  v_exp_f32 v128, v128
  v_exp_f32 v129, v129
  v_exp_f32 v130, v130
  v_exp_f32 v131, v131
  v_mfma_f32_32x32x16_bf16 a[32:47], v[96:99], v[144:147], a[32:47]
  v_exp_f32 v132, v132
  v_exp_f32 v133, v133
  v_exp_f32 v134, v134
  v_exp_f32 v135, v135
  v_cvt_pk_bf16_f32 v152, v128, v129
  v_cvt_pk_bf16_f32 v153, v130, v131
  s_waitcnt lgkmcnt(0)
  v_mfma_f32_32x32x16_bf16 v[112:127], v[92:95], v[52:55], v[112:127]
  v_exp_f32 v136, v136
  v_exp_f32 v137, v137
  v_exp_f32 v138, v138
  v_exp_f32 v139, v139
  v_cvt_pk_bf16_f32 v156, v132, v133
  v_cvt_pk_bf16_f32 v157, v134, v135
  v_mfma_f32_32x32x16_bf16 a[32:47], v[100:103], v[148:151], a[32:47]
  v_exp_f32 v140, v140
  v_exp_f32 v141, v141
  v_exp_f32 v142, v142
  v_exp_f32 v143, v143
  v_cvt_pk_bf16_f32 v154, v136, v137
  v_cvt_pk_bf16_f32 v155, v138, v139
  v_cvt_pk_bf16_f32 v158, v140, v141
  v_cvt_pk_bf16_f32 v159, v142, v143
  ds_read_b128 v[104:107], v11 offset:1280
  ds_read_b128 v[108:111], v11 offset:1920
  v_mfma_f32_32x32x16_bf16 v[128:143], v[84:87], v[56:59], 0
  v_exp_f32 v112, v112
  v_exp_f32 v113, v113
  v_exp_f32 v114, v114
  v_exp_f32 v115, v115
  v_mfma_f32_32x32x16_bf16 a[48:63], v[96:99], v[152:155], a[48:63]
  v_exp_f32 v116, v116
  v_exp_f32 v117, v117
  v_exp_f32 v118, v118
  v_exp_f32 v119, v119
  v_cvt_pk_bf16_f32 v144, v112, v113
  v_cvt_pk_bf16_f32 v145, v114, v115
  v_mfma_f32_32x32x16_bf16 v[128:143], v[92:95], v[60:63], v[128:143]
  v_exp_f32 v120, v120
  v_exp_f32 v121, v121
  v_exp_f32 v122, v122
  v_exp_f32 v123, v123
  v_cvt_pk_bf16_f32 v148, v116, v117
  v_cvt_pk_bf16_f32 v149, v118, v119
  v_mfma_f32_32x32x16_bf16 a[48:63], v[100:103], v[156:159], a[48:63]
  v_exp_f32 v124, v124
  v_exp_f32 v125, v125
  v_exp_f32 v126, v126
  v_exp_f32 v127, v127
  v_cvt_pk_bf16_f32 v146, v120, v121
  v_cvt_pk_bf16_f32 v147, v122, v123
  v_cvt_pk_bf16_f32 v150, v124, v125
  v_cvt_pk_bf16_f32 v151, v126, v127
  ds_read_b128 v[80:83], v8 offset:2048
  ds_read_b32 v88, v9 offset:256
  v_mfma_f32_32x32x16_bf16 v[112:127], v[84:87], v[64:67], 0
  v_exp_f32 v128, v128
  v_exp_f32 v129, v129
  v_exp_f32 v130, v130
  v_exp_f32 v131, v131
  s_waitcnt lgkmcnt(3)
  v_mfma_f32_32x32x16_bf16 a[0:15], v[104:107], v[144:147], a[0:15]
  v_exp_f32 v132, v132
  v_exp_f32 v133, v133
  v_exp_f32 v134, v134
  v_exp_f32 v135, v135
  v_cvt_pk_bf16_f32 v152, v128, v129
  v_cvt_pk_bf16_f32 v153, v130, v131
  v_mfma_f32_32x32x16_bf16 v[112:127], v[92:95], v[68:71], v[112:127]
  v_exp_f32 v136, v136
  v_exp_f32 v137, v137
  v_exp_f32 v138, v138
  v_exp_f32 v139, v139
  v_cvt_pk_bf16_f32 v156, v132, v133
  v_cvt_pk_bf16_f32 v157, v134, v135
  s_waitcnt lgkmcnt(2)
  v_mfma_f32_32x32x16_bf16 a[0:15], v[108:111], v[148:151], a[0:15]
  v_exp_f32 v140, v140
  v_exp_f32 v141, v141
  v_exp_f32 v142, v142
  v_exp_f32 v143, v143
  v_cvt_pk_bf16_f32 v154, v136, v137
  v_cvt_pk_bf16_f32 v155, v138, v139
  v_cvt_pk_bf16_f32 v158, v140, v141
  v_cvt_pk_bf16_f32 v159, v142, v143
  v_mfma_f32_32x32x16_bf16 v[128:143], v[84:87], v[72:75], 0
  v_exp_f32 v112, v112
  v_exp_f32 v113, v113
  v_exp_f32 v114, v114
  v_exp_f32 v115, v115
  v_mfma_f32_32x32x16_bf16 a[16:31], v[104:107], v[152:155], a[16:31]
  v_exp_f32 v116, v116
  v_exp_f32 v117, v117
  v_exp_f32 v118, v118
  v_exp_f32 v119, v119
  v_cvt_pk_bf16_f32 v144, v112, v113
  v_cvt_pk_bf16_f32 v145, v114, v115
  v_mfma_f32_32x32x16_bf16 v[128:143], v[92:95], v[76:79], v[128:143]
  v_exp_f32 v120, v120
  v_exp_f32 v121, v121
  v_exp_f32 v122, v122
  v_exp_f32 v123, v123
  v_cvt_pk_bf16_f32 v148, v116, v117
  v_cvt_pk_bf16_f32 v149, v118, v119
  v_mfma_f32_32x32x16_bf16 a[16:31], v[108:111], v[156:159], a[16:31]
  v_exp_f32 v124, v124
  v_exp_f32 v125, v125
  v_exp_f32 v126, v126
  v_exp_f32 v127, v127
  v_cvt_pk_bf16_f32 v146, v120, v121
  v_cvt_pk_bf16_f32 v147, v122, v123
  v_cvt_pk_bf16_f32 v150, v124, v125
  v_cvt_pk_bf16_f32 v151, v126, v127
  s_waitcnt lgkmcnt(1)
  v_mfma_f32_32x32x16_bf16 v[112:127], v[80:83], v[48:51], 0
  v_exp_f32 v128, v128
  v_exp_f32 v129, v129
  v_exp_f32 v130, v130
  v_exp_f32 v131, v131
  v_mfma_f32_32x32x16_bf16 a[32:47], v[104:107], v[144:147], a[32:47]
  v_exp_f32 v132, v132
  v_exp_f32 v133, v133
  v_exp_f32 v134, v134
  v_exp_f32 v135, v135
  v_cvt_pk_bf16_f32 v152, v128, v129
  v_cvt_pk_bf16_f32 v153, v130, v131
  s_waitcnt lgkmcnt(0)
  v_mfma_f32_32x32x16_bf16 v[112:127], v[88:91], v[52:55], v[112:127]
  v_exp_f32 v136, v136
  v_exp_f32 v137, v137
  v_exp_f32 v138, v138
  v_exp_f32 v139, v139
  v_cvt_pk_bf16_f32 v156, v132, v133
  v_cvt_pk_bf16_f32 v157, v134, v135
  v_mfma_f32_32x32x16_bf16 a[32:47], v[108:111], v[148:151], a[32:47]
  v_exp_f32 v140, v140
  v_exp_f32 v141, v141
  v_exp_f32 v142, v142
  v_exp_f32 v143, v143
  v_cvt_pk_bf16_f32 v154, v136, v137
  v_cvt_pk_bf16_f32 v155, v138, v139
  v_cvt_pk_bf16_f32 v158, v140, v141
  v_cvt_pk_bf16_f32 v159, v142, v143
  v_add_u32 v8, 2048, v8
  v_add_u32 v9, 256, v9
  v_add_u32 v11, 2560, v11
  s_add_u32 s28, s28, 1
  s_cmp_lt_u32 s28, 32
  s_cbranch_scc1 P2L_38
  v_mfma_f32_32x32x16_bf16 a[48:63], v[104:107], v[152:155], a[48:63]
  v_mfma_f32_32x32x16_bf16 a[48:63], v[108:111], v[156:159], a[48:63]
  v_accvgpr_read_b32 v112, a0
  v_accvgpr_read_b32 v113, a1
  v_accvgpr_read_b32 v114, a2
  v_accvgpr_read_b32 v115, a3
  v_accvgpr_read_b32 v116, a4
  v_accvgpr_read_b32 v117, a5
  v_accvgpr_read_b32 v118, a6
  v_accvgpr_read_b32 v119, a7
  v_accvgpr_read_b32 v120, a8
  v_accvgpr_read_b32 v121, a9
  v_accvgpr_read_b32 v122, a10
  v_mov_b32 v123, v122
  s_nop 1
  v_permlane32_swap_b32 v122, v123
  v_rcp_f32 v122, v122
  s_nop 0
  v_mul_f32 v112, v122, v112
  v_mul_f32 v113, v122, v113
  v_mul_f32 v114, v122, v114
  v_mul_f32 v115, v122, v115
  v_mul_f32 v116, v122, v116
  v_mul_f32 v117, v122, v117
  v_mul_f32 v118, v122, v118
  v_mul_f32 v119, v122, v119
  v_mul_f32 v120, v122, v120
  v_mul_f32 v121, v122, v121
  v_cvt_pk_bf16_f32 v188, v112, v113
  v_cvt_pk_bf16_f32 v189, v114, v115
  v_cvt_pk_bf16_f32 v190, v116, v117
  v_cvt_pk_bf16_f32 v191, v118, v119
  v_cvt_pk_bf16_f32 v192, v120, v121
  v_accvgpr_read_b32 v112, a16
  v_accvgpr_read_b32 v113, a17
  v_accvgpr_read_b32 v114, a18
  v_accvgpr_read_b32 v115, a19
  v_accvgpr_read_b32 v116, a20
  v_accvgpr_read_b32 v117, a21
  v_accvgpr_read_b32 v118, a22
  v_accvgpr_read_b32 v119, a23
  v_accvgpr_read_b32 v120, a24
  v_accvgpr_read_b32 v121, a25
  v_accvgpr_read_b32 v122, a26
  v_mov_b32 v123, v122
  s_nop 1
  v_permlane32_swap_b32 v122, v123
  v_rcp_f32 v122, v122
  s_nop 0
  v_mul_f32 v112, v122, v112
  v_mul_f32 v113, v122, v113
  v_mul_f32 v114, v122, v114
  v_mul_f32 v115, v122, v115
  v_mul_f32 v116, v122, v116
  v_mul_f32 v117, v122, v117
  v_mul_f32 v118, v122, v118
  v_mul_f32 v119, v122, v119
  v_mul_f32 v120, v122, v120
  v_mul_f32 v121, v122, v121
  v_cvt_pk_bf16_f32 v193, v112, v113
  v_cvt_pk_bf16_f32 v194, v114, v115
  v_cvt_pk_bf16_f32 v195, v116, v117
  v_cvt_pk_bf16_f32 v196, v118, v119
  v_cvt_pk_bf16_f32 v197, v120, v121
  v_accvgpr_read_b32 v112, a32
  v_accvgpr_read_b32 v113, a33
  v_accvgpr_read_b32 v114, a34
  v_accvgpr_read_b32 v115, a35
  v_accvgpr_read_b32 v116, a36
  v_accvgpr_read_b32 v117, a37
  v_accvgpr_read_b32 v118, a38
  v_accvgpr_read_b32 v119, a39
  v_accvgpr_read_b32 v120, a40
  v_accvgpr_read_b32 v121, a41
  v_accvgpr_read_b32 v122, a42
  v_mov_b32 v123, v122
  s_nop 1
  v_permlane32_swap_b32 v122, v123
  v_rcp_f32 v122, v122
  s_nop 0
  v_mul_f32 v112, v122, v112
  v_mul_f32 v113, v122, v113
  v_mul_f32 v114, v122, v114
  v_mul_f32 v115, v122, v115
  v_mul_f32 v116, v122, v116
  v_mul_f32 v117, v122, v117
  v_mul_f32 v118, v122, v118
  v_mul_f32 v119, v122, v119
  v_mul_f32 v120, v122, v120
  v_mul_f32 v121, v122, v121
  v_cvt_pk_bf16_f32 v198, v112, v113
  v_cvt_pk_bf16_f32 v199, v114, v115
  v_cvt_pk_bf16_f32 v200, v116, v117
  v_cvt_pk_bf16_f32 v201, v118, v119
  v_cvt_pk_bf16_f32 v202, v120, v121
  v_accvgpr_read_b32 v112, a48
  v_accvgpr_read_b32 v113, a49
  v_accvgpr_read_b32 v114, a50
  v_accvgpr_read_b32 v115, a51
  v_accvgpr_read_b32 v116, a52
  v_accvgpr_read_b32 v117, a53
  v_accvgpr_read_b32 v118, a54
  v_accvgpr_read_b32 v119, a55
  v_accvgpr_read_b32 v120, a56
  v_accvgpr_read_b32 v121, a57
  v_accvgpr_read_b32 v122, a58
  v_mov_b32 v123, v122
  s_nop 1
  v_permlane32_swap_b32 v122, v123
  v_rcp_f32 v122, v122
  s_nop 0
  v_mul_f32 v112, v122, v112
  v_mul_f32 v113, v122, v113
  v_mul_f32 v114, v122, v114
  v_mul_f32 v115, v122, v115
  v_mul_f32 v116, v122, v116
  v_mul_f32 v117, v122, v117
  v_mul_f32 v118, v122, v118
  v_mul_f32 v119, v122, v119
  v_mul_f32 v120, v122, v120
  v_mul_f32 v121, v122, v121
  v_cvt_pk_bf16_f32 v203, v112, v113
  v_cvt_pk_bf16_f32 v204, v114, v115
  v_cvt_pk_bf16_f32 v205, v116, v117
  v_cvt_pk_bf16_f32 v206, v118, v119
  v_cvt_pk_bf16_f32 v207, v120, v121
  s_barrier
  v_mul_u32_u24 v9, 1168, v3
  v_lshl_add_u32 v10, v4, 4, v9
  v_lshl_add_u32 v9, v4, 3, v9
  s_mul_i32 s36, s13, 288
  v_add_u32 v9, s36, v9
  ds_write2_b32 v9, v168, v169 offset0:0 offset1:1
  ds_write2_b32 v9, v170, v171 offset0:4 offset1:5
  ds_write2_b32 v9, v173, v174 offset0:9 offset1:10
  ds_write2_b32 v9, v175, v176 offset0:13 offset1:14
  ds_write2_b32 v9, v178, v179 offset0:18 offset1:19
  ds_write2_b32 v9, v180, v181 offset0:22 offset1:23
  ds_write2_b32 v9, v183, v184 offset0:27 offset1:28
  ds_write2_b32 v9, v185, v186 offset0:31 offset1:32
  ds_write2_b32 v9, v188, v189 offset0:36 offset1:37
  ds_write2_b32 v9, v190, v191 offset0:40 offset1:41
  ds_write2_b32 v9, v193, v194 offset0:45 offset1:46
  ds_write2_b32 v9, v195, v196 offset0:49 offset1:50
  ds_write2_b32 v9, v198, v199 offset0:54 offset1:55
  ds_write2_b32 v9, v200, v201 offset0:58 offset1:59
  ds_write2_b32 v9, v203, v204 offset0:63 offset1:64
  ds_write2_b32 v9, v205, v206 offset0:67 offset1:68
  s_mov_b64 exec, 0xffffffff
  ds_write_b32 v9, v172 offset:32
  ds_write_b32 v9, v177 offset:68
  ds_write_b32 v9, v182 offset:104
  ds_write_b32 v9, v187 offset:140
  ds_write_b32 v9, v192 offset:176
  ds_write_b32 v9, v197 offset:212
  ds_write_b32 v9, v202 offset:248
  ds_write_b32 v9, v207 offset:284
  s_mov_b64 exec, -1
  s_waitcnt lgkmcnt(0)
  s_barrier
  ds_read_b128 v[16:19], v10 offset:0
  ds_read_b128 v[20:23], v10 offset:32
  ds_read_b128 v[24:27], v10 offset:64
  ds_read_b128 v[28:31], v10 offset:96
  ds_read_b128 v[32:35], v10 offset:128
  ds_read_b128 v[36:39], v10 offset:160
  ds_read_b128 v[40:43], v10 offset:192
  ds_read_b128 v[44:47], v10 offset:224
  ds_read_b128 v[48:51], v10 offset:256
  ds_read_b128 v[52:55], v10 offset:288
  ds_read_b128 v[56:59], v10 offset:320
  ds_read_b128 v[60:63], v10 offset:352
  ds_read_b128 v[64:67], v10 offset:384
  ds_read_b128 v[68:71], v10 offset:416
  ds_read_b128 v[72:75], v10 offset:448
  ds_read_b128 v[76:79], v10 offset:480
  ds_read_b128 v[80:83], v10 offset:512
  ds_read_b128 v[84:87], v10 offset:544
  ds_read_b128 v[88:91], v10 offset:576
  ds_read_b128 v[92:95], v10 offset:608
  ds_read_b128 v[96:99], v10 offset:640
  ds_read_b128 v[100:103], v10 offset:672
  ds_read_b128 v[104:107], v10 offset:704
  ds_read_b128 v[108:111], v10 offset:736
  ds_read_b128 v[112:115], v10 offset:768
  ds_read_b128 v[116:119], v10 offset:800
  ds_read_b128 v[120:123], v10 offset:832
  ds_read_b128 v[124:127], v10 offset:864
  ds_read_b128 v[128:131], v10 offset:896
  ds_read_b128 v[132:135], v10 offset:928
  ds_read_b128 v[136:139], v10 offset:960
  ds_read_b128 v[140:143], v10 offset:992
  ds_read_b128 v[144:147], v10 offset:1024
  ds_read_b128 v[148:151], v10 offset:1056
  ds_read_b128 v[152:155], v10 offset:1088
  ds_read_b128 v[156:159], v10 offset:1120
  s_waitcnt lgkmcnt(0)
  s_barrier
  s_mov_b32 s30, 0
  s_add_u32 m0, s31, 0
  s_nop 0
  buffer_load_dwordx4 v160, s[44:47], s30 offen offset:0 lds
  s_add_u32 m0, m0, 1024
  s_nop 0
  buffer_load_dwordx4 v161, s[44:47], s30 offen offset:0 lds
  s_add_u32 m0, m0, 1024
  s_nop 0
  buffer_load_dwordx4 v162, s[44:47], s30 offen offset:0 lds
  s_add_u32 m0, m0, 1024
  s_nop 0
  buffer_load_dwordx4 v163, s[44:47], s30 offen offset:0 lds
  s_add_u32 m0, m0, 1024
  s_nop 0
  buffer_load_dwordx4 v164, s[44:47], s30 offen offset:0 lds
  s_add_u32 s30, s30, 18432
  s_add_u32 m0, s31, 5120
  s_nop 0
  buffer_load_dwordx4 v160, s[44:47], s30 offen offset:0 lds
  s_add_u32 m0, m0, 1024
  s_nop 0
  buffer_load_dwordx4 v161, s[44:47], s30 offen offset:0 lds
  s_add_u32 m0, m0, 1024
  s_nop 0
  buffer_load_dwordx4 v162, s[44:47], s30 offen offset:0 lds
  s_add_u32 m0, m0, 1024
  s_nop 0
  buffer_load_dwordx4 v163, s[44:47], s30 offen offset:0 lds
  s_add_u32 m0, m0, 1024
  s_nop 0
  buffer_load_dwordx4 v164, s[44:47], s30 offen offset:0 lds
  s_add_u32 s30, s30, 18432
  s_add_u32 m0, s31, 10240
  s_nop 0
  buffer_load_dwordx4 v160, s[44:47], s30 offen offset:0 lds
  s_add_u32 m0, m0, 1024
  s_nop 0
  buffer_load_dwordx4 v161, s[44:47], s30 offen offset:0 lds
  s_add_u32 m0, m0, 1024
  s_nop 0
  buffer_load_dwordx4 v162, s[44:47], s30 offen offset:0 lds
  s_add_u32 m0, m0, 1024
  s_nop 0
  buffer_load_dwordx4 v163, s[44:47], s30 offen offset:0 lds
  s_add_u32 m0, m0, 1024
  s_nop 0
  buffer_load_dwordx4 v164, s[44:47], s30 offen offset:0 lds
  s_add_u32 s30, s30, 18432
  s_add_u32 m0, s31, 15360
  s_nop 0
  buffer_load_dwordx4 v160, s[44:47], s30 offen offset:0 lds
  s_add_u32 m0, m0, 1024
  s_nop 0
  buffer_load_dwordx4 v161, s[44:47], s30 offen offset:0 lds
  s_add_u32 m0, m0, 1024
  s_nop 0
  buffer_load_dwordx4 v162, s[44:47], s30 offen offset:0 lds
  s_add_u32 m0, m0, 1024
  s_nop 0
  buffer_load_dwordx4 v163, s[44:47], s30 offen offset:0 lds
  s_add_u32 m0, m0, 1024
  s_nop 0
  buffer_load_dwordx4 v164, s[44:47], s30 offen offset:0 lds
  s_add_u32 s30, s30, 18432
  s_add_u32 m0, s31, 20480
  s_nop 0
  buffer_load_dwordx4 v160, s[44:47], s30 offen offset:0 lds
  s_add_u32 m0, m0, 1024
  s_nop 0
  buffer_load_dwordx4 v161, s[44:47], s30 offen offset:0 lds
  s_add_u32 m0, m0, 1024
  s_nop 0
  buffer_load_dwordx4 v162, s[44:47], s30 offen offset:0 lds
  s_add_u32 m0, m0, 1024
  s_nop 0
  buffer_load_dwordx4 v163, s[44:47], s30 offen offset:0 lds
  s_add_u32 m0, m0, 1024
  s_nop 0
  buffer_load_dwordx4 v164, s[44:47], s30 offen offset:0 lds
  s_add_u32 s30, s30, 18432
  s_add_u32 m0, s31, 25600
  s_nop 0
  buffer_load_dwordx4 v160, s[44:47], s30 offen offset:0 lds
  s_add_u32 m0, m0, 1024
  s_nop 0
  buffer_load_dwordx4 v161, s[44:47], s30 offen offset:0 lds
  s_add_u32 m0, m0, 1024
  s_nop 0
  buffer_load_dwordx4 v162, s[44:47], s30 offen offset:0 lds
  s_add_u32 m0, m0, 1024
  s_nop 0
  buffer_load_dwordx4 v163, s[44:47], s30 offen offset:0 lds
  s_add_u32 m0, m0, 1024
  s_nop 0
  buffer_load_dwordx4 v164, s[44:47], s30 offen offset:0 lds
  s_add_u32 s30, s30, 18432
  s_add_u32 m0, s31, 30720
  s_nop 0
  buffer_load_dwordx4 v160, s[44:47], s30 offen offset:0 lds
  s_add_u32 m0, m0, 1024
  s_nop 0
  buffer_load_dwordx4 v161, s[44:47], s30 offen offset:0 lds
  s_add_u32 m0, m0, 1024
  s_nop 0
  buffer_load_dwordx4 v162, s[44:47], s30 offen offset:0 lds
  s_add_u32 m0, m0, 1024
  s_nop 0
  buffer_load_dwordx4 v163, s[44:47], s30 offen offset:0 lds
  s_add_u32 m0, m0, 1024
  s_nop 0
  buffer_load_dwordx4 v164, s[44:47], s30 offen offset:0 lds
  s_add_u32 s30, s30, 18432
  s_add_u32 m0, s31, 35840
  s_nop 0
  buffer_load_dwordx4 v160, s[44:47], s30 offen offset:0 lds
  s_add_u32 m0, m0, 1024
  s_nop 0
  buffer_load_dwordx4 v161, s[44:47], s30 offen offset:0 lds
  s_add_u32 m0, m0, 1024
  s_nop 0
  buffer_load_dwordx4 v162, s[44:47], s30 offen offset:0 lds
  s_add_u32 m0, m0, 1024
  s_nop 0
  buffer_load_dwordx4 v163, s[44:47], s30 offen offset:0 lds
  s_add_u32 m0, m0, 1024
  s_nop 0
  buffer_load_dwordx4 v164, s[44:47], s30 offen offset:0 lds
  s_add_u32 s30, s30, 18432
  s_waitcnt vmcnt(35)
  ds_read_b64_tr_b16 v[200:201], v165 offset:0
  ds_read_b64_tr_b16 v[202:203], v165 offset:1280
  ds_read_b64_tr_b16 v[204:205], v165 offset:64
  ds_read_b64_tr_b16 v[206:207], v165 offset:1344
  ds_read_b64_tr_b16 v[208:209], v165 offset:128
  ds_read_b64_tr_b16 v[210:211], v165 offset:1408
  ds_read_b64_tr_b16 v[212:213], v165 offset:192
  ds_read_b64_tr_b16 v[214:215], v165 offset:1472
  ds_read_b64_tr_b16 v[216:217], v165 offset:256
  ds_read_b64_tr_b16 v[218:219], v165 offset:1536
  s_waitcnt vmcnt(30)
  ds_read_b64_tr_b16 v[220:221], v165 offset:5120
  ds_read_b64_tr_b16 v[222:223], v165 offset:6400
  ds_read_b64_tr_b16 v[224:225], v165 offset:5184
  ds_read_b64_tr_b16 v[226:227], v165 offset:6464
  ds_read_b64_tr_b16 v[228:229], v165 offset:5248
  ds_read_b64_tr_b16 v[230:231], v165 offset:6528
  ds_read_b64_tr_b16 v[232:233], v165 offset:5312
  ds_read_b64_tr_b16 v[234:235], v165 offset:6592
  ds_read_b64_tr_b16 v[236:237], v165 offset:5376
  ds_read_b64_tr_b16 v[238:239], v165 offset:6656
  s_waitcnt lgkmcnt(15)
  v_mfma_f32_32x32x16_bf16 a[0:15], v[200:203], v[16:19], 0
  v_mfma_f32_32x32x16_bf16 a[16:31], v[204:207], v[16:19], 0
  s_waitcnt lgkmcnt(14)
  v_mfma_f32_32x32x16_bf16 a[32:47], v[208:211], v[16:19], 0
  s_waitcnt lgkmcnt(12)
  v_mfma_f32_32x32x16_bf16 a[48:63], v[212:215], v[16:19], 0
  s_waitcnt lgkmcnt(10)
  v_mfma_f32_32x32x16_bf16 a[64:79], v[216:219], v[16:19], 0
  s_add_u32 m0, s31, 0
  s_nop 0
  buffer_load_dwordx4 v160, s[44:47], s30 offen offset:0 lds
  s_add_u32 m0, m0, 1024
  s_nop 0
  buffer_load_dwordx4 v161, s[44:47], s30 offen offset:0 lds
  s_add_u32 m0, m0, 1024
  s_nop 0
  buffer_load_dwordx4 v162, s[44:47], s30 offen offset:0 lds
  s_add_u32 m0, m0, 1024
  s_nop 0
  buffer_load_dwordx4 v163, s[44:47], s30 offen offset:0 lds
  s_add_u32 m0, m0, 1024
  s_nop 0
  buffer_load_dwordx4 v164, s[44:47], s30 offen offset:0 lds
  s_add_u32 s30, s30, 18432
  s_waitcnt vmcnt(30)
  ds_read_b64_tr_b16 v[200:201], v165 offset:10240
  ds_read_b64_tr_b16 v[202:203], v165 offset:11520
  ds_read_b64_tr_b16 v[204:205], v165 offset:10304
  ds_read_b64_tr_b16 v[206:207], v165 offset:11584
  ds_read_b64_tr_b16 v[208:209], v165 offset:10368
  ds_read_b64_tr_b16 v[210:211], v165 offset:11648
  ds_read_b64_tr_b16 v[212:213], v165 offset:10432
  ds_read_b64_tr_b16 v[214:215], v165 offset:11712
  ds_read_b64_tr_b16 v[216:217], v165 offset:10496
  ds_read_b64_tr_b16 v[218:219], v165 offset:11776
  s_waitcnt lgkmcnt(15)
  v_mfma_f32_32x32x16_bf16 a[0:15], v[220:223], v[20:23], a[0:15]
  v_mfma_f32_32x32x16_bf16 a[16:31], v[224:227], v[20:23], a[16:31]
  s_waitcnt lgkmcnt(14)
  v_mfma_f32_32x32x16_bf16 a[32:47], v[228:231], v[20:23], a[32:47]
  s_waitcnt lgkmcnt(12)
  v_mfma_f32_32x32x16_bf16 a[48:63], v[232:235], v[20:23], a[48:63]
  s_waitcnt lgkmcnt(10)
  v_mfma_f32_32x32x16_bf16 a[64:79], v[236:239], v[20:23], a[64:79]
  s_add_u32 m0, s31, 5120
  s_nop 0
  buffer_load_dwordx4 v160, s[44:47], s30 offen offset:0 lds
  s_add_u32 m0, m0, 1024
  s_nop 0
  buffer_load_dwordx4 v161, s[44:47], s30 offen offset:0 lds
  s_add_u32 m0, m0, 1024
  s_nop 0
  buffer_load_dwordx4 v162, s[44:47], s30 offen offset:0 lds
  s_add_u32 m0, m0, 1024
  s_nop 0
  buffer_load_dwordx4 v163, s[44:47], s30 offen offset:0 lds
  s_add_u32 m0, m0, 1024
  s_nop 0
  buffer_load_dwordx4 v164, s[44:47], s30 offen offset:0 lds
  s_add_u32 s30, s30, 18432
  s_waitcnt vmcnt(30)
  ds_read_b64_tr_b16 v[220:221], v165 offset:15360
  ds_read_b64_tr_b16 v[222:223], v165 offset:16640
  ds_read_b64_tr_b16 v[224:225], v165 offset:15424
  ds_read_b64_tr_b16 v[226:227], v165 offset:16704
  ds_read_b64_tr_b16 v[228:229], v165 offset:15488
  ds_read_b64_tr_b16 v[230:231], v165 offset:16768
  ds_read_b64_tr_b16 v[232:233], v165 offset:15552
  ds_read_b64_tr_b16 v[234:235], v165 offset:16832
  ds_read_b64_tr_b16 v[236:237], v165 offset:15616
  ds_read_b64_tr_b16 v[238:239], v165 offset:16896
  s_waitcnt lgkmcnt(15)
  v_mfma_f32_32x32x16_bf16 a[0:15], v[200:203], v[24:27], a[0:15]
  v_mfma_f32_32x32x16_bf16 a[16:31], v[204:207], v[24:27], a[16:31]
  s_waitcnt lgkmcnt(14)
  v_mfma_f32_32x32x16_bf16 a[32:47], v[208:211], v[24:27], a[32:47]
  s_waitcnt lgkmcnt(12)
  v_mfma_f32_32x32x16_bf16 a[48:63], v[212:215], v[24:27], a[48:63]
  s_waitcnt lgkmcnt(10)
  v_mfma_f32_32x32x16_bf16 a[64:79], v[216:219], v[24:27], a[64:79]
  s_add_u32 m0, s31, 10240
  s_nop 0
  buffer_load_dwordx4 v160, s[44:47], s30 offen offset:0 lds
  s_add_u32 m0, m0, 1024
  s_nop 0
  buffer_load_dwordx4 v161, s[44:47], s30 offen offset:0 lds
  s_add_u32 m0, m0, 1024
  s_nop 0
  buffer_load_dwordx4 v162, s[44:47], s30 offen offset:0 lds
  s_add_u32 m0, m0, 1024
  s_nop 0
  buffer_load_dwordx4 v163, s[44:47], s30 offen offset:0 lds
  s_add_u32 m0, m0, 1024
  s_nop 0
  buffer_load_dwordx4 v164, s[44:47], s30 offen offset:0 lds
  s_add_u32 s30, s30, 18432
  s_waitcnt vmcnt(30)
  ds_read_b64_tr_b16 v[200:201], v165 offset:20480
  ds_read_b64_tr_b16 v[202:203], v165 offset:21760
  ds_read_b64_tr_b16 v[204:205], v165 offset:20544
  ds_read_b64_tr_b16 v[206:207], v165 offset:21824
  ds_read_b64_tr_b16 v[208:209], v165 offset:20608
  ds_read_b64_tr_b16 v[210:211], v165 offset:21888
  ds_read_b64_tr_b16 v[212:213], v165 offset:20672
  ds_read_b64_tr_b16 v[214:215], v165 offset:21952
  ds_read_b64_tr_b16 v[216:217], v165 offset:20736
  ds_read_b64_tr_b16 v[218:219], v165 offset:22016
  s_waitcnt lgkmcnt(15)
  v_mfma_f32_32x32x16_bf16 a[0:15], v[220:223], v[28:31], a[0:15]
  v_mfma_f32_32x32x16_bf16 a[16:31], v[224:227], v[28:31], a[16:31]
  s_waitcnt lgkmcnt(14)
  v_mfma_f32_32x32x16_bf16 a[32:47], v[228:231], v[28:31], a[32:47]
  s_waitcnt lgkmcnt(12)
  v_mfma_f32_32x32x16_bf16 a[48:63], v[232:235], v[28:31], a[48:63]
  s_waitcnt lgkmcnt(10)
  v_mfma_f32_32x32x16_bf16 a[64:79], v[236:239], v[28:31], a[64:79]
  s_add_u32 m0, s31, 15360
  s_nop 0
  buffer_load_dwordx4 v160, s[44:47], s30 offen offset:0 lds
  s_add_u32 m0, m0, 1024
  s_nop 0
  buffer_load_dwordx4 v161, s[44:47], s30 offen offset:0 lds
  s_add_u32 m0, m0, 1024
  s_nop 0
  buffer_load_dwordx4 v162, s[44:47], s30 offen offset:0 lds
  s_add_u32 m0, m0, 1024
  s_nop 0
  buffer_load_dwordx4 v163, s[44:47], s30 offen offset:0 lds
  s_add_u32 m0, m0, 1024
  s_nop 0
  buffer_load_dwordx4 v164, s[44:47], s30 offen offset:0 lds
  s_add_u32 s30, s30, 18432
  s_waitcnt vmcnt(30)
  ds_read_b64_tr_b16 v[220:221], v165 offset:25600
  ds_read_b64_tr_b16 v[222:223], v165 offset:26880
  ds_read_b64_tr_b16 v[224:225], v165 offset:25664
  ds_read_b64_tr_b16 v[226:227], v165 offset:26944
  ds_read_b64_tr_b16 v[228:229], v165 offset:25728
  ds_read_b64_tr_b16 v[230:231], v165 offset:27008
  ds_read_b64_tr_b16 v[232:233], v165 offset:25792
  ds_read_b64_tr_b16 v[234:235], v165 offset:27072
  ds_read_b64_tr_b16 v[236:237], v165 offset:25856
  ds_read_b64_tr_b16 v[238:239], v165 offset:27136
  s_waitcnt lgkmcnt(15)
  v_mfma_f32_32x32x16_bf16 a[0:15], v[200:203], v[32:35], a[0:15]
  v_mfma_f32_32x32x16_bf16 a[16:31], v[204:207], v[32:35], a[16:31]
  s_waitcnt lgkmcnt(14)
  v_mfma_f32_32x32x16_bf16 a[32:47], v[208:211], v[32:35], a[32:47]
  s_waitcnt lgkmcnt(12)
  v_mfma_f32_32x32x16_bf16 a[48:63], v[212:215], v[32:35], a[48:63]
  s_waitcnt lgkmcnt(10)
  v_mfma_f32_32x32x16_bf16 a[64:79], v[216:219], v[32:35], a[64:79]
  s_add_u32 m0, s31, 20480
  s_nop 0
  buffer_load_dwordx4 v160, s[44:47], s30 offen offset:0 lds
  s_add_u32 m0, m0, 1024
  s_nop 0
  buffer_load_dwordx4 v161, s[44:47], s30 offen offset:0 lds
  s_add_u32 m0, m0, 1024
  s_nop 0
  buffer_load_dwordx4 v162, s[44:47], s30 offen offset:0 lds
  s_add_u32 m0, m0, 1024
  s_nop 0
  buffer_load_dwordx4 v163, s[44:47], s30 offen offset:0 lds
  s_add_u32 m0, m0, 1024
  s_nop 0
  buffer_load_dwordx4 v164, s[44:47], s30 offen offset:0 lds
  s_add_u32 s30, s30, 18432
  s_waitcnt vmcnt(30)
  ds_read_b64_tr_b16 v[200:201], v165 offset:30720
  ds_read_b64_tr_b16 v[202:203], v165 offset:32000
  ds_read_b64_tr_b16 v[204:205], v165 offset:30784
  ds_read_b64_tr_b16 v[206:207], v165 offset:32064
  ds_read_b64_tr_b16 v[208:209], v165 offset:30848
  ds_read_b64_tr_b16 v[210:211], v165 offset:32128
  ds_read_b64_tr_b16 v[212:213], v165 offset:30912
  ds_read_b64_tr_b16 v[214:215], v165 offset:32192
  ds_read_b64_tr_b16 v[216:217], v165 offset:30976
  ds_read_b64_tr_b16 v[218:219], v165 offset:32256
  s_waitcnt lgkmcnt(15)
  v_mfma_f32_32x32x16_bf16 a[0:15], v[220:223], v[36:39], a[0:15]
  v_mfma_f32_32x32x16_bf16 a[16:31], v[224:227], v[36:39], a[16:31]
  s_waitcnt lgkmcnt(14)
  v_mfma_f32_32x32x16_bf16 a[32:47], v[228:231], v[36:39], a[32:47]
  s_waitcnt lgkmcnt(12)
  v_mfma_f32_32x32x16_bf16 a[48:63], v[232:235], v[36:39], a[48:63]
  s_waitcnt lgkmcnt(10)
  v_mfma_f32_32x32x16_bf16 a[64:79], v[236:239], v[36:39], a[64:79]
  s_add_u32 m0, s31, 25600
  s_nop 0
  buffer_load_dwordx4 v160, s[44:47], s30 offen offset:0 lds
  s_add_u32 m0, m0, 1024
  s_nop 0
  buffer_load_dwordx4 v161, s[44:47], s30 offen offset:0 lds
  s_add_u32 m0, m0, 1024
  s_nop 0
  buffer_load_dwordx4 v162, s[44:47], s30 offen offset:0 lds
  s_add_u32 m0, m0, 1024
  s_nop 0
  buffer_load_dwordx4 v163, s[44:47], s30 offen offset:0 lds
  s_add_u32 m0, m0, 1024
  s_nop 0
  buffer_load_dwordx4 v164, s[44:47], s30 offen offset:0 lds
  s_add_u32 s30, s30, 18432
  s_waitcnt vmcnt(30)
  ds_read_b64_tr_b16 v[220:221], v165 offset:35840
  ds_read_b64_tr_b16 v[222:223], v165 offset:37120
  ds_read_b64_tr_b16 v[224:225], v165 offset:35904
  ds_read_b64_tr_b16 v[226:227], v165 offset:37184
  ds_read_b64_tr_b16 v[228:229], v165 offset:35968
  ds_read_b64_tr_b16 v[230:231], v165 offset:37248
  ds_read_b64_tr_b16 v[232:233], v165 offset:36032
  ds_read_b64_tr_b16 v[234:235], v165 offset:37312
  ds_read_b64_tr_b16 v[236:237], v165 offset:36096
  ds_read_b64_tr_b16 v[238:239], v165 offset:37376
  s_waitcnt lgkmcnt(15)
  v_mfma_f32_32x32x16_bf16 a[0:15], v[200:203], v[40:43], a[0:15]
  v_mfma_f32_32x32x16_bf16 a[16:31], v[204:207], v[40:43], a[16:31]
  s_waitcnt lgkmcnt(14)
  v_mfma_f32_32x32x16_bf16 a[32:47], v[208:211], v[40:43], a[32:47]
  s_waitcnt lgkmcnt(12)
  v_mfma_f32_32x32x16_bf16 a[48:63], v[212:215], v[40:43], a[48:63]
  s_waitcnt lgkmcnt(10)
  v_mfma_f32_32x32x16_bf16 a[64:79], v[216:219], v[40:43], a[64:79]
  s_add_u32 m0, s31, 30720
  s_nop 0
  buffer_load_dwordx4 v160, s[44:47], s30 offen offset:0 lds
  s_add_u32 m0, m0, 1024
  s_nop 0
  buffer_load_dwordx4 v161, s[44:47], s30 offen offset:0 lds
  s_add_u32 m0, m0, 1024
  s_nop 0
  buffer_load_dwordx4 v162, s[44:47], s30 offen offset:0 lds
  s_add_u32 m0, m0, 1024
  s_nop 0
  buffer_load_dwordx4 v163, s[44:47], s30 offen offset:0 lds
  s_add_u32 m0, m0, 1024
  s_nop 0
  buffer_load_dwordx4 v164, s[44:47], s30 offen offset:0 lds
  s_add_u32 s30, s30, 18432
  s_waitcnt vmcnt(30)
  ds_read_b64_tr_b16 v[200:201], v165 offset:0
  ds_read_b64_tr_b16 v[202:203], v165 offset:1280
  ds_read_b64_tr_b16 v[204:205], v165 offset:64
  ds_read_b64_tr_b16 v[206:207], v165 offset:1344
  ds_read_b64_tr_b16 v[208:209], v165 offset:128
  ds_read_b64_tr_b16 v[210:211], v165 offset:1408
  ds_read_b64_tr_b16 v[212:213], v165 offset:192
  ds_read_b64_tr_b16 v[214:215], v165 offset:1472
  ds_read_b64_tr_b16 v[216:217], v165 offset:256
  ds_read_b64_tr_b16 v[218:219], v165 offset:1536
  s_waitcnt lgkmcnt(15)
  v_mfma_f32_32x32x16_bf16 a[0:15], v[220:223], v[44:47], a[0:15]
  v_mfma_f32_32x32x16_bf16 a[16:31], v[224:227], v[44:47], a[16:31]
  s_waitcnt lgkmcnt(14)
  v_mfma_f32_32x32x16_bf16 a[32:47], v[228:231], v[44:47], a[32:47]
  s_waitcnt lgkmcnt(12)
  v_mfma_f32_32x32x16_bf16 a[48:63], v[232:235], v[44:47], a[48:63]
  s_waitcnt lgkmcnt(10)
  v_mfma_f32_32x32x16_bf16 a[64:79], v[236:239], v[44:47], a[64:79]
  s_add_u32 m0, s31, 35840
  s_nop 0
  buffer_load_dwordx4 v160, s[44:47], s30 offen offset:0 lds
  s_add_u32 m0, m0, 1024
  s_nop 0
  buffer_load_dwordx4 v161, s[44:47], s30 offen offset:0 lds
  s_add_u32 m0, m0, 1024
  s_nop 0
  buffer_load_dwordx4 v162, s[44:47], s30 offen offset:0 lds
  s_add_u32 m0, m0, 1024
  s_nop 0
  buffer_load_dwordx4 v163, s[44:47], s30 offen offset:0 lds
  s_add_u32 m0, m0, 1024
  s_nop 0
  buffer_load_dwordx4 v164, s[44:47], s30 offen offset:0 lds
  s_add_u32 s30, s30, 18432
  s_waitcnt vmcnt(30)
  ds_read_b64_tr_b16 v[220:221], v165 offset:5120
  ds_read_b64_tr_b16 v[222:223], v165 offset:6400
  ds_read_b64_tr_b16 v[224:225], v165 offset:5184
  ds_read_b64_tr_b16 v[226:227], v165 offset:6464
  ds_read_b64_tr_b16 v[228:229], v165 offset:5248
  ds_read_b64_tr_b16 v[230:231], v165 offset:6528
  ds_read_b64_tr_b16 v[232:233], v165 offset:5312
  ds_read_b64_tr_b16 v[234:235], v165 offset:6592
  ds_read_b64_tr_b16 v[236:237], v165 offset:5376
  ds_read_b64_tr_b16 v[238:239], v165 offset:6656
  s_waitcnt lgkmcnt(15)
  v_mfma_f32_32x32x16_bf16 a[0:15], v[200:203], v[48:51], a[0:15]
  v_mfma_f32_32x32x16_bf16 a[16:31], v[204:207], v[48:51], a[16:31]
  s_waitcnt lgkmcnt(14)
  v_mfma_f32_32x32x16_bf16 a[32:47], v[208:211], v[48:51], a[32:47]
  s_waitcnt lgkmcnt(12)
  v_mfma_f32_32x32x16_bf16 a[48:63], v[212:215], v[48:51], a[48:63]
  s_waitcnt lgkmcnt(10)
  v_mfma_f32_32x32x16_bf16 a[64:79], v[216:219], v[48:51], a[64:79]
  s_add_u32 m0, s31, 0
  s_nop 0
  buffer_load_dwordx4 v160, s[44:47], s30 offen offset:0 lds
  s_add_u32 m0, m0, 1024
  s_nop 0
  buffer_load_dwordx4 v161, s[44:47], s30 offen offset:0 lds
  s_add_u32 m0, m0, 1024
  s_nop 0
  buffer_load_dwordx4 v162, s[44:47], s30 offen offset:0 lds
  s_add_u32 m0, m0, 1024
  s_nop 0
  buffer_load_dwordx4 v163, s[44:47], s30 offen offset:0 lds
  s_add_u32 m0, m0, 1024
  s_nop 0
  buffer_load_dwordx4 v164, s[44:47], s30 offen offset:0 lds
  s_add_u32 s30, s30, 18432
  s_waitcnt vmcnt(30)
  ds_read_b64_tr_b16 v[200:201], v165 offset:10240
  ds_read_b64_tr_b16 v[202:203], v165 offset:11520
  ds_read_b64_tr_b16 v[204:205], v165 offset:10304
  ds_read_b64_tr_b16 v[206:207], v165 offset:11584
  ds_read_b64_tr_b16 v[208:209], v165 offset:10368
  ds_read_b64_tr_b16 v[210:211], v165 offset:11648
  ds_read_b64_tr_b16 v[212:213], v165 offset:10432
  ds_read_b64_tr_b16 v[214:215], v165 offset:11712
  ds_read_b64_tr_b16 v[216:217], v165 offset:10496
  ds_read_b64_tr_b16 v[218:219], v165 offset:11776
  s_waitcnt lgkmcnt(15)
  v_mfma_f32_32x32x16_bf16 a[0:15], v[220:223], v[52:55], a[0:15]
  v_mfma_f32_32x32x16_bf16 a[16:31], v[224:227], v[52:55], a[16:31]
  s_waitcnt lgkmcnt(14)
  v_mfma_f32_32x32x16_bf16 a[32:47], v[228:231], v[52:55], a[32:47]
  s_waitcnt lgkmcnt(12)
  v_mfma_f32_32x32x16_bf16 a[48:63], v[232:235], v[52:55], a[48:63]
  s_waitcnt lgkmcnt(10)
  v_mfma_f32_32x32x16_bf16 a[64:79], v[236:239], v[52:55], a[64:79]
  s_add_u32 m0, s31, 5120
  s_nop 0
  buffer_load_dwordx4 v160, s[44:47], s30 offen offset:0 lds
  s_add_u32 m0, m0, 1024
  s_nop 0
  buffer_load_dwordx4 v161, s[44:47], s30 offen offset:0 lds
  s_add_u32 m0, m0, 1024
  s_nop 0
  buffer_load_dwordx4 v162, s[44:47], s30 offen offset:0 lds
  s_add_u32 m0, m0, 1024
  s_nop 0
  buffer_load_dwordx4 v163, s[44:47], s30 offen offset:0 lds
  s_add_u32 m0, m0, 1024
  s_nop 0
  buffer_load_dwordx4 v164, s[44:47], s30 offen offset:0 lds
  s_add_u32 s30, s30, 18432
  s_waitcnt vmcnt(30)
  ds_read_b64_tr_b16 v[220:221], v165 offset:15360
  ds_read_b64_tr_b16 v[222:223], v165 offset:16640
  ds_read_b64_tr_b16 v[224:225], v165 offset:15424
  ds_read_b64_tr_b16 v[226:227], v165 offset:16704
  ds_read_b64_tr_b16 v[228:229], v165 offset:15488
  ds_read_b64_tr_b16 v[230:231], v165 offset:16768
  ds_read_b64_tr_b16 v[232:233], v165 offset:15552
  ds_read_b64_tr_b16 v[234:235], v165 offset:16832
  ds_read_b64_tr_b16 v[236:237], v165 offset:15616
  ds_read_b64_tr_b16 v[238:239], v165 offset:16896
  s_waitcnt lgkmcnt(15)
  v_mfma_f32_32x32x16_bf16 a[0:15], v[200:203], v[56:59], a[0:15]
  v_mfma_f32_32x32x16_bf16 a[16:31], v[204:207], v[56:59], a[16:31]
  s_waitcnt lgkmcnt(14)
  v_mfma_f32_32x32x16_bf16 a[32:47], v[208:211], v[56:59], a[32:47]
  s_waitcnt lgkmcnt(12)
  v_mfma_f32_32x32x16_bf16 a[48:63], v[212:215], v[56:59], a[48:63]
  s_waitcnt lgkmcnt(10)
  v_mfma_f32_32x32x16_bf16 a[64:79], v[216:219], v[56:59], a[64:79]
  s_add_u32 m0, s31, 10240
  s_nop 0
  buffer_load_dwordx4 v160, s[44:47], s30 offen offset:0 lds
  s_add_u32 m0, m0, 1024
  s_nop 0
  buffer_load_dwordx4 v161, s[44:47], s30 offen offset:0 lds
  s_add_u32 m0, m0, 1024
  s_nop 0
  buffer_load_dwordx4 v162, s[44:47], s30 offen offset:0 lds
  s_add_u32 m0, m0, 1024
  s_nop 0
  buffer_load_dwordx4 v163, s[44:47], s30 offen offset:0 lds
  s_add_u32 m0, m0, 1024
  s_nop 0
  buffer_load_dwordx4 v164, s[44:47], s30 offen offset:0 lds
  s_add_u32 s30, s30, 18432
  s_waitcnt vmcnt(30)
  ds_read_b64_tr_b16 v[200:201], v165 offset:20480
  ds_read_b64_tr_b16 v[202:203], v165 offset:21760
  ds_read_b64_tr_b16 v[204:205], v165 offset:20544
  ds_read_b64_tr_b16 v[206:207], v165 offset:21824
  ds_read_b64_tr_b16 v[208:209], v165 offset:20608
  ds_read_b64_tr_b16 v[210:211], v165 offset:21888
  ds_read_b64_tr_b16 v[212:213], v165 offset:20672
  ds_read_b64_tr_b16 v[214:215], v165 offset:21952
  ds_read_b64_tr_b16 v[216:217], v165 offset:20736
  ds_read_b64_tr_b16 v[218:219], v165 offset:22016
  s_waitcnt lgkmcnt(15)
  v_mfma_f32_32x32x16_bf16 a[0:15], v[220:223], v[60:63], a[0:15]
  v_mfma_f32_32x32x16_bf16 a[16:31], v[224:227], v[60:63], a[16:31]
  s_waitcnt lgkmcnt(14)
  v_mfma_f32_32x32x16_bf16 a[32:47], v[228:231], v[60:63], a[32:47]
  s_waitcnt lgkmcnt(12)
  v_mfma_f32_32x32x16_bf16 a[48:63], v[232:235], v[60:63], a[48:63]
  s_waitcnt lgkmcnt(10)
  v_mfma_f32_32x32x16_bf16 a[64:79], v[236:239], v[60:63], a[64:79]
  s_add_u32 m0, s31, 15360
  s_nop 0
  buffer_load_dwordx4 v160, s[44:47], s30 offen offset:0 lds
  s_add_u32 m0, m0, 1024
  s_nop 0
  buffer_load_dwordx4 v161, s[44:47], s30 offen offset:0 lds
  s_add_u32 m0, m0, 1024
  s_nop 0
  buffer_load_dwordx4 v162, s[44:47], s30 offen offset:0 lds
  s_add_u32 m0, m0, 1024
  s_nop 0
  buffer_load_dwordx4 v163, s[44:47], s30 offen offset:0 lds
  s_add_u32 m0, m0, 1024
  s_nop 0
  buffer_load_dwordx4 v164, s[44:47], s30 offen offset:0 lds
  s_add_u32 s30, s30, 18432
  s_waitcnt vmcnt(30)
  ds_read_b64_tr_b16 v[220:221], v165 offset:25600
  ds_read_b64_tr_b16 v[222:223], v165 offset:26880
  ds_read_b64_tr_b16 v[224:225], v165 offset:25664
  ds_read_b64_tr_b16 v[226:227], v165 offset:26944
  ds_read_b64_tr_b16 v[228:229], v165 offset:25728
  ds_read_b64_tr_b16 v[230:231], v165 offset:27008
  ds_read_b64_tr_b16 v[232:233], v165 offset:25792
  ds_read_b64_tr_b16 v[234:235], v165 offset:27072
  ds_read_b64_tr_b16 v[236:237], v165 offset:25856
  ds_read_b64_tr_b16 v[238:239], v165 offset:27136
  s_waitcnt lgkmcnt(15)
  v_mfma_f32_32x32x16_bf16 a[0:15], v[200:203], v[64:67], a[0:15]
  v_mfma_f32_32x32x16_bf16 a[16:31], v[204:207], v[64:67], a[16:31]
  s_waitcnt lgkmcnt(14)
  v_mfma_f32_32x32x16_bf16 a[32:47], v[208:211], v[64:67], a[32:47]
  s_waitcnt lgkmcnt(12)
  v_mfma_f32_32x32x16_bf16 a[48:63], v[212:215], v[64:67], a[48:63]
  s_waitcnt lgkmcnt(10)
  v_mfma_f32_32x32x16_bf16 a[64:79], v[216:219], v[64:67], a[64:79]
  s_add_u32 m0, s31, 20480
  s_nop 0
  buffer_load_dwordx4 v160, s[44:47], s30 offen offset:0 lds
  s_add_u32 m0, m0, 1024
  s_nop 0
  buffer_load_dwordx4 v161, s[44:47], s30 offen offset:0 lds
  s_add_u32 m0, m0, 1024
  s_nop 0
  buffer_load_dwordx4 v162, s[44:47], s30 offen offset:0 lds
  s_add_u32 m0, m0, 1024
  s_nop 0
  buffer_load_dwordx4 v163, s[44:47], s30 offen offset:0 lds
  s_add_u32 m0, m0, 1024
  s_nop 0
  buffer_load_dwordx4 v164, s[44:47], s30 offen offset:0 lds
  s_add_u32 s30, s30, 18432
  s_waitcnt vmcnt(30)
  ds_read_b64_tr_b16 v[200:201], v165 offset:30720
  ds_read_b64_tr_b16 v[202:203], v165 offset:32000
  ds_read_b64_tr_b16 v[204:205], v165 offset:30784
  ds_read_b64_tr_b16 v[206:207], v165 offset:32064
  ds_read_b64_tr_b16 v[208:209], v165 offset:30848
  ds_read_b64_tr_b16 v[210:211], v165 offset:32128
  ds_read_b64_tr_b16 v[212:213], v165 offset:30912
  ds_read_b64_tr_b16 v[214:215], v165 offset:32192
  ds_read_b64_tr_b16 v[216:217], v165 offset:30976
  ds_read_b64_tr_b16 v[218:219], v165 offset:32256
  s_waitcnt lgkmcnt(15)
  v_mfma_f32_32x32x16_bf16 a[0:15], v[220:223], v[68:71], a[0:15]
  v_mfma_f32_32x32x16_bf16 a[16:31], v[224:227], v[68:71], a[16:31]
  s_waitcnt lgkmcnt(14)
  v_mfma_f32_32x32x16_bf16 a[32:47], v[228:231], v[68:71], a[32:47]
  s_waitcnt lgkmcnt(12)
  v_mfma_f32_32x32x16_bf16 a[48:63], v[232:235], v[68:71], a[48:63]
  s_waitcnt lgkmcnt(10)
  v_mfma_f32_32x32x16_bf16 a[64:79], v[236:239], v[68:71], a[64:79]
  s_add_u32 m0, s31, 25600
  s_nop 0
  buffer_load_dwordx4 v160, s[44:47], s30 offen offset:0 lds
  s_add_u32 m0, m0, 1024
  s_nop 0
  buffer_load_dwordx4 v161, s[44:47], s30 offen offset:0 lds
  s_add_u32 m0, m0, 1024
  s_nop 0
  buffer_load_dwordx4 v162, s[44:47], s30 offen offset:0 lds
  s_add_u32 m0, m0, 1024
  s_nop 0
  buffer_load_dwordx4 v163, s[44:47], s30 offen offset:0 lds
  s_add_u32 m0, m0, 1024
  s_nop 0
  buffer_load_dwordx4 v164, s[44:47], s30 offen offset:0 lds
  s_add_u32 s30, s30, 18432
  s_waitcnt vmcnt(30)
  ds_read_b64_tr_b16 v[220:221], v165 offset:35840
  ds_read_b64_tr_b16 v[222:223], v165 offset:37120
  ds_read_b64_tr_b16 v[224:225], v165 offset:35904
  ds_read_b64_tr_b16 v[226:227], v165 offset:37184
  ds_read_b64_tr_b16 v[228:229], v165 offset:35968
  ds_read_b64_tr_b16 v[230:231], v165 offset:37248
  ds_read_b64_tr_b16 v[232:233], v165 offset:36032
  ds_read_b64_tr_b16 v[234:235], v165 offset:37312
  ds_read_b64_tr_b16 v[236:237], v165 offset:36096
  ds_read_b64_tr_b16 v[238:239], v165 offset:37376
  s_waitcnt lgkmcnt(15)
  v_mfma_f32_32x32x16_bf16 a[0:15], v[200:203], v[72:75], a[0:15]
  v_mfma_f32_32x32x16_bf16 a[16:31], v[204:207], v[72:75], a[16:31]
  s_waitcnt lgkmcnt(14)
  v_mfma_f32_32x32x16_bf16 a[32:47], v[208:211], v[72:75], a[32:47]
  s_waitcnt lgkmcnt(12)
  v_mfma_f32_32x32x16_bf16 a[48:63], v[212:215], v[72:75], a[48:63]
  s_waitcnt lgkmcnt(10)
  v_mfma_f32_32x32x16_bf16 a[64:79], v[216:219], v[72:75], a[64:79]
  s_add_u32 m0, s31, 30720
  s_nop 0
  buffer_load_dwordx4 v160, s[44:47], s30 offen offset:0 lds
  s_add_u32 m0, m0, 1024
  s_nop 0
  buffer_load_dwordx4 v161, s[44:47], s30 offen offset:0 lds
  s_add_u32 m0, m0, 1024
  s_nop 0
  buffer_load_dwordx4 v162, s[44:47], s30 offen offset:0 lds
  s_add_u32 m0, m0, 1024
  s_nop 0
  buffer_load_dwordx4 v163, s[44:47], s30 offen offset:0 lds
  s_add_u32 m0, m0, 1024
  s_nop 0
  buffer_load_dwordx4 v164, s[44:47], s30 offen offset:0 lds
  s_add_u32 s30, s30, 18432
  s_waitcnt vmcnt(30)
  ds_read_b64_tr_b16 v[200:201], v165 offset:0
  ds_read_b64_tr_b16 v[202:203], v165 offset:1280
  ds_read_b64_tr_b16 v[204:205], v165 offset:64
  ds_read_b64_tr_b16 v[206:207], v165 offset:1344
  ds_read_b64_tr_b16 v[208:209], v165 offset:128
  ds_read_b64_tr_b16 v[210:211], v165 offset:1408
  ds_read_b64_tr_b16 v[212:213], v165 offset:192
  ds_read_b64_tr_b16 v[214:215], v165 offset:1472
  ds_read_b64_tr_b16 v[216:217], v165 offset:256
  ds_read_b64_tr_b16 v[218:219], v165 offset:1536
  s_waitcnt lgkmcnt(15)
  v_mfma_f32_32x32x16_bf16 a[0:15], v[220:223], v[76:79], a[0:15]
  v_mfma_f32_32x32x16_bf16 a[16:31], v[224:227], v[76:79], a[16:31]
  s_waitcnt lgkmcnt(14)
  v_mfma_f32_32x32x16_bf16 a[32:47], v[228:231], v[76:79], a[32:47]
  s_waitcnt lgkmcnt(12)
  v_mfma_f32_32x32x16_bf16 a[48:63], v[232:235], v[76:79], a[48:63]
  s_waitcnt lgkmcnt(10)
  v_mfma_f32_32x32x16_bf16 a[64:79], v[236:239], v[76:79], a[64:79]
  s_add_u32 m0, s31, 35840
  s_nop 0
  buffer_load_dwordx4 v160, s[44:47], s30 offen offset:0 lds
  s_add_u32 m0, m0, 1024
  s_nop 0
  buffer_load_dwordx4 v161, s[44:47], s30 offen offset:0 lds
  s_add_u32 m0, m0, 1024
  s_nop 0
  buffer_load_dwordx4 v162, s[44:47], s30 offen offset:0 lds
  s_add_u32 m0, m0, 1024
  s_nop 0
  buffer_load_dwordx4 v163, s[44:47], s30 offen offset:0 lds
  s_add_u32 m0, m0, 1024
  s_nop 0
  buffer_load_dwordx4 v164, s[44:47], s30 offen offset:0 lds
  s_add_u32 s30, s30, 18432
  s_waitcnt vmcnt(30)
  ds_read_b64_tr_b16 v[220:221], v165 offset:5120
  ds_read_b64_tr_b16 v[222:223], v165 offset:6400
  ds_read_b64_tr_b16 v[224:225], v165 offset:5184
  ds_read_b64_tr_b16 v[226:227], v165 offset:6464
  ds_read_b64_tr_b16 v[228:229], v165 offset:5248
  ds_read_b64_tr_b16 v[230:231], v165 offset:6528
  ds_read_b64_tr_b16 v[232:233], v165 offset:5312
  ds_read_b64_tr_b16 v[234:235], v165 offset:6592
  ds_read_b64_tr_b16 v[236:237], v165 offset:5376
  ds_read_b64_tr_b16 v[238:239], v165 offset:6656
  s_waitcnt lgkmcnt(15)
  v_mfma_f32_32x32x16_bf16 a[0:15], v[200:203], v[80:83], a[0:15]
  v_mfma_f32_32x32x16_bf16 a[16:31], v[204:207], v[80:83], a[16:31]
  s_waitcnt lgkmcnt(14)
  v_mfma_f32_32x32x16_bf16 a[32:47], v[208:211], v[80:83], a[32:47]
  s_waitcnt lgkmcnt(12)
  v_mfma_f32_32x32x16_bf16 a[48:63], v[212:215], v[80:83], a[48:63]
  s_waitcnt lgkmcnt(10)
  v_mfma_f32_32x32x16_bf16 a[64:79], v[216:219], v[80:83], a[64:79]
  s_add_u32 m0, s31, 0
  s_nop 0
  buffer_load_dwordx4 v160, s[44:47], s30 offen offset:0 lds
  s_add_u32 m0, m0, 1024
  s_nop 0
  buffer_load_dwordx4 v161, s[44:47], s30 offen offset:0 lds
  s_add_u32 m0, m0, 1024
  s_nop 0
  buffer_load_dwordx4 v162, s[44:47], s30 offen offset:0 lds
  s_add_u32 m0, m0, 1024
  s_nop 0
  buffer_load_dwordx4 v163, s[44:47], s30 offen offset:0 lds
  s_add_u32 m0, m0, 1024
  s_nop 0
  buffer_load_dwordx4 v164, s[44:47], s30 offen offset:0 lds
  s_add_u32 s30, s30, 18432
  s_waitcnt vmcnt(30)
  ds_read_b64_tr_b16 v[200:201], v165 offset:10240
  ds_read_b64_tr_b16 v[202:203], v165 offset:11520
  ds_read_b64_tr_b16 v[204:205], v165 offset:10304
  ds_read_b64_tr_b16 v[206:207], v165 offset:11584
  ds_read_b64_tr_b16 v[208:209], v165 offset:10368
  ds_read_b64_tr_b16 v[210:211], v165 offset:11648
  ds_read_b64_tr_b16 v[212:213], v165 offset:10432
  ds_read_b64_tr_b16 v[214:215], v165 offset:11712
  ds_read_b64_tr_b16 v[216:217], v165 offset:10496
  ds_read_b64_tr_b16 v[218:219], v165 offset:11776
  s_waitcnt lgkmcnt(15)
  v_mfma_f32_32x32x16_bf16 a[0:15], v[220:223], v[84:87], a[0:15]
  v_mfma_f32_32x32x16_bf16 a[16:31], v[224:227], v[84:87], a[16:31]
  s_waitcnt lgkmcnt(14)
  v_mfma_f32_32x32x16_bf16 a[32:47], v[228:231], v[84:87], a[32:47]
  s_waitcnt lgkmcnt(12)
  v_mfma_f32_32x32x16_bf16 a[48:63], v[232:235], v[84:87], a[48:63]
  s_waitcnt lgkmcnt(10)
  v_mfma_f32_32x32x16_bf16 a[64:79], v[236:239], v[84:87], a[64:79]
  s_add_u32 m0, s31, 5120
  s_nop 0
  buffer_load_dwordx4 v160, s[44:47], s30 offen offset:0 lds
  s_add_u32 m0, m0, 1024
  s_nop 0
  buffer_load_dwordx4 v161, s[44:47], s30 offen offset:0 lds
  s_add_u32 m0, m0, 1024
  s_nop 0
  buffer_load_dwordx4 v162, s[44:47], s30 offen offset:0 lds
  s_add_u32 m0, m0, 1024
  s_nop 0
  buffer_load_dwordx4 v163, s[44:47], s30 offen offset:0 lds
  s_add_u32 m0, m0, 1024
  s_nop 0
  buffer_load_dwordx4 v164, s[44:47], s30 offen offset:0 lds
  s_add_u32 s30, s30, 18432
  s_waitcnt vmcnt(30)
  ds_read_b64_tr_b16 v[220:221], v165 offset:15360
  ds_read_b64_tr_b16 v[222:223], v165 offset:16640
  ds_read_b64_tr_b16 v[224:225], v165 offset:15424
  ds_read_b64_tr_b16 v[226:227], v165 offset:16704
  ds_read_b64_tr_b16 v[228:229], v165 offset:15488
  ds_read_b64_tr_b16 v[230:231], v165 offset:16768
  ds_read_b64_tr_b16 v[232:233], v165 offset:15552
  ds_read_b64_tr_b16 v[234:235], v165 offset:16832
  ds_read_b64_tr_b16 v[236:237], v165 offset:15616
  ds_read_b64_tr_b16 v[238:239], v165 offset:16896
  s_waitcnt lgkmcnt(15)
  v_mfma_f32_32x32x16_bf16 a[0:15], v[200:203], v[88:91], a[0:15]
  v_mfma_f32_32x32x16_bf16 a[16:31], v[204:207], v[88:91], a[16:31]
  s_waitcnt lgkmcnt(14)
  v_mfma_f32_32x32x16_bf16 a[32:47], v[208:211], v[88:91], a[32:47]
  s_waitcnt lgkmcnt(12)
  v_mfma_f32_32x32x16_bf16 a[48:63], v[212:215], v[88:91], a[48:63]
  s_waitcnt lgkmcnt(10)
  v_mfma_f32_32x32x16_bf16 a[64:79], v[216:219], v[88:91], a[64:79]
  s_add_u32 m0, s31, 10240
  s_nop 0
  buffer_load_dwordx4 v160, s[44:47], s30 offen offset:0 lds
  s_add_u32 m0, m0, 1024
  s_nop 0
  buffer_load_dwordx4 v161, s[44:47], s30 offen offset:0 lds
  s_add_u32 m0, m0, 1024
  s_nop 0
  buffer_load_dwordx4 v162, s[44:47], s30 offen offset:0 lds
  s_add_u32 m0, m0, 1024
  s_nop 0
  buffer_load_dwordx4 v163, s[44:47], s30 offen offset:0 lds
  s_add_u32 m0, m0, 1024
  s_nop 0
  buffer_load_dwordx4 v164, s[44:47], s30 offen offset:0 lds
  s_add_u32 s30, s30, 18432
  s_waitcnt vmcnt(30)
  ds_read_b64_tr_b16 v[200:201], v165 offset:20480
  ds_read_b64_tr_b16 v[202:203], v165 offset:21760
  ds_read_b64_tr_b16 v[204:205], v165 offset:20544
  ds_read_b64_tr_b16 v[206:207], v165 offset:21824
  ds_read_b64_tr_b16 v[208:209], v165 offset:20608
  ds_read_b64_tr_b16 v[210:211], v165 offset:21888
  ds_read_b64_tr_b16 v[212:213], v165 offset:20672
  ds_read_b64_tr_b16 v[214:215], v165 offset:21952
  ds_read_b64_tr_b16 v[216:217], v165 offset:20736
  ds_read_b64_tr_b16 v[218:219], v165 offset:22016
  s_waitcnt lgkmcnt(15)
  v_mfma_f32_32x32x16_bf16 a[0:15], v[220:223], v[92:95], a[0:15]
  v_mfma_f32_32x32x16_bf16 a[16:31], v[224:227], v[92:95], a[16:31]
  s_waitcnt lgkmcnt(14)
  v_mfma_f32_32x32x16_bf16 a[32:47], v[228:231], v[92:95], a[32:47]
  s_waitcnt lgkmcnt(12)
  v_mfma_f32_32x32x16_bf16 a[48:63], v[232:235], v[92:95], a[48:63]
  s_waitcnt lgkmcnt(10)
  v_mfma_f32_32x32x16_bf16 a[64:79], v[236:239], v[92:95], a[64:79]
  s_add_u32 m0, s31, 15360
  s_nop 0
  buffer_load_dwordx4 v160, s[44:47], s30 offen offset:0 lds
  s_add_u32 m0, m0, 1024
  s_nop 0
  buffer_load_dwordx4 v161, s[44:47], s30 offen offset:0 lds
  s_add_u32 m0, m0, 1024
  s_nop 0
  buffer_load_dwordx4 v162, s[44:47], s30 offen offset:0 lds
  s_add_u32 m0, m0, 1024
  s_nop 0
  buffer_load_dwordx4 v163, s[44:47], s30 offen offset:0 lds
  s_add_u32 m0, m0, 1024
  s_nop 0
  buffer_load_dwordx4 v164, s[44:47], s30 offen offset:0 lds
  s_add_u32 s30, s30, 18432
  s_waitcnt vmcnt(30)
  ds_read_b64_tr_b16 v[220:221], v165 offset:25600
  ds_read_b64_tr_b16 v[222:223], v165 offset:26880
  ds_read_b64_tr_b16 v[224:225], v165 offset:25664
  ds_read_b64_tr_b16 v[226:227], v165 offset:26944
  ds_read_b64_tr_b16 v[228:229], v165 offset:25728
  ds_read_b64_tr_b16 v[230:231], v165 offset:27008
  ds_read_b64_tr_b16 v[232:233], v165 offset:25792
  ds_read_b64_tr_b16 v[234:235], v165 offset:27072
  ds_read_b64_tr_b16 v[236:237], v165 offset:25856
  ds_read_b64_tr_b16 v[238:239], v165 offset:27136
  s_waitcnt lgkmcnt(15)
  v_mfma_f32_32x32x16_bf16 a[0:15], v[200:203], v[96:99], a[0:15]
  v_mfma_f32_32x32x16_bf16 a[16:31], v[204:207], v[96:99], a[16:31]
  s_waitcnt lgkmcnt(14)
  v_mfma_f32_32x32x16_bf16 a[32:47], v[208:211], v[96:99], a[32:47]
  s_waitcnt lgkmcnt(12)
  v_mfma_f32_32x32x16_bf16 a[48:63], v[212:215], v[96:99], a[48:63]
  s_waitcnt lgkmcnt(10)
  v_mfma_f32_32x32x16_bf16 a[64:79], v[216:219], v[96:99], a[64:79]
  s_add_u32 m0, s31, 20480
  s_nop 0
  buffer_load_dwordx4 v160, s[44:47], s30 offen offset:0 lds
  s_add_u32 m0, m0, 1024
  s_nop 0
  buffer_load_dwordx4 v161, s[44:47], s30 offen offset:0 lds
  s_add_u32 m0, m0, 1024
  s_nop 0
  buffer_load_dwordx4 v162, s[44:47], s30 offen offset:0 lds
  s_add_u32 m0, m0, 1024
  s_nop 0
  buffer_load_dwordx4 v163, s[44:47], s30 offen offset:0 lds
  s_add_u32 m0, m0, 1024
  s_nop 0
  buffer_load_dwordx4 v164, s[44:47], s30 offen offset:0 lds
  s_add_u32 s30, s30, 18432
  s_waitcnt vmcnt(30)
  ds_read_b64_tr_b16 v[200:201], v165 offset:30720
  ds_read_b64_tr_b16 v[202:203], v165 offset:32000
  ds_read_b64_tr_b16 v[204:205], v165 offset:30784
  ds_read_b64_tr_b16 v[206:207], v165 offset:32064
  ds_read_b64_tr_b16 v[208:209], v165 offset:30848
  ds_read_b64_tr_b16 v[210:211], v165 offset:32128
  ds_read_b64_tr_b16 v[212:213], v165 offset:30912
  ds_read_b64_tr_b16 v[214:215], v165 offset:32192
  ds_read_b64_tr_b16 v[216:217], v165 offset:30976
  ds_read_b64_tr_b16 v[218:219], v165 offset:32256
  s_waitcnt lgkmcnt(15)
  v_mfma_f32_32x32x16_bf16 a[0:15], v[220:223], v[100:103], a[0:15]
  v_mfma_f32_32x32x16_bf16 a[16:31], v[224:227], v[100:103], a[16:31]
  s_waitcnt lgkmcnt(14)
  v_mfma_f32_32x32x16_bf16 a[32:47], v[228:231], v[100:103], a[32:47]
  s_waitcnt lgkmcnt(12)
  v_mfma_f32_32x32x16_bf16 a[48:63], v[232:235], v[100:103], a[48:63]
  s_waitcnt lgkmcnt(10)
  v_mfma_f32_32x32x16_bf16 a[64:79], v[236:239], v[100:103], a[64:79]
  s_add_u32 m0, s31, 25600
  s_nop 0
  buffer_load_dwordx4 v160, s[44:47], s30 offen offset:0 lds
  s_add_u32 m0, m0, 1024
  s_nop 0
  buffer_load_dwordx4 v161, s[44:47], s30 offen offset:0 lds
  s_add_u32 m0, m0, 1024
  s_nop 0
  buffer_load_dwordx4 v162, s[44:47], s30 offen offset:0 lds
  s_add_u32 m0, m0, 1024
  s_nop 0
  buffer_load_dwordx4 v163, s[44:47], s30 offen offset:0 lds
  s_add_u32 m0, m0, 1024
  s_nop 0
  buffer_load_dwordx4 v164, s[44:47], s30 offen offset:0 lds
  s_add_u32 s30, s30, 18432
  s_waitcnt vmcnt(30)
  ds_read_b64_tr_b16 v[220:221], v165 offset:35840
  ds_read_b64_tr_b16 v[222:223], v165 offset:37120
  ds_read_b64_tr_b16 v[224:225], v165 offset:35904
  ds_read_b64_tr_b16 v[226:227], v165 offset:37184
  ds_read_b64_tr_b16 v[228:229], v165 offset:35968
  ds_read_b64_tr_b16 v[230:231], v165 offset:37248
  ds_read_b64_tr_b16 v[232:233], v165 offset:36032
  ds_read_b64_tr_b16 v[234:235], v165 offset:37312
  ds_read_b64_tr_b16 v[236:237], v165 offset:36096
  ds_read_b64_tr_b16 v[238:239], v165 offset:37376
  s_waitcnt lgkmcnt(15)
  v_mfma_f32_32x32x16_bf16 a[0:15], v[200:203], v[104:107], a[0:15]
  v_mfma_f32_32x32x16_bf16 a[16:31], v[204:207], v[104:107], a[16:31]
  s_waitcnt lgkmcnt(14)
  v_mfma_f32_32x32x16_bf16 a[32:47], v[208:211], v[104:107], a[32:47]
  s_waitcnt lgkmcnt(12)
  v_mfma_f32_32x32x16_bf16 a[48:63], v[212:215], v[104:107], a[48:63]
  s_waitcnt lgkmcnt(10)
  v_mfma_f32_32x32x16_bf16 a[64:79], v[216:219], v[104:107], a[64:79]
  s_add_u32 m0, s31, 30720
  s_nop 0
  buffer_load_dwordx4 v160, s[44:47], s30 offen offset:0 lds
  s_add_u32 m0, m0, 1024
  s_nop 0
  buffer_load_dwordx4 v161, s[44:47], s30 offen offset:0 lds
  s_add_u32 m0, m0, 1024
  s_nop 0
  buffer_load_dwordx4 v162, s[44:47], s30 offen offset:0 lds
  s_add_u32 m0, m0, 1024
  s_nop 0
  buffer_load_dwordx4 v163, s[44:47], s30 offen offset:0 lds
  s_add_u32 m0, m0, 1024
  s_nop 0
  buffer_load_dwordx4 v164, s[44:47], s30 offen offset:0 lds
  s_add_u32 s30, s30, 18432
  s_waitcnt vmcnt(30)
  ds_read_b64_tr_b16 v[200:201], v165 offset:0
  ds_read_b64_tr_b16 v[202:203], v165 offset:1280
  ds_read_b64_tr_b16 v[204:205], v165 offset:64
  ds_read_b64_tr_b16 v[206:207], v165 offset:1344
  ds_read_b64_tr_b16 v[208:209], v165 offset:128
  ds_read_b64_tr_b16 v[210:211], v165 offset:1408
  ds_read_b64_tr_b16 v[212:213], v165 offset:192
  ds_read_b64_tr_b16 v[214:215], v165 offset:1472
  ds_read_b64_tr_b16 v[216:217], v165 offset:256
  ds_read_b64_tr_b16 v[218:219], v165 offset:1536
  s_waitcnt lgkmcnt(15)
  v_mfma_f32_32x32x16_bf16 a[0:15], v[220:223], v[108:111], a[0:15]
  v_mfma_f32_32x32x16_bf16 a[16:31], v[224:227], v[108:111], a[16:31]
  s_waitcnt lgkmcnt(14)
  v_mfma_f32_32x32x16_bf16 a[32:47], v[228:231], v[108:111], a[32:47]
  s_waitcnt lgkmcnt(12)
  v_mfma_f32_32x32x16_bf16 a[48:63], v[232:235], v[108:111], a[48:63]
  s_waitcnt lgkmcnt(10)
  v_mfma_f32_32x32x16_bf16 a[64:79], v[236:239], v[108:111], a[64:79]
  s_add_u32 m0, s31, 35840
  s_nop 0
  buffer_load_dwordx4 v160, s[44:47], s30 offen offset:0 lds
  s_add_u32 m0, m0, 1024
  s_nop 0
  buffer_load_dwordx4 v161, s[44:47], s30 offen offset:0 lds
  s_add_u32 m0, m0, 1024
  s_nop 0
  buffer_load_dwordx4 v162, s[44:47], s30 offen offset:0 lds
  s_add_u32 m0, m0, 1024
  s_nop 0
  buffer_load_dwordx4 v163, s[44:47], s30 offen offset:0 lds
  s_add_u32 m0, m0, 1024
  s_nop 0
  buffer_load_dwordx4 v164, s[44:47], s30 offen offset:0 lds
  s_add_u32 s30, s30, 18432
  s_waitcnt vmcnt(30)
  ds_read_b64_tr_b16 v[220:221], v165 offset:5120
  ds_read_b64_tr_b16 v[222:223], v165 offset:6400
  ds_read_b64_tr_b16 v[224:225], v165 offset:5184
  ds_read_b64_tr_b16 v[226:227], v165 offset:6464
  ds_read_b64_tr_b16 v[228:229], v165 offset:5248
  ds_read_b64_tr_b16 v[230:231], v165 offset:6528
  ds_read_b64_tr_b16 v[232:233], v165 offset:5312
  ds_read_b64_tr_b16 v[234:235], v165 offset:6592
  ds_read_b64_tr_b16 v[236:237], v165 offset:5376
  ds_read_b64_tr_b16 v[238:239], v165 offset:6656
  s_waitcnt lgkmcnt(15)
  v_mfma_f32_32x32x16_bf16 a[0:15], v[200:203], v[112:115], a[0:15]
  v_mfma_f32_32x32x16_bf16 a[16:31], v[204:207], v[112:115], a[16:31]
  s_waitcnt lgkmcnt(14)
  v_mfma_f32_32x32x16_bf16 a[32:47], v[208:211], v[112:115], a[32:47]
  s_waitcnt lgkmcnt(12)
  v_mfma_f32_32x32x16_bf16 a[48:63], v[212:215], v[112:115], a[48:63]
  s_waitcnt lgkmcnt(10)
  v_mfma_f32_32x32x16_bf16 a[64:79], v[216:219], v[112:115], a[64:79]
  s_add_u32 m0, s31, 0
  s_nop 0
  buffer_load_dwordx4 v160, s[44:47], s30 offen offset:0 lds
  s_add_u32 m0, m0, 1024
  s_nop 0
  buffer_load_dwordx4 v161, s[44:47], s30 offen offset:0 lds
  s_add_u32 m0, m0, 1024
  s_nop 0
  buffer_load_dwordx4 v162, s[44:47], s30 offen offset:0 lds
  s_add_u32 m0, m0, 1024
  s_nop 0
  buffer_load_dwordx4 v163, s[44:47], s30 offen offset:0 lds
  s_add_u32 m0, m0, 1024
  s_nop 0
  buffer_load_dwordx4 v164, s[44:47], s30 offen offset:0 lds
  s_add_u32 s30, s30, 18432
  s_waitcnt vmcnt(30)
  ds_read_b64_tr_b16 v[200:201], v165 offset:10240
  ds_read_b64_tr_b16 v[202:203], v165 offset:11520
  ds_read_b64_tr_b16 v[204:205], v165 offset:10304
  ds_read_b64_tr_b16 v[206:207], v165 offset:11584
  ds_read_b64_tr_b16 v[208:209], v165 offset:10368
  ds_read_b64_tr_b16 v[210:211], v165 offset:11648
  ds_read_b64_tr_b16 v[212:213], v165 offset:10432
  ds_read_b64_tr_b16 v[214:215], v165 offset:11712
  ds_read_b64_tr_b16 v[216:217], v165 offset:10496
  ds_read_b64_tr_b16 v[218:219], v165 offset:11776
  s_waitcnt lgkmcnt(15)
  v_mfma_f32_32x32x16_bf16 a[0:15], v[220:223], v[116:119], a[0:15]
  v_mfma_f32_32x32x16_bf16 a[16:31], v[224:227], v[116:119], a[16:31]
  s_waitcnt lgkmcnt(14)
  v_mfma_f32_32x32x16_bf16 a[32:47], v[228:231], v[116:119], a[32:47]
  s_waitcnt lgkmcnt(12)
  v_mfma_f32_32x32x16_bf16 a[48:63], v[232:235], v[116:119], a[48:63]
  s_waitcnt lgkmcnt(10)
  v_mfma_f32_32x32x16_bf16 a[64:79], v[236:239], v[116:119], a[64:79]
  s_add_u32 m0, s31, 5120
  s_nop 0
  buffer_load_dwordx4 v160, s[44:47], s30 offen offset:0 lds
  s_add_u32 m0, m0, 1024
  s_nop 0
  buffer_load_dwordx4 v161, s[44:47], s30 offen offset:0 lds
  s_add_u32 m0, m0, 1024
  s_nop 0
  buffer_load_dwordx4 v162, s[44:47], s30 offen offset:0 lds
  s_add_u32 m0, m0, 1024
  s_nop 0
  buffer_load_dwordx4 v163, s[44:47], s30 offen offset:0 lds
  s_add_u32 m0, m0, 1024
  s_nop 0
  buffer_load_dwordx4 v164, s[44:47], s30 offen offset:0 lds
  s_add_u32 s30, s30, 18432
  s_waitcnt vmcnt(30)
  ds_read_b64_tr_b16 v[220:221], v165 offset:15360
  ds_read_b64_tr_b16 v[222:223], v165 offset:16640
  ds_read_b64_tr_b16 v[224:225], v165 offset:15424
  ds_read_b64_tr_b16 v[226:227], v165 offset:16704
  ds_read_b64_tr_b16 v[228:229], v165 offset:15488
  ds_read_b64_tr_b16 v[230:231], v165 offset:16768
  ds_read_b64_tr_b16 v[232:233], v165 offset:15552
  ds_read_b64_tr_b16 v[234:235], v165 offset:16832
  ds_read_b64_tr_b16 v[236:237], v165 offset:15616
  ds_read_b64_tr_b16 v[238:239], v165 offset:16896
  s_waitcnt lgkmcnt(15)
  v_mfma_f32_32x32x16_bf16 a[0:15], v[200:203], v[120:123], a[0:15]
  v_mfma_f32_32x32x16_bf16 a[16:31], v[204:207], v[120:123], a[16:31]
  s_waitcnt lgkmcnt(14)
  v_mfma_f32_32x32x16_bf16 a[32:47], v[208:211], v[120:123], a[32:47]
  s_waitcnt lgkmcnt(12)
  v_mfma_f32_32x32x16_bf16 a[48:63], v[212:215], v[120:123], a[48:63]
  s_waitcnt lgkmcnt(10)
  v_mfma_f32_32x32x16_bf16 a[64:79], v[216:219], v[120:123], a[64:79]
  s_add_u32 m0, s31, 10240
  s_nop 0
  buffer_load_dwordx4 v160, s[44:47], s30 offen offset:0 lds
  s_add_u32 m0, m0, 1024
  s_nop 0
  buffer_load_dwordx4 v161, s[44:47], s30 offen offset:0 lds
  s_add_u32 m0, m0, 1024
  s_nop 0
  buffer_load_dwordx4 v162, s[44:47], s30 offen offset:0 lds
  s_add_u32 m0, m0, 1024
  s_nop 0
  buffer_load_dwordx4 v163, s[44:47], s30 offen offset:0 lds
  s_add_u32 m0, m0, 1024
  s_nop 0
  buffer_load_dwordx4 v164, s[44:47], s30 offen offset:0 lds
  s_add_u32 s30, s30, 18432
  s_waitcnt vmcnt(30)
  ds_read_b64_tr_b16 v[200:201], v165 offset:20480
  ds_read_b64_tr_b16 v[202:203], v165 offset:21760
  ds_read_b64_tr_b16 v[204:205], v165 offset:20544
  ds_read_b64_tr_b16 v[206:207], v165 offset:21824
  ds_read_b64_tr_b16 v[208:209], v165 offset:20608
  ds_read_b64_tr_b16 v[210:211], v165 offset:21888
  ds_read_b64_tr_b16 v[212:213], v165 offset:20672
  ds_read_b64_tr_b16 v[214:215], v165 offset:21952
  ds_read_b64_tr_b16 v[216:217], v165 offset:20736
  ds_read_b64_tr_b16 v[218:219], v165 offset:22016
  s_waitcnt lgkmcnt(15)
  v_mfma_f32_32x32x16_bf16 a[0:15], v[220:223], v[124:127], a[0:15]
  v_mfma_f32_32x32x16_bf16 a[16:31], v[224:227], v[124:127], a[16:31]
  s_waitcnt lgkmcnt(14)
  v_mfma_f32_32x32x16_bf16 a[32:47], v[228:231], v[124:127], a[32:47]
  s_waitcnt lgkmcnt(12)
  v_mfma_f32_32x32x16_bf16 a[48:63], v[232:235], v[124:127], a[48:63]
  s_waitcnt lgkmcnt(10)
  v_mfma_f32_32x32x16_bf16 a[64:79], v[236:239], v[124:127], a[64:79]
  s_add_u32 m0, s31, 15360
  s_nop 0
  buffer_load_dwordx4 v160, s[44:47], s30 offen offset:0 lds
  s_add_u32 m0, m0, 1024
  s_nop 0
  buffer_load_dwordx4 v161, s[44:47], s30 offen offset:0 lds
  s_add_u32 m0, m0, 1024
  s_nop 0
  buffer_load_dwordx4 v162, s[44:47], s30 offen offset:0 lds
  s_add_u32 m0, m0, 1024
  s_nop 0
  buffer_load_dwordx4 v163, s[44:47], s30 offen offset:0 lds
  s_add_u32 m0, m0, 1024
  s_nop 0
  buffer_load_dwordx4 v164, s[44:47], s30 offen offset:0 lds
  s_add_u32 s30, s30, 18432
  s_waitcnt vmcnt(30)
  ds_read_b64_tr_b16 v[220:221], v165 offset:25600
  ds_read_b64_tr_b16 v[222:223], v165 offset:26880
  ds_read_b64_tr_b16 v[224:225], v165 offset:25664
  ds_read_b64_tr_b16 v[226:227], v165 offset:26944
  ds_read_b64_tr_b16 v[228:229], v165 offset:25728
  ds_read_b64_tr_b16 v[230:231], v165 offset:27008
  ds_read_b64_tr_b16 v[232:233], v165 offset:25792
  ds_read_b64_tr_b16 v[234:235], v165 offset:27072
  ds_read_b64_tr_b16 v[236:237], v165 offset:25856
  ds_read_b64_tr_b16 v[238:239], v165 offset:27136
  s_waitcnt lgkmcnt(15)
  v_mfma_f32_32x32x16_bf16 a[0:15], v[200:203], v[128:131], a[0:15]
  v_mfma_f32_32x32x16_bf16 a[16:31], v[204:207], v[128:131], a[16:31]
  s_waitcnt lgkmcnt(14)
  v_mfma_f32_32x32x16_bf16 a[32:47], v[208:211], v[128:131], a[32:47]
  s_waitcnt lgkmcnt(12)
  v_mfma_f32_32x32x16_bf16 a[48:63], v[212:215], v[128:131], a[48:63]
  s_waitcnt lgkmcnt(10)
  v_mfma_f32_32x32x16_bf16 a[64:79], v[216:219], v[128:131], a[64:79]
  s_waitcnt vmcnt(25)
  ds_read_b64_tr_b16 v[200:201], v165 offset:30720
  ds_read_b64_tr_b16 v[202:203], v165 offset:32000
  ds_read_b64_tr_b16 v[204:205], v165 offset:30784
  ds_read_b64_tr_b16 v[206:207], v165 offset:32064
  ds_read_b64_tr_b16 v[208:209], v165 offset:30848
  ds_read_b64_tr_b16 v[210:211], v165 offset:32128
  ds_read_b64_tr_b16 v[212:213], v165 offset:30912
  ds_read_b64_tr_b16 v[214:215], v165 offset:32192
  ds_read_b64_tr_b16 v[216:217], v165 offset:30976
  ds_read_b64_tr_b16 v[218:219], v165 offset:32256
  s_waitcnt lgkmcnt(15)
  v_mfma_f32_32x32x16_bf16 a[0:15], v[220:223], v[132:135], a[0:15]
  v_mfma_f32_32x32x16_bf16 a[16:31], v[224:227], v[132:135], a[16:31]
  s_waitcnt lgkmcnt(14)
  v_mfma_f32_32x32x16_bf16 a[32:47], v[228:231], v[132:135], a[32:47]
  s_waitcnt lgkmcnt(12)
  v_mfma_f32_32x32x16_bf16 a[48:63], v[232:235], v[132:135], a[48:63]
  s_waitcnt lgkmcnt(10)
  v_mfma_f32_32x32x16_bf16 a[64:79], v[236:239], v[132:135], a[64:79]
  s_waitcnt vmcnt(20)
  ds_read_b64_tr_b16 v[220:221], v165 offset:35840
  ds_read_b64_tr_b16 v[222:223], v165 offset:37120
  ds_read_b64_tr_b16 v[224:225], v165 offset:35904
  ds_read_b64_tr_b16 v[226:227], v165 offset:37184
  ds_read_b64_tr_b16 v[228:229], v165 offset:35968
  ds_read_b64_tr_b16 v[230:231], v165 offset:37248
  ds_read_b64_tr_b16 v[232:233], v165 offset:36032
  ds_read_b64_tr_b16 v[234:235], v165 offset:37312
  ds_read_b64_tr_b16 v[236:237], v165 offset:36096
  ds_read_b64_tr_b16 v[238:239], v165 offset:37376
  s_waitcnt lgkmcnt(15)
  v_mfma_f32_32x32x16_bf16 a[0:15], v[200:203], v[136:139], a[0:15]
  v_mfma_f32_32x32x16_bf16 a[16:31], v[204:207], v[136:139], a[16:31]
  s_waitcnt lgkmcnt(14)
  v_mfma_f32_32x32x16_bf16 a[32:47], v[208:211], v[136:139], a[32:47]
  s_waitcnt lgkmcnt(12)
  v_mfma_f32_32x32x16_bf16 a[48:63], v[212:215], v[136:139], a[48:63]
  s_waitcnt lgkmcnt(10)
  v_mfma_f32_32x32x16_bf16 a[64:79], v[216:219], v[136:139], a[64:79]
  s_waitcnt vmcnt(15)
  ds_read_b64_tr_b16 v[200:201], v165 offset:0
  ds_read_b64_tr_b16 v[202:203], v165 offset:1280
  ds_read_b64_tr_b16 v[204:205], v165 offset:64
  ds_read_b64_tr_b16 v[206:207], v165 offset:1344
  ds_read_b64_tr_b16 v[208:209], v165 offset:128
  ds_read_b64_tr_b16 v[210:211], v165 offset:1408
  ds_read_b64_tr_b16 v[212:213], v165 offset:192
  ds_read_b64_tr_b16 v[214:215], v165 offset:1472
  ds_read_b64_tr_b16 v[216:217], v165 offset:256
  ds_read_b64_tr_b16 v[218:219], v165 offset:1536
  s_waitcnt lgkmcnt(15)
  v_mfma_f32_32x32x16_bf16 a[0:15], v[220:223], v[140:143], a[0:15]
  v_mfma_f32_32x32x16_bf16 a[16:31], v[224:227], v[140:143], a[16:31]
  s_waitcnt lgkmcnt(14)
  v_mfma_f32_32x32x16_bf16 a[32:47], v[228:231], v[140:143], a[32:47]
  s_waitcnt lgkmcnt(12)
  v_mfma_f32_32x32x16_bf16 a[48:63], v[232:235], v[140:143], a[48:63]
  s_waitcnt lgkmcnt(10)
  v_mfma_f32_32x32x16_bf16 a[64:79], v[236:239], v[140:143], a[64:79]
  s_waitcnt vmcnt(10)
  ds_read_b64_tr_b16 v[220:221], v165 offset:5120
  ds_read_b64_tr_b16 v[222:223], v165 offset:6400
  ds_read_b64_tr_b16 v[224:225], v165 offset:5184
  ds_read_b64_tr_b16 v[226:227], v165 offset:6464
  ds_read_b64_tr_b16 v[228:229], v165 offset:5248
  ds_read_b64_tr_b16 v[230:231], v165 offset:6528
  ds_read_b64_tr_b16 v[232:233], v165 offset:5312
  ds_read_b64_tr_b16 v[234:235], v165 offset:6592
  ds_read_b64_tr_b16 v[236:237], v165 offset:5376
  ds_read_b64_tr_b16 v[238:239], v165 offset:6656
  s_waitcnt lgkmcnt(15)
  v_mfma_f32_32x32x16_bf16 a[0:15], v[200:203], v[144:147], a[0:15]
  v_mfma_f32_32x32x16_bf16 a[16:31], v[204:207], v[144:147], a[16:31]
  s_waitcnt lgkmcnt(14)
  v_mfma_f32_32x32x16_bf16 a[32:47], v[208:211], v[144:147], a[32:47]
  s_waitcnt lgkmcnt(12)
  v_mfma_f32_32x32x16_bf16 a[48:63], v[212:215], v[144:147], a[48:63]
  s_waitcnt lgkmcnt(10)
  v_mfma_f32_32x32x16_bf16 a[64:79], v[216:219], v[144:147], a[64:79]
  s_waitcnt vmcnt(5)
  ds_read_b64_tr_b16 v[200:201], v165 offset:10240
  ds_read_b64_tr_b16 v[202:203], v165 offset:11520
  ds_read_b64_tr_b16 v[204:205], v165 offset:10304
  ds_read_b64_tr_b16 v[206:207], v165 offset:11584
  ds_read_b64_tr_b16 v[208:209], v165 offset:10368
  ds_read_b64_tr_b16 v[210:211], v165 offset:11648
  ds_read_b64_tr_b16 v[212:213], v165 offset:10432
  ds_read_b64_tr_b16 v[214:215], v165 offset:11712
  ds_read_b64_tr_b16 v[216:217], v165 offset:10496
  ds_read_b64_tr_b16 v[218:219], v165 offset:11776
  s_waitcnt lgkmcnt(15)
  v_mfma_f32_32x32x16_bf16 a[0:15], v[220:223], v[148:151], a[0:15]
  v_mfma_f32_32x32x16_bf16 a[16:31], v[224:227], v[148:151], a[16:31]
  s_waitcnt lgkmcnt(14)
  v_mfma_f32_32x32x16_bf16 a[32:47], v[228:231], v[148:151], a[32:47]
  s_waitcnt lgkmcnt(12)
  v_mfma_f32_32x32x16_bf16 a[48:63], v[232:235], v[148:151], a[48:63]
  s_waitcnt lgkmcnt(10)
  v_mfma_f32_32x32x16_bf16 a[64:79], v[236:239], v[148:151], a[64:79]
  s_waitcnt vmcnt(0)
  ds_read_b64_tr_b16 v[220:221], v165 offset:15360
  ds_read_b64_tr_b16 v[222:223], v165 offset:16640
  ds_read_b64_tr_b16 v[224:225], v165 offset:15424
  ds_read_b64_tr_b16 v[226:227], v165 offset:16704
  ds_read_b64_tr_b16 v[228:229], v165 offset:15488
  ds_read_b64_tr_b16 v[230:231], v165 offset:16768
  ds_read_b64_tr_b16 v[232:233], v165 offset:15552
  ds_read_b64_tr_b16 v[234:235], v165 offset:16832
  ds_read_b64_tr_b16 v[236:237], v165 offset:15616
  ds_read_b64_tr_b16 v[238:239], v165 offset:16896
  s_waitcnt lgkmcnt(15)
  v_mfma_f32_32x32x16_bf16 a[0:15], v[200:203], v[152:155], a[0:15]
  v_mfma_f32_32x32x16_bf16 a[16:31], v[204:207], v[152:155], a[16:31]
  s_waitcnt lgkmcnt(14)
  v_mfma_f32_32x32x16_bf16 a[32:47], v[208:211], v[152:155], a[32:47]
  s_waitcnt lgkmcnt(12)
  v_mfma_f32_32x32x16_bf16 a[48:63], v[212:215], v[152:155], a[48:63]
  s_waitcnt lgkmcnt(10)
  v_mfma_f32_32x32x16_bf16 a[64:79], v[216:219], v[152:155], a[64:79]
  s_waitcnt lgkmcnt(8)
  v_mfma_f32_32x32x16_bf16 a[0:15], v[220:223], v[156:159], a[0:15]
  s_waitcnt lgkmcnt(6)
  v_mfma_f32_32x32x16_bf16 a[16:31], v[224:227], v[156:159], a[16:31]
  s_waitcnt lgkmcnt(4)
  v_mfma_f32_32x32x16_bf16 a[32:47], v[228:231], v[156:159], a[32:47]
  s_waitcnt lgkmcnt(2)
  v_mfma_f32_32x32x16_bf16 a[48:63], v[232:235], v[156:159], a[48:63]
  s_waitcnt lgkmcnt(0)
  v_mfma_f32_32x32x16_bf16 a[64:79], v[236:239], v[156:159], a[64:79]
  v_mul_u32_u24 v9, 2304, v3
  v_lshl_add_u32 v9, v4, 3, v9
  v_add_u32 v9, s32, v9
  s_mul_i32 s36, s12, 73728
  v_accvgpr_read_b32 v168, a0
  v_accvgpr_read_b32 v169, a1
  v_accvgpr_read_b32 v170, a2
  v_accvgpr_read_b32 v171, a3
  v_accvgpr_read_b32 v172, a4
  v_accvgpr_read_b32 v173, a5
  v_accvgpr_read_b32 v174, a6
  v_accvgpr_read_b32 v175, a7
  v_accvgpr_read_b32 v176, a8
  v_accvgpr_read_b32 v177, a9
  v_accvgpr_read_b32 v178, a10
  v_accvgpr_read_b32 v179, a11
  v_accvgpr_read_b32 v180, a12
  v_accvgpr_read_b32 v181, a13
  v_accvgpr_read_b32 v182, a14
  v_accvgpr_read_b32 v183, a15
  v_cvt_pk_bf16_f32 v184, v168, v169
  v_cvt_pk_bf16_f32 v185, v170, v171
  buffer_store_dwordx2 v[184:185], v9, s[48:51], s36 offen offset:0
  v_cvt_pk_bf16_f32 v186, v172, v173
  v_cvt_pk_bf16_f32 v187, v174, v175
  buffer_store_dwordx2 v[186:187], v9, s[48:51], s36 offen offset:16
  v_cvt_pk_bf16_f32 v188, v176, v177
  v_cvt_pk_bf16_f32 v189, v178, v179
  buffer_store_dwordx2 v[188:189], v9, s[48:51], s36 offen offset:32
  v_cvt_pk_bf16_f32 v190, v180, v181
  v_cvt_pk_bf16_f32 v191, v182, v183
  buffer_store_dwordx2 v[190:191], v9, s[48:51], s36 offen offset:48
  v_accvgpr_read_b32 v168, a16
  v_accvgpr_read_b32 v169, a17
  v_accvgpr_read_b32 v170, a18
  v_accvgpr_read_b32 v171, a19
  v_accvgpr_read_b32 v172, a20
  v_accvgpr_read_b32 v173, a21
  v_accvgpr_read_b32 v174, a22
  v_accvgpr_read_b32 v175, a23
  v_accvgpr_read_b32 v176, a24
  v_accvgpr_read_b32 v177, a25
  v_accvgpr_read_b32 v178, a26
  v_accvgpr_read_b32 v179, a27
  v_accvgpr_read_b32 v180, a28
  v_accvgpr_read_b32 v181, a29
  v_accvgpr_read_b32 v182, a30
  v_accvgpr_read_b32 v183, a31
  v_cvt_pk_bf16_f32 v184, v168, v169
  v_cvt_pk_bf16_f32 v185, v170, v171
  buffer_store_dwordx2 v[184:185], v9, s[48:51], s36 offen offset:64
  v_cvt_pk_bf16_f32 v186, v172, v173
  v_cvt_pk_bf16_f32 v187, v174, v175
  buffer_store_dwordx2 v[186:187], v9, s[48:51], s36 offen offset:80
  v_cvt_pk_bf16_f32 v188, v176, v177
  v_cvt_pk_bf16_f32 v189, v178, v179
  buffer_store_dwordx2 v[188:189], v9, s[48:51], s36 offen offset:96
  v_cvt_pk_bf16_f32 v190, v180, v181
  v_cvt_pk_bf16_f32 v191, v182, v183
  buffer_store_dwordx2 v[190:191], v9, s[48:51], s36 offen offset:112
  v_accvgpr_read_b32 v168, a32
  v_accvgpr_read_b32 v169, a33
  v_accvgpr_read_b32 v170, a34
  v_accvgpr_read_b32 v171, a35
  v_accvgpr_read_b32 v172, a36
  v_accvgpr_read_b32 v173, a37
  v_accvgpr_read_b32 v174, a38
  v_accvgpr_read_b32 v175, a39
  v_accvgpr_read_b32 v176, a40
  v_accvgpr_read_b32 v177, a41
  v_accvgpr_read_b32 v178, a42
  v_accvgpr_read_b32 v179, a43
  v_accvgpr_read_b32 v180, a44
  v_accvgpr_read_b32 v181, a45
  v_accvgpr_read_b32 v182, a46
  v_accvgpr_read_b32 v183, a47
  v_cvt_pk_bf16_f32 v184, v168, v169
  v_cvt_pk_bf16_f32 v185, v170, v171
  buffer_store_dwordx2 v[184:185], v9, s[48:51], s36 offen offset:128
  v_cvt_pk_bf16_f32 v186, v172, v173
  v_cvt_pk_bf16_f32 v187, v174, v175
  buffer_store_dwordx2 v[186:187], v9, s[48:51], s36 offen offset:144
  v_cvt_pk_bf16_f32 v188, v176, v177
  v_cvt_pk_bf16_f32 v189, v178, v179
  buffer_store_dwordx2 v[188:189], v9, s[48:51], s36 offen offset:160
  v_cvt_pk_bf16_f32 v190, v180, v181
  v_cvt_pk_bf16_f32 v191, v182, v183
  buffer_store_dwordx2 v[190:191], v9, s[48:51], s36 offen offset:176
  v_accvgpr_read_b32 v168, a48
  v_accvgpr_read_b32 v169, a49
  v_accvgpr_read_b32 v170, a50
  v_accvgpr_read_b32 v171, a51
  v_accvgpr_read_b32 v172, a52
  v_accvgpr_read_b32 v173, a53
  v_accvgpr_read_b32 v174, a54
  v_accvgpr_read_b32 v175, a55
  v_accvgpr_read_b32 v176, a56
  v_accvgpr_read_b32 v177, a57
  v_accvgpr_read_b32 v178, a58
  v_accvgpr_read_b32 v179, a59
  v_accvgpr_read_b32 v180, a60
  v_accvgpr_read_b32 v181, a61
  v_accvgpr_read_b32 v182, a62
  v_accvgpr_read_b32 v183, a63
  v_cvt_pk_bf16_f32 v184, v168, v169
  v_cvt_pk_bf16_f32 v185, v170, v171
  buffer_store_dwordx2 v[184:185], v9, s[48:51], s36 offen offset:192
  v_cvt_pk_bf16_f32 v186, v172, v173
  v_cvt_pk_bf16_f32 v187, v174, v175
  buffer_store_dwordx2 v[186:187], v9, s[48:51], s36 offen offset:208
  v_cvt_pk_bf16_f32 v188, v176, v177
  v_cvt_pk_bf16_f32 v189, v178, v179
  buffer_store_dwordx2 v[188:189], v9, s[48:51], s36 offen offset:224
  v_cvt_pk_bf16_f32 v190, v180, v181
  v_cvt_pk_bf16_f32 v191, v182, v183
  buffer_store_dwordx2 v[190:191], v9, s[48:51], s36 offen offset:240
  v_accvgpr_read_b32 v168, a64
  v_accvgpr_read_b32 v169, a65
  v_accvgpr_read_b32 v170, a66
  v_accvgpr_read_b32 v171, a67
  v_accvgpr_read_b32 v172, a68
  v_accvgpr_read_b32 v173, a69
  v_accvgpr_read_b32 v174, a70
  v_accvgpr_read_b32 v175, a71
  v_accvgpr_read_b32 v176, a72
  v_accvgpr_read_b32 v177, a73
  v_accvgpr_read_b32 v178, a74
  v_accvgpr_read_b32 v179, a75
  v_accvgpr_read_b32 v180, a76
  v_accvgpr_read_b32 v181, a77
  v_accvgpr_read_b32 v182, a78
  v_accvgpr_read_b32 v183, a79
  v_cvt_pk_bf16_f32 v184, v168, v169
  v_cvt_pk_bf16_f32 v185, v170, v171
  buffer_store_dwordx2 v[184:185], v9, s[48:51], s36 offen offset:256
  v_cvt_pk_bf16_f32 v186, v172, v173
  v_cvt_pk_bf16_f32 v187, v174, v175
  buffer_store_dwordx2 v[186:187], v9, s[48:51], s36 offen offset:272
  v_cvt_pk_bf16_f32 v188, v176, v177
  v_cvt_pk_bf16_f32 v189, v178, v179
  buffer_store_dwordx2 v[188:189], v9, s[48:51], s36 offen offset:288
  v_cvt_pk_bf16_f32 v190, v180, v181
  v_cvt_pk_bf16_f32 v191, v182, v183
  buffer_store_dwordx2 v[190:191], v9, s[48:51], s36 offen offset:304
  s_branch L_end
L_blk_C:
  s_load_dwordx2 s[4:5], s[0:1], 112
  s_load_dwordx2 s[56:57], s[0:1], 56
  s_load_dwordx2 s[58:59], s[0:1], 64
  s_load_dwordx2 s[60:61], s[0:1], 72
  s_load_dwordx2 s[62:63], s[0:1], 80
  s_load_dwordx2 s[64:65], s[0:1], 48
  s_load_dwordx2 s[66:67], s[0:1], 104
  v_and_b32 v32, 63, v0
  v_and_b32 v33, 15, v32
  v_lshrrev_b32 v34, 4, v32
  v_lshlrev_b32 v0, 4, v32
  v_and_b32 v35, 7, v33
  v_lshrrev_b32 v36, 3, v33
  v_and_b32 v37, 1, v34
  v_lshrrev_b32 v38, 1, v34
  v_lshrrev_b32 v39, 2, v33
  v_and_b32 v40, 3, v33
  v_mov_b32 v41, 0x4444
  v_mov_b32 v42, 0xeeee
  v_cmp_eq_u32 s[46:47], 1, v36
  s_nop 1
  v_cndmask_b32 v1, v41, v42, s[46:47]
  s_mul_i32 s36, s13, 36864
  s_add_u32 s36, s36, 15424
  s_waitcnt vmcnt(0)
  v_add_u32 v4, s36, v0
  s_lshl_b32 s37, s13, 10
  v_add_u32 v5, s37, v0
  v_lshlrev_b32 v41, 7, v34
  v_lshl_add_u32 v41, v35, 4, v41
  v_bfe_u32 v7, v0, 2, 7
  s_lshl_b32 s37, s13, 9
  v_add_u32 v6, s37, v41
  s_lshl_b32 s52, s13, 2
  s_lshl_b32 s48, s13, 10
  s_cmp_eq_u32 s13, 2
  s_cselect_b32 s48, 6144, s48
  s_cmp_eq_u32 s13, 3
  s_cselect_b32 s48, 4096, s48
  s_lshr_b32 s37, s48, 1
  v_add_u32 v8, s37, v0
  v_lshrrev_b32 v41, 3, v32
  v_lshlrev_b32 v41, 12, v41
  v_lshl_add_u32 v41, v35, 4, v41
  s_lshl_b32 s37, s13, 16
  s_lshl_b32 s38, s12, 7
  s_add_u32 s37, s37, s38
  v_add_u32 v9, s37, v41
  v_lshlrev_b32 v41, 12, v36
  v_lshl_add_u32 v41, v35, 4, v41
  v_lshl_add_u32 v41, v37, 3, v41
  s_lshl_b32 s37, s13, 13
  s_add_u32 s37, s37, s38
  s_add_u32 s37, s37, 262144
  v_add_u32 v10, s37, v41
  s_lshr_b32 s15, s12, 3
  s_lshl_b32 s15, s15, 4
  s_and_b32 s37, s12, 7
  s_add_u32 s15, s15, s37
  s_lshl_b32 s37, s13, 3
  s_add_u32 s15, s15, s37
  s_add_u32 s37, s12, 64
  s_cmp_eq_u32 s13, 2
  s_cselect_b32 s15, s37, s15
  s_cmp_eq_u32 s13, 3
  s_cselect_b32 s15, 72, s15
  v_lshlrev_b32 v41, 4, v35
  v_lshl_add_u32 v41, v37, 3, v41
  v_lshl_add_u32 v41, v38, 2, v41
  s_lshl_b32 s37, s15, 7
  v_add_u32 v11, s37, v41
  s_lshr_b32 s37, s12, 2
  s_add_u32 s37, s37, 64
  s_lshl_b32 s37, s37, 7
  s_and_b32 s38, s12, 3
  s_lshl_b32 s38, s38, 2
  s_add_u32 s37, s37, s38
  v_lshlrev_b32 v41, 4, v35
  v_add_u32 v41, s37, v41
  s_cmp_eq_u32 s13, 2
  s_cselect_b64 vcc, -1, 0
  v_cndmask_b32 v11, v11, v41, vcc
  s_lshl_b32 s37, s13, 11
  v_lshlrev_b32 v41, 9, v34
  v_add_u32 v41, s37, v41
  v_lshl_add_u32 v42, v33, 4, v41
  v_mov_b32 v12, v42
  s_lshl_b32 s37, s13, 10
  v_add_u32 v13, s37, v0
  v_mov_b32 v41, 0x3f80
  v_mov_b32 v42, 0x3f800000
  v_and_b32 v43, 1, v33
  v_cmp_eq_u32 vcc, 0, v43
  s_nop 1
  v_cndmask_b32 v14, v42, v41, vcc
  v_lshrrev_b32 v43, 1, v35
  v_cmp_eq_u32 s[28:29], 0, v43
  v_cmp_eq_u32 s[30:31], 1, v43
  v_cmp_eq_u32 s[32:33], 2, v43
  v_cmp_eq_u32 s[34:35], 3, v43
  v_mov_b32 v15, 14336
  v_lshlrev_b32 v41, 1, v37
  v_cmp_eq_u32 vcc, v41, v43
  s_nop 1
  v_cndmask_b32 v2, 0, v14, vcc
  v_add_u32 v41, 1, v41
  v_cmp_eq_u32 vcc, v41, v43
  s_nop 1
  v_cndmask_b32 v3, 0, v14, vcc
  v_lshlrev_b32 v41, 1, v37
  v_xor_b32 v41, v41, v33
  v_lshlrev_b32 v41, 4, v41
  v_lshl_add_u32 v41, v34, 13, v41
  s_lshl_b32 s37, s12, 8
  v_add_u32 v16, s37, v41
  v_xor_b32 v28, 64, v16
  v_xor_b32 v29, 128, v16
  v_xor_b32 v30, 192, v16
  v_lshrrev_b32 v42, 1, v39
  v_and_b32 v43, 1, v39
  v_lshlrev_b32 v41, 2, v37
  v_lshl_add_u32 v41, v42, 3, v41
  v_add_u32 v41, v41, v43
  v_lshlrev_b32 v41, 8, v41
  v_lshl_add_u32 v41, v40, 3, v41
  v_lshl_add_u32 v17, v37, 1, v43
  v_lshl_add_u32 v17, v42, 2, v17
  s_lshl_b32 s37, s13, 1
  v_xor_b32 v17, s37, v17
  v_lshl_add_u32 v41, v17, 5, v41
  v_xor_b32 v23, 32, v41
  v_mul_u32_u24 v22, 36864, v38
  v_add_u32 v22, 15424, v22
  v_add_u32 v17, v41, v22
  v_add_u32 v23, v23, v22
  v_add_u32 v22, 73728, v17
  v_add_u32 v31, 73728, v23
  v_lshlrev_b32 v41, 4, v37
  v_lshl_add_u32 v41, v38, 2, v41
  v_add_u32 v41, v41, v43
  v_mul_u32_u24 v41, 288, v41
  v_lshl_add_u32 v41, v42, 6, v41
  v_lshl_add_u32 v41, v40, 3, v41
  v_add_u32 v18, s36, v41
  v_lshl_add_u32 v41, v34, 2, v39
  v_mul_u32_u24 v41, 288, v41
  v_lshl_add_u32 v41, v40, 3, v41
  v_add_u32 v41, 256, v41
  v_add_u32 v19, s36, v41
  v_add_u32 v41, 0, v32
  v_mul_u32_u24 v42, 3641, v41
  v_lshrrev_b32 v42, 16, v42
  v_mul_u32_u24 v43, 18, v42
  v_sub_u32 v43, v41, v43
  v_mul_u32_u24 v42, 1152, v42
  v_lshl_add_u32 v71, v43, 4, v42
  v_add_u32 v41, 64, v32
  v_mul_u32_u24 v42, 3641, v41
  v_lshrrev_b32 v42, 16, v42
  v_mul_u32_u24 v43, 18, v42
  v_sub_u32 v43, v41, v43
  v_mul_u32_u24 v42, 1152, v42
  v_lshl_add_u32 v72, v43, 4, v42
  v_add_u32 v41, 128, v32
  v_mul_u32_u24 v42, 3641, v41
  v_lshrrev_b32 v42, 16, v42
  v_mul_u32_u24 v43, 18, v42
  v_sub_u32 v43, v41, v43
  v_mul_u32_u24 v42, 1152, v42
  v_lshl_add_u32 v73, v43, 4, v42
  v_add_u32 v41, 192, v32
  v_mul_u32_u24 v42, 3641, v41
  v_lshrrev_b32 v42, 16, v42
  v_mul_u32_u24 v43, 18, v42
  v_sub_u32 v43, v41, v43
  v_mul_u32_u24 v42, 1152, v42
  v_lshl_add_u32 v74, v43, 4, v42
  v_add_u32 v41, 256, v32
  v_mul_u32_u24 v42, 3641, v41
  v_lshrrev_b32 v42, 16, v42
  v_mul_u32_u24 v43, 18, v42
  v_sub_u32 v43, v41, v43
  v_mul_u32_u24 v42, 1152, v42
  v_lshl_add_u32 v75, v43, 4, v42
  v_add_u32 v41, 320, v32
  v_mul_u32_u24 v42, 3641, v41
  v_lshrrev_b32 v42, 16, v42
  v_mul_u32_u24 v43, 18, v42
  v_sub_u32 v43, v41, v43
  v_mul_u32_u24 v42, 1152, v42
  v_lshl_add_u32 v76, v43, 4, v42
  v_add_u32 v41, 384, v32
  v_mul_u32_u24 v42, 3641, v41
  v_lshrrev_b32 v42, 16, v42
  v_mul_u32_u24 v43, 18, v42
  v_sub_u32 v43, v41, v43
  v_mul_u32_u24 v42, 1152, v42
  v_lshl_add_u32 v77, v43, 4, v42
  v_add_u32 v41, 448, v32
  v_mul_u32_u24 v42, 3641, v41
  v_lshrrev_b32 v42, 16, v42
  v_mul_u32_u24 v43, 18, v42
  v_sub_u32 v43, v41, v43
  v_mul_u32_u24 v42, 1152, v42
  v_lshl_add_u32 v78, v43, 4, v42
  v_add_u32 v41, 512, v32
  v_mul_u32_u24 v42, 3641, v41
  v_lshrrev_b32 v42, 16, v42
  v_mul_u32_u24 v43, 18, v42
  v_sub_u32 v43, v41, v43
  v_mul_u32_u24 v42, 1152, v42
  v_lshl_add_u32 v79, v43, 4, v42
  v_mul_u32_u24 v41, 1152, v35
  v_lshl_add_u32 v41, v36, 4, v41
  v_lshl_add_u32 v20, v34, 5, v41
  v_mul_u32_u24 v42, 288, v34
  v_add_u32 v21, v41, v42
  s_waitcnt lgkmcnt(0)
  s_mov_b32 s6, 268435456
  s_mov_b32 s7, 0x20000
  s_mov_b32 s10, 4718592
  s_mov_b32 s11, 0x20000
  s_mov_b32 s68, s36
  s_lshl_b32 s17, s15, 12
  s_cmp_lt_u32 s15, 72
  s_cselect_b32 s17, s17, 268435456
  s_cmp_lt_u32 s13, 3
  s_cselect_b32 s45, 0, 268435456
  v_mov_b32 v44, 0
  v_mov_b32 v45, 0
  v_mov_b32 v46, 0
  v_mov_b32 v47, 0
  v_mov_b32 v48, 0x3f803f80
  v_mov_b32 v49, 0x3f803f80
  v_mov_b32 v50, 0x3f803f80
  v_mov_b32 v51, 0x3f803f80
  v_mov_b32 v52, 0x3f003f00
  v_mov_b32 v53, 0x3f003f00
  v_mov_b32 v54, -1
  ds_write_b128 v15, v[44:47]
  ds_write_b128 v15, v[48:51] offset:16
  ds_write_b64 v15, v[52:53] offset:32
  v_cndmask_b32 v44, 0, v14, s[28:29]
  v_cndmask_b32 v45, 0, v14, s[30:31]
  v_cndmask_b32 v46, 0, v14, s[32:33]
  v_cndmask_b32 v47, 0, v14, s[34:35]
  ds_write_b128 v0, v[44:47] offset:14400
  v_and_b32 v14, 3, v32
  v_lshlrev_b32 v14, 8, v14
  s_mul_i32 s16, s13, 131072
  s_mul_i32 s18, s13, 1179648
  s_mov_b32 s8, s56
  s_mov_b32 s9, s57
  s_add_u32 m0, s68, 0
  s_add_u32 s37, s16, 0
  buffer_load_dwordx4 v16, s[8:11], s37 offen offset:0 lds
  s_add_u32 s37, s16, 31744
  buffer_load_dwordx4 v28, s[8:11], s37 offen offset:1024 lds
  s_add_u32 s37, s16, 63488
  buffer_load_dwordx4 v29, s[8:11], s37 offen offset:2048 lds
  s_add_u32 s37, s16, 95232
  buffer_load_dwordx4 v30, s[8:11], s37 offen offset:3072 lds
  s_mov_b32 s8, s58
  s_mov_b32 s9, s59
  s_add_u32 m0, s68, 4096
  s_add_u32 s37, s16, 0
  buffer_load_dwordx4 v16, s[8:11], s37 offen offset:0 lds
  s_add_u32 s37, s16, 31744
  buffer_load_dwordx4 v28, s[8:11], s37 offen offset:1024 lds
  s_add_u32 s37, s16, 63488
  buffer_load_dwordx4 v29, s[8:11], s37 offen offset:2048 lds
  s_add_u32 s37, s16, 95232
  buffer_load_dwordx4 v30, s[8:11], s37 offen offset:3072 lds
  s_mov_b32 s8, s56
  s_mov_b32 s9, s57
  s_add_u32 m0, s68, 8192
  s_add_u32 s37, s16, 524288
  buffer_load_dwordx4 v16, s[8:11], s37 offen offset:0 lds
  s_add_u32 s37, s16, 556032
  buffer_load_dwordx4 v28, s[8:11], s37 offen offset:1024 lds
  s_add_u32 s37, s16, 587776
  buffer_load_dwordx4 v29, s[8:11], s37 offen offset:2048 lds
  s_add_u32 s37, s16, 619520
  buffer_load_dwordx4 v30, s[8:11], s37 offen offset:3072 lds
  s_mov_b32 s8, s62
  s_mov_b32 s9, s63
  s_xor_b32 s37, s13, 0
  s_lshl_b32 s37, s37, 5
  s_lshl_b32 s38, s12, 7
  s_add_u32 s37, s37, s38
  s_mul_i32 s37, s37, 1152
  s_mul_i32 s38, s13, 288
  s_add_u32 s37, s37, s38
  s_add_u32 m0, s68, 12288
  s_nop 0
  buffer_load_dwordx4 v71, s[8:11], s37 offen  lds
  s_add_u32 m0, s68, 13312
  s_nop 0
  buffer_load_dwordx4 v72, s[8:11], s37 offen  lds
  s_add_u32 m0, s68, 14336
  s_nop 0
  buffer_load_dwordx4 v73, s[8:11], s37 offen  lds
  s_add_u32 m0, s68, 15360
  s_nop 0
  buffer_load_dwordx4 v74, s[8:11], s37 offen  lds
  s_add_u32 m0, s68, 16384
  s_nop 0
  buffer_load_dwordx4 v75, s[8:11], s37 offen  lds
  s_add_u32 m0, s68, 17408
  s_nop 0
  buffer_load_dwordx4 v76, s[8:11], s37 offen  lds
  s_add_u32 m0, s68, 18432
  s_nop 0
  buffer_load_dwordx4 v77, s[8:11], s37 offen  lds
  s_add_u32 m0, s68, 19456
  s_nop 0
  buffer_load_dwordx4 v78, s[8:11], s37 offen  lds
  s_add_u32 m0, s68, 20480
  s_nop 0
  buffer_load_dwordx4 v79, s[8:11], s37 offen  lds
  s_mov_b32 s8, s58
  s_mov_b32 s9, s59
  s_add_u32 m0, s68, 24576
  s_add_u32 s37, s16, 524288
  buffer_load_dwordx4 v16, s[8:11], s37 offen offset:0 lds
  s_add_u32 s37, s16, 556032
  buffer_load_dwordx4 v28, s[8:11], s37 offen offset:1024 lds
  s_add_u32 s37, s16, 587776
  buffer_load_dwordx4 v29, s[8:11], s37 offen offset:2048 lds
  s_add_u32 s37, s16, 619520
  buffer_load_dwordx4 v30, s[8:11], s37 offen offset:3072 lds
  s_mov_b32 s8, s56
  s_mov_b32 s9, s57
  s_add_u32 m0, s68, 28672
  s_add_u32 s37, s16, 1179648
  buffer_load_dwordx4 v16, s[8:11], s37 offen offset:0 lds
  s_add_u32 s37, s16, 1211392
  buffer_load_dwordx4 v28, s[8:11], s37 offen offset:1024 lds
  s_add_u32 s37, s16, 1243136
  buffer_load_dwordx4 v29, s[8:11], s37 offen offset:2048 lds
  s_add_u32 s37, s16, 1274880
  buffer_load_dwordx4 v30, s[8:11], s37 offen offset:3072 lds
  s_mov_b32 s8, s58
  s_mov_b32 s9, s59
  s_add_u32 m0, s68, 32768
  s_add_u32 s37, s16, 1179648
  buffer_load_dwordx4 v16, s[8:11], s37 offen offset:0 lds
  s_add_u32 s37, s16, 1211392
  buffer_load_dwordx4 v28, s[8:11], s37 offen offset:1024 lds
  s_add_u32 s37, s16, 1243136
  buffer_load_dwordx4 v29, s[8:11], s37 offen offset:2048 lds
  s_add_u32 s37, s16, 1274880
  buffer_load_dwordx4 v30, s[8:11], s37 offen offset:3072 lds
  s_waitcnt vmcnt(29) lgkmcnt(0)
  s_barrier
  ds_read_b64_tr_b16 v[32:33], v17 offset:0
  ds_read_b64_tr_b16 v[34:35], v17 offset:512
  ds_read_b64_tr_b16 v[36:37], v22 offset:0
  ds_read_b64_tr_b16 v[38:39], v22 offset:512
  ds_read_b64_tr_b16 v[80:81], v23 offset:0
  ds_read_b64_tr_b16 v[82:83], v23 offset:512
  ds_read_b64_tr_b16 v[84:85], v31 offset:0
  ds_read_b64_tr_b16 v[86:87], v31 offset:512
  s_waitcnt vmcnt(25) lgkmcnt(0)
  s_barrier
  s_mov_b32 s8, s56
  s_mov_b32 s9, s57
  s_add_u32 m0, s68, 0
  s_add_u32 s37, s16, 1703936
  buffer_load_dwordx4 v16, s[8:11], s37 offen offset:0 lds
  s_add_u32 s37, s16, 1735680
  buffer_load_dwordx4 v28, s[8:11], s37 offen offset:1024 lds
  s_add_u32 s37, s16, 1767424
  buffer_load_dwordx4 v29, s[8:11], s37 offen offset:2048 lds
  s_add_u32 s37, s16, 1799168
  buffer_load_dwordx4 v30, s[8:11], s37 offen offset:3072 lds
  ds_read_b64_tr_b16 v[88:89], v17 offset:4096
  ds_read_b64_tr_b16 v[90:91], v17 offset:4608
  ds_read_b64_tr_b16 v[92:93], v22 offset:4096
  ds_read_b64_tr_b16 v[94:95], v22 offset:4608
  ds_read_b64_tr_b16 v[96:97], v23 offset:4096
  ds_read_b64_tr_b16 v[98:99], v23 offset:4608
  ds_read_b64_tr_b16 v[100:101], v31 offset:4096
  ds_read_b64_tr_b16 v[102:103], v31 offset:4608
  s_waitcnt vmcnt(25) lgkmcnt(0)
  s_barrier
  s_mov_b32 s8, s58
  s_mov_b32 s9, s59
  s_add_u32 m0, s68, 4096
  s_add_u32 s37, s16, 1703936
  buffer_load_dwordx4 v16, s[8:11], s37 offen offset:0 lds
  s_add_u32 s37, s16, 1735680
  buffer_load_dwordx4 v28, s[8:11], s37 offen offset:1024 lds
  s_add_u32 s37, s16, 1767424
  buffer_load_dwordx4 v29, s[8:11], s37 offen offset:2048 lds
  s_add_u32 s37, s16, 1799168
  buffer_load_dwordx4 v30, s[8:11], s37 offen offset:3072 lds
  ds_read_b64_tr_b16 v[40:41], v17 offset:8192
  ds_read_b64_tr_b16 v[42:43], v17 offset:8704
  ds_read_b64_tr_b16 v[44:45], v22 offset:8192
  ds_read_b64_tr_b16 v[46:47], v22 offset:8704
  ds_read_b64_tr_b16 v[200:201], v23 offset:8192
  ds_read_b64_tr_b16 v[202:203], v23 offset:8704
  ds_read_b64_tr_b16 v[204:205], v31 offset:8192
  ds_read_b64_tr_b16 v[206:207], v31 offset:8704
  s_waitcnt vmcnt(20) lgkmcnt(0)
  s_barrier
  s_mov_b32 s8, s56
  s_mov_b32 s9, s57
  s_add_u32 m0, s68, 8192
  s_add_u32 s37, s16, 2359296
  buffer_load_dwordx4 v16, s[8:11], s37 offen offset:0 lds
  s_add_u32 s37, s16, 2391040
  buffer_load_dwordx4 v28, s[8:11], s37 offen offset:1024 lds
  s_add_u32 s37, s16, 2422784
  buffer_load_dwordx4 v29, s[8:11], s37 offen offset:2048 lds
  s_add_u32 s37, s16, 2454528
  buffer_load_dwordx4 v30, s[8:11], s37 offen offset:3072 lds
  ds_read_b64_tr_b16 a[176:177], v18 offset:12288
  ds_read_b64_tr_b16 a[178:179], v18 offset:12864
  ds_read_b64_tr_b16 a[180:181], v18 offset:14592
  ds_read_b64_tr_b16 a[182:183], v18 offset:15168
  ds_read_b64_tr_b16 a[184:185], v18 offset:12320
  ds_read_b64_tr_b16 a[186:187], v18 offset:12896
  ds_read_b64_tr_b16 a[188:189], v18 offset:14624
  ds_read_b64_tr_b16 a[190:191], v18 offset:15200
  ds_read_b64_tr_b16 a[48:49], v18 offset:12416
  ds_read_b64_tr_b16 a[50:51], v18 offset:12992
  ds_read_b64_tr_b16 a[52:53], v18 offset:14720
  ds_read_b64_tr_b16 a[54:55], v18 offset:15296
  ds_read_b64_tr_b16 a[56:57], v18 offset:12448
  ds_read_b64_tr_b16 a[58:59], v18 offset:13024
  ds_read_b64_tr_b16 a[60:61], v18 offset:14752
  ds_read_b64_tr_b16 a[62:63], v18 offset:15328
  ds_read_b64_tr_b16 a[240:241], v19 offset:12288
  ds_read_b64_tr_b16 a[242:243], v19 offset:16896
  s_waitcnt vmcnt(20) lgkmcnt(0)
  s_barrier
  s_mov_b32 s8, s62
  s_mov_b32 s9, s63
  s_xor_b32 s37, s13, 1
  s_lshl_b32 s37, s37, 5
  s_lshl_b32 s38, s12, 7
  s_add_u32 s37, s37, s38
  s_mul_i32 s37, s37, 1152
  s_mul_i32 s38, s13, 288
  s_add_u32 s37, s37, s38
  s_add_u32 m0, s68, 12288
  s_nop 0
  buffer_load_dwordx4 v71, s[8:11], s37 offen  lds
  s_add_u32 m0, s68, 13312
  s_nop 0
  buffer_load_dwordx4 v72, s[8:11], s37 offen  lds
  s_add_u32 m0, s68, 14336
  s_nop 0
  buffer_load_dwordx4 v73, s[8:11], s37 offen  lds
  s_add_u32 m0, s68, 15360
  s_nop 0
  buffer_load_dwordx4 v74, s[8:11], s37 offen  lds
  s_add_u32 m0, s68, 16384
  s_nop 0
  buffer_load_dwordx4 v75, s[8:11], s37 offen  lds
  s_add_u32 m0, s68, 17408
  s_nop 0
  buffer_load_dwordx4 v76, s[8:11], s37 offen  lds
  s_add_u32 m0, s68, 18432
  s_nop 0
  buffer_load_dwordx4 v77, s[8:11], s37 offen  lds
  s_add_u32 m0, s68, 19456
  s_nop 0
  buffer_load_dwordx4 v78, s[8:11], s37 offen  lds
  s_add_u32 m0, s68, 20480
  s_nop 0
  buffer_load_dwordx4 v79, s[8:11], s37 offen  lds
  ds_read_b64_tr_b16 a[64:65], v17 offset:24576
  ds_read_b64_tr_b16 a[66:67], v17 offset:25088
  ds_read_b64_tr_b16 a[68:69], v22 offset:24576
  ds_read_b64_tr_b16 a[70:71], v22 offset:25088
  ds_read_b64_tr_b16 v[208:209], v23 offset:24576
  ds_read_b64_tr_b16 v[210:211], v23 offset:25088
  ds_read_b64_tr_b16 v[212:213], v31 offset:24576
  ds_read_b64_tr_b16 v[214:215], v31 offset:25088
  s_waitcnt vmcnt(25) lgkmcnt(0)
  s_barrier
  s_mov_b32 s8, s58
  s_mov_b32 s9, s59
  s_add_u32 m0, s68, 24576
  s_add_u32 s37, s16, 2359296
  buffer_load_dwordx4 v16, s[8:11], s37 offen offset:0 lds
  s_add_u32 s37, s16, 2391040
  buffer_load_dwordx4 v28, s[8:11], s37 offen offset:1024 lds
  s_add_u32 s37, s16, 2422784
  buffer_load_dwordx4 v29, s[8:11], s37 offen offset:2048 lds
  s_add_u32 s37, s16, 2454528
  buffer_load_dwordx4 v30, s[8:11], s37 offen offset:3072 lds
  ds_read_b64_tr_b16 a[72:73], v17 offset:28672
  ds_read_b64_tr_b16 a[74:75], v17 offset:29184
  ds_read_b64_tr_b16 a[76:77], v22 offset:28672
  ds_read_b64_tr_b16 a[78:79], v22 offset:29184
  ds_read_b64_tr_b16 v[104:105], v23 offset:28672
  ds_read_b64_tr_b16 v[106:107], v23 offset:29184
  ds_read_b64_tr_b16 v[108:109], v31 offset:28672
  ds_read_b64_tr_b16 v[110:111], v31 offset:29184
  s_waitcnt vmcnt(25) lgkmcnt(0)
  s_barrier
  s_mov_b32 s8, s56
  s_mov_b32 s9, s57
  s_add_u32 m0, s68, 28672
  s_add_u32 s37, s16, 2883584
  buffer_load_dwordx4 v16, s[8:11], s37 offen offset:0 lds
  s_add_u32 s37, s16, 2915328
  buffer_load_dwordx4 v28, s[8:11], s37 offen offset:1024 lds
  s_add_u32 s37, s16, 2947072
  buffer_load_dwordx4 v29, s[8:11], s37 offen offset:2048 lds
  s_add_u32 s37, s16, 2978816
  buffer_load_dwordx4 v30, s[8:11], s37 offen offset:3072 lds
  ds_read_b64_tr_b16 v[112:113], v17 offset:32768
  ds_read_b64_tr_b16 v[114:115], v17 offset:33280
  ds_read_b64_tr_b16 v[116:117], v22 offset:32768
  ds_read_b64_tr_b16 v[118:119], v22 offset:33280
  ds_read_b64_tr_b16 v[120:121], v23 offset:32768
  ds_read_b64_tr_b16 v[122:123], v23 offset:33280
  ds_read_b64_tr_b16 v[124:125], v31 offset:32768
  ds_read_b64_tr_b16 v[126:127], v31 offset:33280
  s_waitcnt vmcnt(25) lgkmcnt(0)
  s_barrier
  s_mov_b32 s8, s58
  s_mov_b32 s9, s59
  s_add_u32 m0, s68, 32768
  s_add_u32 s37, s16, 2883584
  buffer_load_dwordx4 v16, s[8:11], s37 offen offset:0 lds
  s_add_u32 s37, s16, 2915328
  buffer_load_dwordx4 v28, s[8:11], s37 offen offset:1024 lds
  s_add_u32 s37, s16, 2947072
  buffer_load_dwordx4 v29, s[8:11], s37 offen offset:2048 lds
  s_add_u32 s37, s16, 2978816
  buffer_load_dwordx4 v30, s[8:11], s37 offen offset:3072 lds
  ds_read_b64_tr_b16 v[216:217], v17 offset:0
  ds_read_b64_tr_b16 v[218:219], v17 offset:512
  ds_read_b64_tr_b16 v[220:221], v22 offset:0
  ds_read_b64_tr_b16 v[222:223], v22 offset:512
  ds_read_b64_tr_b16 v[224:225], v23 offset:0
  ds_read_b64_tr_b16 v[226:227], v23 offset:512
  ds_read_b64_tr_b16 v[228:229], v31 offset:0
  ds_read_b64_tr_b16 v[230:231], v31 offset:512
  s_waitcnt vmcnt(25) lgkmcnt(0)
  s_barrier
  ds_read_b64_tr_b16 a[80:81], v17 offset:4096
  ds_read_b64_tr_b16 a[82:83], v17 offset:4608
  ds_read_b64_tr_b16 a[84:85], v22 offset:4096
  ds_read_b64_tr_b16 a[86:87], v22 offset:4608
  ds_read_b64_tr_b16 v[232:233], v23 offset:4096
  ds_read_b64_tr_b16 v[234:235], v23 offset:4608
  ds_read_b64_tr_b16 v[236:237], v31 offset:4096
  ds_read_b64_tr_b16 v[238:239], v31 offset:4608
  s_waitcnt vmcnt(21) lgkmcnt(0)
  s_barrier
  ds_read_b64_tr_b16 a[88:89], v17 offset:8192
  ds_read_b64_tr_b16 a[90:91], v17 offset:8704
  ds_read_b64_tr_b16 a[92:93], v22 offset:8192
  ds_read_b64_tr_b16 a[94:95], v22 offset:8704
  ds_read_b64_tr_b16 v[128:129], v23 offset:8192
  ds_read_b64_tr_b16 v[130:131], v23 offset:8704
  ds_read_b64_tr_b16 v[132:133], v31 offset:8192
  ds_read_b64_tr_b16 v[134:135], v31 offset:8704
  v_mov_b32 v60, 0
  global_load_dword v61, v60, s[66:67] offset:192 sc1
  s_waitcnt vmcnt(12) lgkmcnt(0)
  s_barrier
  s_mov_b32 s8, s62
  s_mov_b32 s9, s63
  s_xor_b32 s37, s13, 2
  s_lshl_b32 s37, s37, 5
  s_lshl_b32 s38, s12, 7
  s_add_u32 s37, s37, s38
  s_mul_i32 s37, s37, 1152
  s_mul_i32 s38, s13, 288
  s_add_u32 s37, s37, s38
  s_add_u32 m0, s68, 0
  s_nop 0
  buffer_load_dwordx4 v71, s[8:11], s37 offen  lds
  s_add_u32 m0, s68, 1024
  s_nop 0
  buffer_load_dwordx4 v72, s[8:11], s37 offen  lds
  s_add_u32 m0, s68, 2048
  s_nop 0
  buffer_load_dwordx4 v73, s[8:11], s37 offen  lds
  s_add_u32 m0, s68, 3072
  s_nop 0
  buffer_load_dwordx4 v74, s[8:11], s37 offen  lds
  s_add_u32 m0, s68, 4096
  s_nop 0
  buffer_load_dwordx4 v75, s[8:11], s37 offen  lds
  s_add_u32 m0, s68, 5120
  s_nop 0
  buffer_load_dwordx4 v76, s[8:11], s37 offen  lds
  s_add_u32 m0, s68, 6144
  s_nop 0
  buffer_load_dwordx4 v77, s[8:11], s37 offen  lds
  s_add_u32 m0, s68, 7168
  s_nop 0
  buffer_load_dwordx4 v78, s[8:11], s37 offen  lds
  s_add_u32 m0, s68, 8192
  s_nop 0
  buffer_load_dwordx4 v79, s[8:11], s37 offen  lds
  ds_read_b64_tr_b16 a[192:193], v18 offset:12288
  ds_read_b64_tr_b16 a[194:195], v18 offset:12864
  ds_read_b64_tr_b16 a[196:197], v18 offset:14592
  ds_read_b64_tr_b16 a[198:199], v18 offset:15168
  ds_read_b64_tr_b16 a[200:201], v18 offset:12320
  ds_read_b64_tr_b16 a[202:203], v18 offset:12896
  ds_read_b64_tr_b16 a[204:205], v18 offset:14624
  ds_read_b64_tr_b16 a[206:207], v18 offset:15200
  ds_read_b64_tr_b16 a[96:97], v18 offset:12416
  ds_read_b64_tr_b16 a[98:99], v18 offset:12992
  ds_read_b64_tr_b16 a[100:101], v18 offset:14720
  ds_read_b64_tr_b16 a[102:103], v18 offset:15296
  ds_read_b64_tr_b16 a[104:105], v18 offset:12448
  ds_read_b64_tr_b16 a[106:107], v18 offset:13024
  ds_read_b64_tr_b16 a[108:109], v18 offset:14752
  ds_read_b64_tr_b16 a[110:111], v18 offset:15328
  ds_read_b64_tr_b16 a[244:245], v19 offset:12288
  ds_read_b64_tr_b16 a[246:247], v19 offset:16896
  s_waitcnt vmcnt(17) lgkmcnt(0)
  s_barrier
  s_mov_b32 s8, s56
  s_mov_b32 s9, s57
  s_add_u32 m0, s68, 12288
  s_add_u32 s37, s16, 3538944
  buffer_load_dwordx4 v16, s[8:11], s37 offen offset:0 lds
  s_add_u32 s37, s16, 3570688
  buffer_load_dwordx4 v28, s[8:11], s37 offen offset:1024 lds
  s_add_u32 s37, s16, 3602432
  buffer_load_dwordx4 v29, s[8:11], s37 offen offset:2048 lds
  s_add_u32 s37, s16, 3634176
  buffer_load_dwordx4 v30, s[8:11], s37 offen offset:3072 lds
  s_mov_b32 s8, s58
  s_mov_b32 s9, s59
  s_add_u32 m0, s68, 16384
  s_add_u32 s37, s16, 3538944
  buffer_load_dwordx4 v16, s[8:11], s37 offen offset:0 lds
  s_add_u32 s37, s16, 3570688
  buffer_load_dwordx4 v28, s[8:11], s37 offen offset:1024 lds
  s_add_u32 s37, s16, 3602432
  buffer_load_dwordx4 v29, s[8:11], s37 offen offset:2048 lds
  s_add_u32 s37, s16, 3634176
  buffer_load_dwordx4 v30, s[8:11], s37 offen offset:3072 lds
  s_mov_b32 s8, s56
  s_mov_b32 s9, s57
  s_add_u32 m0, s68, 20480
  s_add_u32 s37, s16, 4063232
  buffer_load_dwordx4 v16, s[8:11], s37 offen offset:0 lds
  s_add_u32 s37, s16, 4094976
  buffer_load_dwordx4 v28, s[8:11], s37 offen offset:1024 lds
  s_add_u32 s37, s16, 4126720
  buffer_load_dwordx4 v29, s[8:11], s37 offen offset:2048 lds
  s_add_u32 s37, s16, 4158464
  buffer_load_dwordx4 v30, s[8:11], s37 offen offset:3072 lds
  ds_read_b64_tr_b16 v[136:137], v17 offset:24576
  ds_read_b64_tr_b16 v[138:139], v17 offset:25088
  ds_read_b64_tr_b16 v[140:141], v22 offset:24576
  ds_read_b64_tr_b16 v[142:143], v22 offset:25088
  ds_read_b64_tr_b16 v[144:145], v23 offset:24576
  ds_read_b64_tr_b16 v[146:147], v23 offset:25088
  ds_read_b64_tr_b16 v[148:149], v31 offset:24576
  ds_read_b64_tr_b16 v[150:151], v31 offset:25088
  s_waitcnt vmcnt(25) lgkmcnt(0)
  s_barrier
  ds_read_b64_tr_b16 a[112:113], v17 offset:28672
  ds_read_b64_tr_b16 a[114:115], v17 offset:29184
  ds_read_b64_tr_b16 a[116:117], v22 offset:28672
  ds_read_b64_tr_b16 a[118:119], v22 offset:29184
  ds_read_b64_tr_b16 v[240:241], v23 offset:28672
  ds_read_b64_tr_b16 v[242:243], v23 offset:29184
  ds_read_b64_tr_b16 v[244:245], v31 offset:28672
  ds_read_b64_tr_b16 v[246:247], v31 offset:29184
  s_waitcnt vmcnt(21) lgkmcnt(0)
  s_barrier
  ds_read_b64_tr_b16 v[248:249], v17 offset:32768
  ds_read_b64_tr_b16 v[250:251], v17 offset:33280
  ds_read_b64_tr_b16 v[252:253], v22 offset:32768
  ds_read_b64_tr_b16 v[254:255], v22 offset:33280
  ds_read_b64_tr_b16 a[0:1], v23 offset:32768
  ds_read_b64_tr_b16 a[2:3], v23 offset:33280
  ds_read_b64_tr_b16 a[4:5], v31 offset:32768
  ds_read_b64_tr_b16 a[6:7], v31 offset:33280
  s_waitcnt vmcnt(12) lgkmcnt(0)
  s_barrier
  s_mov_b32 s8, s62
  s_mov_b32 s9, s63
  s_xor_b32 s37, s13, 3
  s_lshl_b32 s37, s37, 5
  s_lshl_b32 s38, s12, 7
  s_add_u32 s37, s37, s38
  s_mul_i32 s37, s37, 1152
  s_mul_i32 s38, s13, 288
  s_add_u32 s37, s37, s38
  s_add_u32 m0, s68, 24576
  s_nop 0
  buffer_load_dwordx4 v71, s[8:11], s37 offen  lds
  s_add_u32 m0, s68, 25600
  s_nop 0
  buffer_load_dwordx4 v72, s[8:11], s37 offen  lds
  s_add_u32 m0, s68, 26624
  s_nop 0
  buffer_load_dwordx4 v73, s[8:11], s37 offen  lds
  s_add_u32 m0, s68, 27648
  s_nop 0
  buffer_load_dwordx4 v74, s[8:11], s37 offen  lds
  s_add_u32 m0, s68, 28672
  s_nop 0
  buffer_load_dwordx4 v75, s[8:11], s37 offen  lds
  s_add_u32 m0, s68, 29696
  s_nop 0
  buffer_load_dwordx4 v76, s[8:11], s37 offen  lds
  s_add_u32 m0, s68, 30720
  s_nop 0
  buffer_load_dwordx4 v77, s[8:11], s37 offen  lds
  s_add_u32 m0, s68, 31744
  s_nop 0
  buffer_load_dwordx4 v78, s[8:11], s37 offen  lds
  s_add_u32 m0, s68, 32768
  s_nop 0
  buffer_load_dwordx4 v79, s[8:11], s37 offen  lds
  ds_read_b64_tr_b16 a[120:121], v18 offset:0
  ds_read_b64_tr_b16 a[122:123], v18 offset:576
  ds_read_b64_tr_b16 a[124:125], v18 offset:2304
  ds_read_b64_tr_b16 a[126:127], v18 offset:2880
  ds_read_b64_tr_b16 a[208:209], v18 offset:32
  ds_read_b64_tr_b16 a[210:211], v18 offset:608
  ds_read_b64_tr_b16 a[212:213], v18 offset:2336
  ds_read_b64_tr_b16 a[214:215], v18 offset:2912
  ds_read_b64_tr_b16 a[216:217], v18 offset:128
  ds_read_b64_tr_b16 a[218:219], v18 offset:704
  ds_read_b64_tr_b16 a[220:221], v18 offset:2432
  ds_read_b64_tr_b16 a[222:223], v18 offset:3008
  ds_read_b64_tr_b16 a[224:225], v18 offset:160
  ds_read_b64_tr_b16 a[226:227], v18 offset:736
  ds_read_b64_tr_b16 a[228:229], v18 offset:2464
  ds_read_b64_tr_b16 a[230:231], v18 offset:3040
  ds_read_b64_tr_b16 a[248:249], v19 offset:0
  ds_read_b64_tr_b16 a[250:251], v19 offset:4608
  s_waitcnt vmcnt(17) lgkmcnt(0)
  s_barrier
  s_mov_b32 s8, s58
  s_mov_b32 s9, s59
  s_add_u32 m0, s68, 0
  s_add_u32 s37, s16, 4063232
  buffer_load_dwordx4 v16, s[8:11], s37 offen offset:0 lds
  s_add_u32 s37, s16, 4094976
  buffer_load_dwordx4 v28, s[8:11], s37 offen offset:1024 lds
  s_add_u32 s37, s16, 4126720
  buffer_load_dwordx4 v29, s[8:11], s37 offen offset:2048 lds
  s_add_u32 s37, s16, 4158464
  buffer_load_dwordx4 v30, s[8:11], s37 offen offset:3072 lds
  s_mov_b32 s8, s56
  s_mov_b32 s9, s57
  s_add_u32 m0, s68, 4096
  s_add_u32 s37, s18, 1048576
  buffer_load_dwordx4 v16, s[8:11], s37 offen offset:0 lds
  s_add_u32 s37, s18, 1080320
  buffer_load_dwordx4 v28, s[8:11], s37 offen offset:1024 lds
  s_add_u32 s37, s18, 1112064
  buffer_load_dwordx4 v29, s[8:11], s37 offen offset:2048 lds
  s_add_u32 s37, s18, 1143808
  buffer_load_dwordx4 v30, s[8:11], s37 offen offset:3072 lds
  s_mov_b32 s8, s58
  s_mov_b32 s9, s59
  s_add_u32 m0, s68, 8192
  s_add_u32 s37, s18, 1048576
  buffer_load_dwordx4 v16, s[8:11], s37 offen offset:0 lds
  s_add_u32 s37, s18, 1080320
  buffer_load_dwordx4 v28, s[8:11], s37 offen offset:1024 lds
  s_add_u32 s37, s18, 1112064
  buffer_load_dwordx4 v29, s[8:11], s37 offen offset:2048 lds
  s_add_u32 s37, s18, 1143808
  buffer_load_dwordx4 v30, s[8:11], s37 offen offset:3072 lds
  ds_read_b64_tr_b16 a[128:129], v17 offset:12288
  ds_read_b64_tr_b16 a[130:131], v17 offset:12800
  ds_read_b64_tr_b16 a[132:133], v22 offset:12288
  ds_read_b64_tr_b16 a[134:135], v22 offset:12800
  ds_read_b64_tr_b16 v[152:153], v23 offset:12288
  ds_read_b64_tr_b16 v[154:155], v23 offset:12800
  ds_read_b64_tr_b16 v[156:157], v31 offset:12288
  ds_read_b64_tr_b16 v[158:159], v31 offset:12800
  s_waitcnt vmcnt(25) lgkmcnt(0)
  s_barrier
  s_mov_b32 s8, s60
  s_mov_b32 s9, s61
  s_add_u32 m0, s68, 12288
  s_add_u32 s37, s16, 0
  buffer_load_dwordx4 v16, s[8:11], s37 offen offset:0 lds
  s_add_u32 s37, s16, 31744
  buffer_load_dwordx4 v28, s[8:11], s37 offen offset:1024 lds
  s_add_u32 s37, s16, 63488
  buffer_load_dwordx4 v29, s[8:11], s37 offen offset:2048 lds
  s_add_u32 s37, s16, 95232
  buffer_load_dwordx4 v30, s[8:11], s37 offen offset:3072 lds
  ds_read_b64_tr_b16 v[160:161], v17 offset:16384
  ds_read_b64_tr_b16 v[162:163], v17 offset:16896
  ds_read_b64_tr_b16 v[164:165], v22 offset:16384
  ds_read_b64_tr_b16 v[166:167], v22 offset:16896
  ds_read_b64_tr_b16 v[168:169], v23 offset:16384
  ds_read_b64_tr_b16 v[170:171], v23 offset:16896
  ds_read_b64_tr_b16 v[172:173], v31 offset:16384
  ds_read_b64_tr_b16 v[174:175], v31 offset:16896
  s_waitcnt vmcnt(25) lgkmcnt(0)
  s_barrier
  s_add_u32 m0, s68, 16384
  s_add_u32 s37, s16, 524288
  buffer_load_dwordx4 v16, s[8:11], s37 offen offset:0 lds
  s_add_u32 s37, s16, 556032
  buffer_load_dwordx4 v28, s[8:11], s37 offen offset:1024 lds
  s_add_u32 s37, s16, 587776
  buffer_load_dwordx4 v29, s[8:11], s37 offen offset:2048 lds
  s_add_u32 s37, s16, 619520
  buffer_load_dwordx4 v30, s[8:11], s37 offen offset:3072 lds
  ds_read_b64_tr_b16 a[136:137], v17 offset:20480
  ds_read_b64_tr_b16 a[138:139], v17 offset:20992
  ds_read_b64_tr_b16 a[140:141], v22 offset:20480
  ds_read_b64_tr_b16 a[142:143], v22 offset:20992
  ds_read_b64_tr_b16 a[8:9], v23 offset:20480
  ds_read_b64_tr_b16 a[10:11], v23 offset:20992
  ds_read_b64_tr_b16 a[12:13], v31 offset:20480
  ds_read_b64_tr_b16 a[14:15], v31 offset:20992
  s_waitcnt vmcnt(20) lgkmcnt(0)
  s_barrier
  s_add_u32 m0, s68, 20480
  s_add_u32 s37, s16, 1179648
  buffer_load_dwordx4 v16, s[8:11], s37 offen offset:0 lds
  s_add_u32 s37, s16, 1211392
  buffer_load_dwordx4 v28, s[8:11], s37 offen offset:1024 lds
  s_add_u32 s37, s16, 1243136
  buffer_load_dwordx4 v29, s[8:11], s37 offen offset:2048 lds
  s_add_u32 s37, s16, 1274880
  buffer_load_dwordx4 v30, s[8:11], s37 offen offset:3072 lds
  ds_read_b64_tr_b16 a[144:145], v18 offset:24576
  ds_read_b64_tr_b16 a[146:147], v18 offset:25152
  ds_read_b64_tr_b16 a[148:149], v18 offset:26880
  ds_read_b64_tr_b16 a[150:151], v18 offset:27456
  ds_read_b64_tr_b16 a[152:153], v18 offset:24608
  ds_read_b64_tr_b16 a[154:155], v18 offset:25184
  ds_read_b64_tr_b16 a[156:157], v18 offset:26912
  ds_read_b64_tr_b16 a[158:159], v18 offset:27488
  ds_read_b64_tr_b16 a[232:233], v18 offset:24704
  ds_read_b64_tr_b16 a[234:235], v18 offset:25280
  ds_read_b64_tr_b16 a[236:237], v18 offset:27008
  ds_read_b64_tr_b16 a[238:239], v18 offset:27584
  ds_read_b64_tr_b16 a[160:161], v18 offset:24736
  ds_read_b64_tr_b16 a[162:163], v18 offset:25312
  ds_read_b64_tr_b16 a[164:165], v18 offset:27040
  ds_read_b64_tr_b16 a[166:167], v18 offset:27616
  ds_read_b64_tr_b16 a[252:253], v19 offset:24576
  ds_read_b64_tr_b16 a[254:255], v19 offset:29184
  s_waitcnt vmcnt(20) lgkmcnt(0)
  s_barrier
  s_add_u32 m0, s68, 24576
  s_add_u32 s37, s16, 1703936
  buffer_load_dwordx4 v16, s[8:11], s37 offen offset:0 lds
  s_add_u32 s37, s16, 1735680
  buffer_load_dwordx4 v28, s[8:11], s37 offen offset:1024 lds
  s_add_u32 s37, s16, 1767424
  buffer_load_dwordx4 v29, s[8:11], s37 offen offset:2048 lds
  s_add_u32 s37, s16, 1799168
  buffer_load_dwordx4 v30, s[8:11], s37 offen offset:3072 lds
  s_add_u32 m0, s68, 28672
  s_add_u32 s37, s16, 2359296
  buffer_load_dwordx4 v16, s[8:11], s37 offen offset:0 lds
  s_add_u32 s37, s16, 2391040
  buffer_load_dwordx4 v28, s[8:11], s37 offen offset:1024 lds
  s_add_u32 s37, s16, 2422784
  buffer_load_dwordx4 v29, s[8:11], s37 offen offset:2048 lds
  s_add_u32 s37, s16, 2454528
  buffer_load_dwordx4 v30, s[8:11], s37 offen offset:3072 lds
  s_add_u32 m0, s68, 32768
  s_add_u32 s37, s16, 2883584
  buffer_load_dwordx4 v16, s[8:11], s37 offen offset:0 lds
  s_add_u32 s37, s16, 2915328
  buffer_load_dwordx4 v28, s[8:11], s37 offen offset:1024 lds
  s_add_u32 s37, s16, 2947072
  buffer_load_dwordx4 v29, s[8:11], s37 offen offset:2048 lds
  s_add_u32 s37, s16, 2978816
  buffer_load_dwordx4 v30, s[8:11], s37 offen offset:3072 lds
  ds_read_b64_tr_b16 a[16:17], v17 offset:0
  ds_read_b64_tr_b16 a[18:19], v17 offset:512
  ds_read_b64_tr_b16 a[20:21], v22 offset:0
  ds_read_b64_tr_b16 a[22:23], v22 offset:512
  ds_read_b64_tr_b16 a[24:25], v23 offset:0
  ds_read_b64_tr_b16 a[26:27], v23 offset:512
  ds_read_b64_tr_b16 a[28:29], v31 offset:0
  ds_read_b64_tr_b16 a[30:31], v31 offset:512
  s_waitcnt vmcnt(28) lgkmcnt(0)
  s_barrier
  s_add_u32 m0, s68, 0
  s_add_u32 s37, s16, 3538944
  buffer_load_dwordx4 v16, s[8:11], s37 offen offset:0 lds
  s_add_u32 s37, s16, 3570688
  buffer_load_dwordx4 v28, s[8:11], s37 offen offset:1024 lds
  s_add_u32 s37, s16, 3602432
  buffer_load_dwordx4 v29, s[8:11], s37 offen offset:2048 lds
  s_add_u32 s37, s16, 3634176
  buffer_load_dwordx4 v30, s[8:11], s37 offen offset:3072 lds
  ds_read_b64_tr_b16 a[168:169], v17 offset:4096
  ds_read_b64_tr_b16 a[170:171], v17 offset:4608
  ds_read_b64_tr_b16 a[172:173], v22 offset:4096
  ds_read_b64_tr_b16 a[174:175], v22 offset:4608
  ds_read_b64_tr_b16 v[176:177], v23 offset:4096
  ds_read_b64_tr_b16 v[178:179], v23 offset:4608
  ds_read_b64_tr_b16 v[180:181], v31 offset:4096
  ds_read_b64_tr_b16 v[182:183], v31 offset:4608
  s_waitcnt vmcnt(28) lgkmcnt(0)
  s_barrier
  s_add_u32 m0, s68, 4096
  s_add_u32 s37, s16, 4063232
  buffer_load_dwordx4 v16, s[8:11], s37 offen offset:0 lds
  s_add_u32 s37, s16, 4094976
  buffer_load_dwordx4 v28, s[8:11], s37 offen offset:1024 lds
  s_add_u32 s37, s16, 4126720
  buffer_load_dwordx4 v29, s[8:11], s37 offen offset:2048 lds
  s_add_u32 s37, s16, 4158464
  buffer_load_dwordx4 v30, s[8:11], s37 offen offset:3072 lds
  ds_read_b64_tr_b16 v[184:185], v17 offset:8192
  ds_read_b64_tr_b16 v[186:187], v17 offset:8704
  ds_read_b64_tr_b16 v[188:189], v22 offset:8192
  ds_read_b64_tr_b16 v[190:191], v22 offset:8704
  ds_read_b64_tr_b16 v[192:193], v23 offset:8192
  ds_read_b64_tr_b16 v[194:195], v23 offset:8704
  ds_read_b64_tr_b16 v[196:197], v31 offset:8192
  ds_read_b64_tr_b16 v[198:199], v31 offset:8704
  s_waitcnt vmcnt(28) lgkmcnt(0)
  s_barrier
  s_add_u32 m0, s68, 8192
  s_add_u32 s37, s18, 1048576
  buffer_load_dwordx4 v16, s[8:11], s37 offen offset:0 lds
  s_add_u32 s37, s18, 1080320
  buffer_load_dwordx4 v28, s[8:11], s37 offen offset:1024 lds
  s_add_u32 s37, s18, 1112064
  buffer_load_dwordx4 v29, s[8:11], s37 offen offset:2048 lds
  s_add_u32 s37, s18, 1143808
  buffer_load_dwordx4 v30, s[8:11], s37 offen offset:3072 lds
  s_mov_b32 s8, s64
  s_mov_b32 s9, s65
  s_mov_b32 s10, 9216
  s_mul_i32 s37, s13, 6
  s_add_u32 s37, s37, 0
  s_add_u32 s38, s37, -9
  s_cmp_gt_u32 s37, 8
  s_cselect_b32 s37, s38, s37
  s_lshr_b32 s38, s37, 1
  s_mul_i32 s38, s38, 288
  s_and_b32 s39, s37, 1
  s_lshl_b32 s39, s39, 7
  s_add_u32 s38, s38, s39
  buffer_load_dwordx4 v[48:51], v20, s[8:11], s38 offen
  s_mul_i32 s37, s13, 6
  s_add_u32 s37, s37, 2
  s_add_u32 s38, s37, -9
  s_cmp_gt_u32 s37, 8
  s_cselect_b32 s37, s38, s37
  s_lshr_b32 s38, s37, 1
  s_mul_i32 s38, s38, 288
  s_and_b32 s39, s37, 1
  s_lshl_b32 s39, s39, 7
  s_add_u32 s38, s38, s39
  s_cmp_eq_u32 s37, 8
  s_cselect_b32 s38, 256, s38
  s_cselect_b64 vcc, -1, 0
  v_cndmask_b32 v21, v20, v21, vcc
  buffer_load_dwordx4 v[52:55], v21, s[8:11], s38 offen
  s_mul_i32 s37, s13, 6
  s_add_u32 s37, s37, 4
  s_add_u32 s38, s37, -9
  s_cmp_gt_u32 s37, 8
  s_cselect_b32 s37, s38, s37
  s_lshr_b32 s38, s37, 1
  s_mul_i32 s38, s38, 288
  s_and_b32 s39, s37, 1
  s_lshl_b32 s39, s39, 7
  s_add_u32 s38, s38, s39
  buffer_load_dwordx4 v[56:59], v20, s[8:11], s38 offen
  s_lshl_b32 s37, s12, 9
  s_add_u32 s43, s37, 917504
  v_readfirstlane_b32 s53, v61
  v_mov_b32 v24, 0
  global_load_dwordx4 v[64:67], v24, s[66:67] offset:128 sc1
  global_load_dwordx4 v[68:71], v24, s[66:67] offset:144 sc1
  global_load_dword v64, v24, s[66:67] offset:0 sc1
  global_load_dword v25, v24, s[66:67] offset:192 sc1
  buffer_load_dword v26, v24, s[4:7], s43 offen sc1
  buffer_load_dword v27, v24, s[4:7], s43 offen offset:256 sc1
  ds_read_b64_tr_b16 a[32:33], v17 offset:12288
  ds_read_b64_tr_b16 a[34:35], v17 offset:12800
  ds_read_b64_tr_b16 a[36:37], v22 offset:12288
  ds_read_b64_tr_b16 a[38:39], v22 offset:12800
  ds_read_b64_tr_b16 a[40:41], v23 offset:12288
  ds_read_b64_tr_b16 a[42:43], v23 offset:12800
  ds_read_b64_tr_b16 a[44:45], v31 offset:12288
  ds_read_b64_tr_b16 a[46:47], v31 offset:12800
  s_waitcnt vmcnt(37) lgkmcnt(0)
  s_barrier
  ds_write_b128 v4, a[48:51] offset:12288
  ds_write_b128 v4, a[52:55] offset:13312
  ds_write_b128 v4, a[56:59] offset:14336
  ds_write_b128 v4, a[60:63] offset:15360
  ds_read_b64_tr_b16 a[48:49], v17 offset:16384
  ds_read_b64_tr_b16 a[50:51], v17 offset:16896
  ds_read_b64_tr_b16 a[52:53], v22 offset:16384
  ds_read_b64_tr_b16 a[54:55], v22 offset:16896
  ds_read_b64_tr_b16 a[56:57], v23 offset:16384
  ds_read_b64_tr_b16 a[58:59], v23 offset:16896
  ds_read_b64_tr_b16 a[60:61], v31 offset:16384
  ds_read_b64_tr_b16 a[62:63], v31 offset:16896
  s_waitcnt vmcnt(33) lgkmcnt(0)
  s_barrier
  ds_write_b128 v4, a[64:67] offset:16384
  ds_write_b128 v4, a[68:71] offset:17408
  ds_write_b128 v4, a[72:75] offset:18432
  ds_write_b128 v4, a[76:79] offset:19456
  ds_read_b64_tr_b16 a[64:65], v17 offset:20480
  ds_read_b64_tr_b16 a[66:67], v17 offset:20992
  ds_read_b64_tr_b16 a[68:69], v22 offset:20480
  ds_read_b64_tr_b16 a[70:71], v22 offset:20992
  ds_read_b64_tr_b16 a[72:73], v23 offset:20480
  ds_read_b64_tr_b16 a[74:75], v23 offset:20992
  ds_read_b64_tr_b16 a[76:77], v31 offset:20480
  ds_read_b64_tr_b16 a[78:79], v31 offset:20992
  s_waitcnt vmcnt(29) lgkmcnt(0)
  s_barrier
  ds_write_b128 v4, a[80:83] offset:20480
  ds_write_b128 v4, a[84:87] offset:21504
  ds_write_b128 v4, a[88:91] offset:22528
  ds_write_b128 v4, a[92:95] offset:23552
  ds_read_b64_tr_b16 a[80:81], v17 offset:24576
  ds_read_b64_tr_b16 a[82:83], v17 offset:25088
  ds_read_b64_tr_b16 a[84:85], v22 offset:24576
  ds_read_b64_tr_b16 a[86:87], v22 offset:25088
  ds_read_b64_tr_b16 a[88:89], v23 offset:24576
  ds_read_b64_tr_b16 a[90:91], v23 offset:25088
  ds_read_b64_tr_b16 a[92:93], v31 offset:24576
  ds_read_b64_tr_b16 a[94:95], v31 offset:25088
  s_waitcnt vmcnt(25) lgkmcnt(0)
  s_barrier
  ds_write_b128 v4, a[96:99] offset:24576
  ds_write_b128 v4, a[100:103] offset:25600
  ds_write_b128 v4, a[104:107] offset:26624
  ds_write_b128 v4, a[108:111] offset:27648
  ds_read_b64_tr_b16 a[96:97], v17 offset:28672
  ds_read_b64_tr_b16 a[98:99], v17 offset:29184
  ds_read_b64_tr_b16 a[100:101], v22 offset:28672
  ds_read_b64_tr_b16 a[102:103], v22 offset:29184
  ds_read_b64_tr_b16 a[104:105], v23 offset:28672
  ds_read_b64_tr_b16 a[106:107], v23 offset:29184
  ds_read_b64_tr_b16 a[108:109], v31 offset:28672
  ds_read_b64_tr_b16 a[110:111], v31 offset:29184
  s_waitcnt vmcnt(21) lgkmcnt(0)
  s_barrier
  ds_write_b128 v4, a[112:115] offset:28672
  ds_write_b128 v4, a[116:119] offset:29696
  ds_write_b128 v4, a[120:123] offset:30720
  ds_write_b128 v4, a[124:127] offset:31744
  ds_read_b64_tr_b16 a[112:113], v17 offset:32768
  ds_read_b64_tr_b16 a[114:115], v17 offset:33280
  ds_read_b64_tr_b16 a[116:117], v22 offset:32768
  ds_read_b64_tr_b16 a[118:119], v22 offset:33280
  ds_read_b64_tr_b16 a[120:121], v23 offset:32768
  ds_read_b64_tr_b16 a[122:123], v23 offset:33280
  ds_read_b64_tr_b16 a[124:125], v31 offset:32768
  ds_read_b64_tr_b16 a[126:127], v31 offset:33280
  s_waitcnt vmcnt(17) lgkmcnt(0)
  s_barrier
  ds_write_b128 v4, a[128:131] offset:32768
  ds_write_b128 v4, a[132:135] offset:33792
  ds_write_b128 v4, a[136:139] offset:34816
  ds_write_b128 v4, a[140:143] offset:35840
  ds_read_b64_tr_b16 a[128:129], v17 offset:0
  ds_read_b64_tr_b16 a[130:131], v17 offset:512
  ds_read_b64_tr_b16 a[132:133], v22 offset:0
  ds_read_b64_tr_b16 a[134:135], v22 offset:512
  ds_read_b64_tr_b16 a[136:137], v23 offset:0
  ds_read_b64_tr_b16 a[138:139], v23 offset:512
  ds_read_b64_tr_b16 a[140:141], v31 offset:0
  ds_read_b64_tr_b16 a[142:143], v31 offset:512
  s_waitcnt vmcnt(13) lgkmcnt(0)
  s_barrier
  ds_write_b128 v4, a[144:147] offset:0
  ds_write_b128 v4, a[148:151] offset:1024
  ds_write_b128 v4, a[152:155] offset:2048
  ds_write_b128 v4, a[156:159] offset:3072
  ds_read_b64_tr_b16 a[144:145], v17 offset:4096
  ds_read_b64_tr_b16 a[146:147], v17 offset:4608
  ds_read_b64_tr_b16 a[148:149], v22 offset:4096
  ds_read_b64_tr_b16 a[150:151], v22 offset:4608
  ds_read_b64_tr_b16 a[152:153], v23 offset:4096
  ds_read_b64_tr_b16 a[154:155], v23 offset:4608
  ds_read_b64_tr_b16 a[156:157], v31 offset:4096
  ds_read_b64_tr_b16 a[158:159], v31 offset:4608
  s_waitcnt vmcnt(9) lgkmcnt(0)
  s_barrier
  ds_write_b128 v4, a[160:163] offset:4096
  ds_write_b128 v4, a[164:167] offset:5120
  ds_write_b128 v4, a[168:171] offset:6144
  ds_write_b128 v4, a[172:175] offset:7168
  ds_read_b64_tr_b16 a[160:161], v17 offset:8192
  ds_read_b64_tr_b16 a[162:163], v17 offset:8704
  ds_read_b64_tr_b16 a[164:165], v22 offset:8192
  ds_read_b64_tr_b16 a[166:167], v22 offset:8704
  ds_read_b64_tr_b16 a[168:169], v23 offset:8192
  ds_read_b64_tr_b16 a[170:171], v23 offset:8704
  ds_read_b64_tr_b16 a[172:173], v31 offset:8192
  ds_read_b64_tr_b16 a[174:175], v31 offset:8704
  s_waitcnt lgkmcnt(0)
  s_barrier
  ds_write_b128 v4, v[32:35] offset:8192
  ds_write_b128 v4, v[36:39] offset:9216
  ds_write_b128 v4, v[40:43] offset:10240
  ds_write_b128 v4, v[44:47] offset:11264
  s_mov_b32 s70, 0x3e0293ee
  s_mov_b32 s71, 0x3e0293ee
  s_mov_b32 s69, 0x35800000
  s_mov_b32 s23, 0x14000000
  s_mov_b32 s14, 0
  s_mov_b32 s16, 1
  s_mov_b32 s49, 32768
  s_lshl_b32 s22, s13, 11
  s_add_u32 s22, s22, 1024
  s_mov_b32 s19, 294912
  s_mov_b32 s20, 304128
  s_mov_b32 s21, 313344
  s_lshl_b32 s37, s12, 14
  s_add_u32 s18, s37, 16777216
  s_add_u32 s24, s18, 524288
  s_lshl_b32 s38, s13, 11
  s_add_u32 s27, s24, s38
  s_add_u32 s27, s27, 8192
  s_mov_b32 m0, 162880
  s_lshl_b32 s37, s12, 11
  s_add_u32 s25, s37, 1048576
  s_lshl_b32 s37, s12, 12
  s_add_u32 s26, s37, 5242880
  s_lshl_b32 s37, s13, 10
  s_add_u32 s26, s26, s37
  s_lshl_b32 s37, s12, 7
  s_add_u32 s42, s37, 933888
  s_lshr_b32 s37, s12, 2
  s_add_u32 s37, s37, 64
  s_lshl_b32 s37, s37, 12
  s_and_b32 s38, s12, 3
  s_lshl_b32 s38, s38, 5
  s_add_u32 s37, s37, s38
  s_cmp_eq_u32 s13, 2
  s_cselect_b32 s17, s37, s17
  s_sub_u32 s51, s42, 14336
  s_mov_b32 s37, 268435456
  s_cmp_eq_u32 s13, 3
  s_cselect_b32 s51, s51, s37
  s_add_u32 s54, s12, s13
  s_and_b32 s54, s54, 3
  s_lshl_b32 s54, s54, 8
  s_add_u32 s54, s54, 327680
  s_lshl_b32 s55, s12, 2
  s_add_u32 s55, s55, 327680
  s_cmp_ge_u32 s13, 3
  s_cselect_b32 s54, s54, s37
  s_cmp_eq_u32 s13, 1
  s_cselect_b32 s55, s55, s37
  s_mov_b32 s40, 0
  s_branch CBC_41
CB_40:
  v_mov_b32 v24, 0
  global_load_dwordx4 v[64:67], v24, s[66:67] offset:128 sc1
  global_load_dwordx4 v[68:71], v24, s[66:67] offset:144 sc1
  global_load_dword v64, v24, s[66:67] offset:0 sc1
  global_load_dword v25, v24, s[66:67] offset:192 sc1
  buffer_load_dword v26, v24, s[4:7], s43 offen sc1
  buffer_load_dword v27, v24, s[4:7], s43 offen offset:256 sc1
  s_add_u32 s40, s40, 1
  s_cmp_gt_u32 s40, 200000
  s_cbranch_scc1 L_fail
CBC_41:
  s_waitcnt vmcnt(5)
  v_add3_u32 v65, v65, v66, v67
  s_waitcnt vmcnt(4)
  v_add3_u32 v68, v68, v69, v70
  v_add3_u32 v65, v65, v68, v71
  s_waitcnt vmcnt(3)
  v_add_u32 v65, v65, v64
  s_waitcnt vmcnt(0)
  v_min_u32 v26, v26, v27
  v_readfirstlane_b32 s37, v25
  v_readfirstlane_b32 s38, v64
  v_readfirstlane_b32 s39, v65
  v_readfirstlane_b32 s44, v26
  s_cmp_lt_u32 s37, 8
  s_cbranch_scc1 CB_40
  s_cmp_lt_u32 s38, 32
  s_cselect_b32 s50, 1, 0
  s_cselect_b32 s39, s39, 256
  s_cmp_lt_u32 s39, 256
  s_cbranch_scc1 CB_40
  s_cmp_ge_u32 s53, 8
  s_cselect_b32 s44, s44, 0
  s_mov_b32 s37, 1
  s_cmp_ge_u32 s44, s37
  s_cbranch_scc1 KVOK_43
  s_mov_b32 s40, 0
KVW_42:
  v_mov_b32 v24, 0
  buffer_load_dword v25, v24, s[4:7], s43 offen offset:256 sc1
  buffer_load_dword v24, v24, s[4:7], s43 offen sc1
  s_add_u32 s40, s40, 1
  s_cmp_gt_u32 s40, 200000
  s_cbranch_scc1 L_fail
  s_waitcnt vmcnt(0)
  v_min_u32 v24, v24, v25
  s_nop 0
  v_readfirstlane_b32 s44, v24
  s_nop 0
  s_cmp_lt_u32 s44, s37
  s_cbranch_scc1 KVW_42
KVOK_43:
  buffer_load_dwordx4 v[16:19], v12, s[4:7], s18 offen sc1
  buffer_load_dwordx4 v[20:23], v12, s[4:7], s18 offen offset:256 sc1
  s_add_u32 s18, s18, 8192
  s_xor_b32 s9, s13, 3
  s_or_b32 s9, s9, s12
  s_mov_b32 s64, 268435456
  s_sub_u32 s60, s55, 14336
  s_and_b32 s61, s54, 4294963455
  s_mov_b32 s2, 0
  s_mov_b32 s3, -1
  s_lshl_b32 s10, 1, s12
  s_mov_b32 s11, s10
  s_mov_b32 s8, s42
  s_mov_b32 s42, 514048
  s_sub_u32 s68, s43, 14592
  s_cmp_eq_u32 s13, 3
  s_cselect_b32 s44, s44, 16
  v_mov_b32 v24, 162880
  v_mov_b32 v25, 0
  ds_write2_b32 v24, v25, v25 offset0:64 offset1:128
  s_mov_b32 s80, 0
  s_mov_b32 s81, 0
  s_mov_b32 s82, 0
  s_mov_b32 s83, 0
  s_mov_b32 s84, 0
  s_mov_b32 s85, 0
  s_mov_b32 s86, 0
  s_mov_b32 s87, 0
  s_mov_b32 s88, 0
  s_mov_b32 s89, 0
  s_mov_b32 s90, 0
  s_mov_b32 s91, 0
  s_mov_b32 s92, 0
  s_mov_b32 s93, 0
  s_mov_b32 s94, 0
  s_mov_b32 s95, 0
  s_cmp_lg_u32 s50, 0
  s_cbranch_scc1 CSTEP_1_prep
CSTEP_0_prep:
  v_mov_b32 v32, 0
  v_mov_b32 v33, 0
  v_mov_b32 v34, 0
  v_mov_b32 v35, 0
  v_mov_b32 v36, 0
  v_mov_b32 v37, 0
  v_mov_b32 v38, 0
  v_mov_b32 v39, 0
  v_mov_b32 v40, 0
  v_mov_b32 v41, 0
  v_mov_b32 v42, 0
  v_mov_b32 v43, 0
  v_mov_b32 v44, 0
  v_mov_b32 v45, 0
  v_mov_b32 v46, 0
  v_mov_b32 v47, 0
  ds_read_b128 v[60:63], v4 offset:8192
  ds_read_b128 v[64:67], v4 offset:9216
  ds_read_b128 v[68:71], v4 offset:18432
  ds_read_b128 v[72:75], v4 offset:19456
  s_add_u32 s53, s14, 1
  s_add_u32 s65, s21, s45
  s_add_u32 s62, s14, 8
  s_lshr_b32 s62, s62, 2
  s_min_u32 s62, s62, 16
  s_cmp_eq_u32 s13, 3
  s_cbranch_scc1 PW_46
  s_mul_i32 s37, s13, 3072
  v_add_u32 v77, s37, v0
  ds_write_b128 v77, v[48:51] offset:0
  ds_write_b128 v77, v[52:55] offset:1024
  ds_write_b128 v77, v[56:59] offset:2048
PW_46:
  s_waitcnt lgkmcnt(0)
  s_barrier
  ds_read_b128 v[76:79], v13 offset:5120
.p2align 8
  s_nop 0
CBA_0:
  s_waitcnt lgkmcnt(0)
  s_barrier
  ds_read_b128 v[48:51], v0 offset:0
  ds_read_b128 v[52:55], v0 offset:1024
  s_waitcnt lgkmcnt(1)
  v_smfmac_f32_16x16x64_bf16 v[32:35], v[48:51], v[60:67], v1
  ds_read_b128 v[56:59], v0 offset:2048
  v_smfmac_f32_16x16x64_bf16 v[36:39], v[48:51], v[80:87], v1
  ds_read_b128 v[60:63], v4 offset:22528
  v_smfmac_f32_16x16x64_bf16 v[40:43], v[48:51], v[88:95], v1
  ds_read_b128 v[64:67], v4 offset:23552
  v_smfmac_f32_16x16x64_bf16 v[44:47], v[48:51], v[96:103], v1
  ds_read_b128 v[48:51], v0 offset:3072
  s_waitcnt lgkmcnt(4)
  v_smfmac_f32_16x16x64_bf16 v[32:35], v[52:55], v[68:75], v1
  ds_read_b128 v[68:71], v4 offset:32768
  v_smfmac_f32_16x16x64_bf16 v[36:39], v[52:55], v[104:111], v1
  ds_read_b128 v[72:75], v4 offset:33792
  v_smfmac_f32_16x16x64_bf16 v[40:43], v[52:55], v[112:119], v1
  v_smfmac_f32_16x16x64_bf16 v[44:47], v[52:55], v[120:127], v1
  ds_read_b128 v[52:55], v0 offset:4096
  s_waitcnt lgkmcnt(3)
  v_smfmac_f32_16x16x64_bf16 v[32:35], v[56:59], v[60:67], v1
  ds_read_b128 v[60:63], v4 offset:6144
  v_smfmac_f32_16x16x64_bf16 v[36:39], v[56:59], v[128:135], v1
  ds_read_b128 v[64:67], v4 offset:7168
  v_smfmac_f32_16x16x64_bf16 v[40:43], v[56:59], v[136:143], v1
  s_waitcnt vmcnt(0)
  ds_write_b128 v13, v[76:79] offset:5120
  v_smfmac_f32_16x16x64_bf16 v[44:47], v[56:59], v[144:151], v1
  v_max3_u32 v76, v76, v77, v78
  s_waitcnt lgkmcnt(3)
  v_smfmac_f32_16x16x64_bf16 v[32:35], v[48:51], v[68:75], v1
  v_max_u32 v76, v76, v79
  ds_read_b128 v[68:71], v4 offset:10240
  v_smfmac_f32_16x16x64_bf16 v[36:39], v[48:51], v[152:159], v1
  v_cmp_eq_u32 vcc, -1, v76
  s_cbranch_vccnz LATE_45
LOK_47:
  ds_read_b128 v[72:75], v4 offset:11264
  v_smfmac_f32_16x16x64_bf16 v[40:43], v[48:51], v[160:167], v1
  v_smfmac_f32_16x16x64_bf16 v[44:47], v[48:51], v[168:175], v1
  s_waitcnt lgkmcnt(2)
  s_barrier
  ds_read_b128 v[56:59], v0 offset:5120
  v_smfmac_f32_16x16x64_bf16 v[32:35], v[52:55], v[60:67], v1
  ds_read_b128 v[48:51], v0 offset:6144
  buffer_load_dwordx4 v[24:27], v12, s[4:7], s18 offen sc1
  v_lshlrev_b32 v78, 3, v0
  v_smfmac_f32_16x16x64_bf16 v[36:39], v[52:55], v[176:183], v1
  ds_read_b128 v[60:63], v4 offset:16384
  buffer_load_dwordx4 v[28:31], v12, s[4:7], s18 offen offset:256 sc1
  v_smfmac_f32_16x16x64_bf16 v[40:43], v[52:55], v[184:191], v1
  ds_read_b128 v[64:67], v4 offset:17408
  v_mov_b32 v76, -1
  v_smfmac_f32_16x16x64_bf16 v[44:47], v[52:55], v[192:199], v1
  ds_read_b128 v[52:55], v0 offset:7168
  buffer_store_dword v76, v11, s[4:7], s65 offen
  s_waitcnt lgkmcnt(3)
  v_smfmac_f32_16x16x64_bf16 v[32:35], v[56:59], v[68:75], v1
  ds_read_b128 v[68:71], v4 offset:20480
  s_mov_b64 exec, 0xffff
  buffer_load_dword v78, s[4:7], s27 offen sc1 lds
  s_mov_b64 exec, -1
  v_smfmac_f32_16x16x64_bf16 v[36:39], v[56:59], v[200:207], v1
  ds_read_b128 v[72:75], v4 offset:21504
  s_waitcnt lgkmcnt(3)
  v_smfmac_f32_16x16x64_bf16 v[40:43], v[56:59], v[60:67], v1
  ds_read_b128 v[60:63], v4 offset:28672
  v_mov_b32 v77, s14
  v_smfmac_f32_16x16x64_bf16 v[44:47], v[56:59], v[208:215], v1
  ds_read_b128 v[56:59], v0 offset:8192
  buffer_store_dword v77, v15, s[4:7], s51 offen sc1
  v_smfmac_f32_16x16x64_bf16 v[32:35], v[48:51], v[216:223], v1
  ds_read_b128 v[64:67], v4 offset:29696
  s_cmp_lt_u32 s44, s62
  s_cbranch_scc1 KVF_48
KVB_49:
  v_smfmac_f32_16x16x64_bf16 v[36:39], v[48:51], v[224:231], v1
  v_mov_b32 v76, 0
  s_waitcnt lgkmcnt(2)
  v_smfmac_f32_16x16x64_bf16 v[40:43], v[48:51], v[68:75], v1
  ds_read_b128 v[68:71], v4 offset:34816
  v_mov_b32 v77, 0
  v_smfmac_f32_16x16x64_bf16 v[44:47], v[48:51], v[232:239], v1
  ds_read_b128 v[72:75], v4 offset:35840
  v_mov_b32 v78, 0
  s_waitcnt lgkmcnt(2)
  v_smfmac_f32_16x16x64_bf16 v[32:35], v[52:55], v[60:67], v1
  v_mov_b32 v79, 0
  v_smfmac_f32_16x16x64_bf16 v[36:39], v[52:55], v[240:247], v1
  v_smfmac_f32_16x16x64_bf16 v[40:43], v[52:55], v[248:255], v1
  v_mov_b32 v60, 0
  v_smfmac_f32_16x16x64_bf16 v[44:47], v[52:55], a[0:7], v1
  v_mov_b32 v61, 0
  s_waitcnt lgkmcnt(0)
  v_smfmac_f32_16x16x64_bf16 v[32:35], v[56:59], v[68:75], v1
  v_mov_b32 v62, 0
  v_smfmac_f32_16x16x64_bf16 v[36:39], v[56:59], a[8:15], v1
  v_mov_b32 v63, 0
  v_smfmac_f32_16x16x64_bf16 v[40:43], v[56:59], a[16:23], v1
  v_smfmac_f32_16x16x64_bf16 v[44:47], v[56:59], a[24:31], v1
  v_smfmac_f32_16x16x64_bf16 v[76:79], v[48:51], a[80:87], v1
  v_smfmac_f32_16x16x64_bf16 v[60:63], v[48:51], a[88:95], v1
  ds_read_b128 v[48:51], v0 offset:0
  v_cvt_pk_bf16_f32 v32, v32, v33
  v_cvt_pk_bf16_f32 v33, v34, v35
  v_cvt_pk_bf16_f32 v36, v36, v37
  v_cvt_pk_bf16_f32 v37, v38, v39
  v_mfma_f32_16x16x16_bf16 v[64:67], v[32:33], v[2:3], 0
  v_cvt_pk_bf16_f32 v40, v40, v41
  v_cvt_pk_bf16_f32 v41, v42, v43
  v_mfma_f32_16x16x16_bf16 v[68:71], v[36:37], v[2:3], 0
  v_cvt_pk_bf16_f32 v44, v44, v45
  v_cvt_pk_bf16_f32 v45, v46, v47
  v_mfma_f32_16x16x16_bf16 v[32:35], v[40:41], v[2:3], 0
  s_nop 0
  v_mfma_f32_16x16x16_bf16 v[36:39], v[44:45], v[2:3], 0
  v_add_u32 v72, s52, v0
  v_cvt_pk_bf16_f32 v64, v64, v65
  v_cvt_pk_bf16_f32 v65, v66, v67
  v_cvt_pk_bf16_f32 v66, v68, v69
  v_cvt_pk_bf16_f32 v67, v70, v71
  s_nop 0
  v_cvt_pk_bf16_f32 v40, v32, v33
  v_cvt_pk_bf16_f32 v41, v34, v35
  s_waitcnt vmcnt(5)
  v_mfma_f32_16x16x32_bf16 v[44:47], v[20:23], v[64:67], 0
  v_cvt_pk_bf16_f32 v42, v36, v37
  v_cvt_pk_bf16_f32 v43, v38, v39
  v_mfma_f32_16x16x32_bf16 v[36:39], v[16:19], v[64:67], 0
  s_nop 0
  v_mfma_f32_16x16x32_bf16 v[32:35], v[40:43], v[64:67], 0
  v_smfmac_f32_16x16x64_bf16 v[76:79], v[52:55], a[112:119], v1
  v_smfmac_f32_16x16x64_bf16 v[60:63], v[52:55], a[120:127], v1
  ds_read_b128 v[52:55], v0 offset:1024
  buffer_load_dwordx4 v[16:19], v12, s[4:7], s24 offen sc1
  buffer_store_dwordx4 v[40:43], v6, s[4:7], s25 offen sc1
  s_nop 0
  v_cndmask_b32 v36, v36, v44, s[46:47]
  v_cndmask_b32 v37, v37, v45, s[46:47]
  v_cndmask_b32 v38, v38, v46, s[46:47]
  v_cndmask_b32 v39, v39, v47, s[46:47]
  ds_write_b128 v5, v[36:39] offset:9216
  buffer_load_dwordx4 v[20:23], v12, s[4:7], s24 offen offset:256 sc1
  v_cndmask_b32 v32, v32, v33, s[46:47]
  v_cndmask_b32 v34, v34, v35, s[46:47]
  v_cndmask_b32 v32, v32, v34, s[2:3]
  ds_write_b32 v72, v32 offset:13312
  v_smfmac_f32_16x16x64_bf16 v[76:79], v[56:59], a[144:151], v1
  v_smfmac_f32_16x16x64_bf16 v[60:63], v[56:59], a[152:159], v1
  ds_read_b128 v[56:59], v0 offset:2048
  s_waitcnt lgkmcnt(3)
  v_smfmac_f32_16x16x64_bf16 v[76:79], v[48:51], a[32:39], v1
  v_smfmac_f32_16x16x64_bf16 v[60:63], v[48:51], a[40:47], v1
  ds_read_b128 v[48:51], v0 offset:3072
  s_waitcnt lgkmcnt(2)
  s_barrier
  ds_read_b128 v[32:35], v0 offset:9216
  v_smfmac_f32_16x16x64_bf16 v[76:79], v[52:55], a[64:71], v1
  ds_read_b128 v[36:39], v0 offset:10240
  v_smfmac_f32_16x16x64_bf16 v[60:63], v[52:55], a[72:79], v1
  ds_read_b128 v[52:55], v0 offset:4096
  s_waitcnt lgkmcnt(4)
  v_smfmac_f32_16x16x64_bf16 v[76:79], v[56:59], a[96:103], v1
  ds_read_b128 v[40:43], v0 offset:11264
  v_smfmac_f32_16x16x64_bf16 v[60:63], v[56:59], a[104:111], v1
  ds_read_b128 v[56:59], v0 offset:5120
  s_waitcnt lgkmcnt(4)
  v_smfmac_f32_16x16x64_bf16 v[76:79], v[48:51], a[128:135], v1
  ds_read_b128 v[44:47], v0 offset:12288
  v_smfmac_f32_16x16x64_bf16 v[60:63], v[48:51], a[136:143], v1
  ds_read_b128 v[68:71], v15 offset:16
  s_waitcnt lgkmcnt(4)
  v_smfmac_f32_16x16x64_bf16 v[76:79], v[52:55], a[160:167], v1
  ds_read_b128 v[48:51], v0 offset:13312
  v_smfmac_f32_16x16x64_bf16 v[60:63], v[52:55], a[168:175], v1
  ds_read_b64 v[72:73], v15 offset:32
  s_waitcnt lgkmcnt(4)
  v_smfmac_f32_16x16x64_bf16 v[76:79], v[56:59], a[48:55], v1
  v_smfmac_f32_16x16x64_bf16 v[60:63], v[56:59], a[56:63], v1
  v_pk_add_f32 v[32:33], v[32:33], v[36:37]
  v_pk_add_f32 v[34:35], v[34:35], v[38:39]
  s_waitcnt lgkmcnt(2)
  v_pk_add_f32 v[40:41], v[40:41], v[44:45]
  v_pk_add_f32 v[42:43], v[42:43], v[46:47]
  v_pk_add_f32 v[32:33], v[32:33], v[40:41]
  v_pk_add_f32 v[34:35], v[34:35], v[42:43]
  v_pk_mul_f32 v[32:33], v[32:33], s[70:71]
  v_pk_mul_f32 v[34:35], v[34:35], s[70:71]
  v_cvt_pk_bf16_f32 v64, v76, v77
  v_cvt_pk_bf16_f32 v65, v78, v79
  v_cvt_pk_bf16_f32 v66, v60, v61
  v_cvt_pk_bf16_f32 v67, v62, v63
  s_cmp_eq_u32 s14, 63
  s_cbranch_scc1 CDONE_44
  v_exp_f32 v32, v32
  v_exp_f32 v33, v33
  v_exp_f32 v34, v34
  buffer_store_dwordx4 v[64:67], v0, s[4:7], s26 offen sc1
  v_exp_f32 v35, v35
  s_waitcnt lgkmcnt(0)
  v_pk_add_f32 v[48:49], v[48:49], v[50:51]
  v_cvt_pk_bf16_f32 v44, v32, v33
  v_cvt_pk_bf16_f32 v46, v32, v33
  v_cvt_pk_bf16_f32 v45, v34, v35
  v_cvt_pk_bf16_f32 v47, v34, v35
  v_add_f32 v48, v48, v49
  v_mov_b32_dpp v44, v46 row_ror:8 row_mask:0xf bank_mask:0xc
  v_mul_f32 v48, s70, v48
  v_mov_b32_dpp v45, v47 row_ror:8 row_mask:0xf bank_mask:0xc
  v_mov_b32_dpp v46, v46 row_ror:8 row_mask:0xf bank_mask:0x3
  v_mov_b32_dpp v47, v47 row_ror:8 row_mask:0xf bank_mask:0x3
  v_exp_f32 v49, v48
  s_nop 0
  v_mfma_f32_16x16x32_bf16 v[76:79], v[68:71], v[44:47], 0
  v_mov_b32 v48, v49
  s_waitcnt vmcnt(8)
  v_mfma_f32_16x16x32_bf16 v[32:35], v[24:27], v[44:47], 0
  v_mov_b32_dpp v48, v49 row_ror:8 row_mask:0xf bank_mask:0xc
  v_mov_b32_dpp v49, v49 row_ror:8 row_mask:0xf bank_mask:0x3
  s_waitcnt vmcnt(7)
  v_mfma_f32_16x16x32_bf16 v[36:39], v[28:31], v[44:47], 0
  v_cvt_pk_bf16_f32 v40, v48, v49
  v_cvt_pk_bf16_f32 v41, v48, v49
  v_mov_b32 v48, 0
  v_mov_b32 v49, 0
  v_permlane32_swap_b32 v40, v41
  v_mov_b32 v50, 0
  v_mov_b32 v51, 0
  v_mfma_f32_16x16x16_bf16 v[76:79], v[72:73], v[40:41], v[76:79]
  ds_read_b128 v[52:55], v15
  v_mfma_f32_16x16x16_bf16 v[32:35], v[64:65], v[40:41], v[32:35]
  ds_read_b128 v[56:59], v15
  v_mfma_f32_16x16x16_bf16 v[36:39], v[66:67], v[40:41], v[36:39]
  v_xor_b32 v40, 1536, v6
  s_nop 2
  v_subrev_u32 v74, s69, v76
  v_rcp_f32 v42, v76
  v_cmp_lt_u32 vcc, s23, v74
  s_cbranch_vccnz SMX_50
SMK_51:
  ds_read_b128 v[60:63], v15
  v_pk_mul_f32 v[32:33], v[32:33], v[42:43] op_sel_hi:[1,0]
  v_pk_mul_f32 v[34:35], v[34:35], v[42:43] op_sel_hi:[1,0]
  v_pk_mul_f32 v[36:37], v[36:37], v[42:43] op_sel_hi:[1,0]
  v_pk_mul_f32 v[38:39], v[38:39], v[42:43] op_sel_hi:[1,0]
  v_cvt_pk_bf16_f32 v44, v32, v33
  v_cvt_pk_bf16_f32 v45, v34, v35
  v_cvt_pk_bf16_f32 v46, v36, v37
  v_cvt_pk_bf16_f32 v47, v38, v39
  ds_write_b128 v6, v[44:47] offset:7168
  ds_read_b128 v[24:27], v4 offset:12288
  v_mfma_f32_16x16x32_bf16 v[76:79], v[44:47], a[240:243], 0
  ds_read_b128 v[28:31], v4 offset:13312
  v_xor_b32 v32, 512, v6
  v_xor_b32 v36, 1024, v6
  v_smfmac_f32_16x16x64_bf16 v[48:51], v[44:47], a[176:183], v1
  ds_read_b128 v[68:71], v4 offset:14336
  s_waitcnt lgkmcnt(4)
  v_smfmac_f32_16x16x64_bf16 v[52:55], v[44:47], a[184:191], v1
  ds_read_b128 v[72:75], v4 offset:15360
  s_waitcnt lgkmcnt(4)
  s_barrier
  ds_read_b128 v[32:35], v32 offset:7168
  ds_read_b128 v[36:39], v36 offset:7168
  ds_read_b128 v[40:43], v40 offset:7168
  s_waitcnt lgkmcnt(5)
  v_smfmac_f32_16x16x64_bf16 v[56:59], v[44:47], v[24:31], v1
  ds_read_b128 v[24:27], v4 offset:30720
  s_waitcnt lgkmcnt(4)
  v_smfmac_f32_16x16x64_bf16 v[60:63], v[44:47], v[68:75], v1
  ds_read_b128 v[28:31], v4 offset:31744
  v_mov_b32 v67, s53
  v_mov_b32 v64, 0
  s_waitcnt lgkmcnt(4)
  v_mfma_f32_16x16x32_bf16 v[76:79], v[32:35], a[244:247], v[76:79]
  ds_read_b128 v[68:71], v4 offset:0
  s_waitcnt lgkmcnt(3)
  v_mfma_f32_16x16x32_bf16 v[76:79], v[36:39], a[248:251], v[76:79]
  ds_read_b128 v[72:75], v4 offset:1024
  v_mfma_f32_16x16x32_bf16 v[76:79], v[40:43], a[252:255], v[76:79]
  buffer_store_dword v67, v15, s[4:7], s60 offen
  v_smfmac_f32_16x16x64_bf16 v[48:51], v[32:35], a[192:199], v1
  s_waitcnt lgkmcnt(2)
  v_smfmac_f32_16x16x64_bf16 v[48:51], v[36:39], v[24:31], v1
  ds_read_b128 v[24:27], v4 offset:2048
  s_waitcnt lgkmcnt(1)
  v_smfmac_f32_16x16x64_bf16 v[48:51], v[40:43], v[68:75], v1
  ds_read_b128 v[28:31], v4 offset:3072
  v_cvt_pk_bf16_f32 v76, v76, v77
  v_smfmac_f32_16x16x64_bf16 v[52:55], v[32:35], a[200:207], v1
  ds_read_b128 v[68:71], v4 offset:24576
  v_cvt_pk_bf16_f32 v77, v78, v79
  v_smfmac_f32_16x16x64_bf16 v[52:55], v[36:39], a[208:215], v1
  ds_read_b128 v[72:75], v4 offset:25600
  buffer_load_dword v64, v7, s[4:7], s61 offen sc1
  v_and_or_b32 v76, v76, -2, s16
  s_waitcnt lgkmcnt(2)
  v_smfmac_f32_16x16x64_bf16 v[52:55], v[40:43], v[24:31], v1
  ds_read_b128 v[24:27], v4 offset:26624
  s_mov_b64 exec, 0xffffffff
  buffer_store_dwordx2 v[76:77], v10, s[4:7], 0 offen
  s_mov_b64 exec, -1
  s_waitcnt lgkmcnt(1)
  v_smfmac_f32_16x16x64_bf16 v[56:59], v[32:35], v[68:75], v1
  ds_read_b128 v[28:31], v4 offset:27648
  buffer_load_dword v64, v7, s[4:7], s61 offen sc1
  v_cvt_pk_bf16_f32 v48, v48, v49
  v_cvt_pk_bf16_f32 v49, v50, v51
  v_cvt_pk_bf16_f32 v51, v54, v55
  v_cvt_pk_bf16_f32 v50, v52, v53
  v_and_or_b32 v50, v50, -2, s16
  v_and_or_b32 v48, v48, -2, s16
  v_permlane16_swap_b32 v49, v51
  s_nop 0
  v_permlane16_swap_b32 v48, v50
  buffer_store_dwordx4 v[48:51], v9, s[4:7], 0 offen
  s_nop 0
  v_smfmac_f32_16x16x64_bf16 v[56:59], v[36:39], a[216:223], v1
  ds_read_b128 v[68:71], v4 offset:4096
  v_smfmac_f32_16x16x64_bf16 v[56:59], v[40:43], a[232:239], v1
  ds_read_b128 v[72:75], v4 offset:5120
  buffer_load_dword v64, v7, s[4:7], s61 offen sc1
  s_waitcnt lgkmcnt(2)
  v_smfmac_f32_16x16x64_bf16 v[60:63], v[32:35], v[24:31], v1
  v_smfmac_f32_16x16x64_bf16 v[60:63], v[36:39], a[224:231], v1
  buffer_load_dword v64, v7, s[4:7], s61 offen sc1
  s_waitcnt lgkmcnt(0)
  v_smfmac_f32_16x16x64_bf16 v[60:63], v[40:43], v[68:75], v1
  s_cmp_lg_u32 s13, 3
  v_cvt_pk_bf16_f32 v56, v56, v57
  v_cvt_pk_bf16_f32 v57, v58, v59
  s_nop 4
  v_cvt_pk_bf16_f32 v59, v62, v63
  v_cvt_pk_bf16_f32 v58, v60, v61
  v_and_or_b32 v58, v58, -2, s16
  v_and_or_b32 v56, v56, -2, s16
  v_permlane16_swap_b32 v57, v59
  s_nop 0
  v_permlane16_swap_b32 v56, v58
  buffer_store_dwordx4 v[56:59], v9, s[4:7], s49 offen
  s_cbranch_scc1 W3_54
  v_cmp_gt_u32 vcc, s53, v64
  s_nop 0
  s_andn2_b64 vcc, vcc, s[10:11]
  s_cbranch_scc1 SPIN_56
GO_57:
  s_barrier
  v_mov_b32 v32, 0
  v_mov_b32 v33, 0
  v_mov_b32 v34, 0
  v_mov_b32 v35, 0
  v_mov_b32 v36, 0
  v_mov_b32 v37, 0
  v_mov_b32 v38, 0
  v_mov_b32 v39, 0
  v_mov_b32 v40, 0
  v_mov_b32 v41, 0
  v_mov_b32 v42, 0
  v_mov_b32 v43, 0
  v_mov_b32 v44, 0
  v_mov_b32 v45, 0
  v_mov_b32 v46, 0
  v_mov_b32 v47, 0
  s_mov_b32 s40, 0
  s_add_u32 s37, s14, 3
  s_lshr_b32 s37, s37, 2
  s_add_u32 s37, s37, 1
  s_min_u32 s37, s37, 16
  v_mov_b32 v52, 162880
  ds_read2_b32 v[52:53], v52 offset0:64 offset1:128
  s_waitcnt lgkmcnt(0)
  v_min_u32 v52, v52, v53
  s_nop 0
  v_readfirstlane_b32 s38, v52
  s_nop 0
  s_max_u32 s44, s44, s38
  s_cmp_ge_u32 s44, s37
  s_cbranch_scc1 KVOK_59
  s_mov_b32 s40, 0
KVW_58:
  v_mov_b32 v58, 0
  buffer_load_dword v59, v58, s[4:7], s43 offen offset:256 sc1
  buffer_load_dword v58, v58, s[4:7], s43 offen sc1
  s_add_u32 s40, s40, 1
  s_cmp_gt_u32 s40, 200000
  s_cbranch_scc1 L_fail
  s_waitcnt vmcnt(0)
  v_min_u32 v58, v58, v59
  s_nop 0
  v_readfirstlane_b32 s44, v58
  s_nop 0
  s_cmp_lt_u32 s44, s37
  s_cbranch_scc1 KVW_58
KVOK_59:
  s_nop 15
  s_nop 15
  s_nop 15
  s_nop 15
  s_nop 15
  s_nop 7
  ds_read_b128 v[60:63], v4 offset:8192
  s_waitcnt vmcnt(0)
  ds_read_b128 v[64:67], v4 offset:9216
  ds_read_b128 v[68:71], v4 offset:18432
  ds_read_b128 v[72:75], v4 offset:19456
  s_add_u32 s41, s19, s48
  s_add_u32 s39, s19, s22
  s_xor_b32 s16, s16, 1
  s_mov_b32 s37, s21
  s_mov_b32 s21, s20
  s_mov_b32 s20, s19
  s_mov_b32 s19, s37
  s_add_u32 s18, s24, 8192
  s_add_u32 s24, s24, 524288
  s_add_u32 s27, s27, 524288
  s_add_u32 s25, s25, 65536
  s_mov_b32 s64, s26
  s_add_u32 s26, s26, 131072
  s_add_u32 s14, s14, 1
  s_mov_b32 s40, 0
  s_add_u32 s53, s14, 1
  s_add_u32 s65, s21, s45
  s_add_u32 s62, s14, 8
  s_lshr_b32 s62, s62, 2
  s_min_u32 s62, s62, 16
  buffer_load_dwordx4 v[24:27], v0, s[4:7], s41 offen offset:0 sc1
  s_nop 15
  s_nop 15
  s_nop 5
  buffer_load_dwordx4 v[24:27], v0, s[4:7], s41 offen offset:0 sc1
  s_nop 15
  s_nop 3
  buffer_load_dwordx4 v[76:79], v0, s[4:7], s39 offen sc1
  s_waitcnt vmcnt(2)
  v_max3_u32 v48, v24, v25, v26
  v_max_u32 v48, v48, v27
  v_cmp_eq_u32 vcc, -1, v48
  s_cbranch_vccnz P2S_61
  ds_write_b128 v8, v[24:27] offset:0
  s_branch CBA_0
W3_54:
  ds_read_b128 v[76:79], v0 offset:14400
  s_cmp_lg_u32 s13, 0
  s_cbranch_scc1 W2_53
  s_barrier
  s_nop 3
  buffer_load_dwordx4 v[60:63], v0, s[4:7], s17 offen offset:0 sc1
  buffer_load_dwordx4 v[64:67], v0, s[4:7], s17 offen offset:1024 sc1
  buffer_load_dwordx4 v[68:71], v0, s[4:7], s17 offen offset:2048 sc1
  buffer_load_dwordx4 v[72:75], v0, s[4:7], s17 offen offset:3072 sc1
  v_mov_b32 v32, 0
  v_mov_b32 v33, 0
  v_mov_b32 v34, 0
  v_mov_b32 v35, 0
  v_mov_b32 v36, 0
  v_mov_b32 v37, 0
  v_mov_b32 v38, 0
  v_mov_b32 v39, 0
  v_mov_b32 v40, 0
  v_mov_b32 v41, 0
  v_mov_b32 v42, 0
  v_mov_b32 v43, 0
  v_mov_b32 v44, 0
  v_mov_b32 v45, 0
  v_mov_b32 v46, 0
  v_mov_b32 v47, 0
  s_mov_b32 s40, 0
  s_waitcnt vmcnt(3) lgkmcnt(0)
  v_mfma_f32_16x16x32_bf16 v[48:51], v[60:63], v[76:79], 0
  v_bitop3_b32 v52, v60, v62, s16 bitop3:0x7e
  s_waitcnt vmcnt(2)
  v_mfma_f32_16x16x32_bf16 v[48:51], v[64:67], v[76:79], v[48:51]
  v_bitop3_b32 v52, v52, v64, s16 bitop3:0xf6
  v_bitop3_b32 v52, v52, v66, s16 bitop3:0xf6
  s_waitcnt vmcnt(1)
  v_mfma_f32_16x16x32_bf16 v[48:51], v[68:71], v[76:79], v[48:51]
  v_bitop3_b32 v52, v52, v68, s16 bitop3:0xf6
  v_bitop3_b32 v52, v52, v70, s16 bitop3:0xf6
  s_waitcnt vmcnt(0)
  v_mfma_f32_16x16x32_bf16 v[48:51], v[72:75], v[76:79], v[48:51]
  v_bitop3_b32 v52, v52, v72, s16 bitop3:0xf6
  v_bitop3_b32 v52, v52, v74, s16 bitop3:0xf6
  v_and_b32 v52, 1, v52
  v_cmp_ne_u32 vcc, 0, v52
  s_cbranch_vccnz P1_62
P1K_63:
  s_nop 2
  v_permlane32_swap_b32 v48, v50
  v_permlane32_swap_b32 v49, v51
  v_pk_add_f32 v[48:49], v[48:49], v[50:51]
  v_cvt_pk_bf16_f32 v48, v48, v49
  buffer_store_dword v48, v11, s[4:7], s19 offen
  ds_read_b128 v[60:63], v4 offset:8192
  ds_read_b128 v[64:67], v4 offset:9216
  ds_read_b128 v[68:71], v4 offset:18432
  ds_read_b128 v[72:75], v4 offset:19456
  s_add_u32 s41, s19, s48
  s_add_u32 s39, s19, s22
  s_xor_b32 s16, s16, 1
  s_mov_b32 s37, s21
  s_mov_b32 s21, s20
  s_mov_b32 s20, s19
  s_mov_b32 s19, s37
  s_add_u32 s18, s24, 8192
  s_add_u32 s24, s24, 524288
  s_add_u32 s27, s27, 524288
  s_add_u32 s25, s25, 65536
  s_mov_b32 s64, s26
  s_add_u32 s26, s26, 131072
  s_add_u32 s14, s14, 1
  s_mov_b32 s40, 0
  s_add_u32 s53, s14, 1
  s_add_u32 s65, s21, s45
  s_add_u32 s62, s14, 8
  s_lshr_b32 s62, s62, 2
  s_min_u32 s62, s62, 16
  s_nop 15
  s_nop 8
  buffer_load_dwordx4 v[24:27], v0, s[4:7], s41 offen offset:0 sc1
  buffer_load_dwordx4 v[28:31], v0, s[4:7], s41 offen offset:2048 sc1
  s_nop 15
  s_nop 15
  s_nop 5
  buffer_load_dwordx4 v[24:27], v0, s[4:7], s41 offen offset:0 sc1
  buffer_load_dwordx4 v[28:31], v0, s[4:7], s41 offen offset:2048 sc1
  s_nop 15
  s_nop 3
  buffer_load_dwordx4 v[76:79], v0, s[4:7], s39 offen sc1
  s_waitcnt vmcnt(4)
  v_max3_u32 v48, v24, v25, v26
  v_max_u32 v48, v48, v27
  ds_write_b128 v8, v[24:27] offset:0
  s_waitcnt vmcnt(3)
  v_max3_u32 v48, v48, v28, v29
  v_max3_u32 v48, v48, v30, v31
  v_cmp_eq_u32 vcc, -1, v48
  s_cbranch_vccnz P2S_66
  ds_write_b128 v8, v[28:31] offset:1024
  s_branch CBA_0
W2_53:
  s_cmp_lg_u32 s13, 2
  s_cbranch_scc1 W1_52
  v_lshrrev_b32 v53, 5, v0
  v_lshlrev_b32 v53, 7, v53
  v_and_or_b32 v53, v0, 16, v53
  s_barrier
  buffer_load_dwordx4 v[60:63], v53, s[4:7], s17 offen sc1
  v_mov_b32 v32, 0
  v_mov_b32 v33, 0
  v_mov_b32 v34, 0
  v_mov_b32 v35, 0
  v_mov_b32 v36, 0
  v_mov_b32 v37, 0
  v_mov_b32 v38, 0
  v_mov_b32 v39, 0
  v_mov_b32 v40, 0
  v_mov_b32 v41, 0
  v_mov_b32 v42, 0
  v_mov_b32 v43, 0
  v_mov_b32 v44, 0
  v_mov_b32 v45, 0
  v_mov_b32 v46, 0
  v_mov_b32 v47, 0
  s_mov_b32 s40, 0
  s_waitcnt vmcnt(0) lgkmcnt(0)
  v_mfma_f32_16x16x32_bf16 v[48:51], v[60:63], v[76:79], 0
  v_bitop3_b32 v52, v60, v62, s16 bitop3:0x7e
  v_and_b32 v52, 1, v52
  v_cmp_ne_u32 vcc, 0, v52
  s_cbranch_vccnz Q1_67
Q1K_68:
  s_nop 3
  v_pk_add_f32 v[48:49], v[48:49], v[50:51]
  s_nop 1
  v_permlane32_swap_b32 v48, v49
  v_add_f32 v48, v48, v49
  v_mov_b32 v49, v48
  s_nop 1
  v_permlane16_swap_b32 v48, v49
  v_add_f32 v48, v48, v49
  v_mov_b32 v49, v48
  s_nop 1
  v_permlane32_swap_b32 v48, v49
  v_cvt_pk_bf16_f32 v48, v48, v49
  buffer_store_dword v48, v11, s[4:7], s19 offen
  ds_read_b128 v[60:63], v4 offset:8192
  ds_read_b128 v[64:67], v4 offset:9216
  ds_read_b128 v[68:71], v4 offset:18432
  ds_read_b128 v[72:75], v4 offset:19456
  s_add_u32 s41, s19, s48
  s_add_u32 s39, s19, s22
  s_xor_b32 s16, s16, 1
  s_mov_b32 s37, s21
  s_mov_b32 s21, s20
  s_mov_b32 s20, s19
  s_mov_b32 s19, s37
  s_add_u32 s18, s24, 8192
  s_add_u32 s24, s24, 524288
  s_add_u32 s27, s27, 524288
  s_add_u32 s25, s25, 65536
  s_mov_b32 s64, s26
  s_add_u32 s26, s26, 131072
  s_add_u32 s14, s14, 1
  s_mov_b32 s40, 0
  s_add_u32 s53, s14, 1
  s_add_u32 s65, s21, s45
  s_add_u32 s62, s14, 8
  s_lshr_b32 s62, s62, 2
  s_min_u32 s62, s62, 16
  s_nop 15
  s_nop 13
  buffer_load_dwordx4 v[24:27], v0, s[4:7], s41 offen offset:0 sc1
  buffer_load_dwordx4 v[28:31], v0, s[4:7], s41 offen offset:2048 sc1
  s_nop 15
  s_nop 15
  s_nop 5
  buffer_load_dwordx4 v[24:27], v0, s[4:7], s41 offen offset:0 sc1
  buffer_load_dwordx4 v[28:31], v0, s[4:7], s41 offen offset:2048 sc1
  s_nop 15
  s_nop 3
  buffer_load_dwordx4 v[76:79], v0, s[4:7], s39 offen sc1
  s_waitcnt vmcnt(4)
  v_max3_u32 v48, v24, v25, v26
  v_max_u32 v48, v48, v27
  ds_write_b128 v8, v[24:27] offset:0
  s_waitcnt vmcnt(3)
  v_max3_u32 v48, v48, v28, v29
  v_max3_u32 v48, v48, v30, v31
  v_cmp_eq_u32 vcc, -1, v48
  s_cbranch_vccnz P2S_71
  ds_write_b128 v8, v[28:31] offset:1024
  s_branch CBA_0
W1_52:
  v_mov_b32 v32, 0
  v_mov_b32 v33, 0
  v_mov_b32 v34, 0
  v_mov_b32 v35, 0
  v_mov_b32 v36, 0
  v_mov_b32 v37, 0
  v_mov_b32 v38, 0
  v_mov_b32 v39, 0
  v_mov_b32 v40, 0
  v_mov_b32 v41, 0
  v_mov_b32 v42, 0
  v_mov_b32 v43, 0
  v_mov_b32 v44, 0
  v_mov_b32 v45, 0
  v_mov_b32 v46, 0
  v_mov_b32 v47, 0
  s_mov_b32 s40, 0
  s_barrier
  s_nop 15
  s_nop 15
  s_nop 15
  s_nop 9
  buffer_load_dwordx4 v[60:63], v0, s[4:7], s17 offen offset:0 sc1
  buffer_load_dwordx4 v[64:67], v0, s[4:7], s17 offen offset:1024 sc1
  buffer_load_dwordx4 v[68:71], v0, s[4:7], s17 offen offset:2048 sc1
  buffer_load_dwordx4 v[72:75], v0, s[4:7], s17 offen offset:3072 sc1
  s_waitcnt vmcnt(3) lgkmcnt(0)
  v_mfma_f32_16x16x32_bf16 v[48:51], v[60:63], v[76:79], 0
  v_bitop3_b32 v52, v60, v62, s16 bitop3:0x7e
  s_waitcnt vmcnt(2)
  v_mfma_f32_16x16x32_bf16 v[48:51], v[64:67], v[76:79], v[48:51]
  v_bitop3_b32 v52, v52, v64, s16 bitop3:0xf6
  v_bitop3_b32 v52, v52, v66, s16 bitop3:0xf6
  s_waitcnt vmcnt(1)
  v_mfma_f32_16x16x32_bf16 v[48:51], v[68:71], v[76:79], v[48:51]
  v_bitop3_b32 v52, v52, v68, s16 bitop3:0xf6
  v_bitop3_b32 v52, v52, v70, s16 bitop3:0xf6
  s_waitcnt vmcnt(0)
  v_mfma_f32_16x16x32_bf16 v[48:51], v[72:75], v[76:79], v[48:51]
  v_bitop3_b32 v52, v52, v72, s16 bitop3:0xf6
  v_bitop3_b32 v52, v52, v74, s16 bitop3:0xf6
  v_and_b32 v52, 1, v52
  v_cmp_ne_u32 vcc, 0, v52
  s_cbranch_vccnz P1_72
P1K_73:
  s_nop 2
  v_permlane32_swap_b32 v48, v50
  v_permlane32_swap_b32 v49, v51
  v_pk_add_f32 v[48:49], v[48:49], v[50:51]
  v_cvt_pk_bf16_f32 v48, v48, v49
  buffer_store_dword v48, v11, s[4:7], s19 offen
  ds_read_b128 v[60:63], v4 offset:8192
  ds_read_b128 v[64:67], v4 offset:9216
  ds_read_b128 v[68:71], v4 offset:18432
  ds_read_b128 v[72:75], v4 offset:19456
  s_add_u32 s41, s19, s48
  s_add_u32 s39, s19, s22
  s_xor_b32 s16, s16, 1
  s_mov_b32 s37, s21
  s_mov_b32 s21, s20
  s_mov_b32 s20, s19
  s_mov_b32 s19, s37
  s_add_u32 s18, s24, 8192
  s_add_u32 s24, s24, 524288
  s_add_u32 s27, s27, 524288
  s_add_u32 s25, s25, 65536
  s_mov_b32 s64, s26
  s_add_u32 s26, s26, 131072
  s_add_u32 s14, s14, 1
  s_mov_b32 s40, 0
  s_add_u32 s53, s14, 1
  s_add_u32 s65, s21, s45
  s_add_u32 s62, s14, 8
  s_lshr_b32 s62, s62, 2
  s_min_u32 s62, s62, 16
  s_nop 15
  s_nop 15
  s_nop 15
  s_nop 15
  s_nop 9
  buffer_load_dwordx4 v[76:79], v0, s[4:7], s39 offen sc1
  s_branch CBA_0
LATE_45:
  buffer_load_dwordx4 v[76:79], v0, s[4:7], s39 offen sc1
  s_add_u32 s40, s40, 1
  s_add_u32 s92, s92, 1
  s_cmp_gt_u32 s40, 200000
  s_cbranch_scc1 L_fail
  s_waitcnt vmcnt(0)
  ds_write_b128 v13, v[76:79] offset:5120
  s_nop 1
  v_max3_u32 v76, v76, v77, v78
  v_max_u32 v76, v76, v79
  v_cmp_eq_u32 vcc, -1, v76
  s_cbranch_vccnz LATE_45
  s_waitcnt lgkmcnt(0)
  s_branch LOK_47
KVF_48:
  buffer_load_dword v15, s[4:7], s68 offen offset:256 sc1 lds
  buffer_load_dword v15, s[4:7], s68 offen offset:512 sc1 lds
  s_branch KVB_49
SMX_50:
  ds_read_b128 v[36:39], v0 offset:9216
  ds_read_b128 v[52:55], v0 offset:10240
  ds_read_b128 v[56:59], v0 offset:11264
  ds_read_b128 v[60:63], v0 offset:12288
  ds_read_b128 v[48:51], v0 offset:13312
  s_waitcnt lgkmcnt(3)
  v_pk_add_f32 v[36:37], v[36:37], v[52:53]
  v_pk_add_f32 v[38:39], v[38:39], v[54:55]
  s_waitcnt lgkmcnt(1)
  v_pk_add_f32 v[56:57], v[56:57], v[60:61]
  v_pk_add_f32 v[58:59], v[58:59], v[62:63]
  v_pk_add_f32 v[36:37], v[36:37], v[56:57]
  v_pk_add_f32 v[38:39], v[38:39], v[58:59]
  v_mov_b32 v32, v36
  v_mov_b32 v33, v37
  v_mov_b32 v34, v38
  v_mov_b32 v35, v39
  v_pk_mul_f32 v[32:33], v[32:33], s[70:71]
  v_pk_mul_f32 v[34:35], v[34:35], s[70:71]
  s_waitcnt lgkmcnt(0)
  v_pk_add_f32 v[48:49], v[48:49], v[50:51]
  v_add_f32 v48, v48, v49
  v_mul_f32 v48, s70, v48
  v_max3_f32 v74, v32, v33, v34
  v_max3_f32 v74, v74, v48, v35
  s_nop 1
  v_max_f32_dpp v74, v74, v74 row_ror:8 row_mask:0xf bank_mask:0xf
  v_mov_b32 v75, v74
  s_nop 1
  v_permlane32_swap_b32 v74, v75
  v_max_f32 v74, v74, v75
  v_mov_b32 v75, v74
  s_nop 1
  v_permlane16_swap_b32 v74, v75
  v_max_f32 v74, v74, v75
  v_sub_f32 v48, v48, v74
  v_sub_f32 v32, v32, v74
  v_sub_f32 v33, v33, v74
  v_sub_f32 v34, v34, v74
  v_sub_f32 v35, v35, v74
  v_exp_f32 v32, v32
  v_exp_f32 v33, v33
  v_exp_f32 v34, v34
  v_exp_f32 v35, v35
  v_cvt_pk_bf16_f32 v44, v32, v33
  v_cvt_pk_bf16_f32 v46, v32, v33
  v_cvt_pk_bf16_f32 v45, v34, v35
  v_cvt_pk_bf16_f32 v47, v34, v35
  v_mov_b32_dpp v44, v46 row_ror:8 row_mask:0xf bank_mask:0xc
  s_nop 0
  v_mov_b32_dpp v45, v47 row_ror:8 row_mask:0xf bank_mask:0xc
  v_mov_b32_dpp v46, v46 row_ror:8 row_mask:0xf bank_mask:0x3
  v_mov_b32_dpp v47, v47 row_ror:8 row_mask:0xf bank_mask:0x3
  v_exp_f32 v49, v48
  s_nop 0
  v_mfma_f32_16x16x32_bf16 v[76:79], v[68:71], v[44:47], 0
  v_mov_b32 v48, v49
  v_mfma_f32_16x16x32_bf16 v[32:35], v[24:27], v[44:47], 0
  s_nop 0
  v_mov_b32_dpp v48, v49 row_ror:8 row_mask:0xf bank_mask:0xc
  v_mov_b32_dpp v49, v49 row_ror:8 row_mask:0xf bank_mask:0x3
  v_mfma_f32_16x16x32_bf16 v[36:39], v[28:31], v[44:47], 0
  v_cvt_pk_bf16_f32 v40, v48, v49
  v_cvt_pk_bf16_f32 v41, v48, v49
  v_mov_b32 v48, 0
  v_mov_b32 v49, 0
  v_permlane32_swap_b32 v40, v41
  v_mov_b32 v50, 0
  v_mov_b32 v51, 0
  v_mfma_f32_16x16x16_bf16 v[76:79], v[72:73], v[40:41], v[76:79]
  ds_read_b128 v[52:55], v15
  v_mfma_f32_16x16x16_bf16 v[32:35], v[64:65], v[40:41], v[32:35]
  ds_read_b128 v[56:59], v15
  v_mfma_f32_16x16x16_bf16 v[36:39], v[66:67], v[40:41], v[36:39]
  v_xor_b32 v40, 1536, v6
  s_nop 2
  v_rcp_f32 v42, v76
  s_branch SMK_51
SPIN_56:
  s_mov_b32 s40, 0
SPIN_56_l:
  buffer_load_dword v64, v7, s[4:7], s61 offen sc1
  s_add_u32 s91, s91, 1
  s_nop 1
  v_cmp_gt_u32 vcc, s53, v64
  s_nop 0
  s_andn2_b64 vcc, vcc, s[10:11]
  s_cbranch_scc0 SPIN_56_d
  buffer_load_dword v64, v7, s[4:7], s61 offen sc1
  s_add_u32 s91, s91, 1
  s_nop 1
  v_cmp_gt_u32 vcc, s53, v64
  s_nop 0
  s_andn2_b64 vcc, vcc, s[10:11]
  s_cbranch_scc0 SPIN_56_d
  buffer_load_dword v64, v7, s[4:7], s61 offen sc1
  s_add_u32 s91, s91, 1
  s_nop 1
  v_cmp_gt_u32 vcc, s53, v64
  s_nop 0
  s_andn2_b64 vcc, vcc, s[10:11]
  s_cbranch_scc0 SPIN_56_d
  buffer_load_dword v64, v7, s[4:7], s61 offen sc1
  s_add_u32 s91, s91, 1
  s_nop 1
  v_cmp_gt_u32 vcc, s53, v64
  s_nop 0
  s_andn2_b64 vcc, vcc, s[10:11]
  s_cbranch_scc0 SPIN_56_d
  s_add_u32 s40, s40, 1
  s_cmp_lt_u32 s40, 32
  s_cbranch_scc1 SPIN_56_l
SPIN_56_d:
  s_branch GO_57
P2S_61:
  s_add_u32 s89, s89, 1
  s_waitcnt vmcnt(1)
  v_max3_u32 v48, v24, v25, v26
  v_max_u32 v48, v48, v27
  v_cmp_eq_u32 vcc, -1, v48
  s_cbranch_vccnz P2_60
  ds_write_b128 v8, v[24:27] offset:0
  s_branch CBA_0
P2_60:
  buffer_load_dwordx4 v[24:27], v0, s[4:7], s41 offen offset:0 sc1
  buffer_load_dwordx4 v[76:79], v0, s[4:7], s39 offen sc1
  s_add_u32 s40, s40, 1
  s_add_u32 s94, s94, 1
  s_cmp_gt_u32 s40, 200000
  s_cbranch_scc1 L_fail
  s_waitcnt vmcnt(1)
  v_max3_u32 v48, v24, v25, v26
  v_max_u32 v48, v48, v27
  v_cmp_eq_u32 vcc, -1, v48
  s_cbranch_vccnz P2_60
  ds_write_b128 v8, v[24:27] offset:0
  s_branch CBA_0
P1_62:
  buffer_load_dwordx4 v[60:63], v0, s[4:7], s17 offen offset:0 sc1
  buffer_load_dwordx4 v[64:67], v0, s[4:7], s17 offen offset:1024 sc1
  buffer_load_dwordx4 v[68:71], v0, s[4:7], s17 offen offset:2048 sc1
  buffer_load_dwordx4 v[72:75], v0, s[4:7], s17 offen offset:3072 sc1
  s_add_u32 s40, s40, 1
  s_add_u32 s93, s93, 1
  s_cmp_gt_u32 s40, 200000
  s_cbranch_scc1 L_fail
  s_waitcnt vmcnt(3)
  v_mfma_f32_16x16x32_bf16 v[48:51], v[60:63], v[76:79], 0
  v_bitop3_b32 v52, v60, v62, s16 bitop3:0x7e
  s_waitcnt vmcnt(2)
  v_mfma_f32_16x16x32_bf16 v[48:51], v[64:67], v[76:79], v[48:51]
  v_bitop3_b32 v52, v52, v64, s16 bitop3:0xf6
  v_bitop3_b32 v52, v52, v66, s16 bitop3:0xf6
  s_waitcnt vmcnt(1)
  v_mfma_f32_16x16x32_bf16 v[48:51], v[68:71], v[76:79], v[48:51]
  v_bitop3_b32 v52, v52, v68, s16 bitop3:0xf6
  v_bitop3_b32 v52, v52, v70, s16 bitop3:0xf6
  s_waitcnt vmcnt(0)
  v_mfma_f32_16x16x32_bf16 v[48:51], v[72:75], v[76:79], v[48:51]
  v_bitop3_b32 v52, v52, v72, s16 bitop3:0xf6
  v_bitop3_b32 v52, v52, v74, s16 bitop3:0xf6
  v_and_b32 v52, 1, v52
  v_cmp_ne_u32 vcc, 0, v52
  s_cbranch_vccz P1K_63
  s_branch P1_62
P2S_66:
  s_add_u32 s89, s89, 1
  s_waitcnt vmcnt(2)
  v_max3_u32 v48, v24, v25, v26
  v_max_u32 v48, v48, v27
  ds_write_b128 v8, v[24:27] offset:0
  s_waitcnt vmcnt(1)
  v_max3_u32 v48, v48, v28, v29
  v_max3_u32 v48, v48, v30, v31
  v_cmp_eq_u32 vcc, -1, v48
  s_cbranch_vccnz P2_65
  ds_write_b128 v8, v[28:31] offset:1024
  s_branch CBA_0
P2_65:
  buffer_load_dwordx4 v[24:27], v0, s[4:7], s41 offen offset:0 sc1
  buffer_load_dwordx4 v[28:31], v0, s[4:7], s41 offen offset:2048 sc1
  buffer_load_dwordx4 v[76:79], v0, s[4:7], s39 offen sc1
  s_add_u32 s40, s40, 1
  s_add_u32 s94, s94, 1
  s_cmp_gt_u32 s40, 200000
  s_cbranch_scc1 L_fail
  s_waitcnt vmcnt(2)
  v_max3_u32 v48, v24, v25, v26
  v_max_u32 v48, v48, v27
  ds_write_b128 v8, v[24:27] offset:0
  s_waitcnt vmcnt(1)
  v_max3_u32 v48, v48, v28, v29
  v_max3_u32 v48, v48, v30, v31
  v_cmp_eq_u32 vcc, -1, v48
  s_cbranch_vccnz P2_65
  ds_write_b128 v8, v[28:31] offset:1024
  s_branch CBA_0
Q1_67:
  buffer_load_dwordx4 v[60:63], v53, s[4:7], s17 offen sc1
  s_add_u32 s40, s40, 1
  s_add_u32 s93, s93, 1
  s_cmp_gt_u32 s40, 200000
  s_cbranch_scc1 L_fail
  s_waitcnt vmcnt(0)
  v_mfma_f32_16x16x32_bf16 v[48:51], v[60:63], v[76:79], 0
  v_bitop3_b32 v52, v60, v62, s16 bitop3:0x7e
  v_and_b32 v52, 1, v52
  v_cmp_ne_u32 vcc, 0, v52
  s_cbranch_vccz Q1K_68
  s_branch Q1_67
P2S_71:
  s_add_u32 s89, s89, 1
  s_waitcnt vmcnt(2)
  v_max3_u32 v48, v24, v25, v26
  v_max_u32 v48, v48, v27
  ds_write_b128 v8, v[24:27] offset:0
  s_waitcnt vmcnt(1)
  v_max3_u32 v48, v48, v28, v29
  v_max3_u32 v48, v48, v30, v31
  v_cmp_eq_u32 vcc, -1, v48
  s_cbranch_vccnz P2_70
  ds_write_b128 v8, v[28:31] offset:1024
  s_branch CBA_0
P2_70:
  buffer_load_dwordx4 v[24:27], v0, s[4:7], s41 offen offset:0 sc1
  buffer_load_dwordx4 v[28:31], v0, s[4:7], s41 offen offset:2048 sc1
  buffer_load_dwordx4 v[76:79], v0, s[4:7], s39 offen sc1
  s_add_u32 s40, s40, 1
  s_add_u32 s94, s94, 1
  s_cmp_gt_u32 s40, 200000
  s_cbranch_scc1 L_fail
  s_waitcnt vmcnt(2)
  v_max3_u32 v48, v24, v25, v26
  v_max_u32 v48, v48, v27
  ds_write_b128 v8, v[24:27] offset:0
  s_waitcnt vmcnt(1)
  v_max3_u32 v48, v48, v28, v29
  v_max3_u32 v48, v48, v30, v31
  v_cmp_eq_u32 vcc, -1, v48
  s_cbranch_vccnz P2_70
  ds_write_b128 v8, v[28:31] offset:1024
  s_branch CBA_0
P1_72:
  buffer_load_dwordx4 v[60:63], v0, s[4:7], s17 offen offset:0 sc1
  buffer_load_dwordx4 v[64:67], v0, s[4:7], s17 offen offset:1024 sc1
  buffer_load_dwordx4 v[68:71], v0, s[4:7], s17 offen offset:2048 sc1
  buffer_load_dwordx4 v[72:75], v0, s[4:7], s17 offen offset:3072 sc1
  s_add_u32 s40, s40, 1
  s_add_u32 s93, s93, 1
  s_cmp_gt_u32 s40, 200000
  s_cbranch_scc1 L_fail
  s_waitcnt vmcnt(3)
  v_mfma_f32_16x16x32_bf16 v[48:51], v[60:63], v[76:79], 0
  v_bitop3_b32 v52, v60, v62, s16 bitop3:0x7e
  s_waitcnt vmcnt(2)
  v_mfma_f32_16x16x32_bf16 v[48:51], v[64:67], v[76:79], v[48:51]
  v_bitop3_b32 v52, v52, v64, s16 bitop3:0xf6
  v_bitop3_b32 v52, v52, v66, s16 bitop3:0xf6
  s_waitcnt vmcnt(1)
  v_mfma_f32_16x16x32_bf16 v[48:51], v[68:71], v[76:79], v[48:51]
  v_bitop3_b32 v52, v52, v68, s16 bitop3:0xf6
  v_bitop3_b32 v52, v52, v70, s16 bitop3:0xf6
  s_waitcnt vmcnt(0)
  v_mfma_f32_16x16x32_bf16 v[48:51], v[72:75], v[76:79], v[48:51]
  v_bitop3_b32 v52, v52, v72, s16 bitop3:0xf6
  v_bitop3_b32 v52, v52, v74, s16 bitop3:0xf6
  v_and_b32 v52, 1, v52
  v_cmp_ne_u32 vcc, 0, v52
  s_cbranch_vccz P1K_73
  s_branch P1_72
CSTEP_1_prep:
  v_mov_b32 v32, 0
  v_mov_b32 v33, 0
  v_mov_b32 v34, 0
  v_mov_b32 v35, 0
  v_mov_b32 v36, 0
  v_mov_b32 v37, 0
  v_mov_b32 v38, 0
  v_mov_b32 v39, 0
  v_mov_b32 v40, 0
  v_mov_b32 v41, 0
  v_mov_b32 v42, 0
  v_mov_b32 v43, 0
  v_mov_b32 v44, 0
  v_mov_b32 v45, 0
  v_mov_b32 v46, 0
  v_mov_b32 v47, 0
  ds_read_b128 v[60:63], v4 offset:8192
  ds_read_b128 v[64:67], v4 offset:9216
  ds_read_b128 v[68:71], v4 offset:18432
  ds_read_b128 v[72:75], v4 offset:19456
  s_add_u32 s53, s14, 1
  s_add_u32 s65, s21, s45
  s_add_u32 s62, s14, 8
  s_lshr_b32 s62, s62, 2
  s_min_u32 s62, s62, 16
  s_cmp_eq_u32 s13, 3
  s_cbranch_scc1 PW_76
  s_mul_i32 s37, s13, 3072
  v_add_u32 v77, s37, v0
  ds_write_b128 v77, v[48:51] offset:0
  ds_write_b128 v77, v[52:55] offset:1024
  ds_write_b128 v77, v[56:59] offset:2048
PW_76:
  s_waitcnt lgkmcnt(0)
  s_barrier
  ds_read_b128 v[76:79], v13 offset:5120
.p2align 8
  s_nop 0
CBA_1:
  s_waitcnt lgkmcnt(0)
  s_barrier
  ds_read_b128 v[48:51], v0 offset:0
  ds_read_b128 v[52:55], v0 offset:1024
  s_waitcnt lgkmcnt(1)
  v_smfmac_f32_16x16x64_bf16 v[32:35], v[48:51], v[60:67], v1
  ds_read_b128 v[56:59], v0 offset:2048
  v_smfmac_f32_16x16x64_bf16 v[36:39], v[48:51], v[80:87], v1
  ds_read_b128 v[60:63], v4 offset:22528
  v_smfmac_f32_16x16x64_bf16 v[40:43], v[48:51], v[88:95], v1
  ds_read_b128 v[64:67], v4 offset:23552
  v_smfmac_f32_16x16x64_bf16 v[44:47], v[48:51], v[96:103], v1
  ds_read_b128 v[48:51], v0 offset:3072
  s_waitcnt lgkmcnt(4)
  v_smfmac_f32_16x16x64_bf16 v[32:35], v[52:55], v[68:75], v1
  ds_read_b128 v[68:71], v4 offset:32768
  v_smfmac_f32_16x16x64_bf16 v[36:39], v[52:55], v[104:111], v1
  ds_read_b128 v[72:75], v4 offset:33792
  v_smfmac_f32_16x16x64_bf16 v[40:43], v[52:55], v[112:119], v1
  v_smfmac_f32_16x16x64_bf16 v[44:47], v[52:55], v[120:127], v1
  ds_read_b128 v[52:55], v0 offset:4096
  s_waitcnt lgkmcnt(3)
  v_smfmac_f32_16x16x64_bf16 v[32:35], v[56:59], v[60:67], v1
  ds_read_b128 v[60:63], v4 offset:6144
  v_smfmac_f32_16x16x64_bf16 v[36:39], v[56:59], v[128:135], v1
  ds_read_b128 v[64:67], v4 offset:7168
  v_smfmac_f32_16x16x64_bf16 v[40:43], v[56:59], v[136:143], v1
  s_waitcnt vmcnt(0)
  ds_write_b128 v13, v[76:79] offset:5120
  v_smfmac_f32_16x16x64_bf16 v[44:47], v[56:59], v[144:151], v1
  v_max3_u32 v76, v76, v77, v78
  s_waitcnt lgkmcnt(3)
  v_smfmac_f32_16x16x64_bf16 v[32:35], v[48:51], v[68:75], v1
  v_max_u32 v76, v76, v79
  ds_read_b128 v[68:71], v4 offset:10240
  v_smfmac_f32_16x16x64_bf16 v[36:39], v[48:51], v[152:159], v1
  v_cmp_eq_u32 vcc, -1, v76
  s_cbranch_vccnz LATE_75
LOK_77:
  ds_read_b128 v[72:75], v4 offset:11264
  v_smfmac_f32_16x16x64_bf16 v[40:43], v[48:51], v[160:167], v1
  v_smfmac_f32_16x16x64_bf16 v[44:47], v[48:51], v[168:175], v1
  s_waitcnt lgkmcnt(2)
  s_barrier
  ds_read_b128 v[56:59], v0 offset:5120
  v_smfmac_f32_16x16x64_bf16 v[32:35], v[52:55], v[60:67], v1
  ds_read_b128 v[48:51], v0 offset:6144
  buffer_load_dwordx4 v[24:27], v12, s[4:7], s18 offen sc1
  v_lshlrev_b32 v78, 3, v0
  v_smfmac_f32_16x16x64_bf16 v[36:39], v[52:55], v[176:183], v1
  ds_read_b128 v[60:63], v4 offset:16384
  buffer_load_dwordx4 v[28:31], v12, s[4:7], s18 offen offset:256 sc1
  v_smfmac_f32_16x16x64_bf16 v[40:43], v[52:55], v[184:191], v1
  ds_read_b128 v[64:67], v4 offset:17408
  v_mov_b32 v76, -1
  v_smfmac_f32_16x16x64_bf16 v[44:47], v[52:55], v[192:199], v1
  ds_read_b128 v[52:55], v0 offset:7168
  buffer_store_dword v76, v11, s[4:7], s65 offen sc1
  s_waitcnt lgkmcnt(3)
  v_smfmac_f32_16x16x64_bf16 v[32:35], v[56:59], v[68:75], v1
  ds_read_b128 v[68:71], v4 offset:20480
  s_mov_b64 exec, 0xffff
  buffer_load_dword v78, s[4:7], s27 offen sc1 lds
  s_mov_b64 exec, -1
  v_smfmac_f32_16x16x64_bf16 v[36:39], v[56:59], v[200:207], v1
  ds_read_b128 v[72:75], v4 offset:21504
  s_waitcnt lgkmcnt(3)
  v_smfmac_f32_16x16x64_bf16 v[40:43], v[56:59], v[60:67], v1
  ds_read_b128 v[60:63], v4 offset:28672
  v_mov_b32 v77, s14
  v_smfmac_f32_16x16x64_bf16 v[44:47], v[56:59], v[208:215], v1
  ds_read_b128 v[56:59], v0 offset:8192
  buffer_store_dword v77, v15, s[4:7], s51 offen sc1
  v_smfmac_f32_16x16x64_bf16 v[32:35], v[48:51], v[216:223], v1
  ds_read_b128 v[64:67], v4 offset:29696
  s_cmp_lt_u32 s44, s62
  s_cbranch_scc1 KVF_78
KVB_79:
  v_smfmac_f32_16x16x64_bf16 v[36:39], v[48:51], v[224:231], v1
  v_mov_b32 v76, 0
  s_waitcnt lgkmcnt(2)
  v_smfmac_f32_16x16x64_bf16 v[40:43], v[48:51], v[68:75], v1
  ds_read_b128 v[68:71], v4 offset:34816
  v_mov_b32 v77, 0
  v_smfmac_f32_16x16x64_bf16 v[44:47], v[48:51], v[232:239], v1
  ds_read_b128 v[72:75], v4 offset:35840
  v_mov_b32 v78, 0
  s_waitcnt lgkmcnt(2)
  v_smfmac_f32_16x16x64_bf16 v[32:35], v[52:55], v[60:67], v1
  v_mov_b32 v79, 0
  v_smfmac_f32_16x16x64_bf16 v[36:39], v[52:55], v[240:247], v1
  v_smfmac_f32_16x16x64_bf16 v[40:43], v[52:55], v[248:255], v1
  v_mov_b32 v60, 0
  v_smfmac_f32_16x16x64_bf16 v[44:47], v[52:55], a[0:7], v1
  v_mov_b32 v61, 0
  s_waitcnt lgkmcnt(0)
  v_smfmac_f32_16x16x64_bf16 v[32:35], v[56:59], v[68:75], v1
  v_mov_b32 v62, 0
  v_smfmac_f32_16x16x64_bf16 v[36:39], v[56:59], a[8:15], v1
  v_mov_b32 v63, 0
  v_smfmac_f32_16x16x64_bf16 v[40:43], v[56:59], a[16:23], v1
  v_smfmac_f32_16x16x64_bf16 v[44:47], v[56:59], a[24:31], v1
  v_smfmac_f32_16x16x64_bf16 v[76:79], v[48:51], a[80:87], v1
  v_smfmac_f32_16x16x64_bf16 v[60:63], v[48:51], a[88:95], v1
  ds_read_b128 v[48:51], v0 offset:0
  v_cvt_pk_bf16_f32 v32, v32, v33
  v_cvt_pk_bf16_f32 v33, v34, v35
  v_cvt_pk_bf16_f32 v36, v36, v37
  v_cvt_pk_bf16_f32 v37, v38, v39
  v_mfma_f32_16x16x16_bf16 v[64:67], v[32:33], v[2:3], 0
  v_cvt_pk_bf16_f32 v40, v40, v41
  v_cvt_pk_bf16_f32 v41, v42, v43
  v_mfma_f32_16x16x16_bf16 v[68:71], v[36:37], v[2:3], 0
  v_cvt_pk_bf16_f32 v44, v44, v45
  v_cvt_pk_bf16_f32 v45, v46, v47
  v_mfma_f32_16x16x16_bf16 v[32:35], v[40:41], v[2:3], 0
  s_nop 0
  v_mfma_f32_16x16x16_bf16 v[36:39], v[44:45], v[2:3], 0
  v_add_u32 v72, s52, v0
  v_cvt_pk_bf16_f32 v64, v64, v65
  v_cvt_pk_bf16_f32 v65, v66, v67
  v_cvt_pk_bf16_f32 v66, v68, v69
  v_cvt_pk_bf16_f32 v67, v70, v71
  s_nop 0
  v_cvt_pk_bf16_f32 v40, v32, v33
  v_cvt_pk_bf16_f32 v41, v34, v35
  s_waitcnt vmcnt(5)
  v_mfma_f32_16x16x32_bf16 v[44:47], v[20:23], v[64:67], 0
  v_cvt_pk_bf16_f32 v42, v36, v37
  v_cvt_pk_bf16_f32 v43, v38, v39
  v_mfma_f32_16x16x32_bf16 v[36:39], v[16:19], v[64:67], 0
  s_nop 0
  v_mfma_f32_16x16x32_bf16 v[32:35], v[40:43], v[64:67], 0
  v_smfmac_f32_16x16x64_bf16 v[76:79], v[52:55], a[112:119], v1
  v_smfmac_f32_16x16x64_bf16 v[60:63], v[52:55], a[120:127], v1
  ds_read_b128 v[52:55], v0 offset:1024
  buffer_load_dwordx4 v[16:19], v12, s[4:7], s24 offen sc1
  buffer_store_dwordx4 v[40:43], v6, s[4:7], s25 offen sc1
  s_nop 0
  v_cndmask_b32 v36, v36, v44, s[46:47]
  v_cndmask_b32 v37, v37, v45, s[46:47]
  v_cndmask_b32 v38, v38, v46, s[46:47]
  v_cndmask_b32 v39, v39, v47, s[46:47]
  ds_write_b128 v5, v[36:39] offset:9216
  buffer_load_dwordx4 v[20:23], v12, s[4:7], s24 offen offset:256 sc1
  v_cndmask_b32 v32, v32, v33, s[46:47]
  v_cndmask_b32 v34, v34, v35, s[46:47]
  v_cndmask_b32 v32, v32, v34, s[2:3]
  ds_write_b32 v72, v32 offset:13312
  v_smfmac_f32_16x16x64_bf16 v[76:79], v[56:59], a[144:151], v1
  v_smfmac_f32_16x16x64_bf16 v[60:63], v[56:59], a[152:159], v1
  ds_read_b128 v[56:59], v0 offset:2048
  s_waitcnt lgkmcnt(3)
  v_smfmac_f32_16x16x64_bf16 v[76:79], v[48:51], a[32:39], v1
  v_smfmac_f32_16x16x64_bf16 v[60:63], v[48:51], a[40:47], v1
  ds_read_b128 v[48:51], v0 offset:3072
  s_waitcnt lgkmcnt(2)
  s_barrier
  ds_read_b128 v[32:35], v0 offset:9216
  v_smfmac_f32_16x16x64_bf16 v[76:79], v[52:55], a[64:71], v1
  ds_read_b128 v[36:39], v0 offset:10240
  v_smfmac_f32_16x16x64_bf16 v[60:63], v[52:55], a[72:79], v1
  ds_read_b128 v[52:55], v0 offset:4096
  s_waitcnt lgkmcnt(4)
  v_smfmac_f32_16x16x64_bf16 v[76:79], v[56:59], a[96:103], v1
  ds_read_b128 v[40:43], v0 offset:11264
  v_smfmac_f32_16x16x64_bf16 v[60:63], v[56:59], a[104:111], v1
  ds_read_b128 v[56:59], v0 offset:5120
  s_waitcnt lgkmcnt(4)
  v_smfmac_f32_16x16x64_bf16 v[76:79], v[48:51], a[128:135], v1
  ds_read_b128 v[44:47], v0 offset:12288
  v_smfmac_f32_16x16x64_bf16 v[60:63], v[48:51], a[136:143], v1
  ds_read_b128 v[68:71], v15 offset:16
  s_waitcnt lgkmcnt(4)
  v_smfmac_f32_16x16x64_bf16 v[76:79], v[52:55], a[160:167], v1
  ds_read_b128 v[48:51], v0 offset:13312
  v_smfmac_f32_16x16x64_bf16 v[60:63], v[52:55], a[168:175], v1
  ds_read_b64 v[72:73], v15 offset:32
  s_waitcnt lgkmcnt(4)
  v_smfmac_f32_16x16x64_bf16 v[76:79], v[56:59], a[48:55], v1
  v_smfmac_f32_16x16x64_bf16 v[60:63], v[56:59], a[56:63], v1
  v_pk_add_f32 v[32:33], v[32:33], v[36:37]
  v_pk_add_f32 v[34:35], v[34:35], v[38:39]
  s_waitcnt lgkmcnt(2)
  v_pk_add_f32 v[40:41], v[40:41], v[44:45]
  v_pk_add_f32 v[42:43], v[42:43], v[46:47]
  v_pk_add_f32 v[32:33], v[32:33], v[40:41]
  v_pk_add_f32 v[34:35], v[34:35], v[42:43]
  v_pk_mul_f32 v[32:33], v[32:33], s[70:71]
  v_pk_mul_f32 v[34:35], v[34:35], s[70:71]
  v_cvt_pk_bf16_f32 v64, v76, v77
  v_cvt_pk_bf16_f32 v65, v78, v79
  v_cvt_pk_bf16_f32 v66, v60, v61
  v_cvt_pk_bf16_f32 v67, v62, v63
  s_cmp_eq_u32 s14, 63
  s_cbranch_scc1 CDONE_44
  v_exp_f32 v32, v32
  v_exp_f32 v33, v33
  v_exp_f32 v34, v34
  buffer_store_dwordx4 v[64:67], v0, s[4:7], s26 offen sc1
  v_exp_f32 v35, v35
  s_waitcnt lgkmcnt(0)
  v_pk_add_f32 v[48:49], v[48:49], v[50:51]
  v_cvt_pk_bf16_f32 v44, v32, v33
  v_cvt_pk_bf16_f32 v46, v32, v33
  v_cvt_pk_bf16_f32 v45, v34, v35
  v_cvt_pk_bf16_f32 v47, v34, v35
  v_add_f32 v48, v48, v49
  v_mov_b32_dpp v44, v46 row_ror:8 row_mask:0xf bank_mask:0xc
  v_mul_f32 v48, s70, v48
  v_mov_b32_dpp v45, v47 row_ror:8 row_mask:0xf bank_mask:0xc
  v_mov_b32_dpp v46, v46 row_ror:8 row_mask:0xf bank_mask:0x3
  v_mov_b32_dpp v47, v47 row_ror:8 row_mask:0xf bank_mask:0x3
  v_exp_f32 v49, v48
  s_nop 0
  v_mfma_f32_16x16x32_bf16 v[76:79], v[68:71], v[44:47], 0
  v_mov_b32 v48, v49
  s_waitcnt vmcnt(8)
  v_mfma_f32_16x16x32_bf16 v[32:35], v[24:27], v[44:47], 0
  v_mov_b32_dpp v48, v49 row_ror:8 row_mask:0xf bank_mask:0xc
  v_mov_b32_dpp v49, v49 row_ror:8 row_mask:0xf bank_mask:0x3
  s_waitcnt vmcnt(7)
  v_mfma_f32_16x16x32_bf16 v[36:39], v[28:31], v[44:47], 0
  v_cvt_pk_bf16_f32 v40, v48, v49
  v_cvt_pk_bf16_f32 v41, v48, v49
  v_mov_b32 v48, 0
  v_mov_b32 v49, 0
  v_permlane32_swap_b32 v40, v41
  v_mov_b32 v50, 0
  v_mov_b32 v51, 0
  v_mfma_f32_16x16x16_bf16 v[76:79], v[72:73], v[40:41], v[76:79]
  ds_read_b128 v[52:55], v15
  v_mfma_f32_16x16x16_bf16 v[32:35], v[64:65], v[40:41], v[32:35]
  ds_read_b128 v[56:59], v15
  v_mfma_f32_16x16x16_bf16 v[36:39], v[66:67], v[40:41], v[36:39]
  v_xor_b32 v40, 1536, v6
  s_nop 2
  v_subrev_u32 v74, s69, v76
  v_rcp_f32 v42, v76
  v_cmp_lt_u32 vcc, s23, v74
  s_cbranch_vccnz SMX_80
SMK_81:
  ds_read_b128 v[60:63], v15
  v_pk_mul_f32 v[32:33], v[32:33], v[42:43] op_sel_hi:[1,0]
  v_pk_mul_f32 v[34:35], v[34:35], v[42:43] op_sel_hi:[1,0]
  v_pk_mul_f32 v[36:37], v[36:37], v[42:43] op_sel_hi:[1,0]
  v_pk_mul_f32 v[38:39], v[38:39], v[42:43] op_sel_hi:[1,0]
  v_cvt_pk_bf16_f32 v44, v32, v33
  v_cvt_pk_bf16_f32 v45, v34, v35
  v_cvt_pk_bf16_f32 v46, v36, v37
  v_cvt_pk_bf16_f32 v47, v38, v39
  ds_write_b128 v6, v[44:47] offset:7168
  ds_read_b128 v[24:27], v4 offset:12288
  v_mfma_f32_16x16x32_bf16 v[76:79], v[44:47], a[240:243], 0
  ds_read_b128 v[28:31], v4 offset:13312
  v_xor_b32 v32, 512, v6
  v_xor_b32 v36, 1024, v6
  v_smfmac_f32_16x16x64_bf16 v[48:51], v[44:47], a[176:183], v1
  ds_read_b128 v[68:71], v4 offset:14336
  s_waitcnt lgkmcnt(4)
  v_smfmac_f32_16x16x64_bf16 v[52:55], v[44:47], a[184:191], v1
  ds_read_b128 v[72:75], v4 offset:15360
  s_waitcnt lgkmcnt(4)
  s_barrier
  ds_read_b128 v[32:35], v32 offset:7168
  ds_read_b128 v[36:39], v36 offset:7168
  ds_read_b128 v[40:43], v40 offset:7168
  s_waitcnt lgkmcnt(5)
  v_smfmac_f32_16x16x64_bf16 v[56:59], v[44:47], v[24:31], v1
  ds_read_b128 v[24:27], v4 offset:30720
  s_waitcnt lgkmcnt(4)
  v_smfmac_f32_16x16x64_bf16 v[60:63], v[44:47], v[68:75], v1
  ds_read_b128 v[28:31], v4 offset:31744
  v_mov_b32 v67, s53
  v_mov_b32 v64, 0
  s_waitcnt lgkmcnt(4)
  v_mfma_f32_16x16x32_bf16 v[76:79], v[32:35], a[244:247], v[76:79]
  ds_read_b128 v[68:71], v4 offset:0
  s_waitcnt lgkmcnt(3)
  v_mfma_f32_16x16x32_bf16 v[76:79], v[36:39], a[248:251], v[76:79]
  ds_read_b128 v[72:75], v4 offset:1024
  v_mfma_f32_16x16x32_bf16 v[76:79], v[40:43], a[252:255], v[76:79]
  buffer_store_dword v67, v15, s[4:7], s60 offen sc1
  v_smfmac_f32_16x16x64_bf16 v[48:51], v[32:35], a[192:199], v1
  s_waitcnt lgkmcnt(2)
  v_smfmac_f32_16x16x64_bf16 v[48:51], v[36:39], v[24:31], v1
  ds_read_b128 v[24:27], v4 offset:2048
  s_waitcnt lgkmcnt(1)
  v_smfmac_f32_16x16x64_bf16 v[48:51], v[40:43], v[68:75], v1
  ds_read_b128 v[28:31], v4 offset:3072
  v_cvt_pk_bf16_f32 v76, v76, v77
  v_smfmac_f32_16x16x64_bf16 v[52:55], v[32:35], a[200:207], v1
  ds_read_b128 v[68:71], v4 offset:24576
  v_cvt_pk_bf16_f32 v77, v78, v79
  v_smfmac_f32_16x16x64_bf16 v[52:55], v[36:39], a[208:215], v1
  ds_read_b128 v[72:75], v4 offset:25600
  buffer_load_dword v64, v7, s[4:7], s61 offen sc1
  v_and_or_b32 v76, v76, -2, s16
  s_waitcnt lgkmcnt(2)
  v_smfmac_f32_16x16x64_bf16 v[52:55], v[40:43], v[24:31], v1
  ds_read_b128 v[24:27], v4 offset:26624
  s_mov_b64 exec, 0xffffffff
  buffer_store_dwordx2 v[76:77], v10, s[4:7], 0 offen sc1
  s_mov_b64 exec, -1
  s_waitcnt lgkmcnt(1)
  v_smfmac_f32_16x16x64_bf16 v[56:59], v[32:35], v[68:75], v1
  ds_read_b128 v[28:31], v4 offset:27648
  buffer_load_dword v64, v7, s[4:7], s61 offen sc1
  v_cvt_pk_bf16_f32 v48, v48, v49
  v_cvt_pk_bf16_f32 v49, v50, v51
  v_cvt_pk_bf16_f32 v51, v54, v55
  v_cvt_pk_bf16_f32 v50, v52, v53
  v_and_or_b32 v50, v50, -2, s16
  v_and_or_b32 v48, v48, -2, s16
  v_permlane16_swap_b32 v49, v51
  s_nop 0
  v_permlane16_swap_b32 v48, v50
  buffer_store_dwordx4 v[48:51], v9, s[4:7], 0 offen sc1
  s_nop 0
  v_smfmac_f32_16x16x64_bf16 v[56:59], v[36:39], a[216:223], v1
  ds_read_b128 v[68:71], v4 offset:4096
  v_smfmac_f32_16x16x64_bf16 v[56:59], v[40:43], a[232:239], v1
  ds_read_b128 v[72:75], v4 offset:5120
  buffer_load_dword v64, v7, s[4:7], s61 offen sc1
  s_waitcnt lgkmcnt(2)
  v_smfmac_f32_16x16x64_bf16 v[60:63], v[32:35], v[24:31], v1
  v_smfmac_f32_16x16x64_bf16 v[60:63], v[36:39], a[224:231], v1
  buffer_load_dword v64, v7, s[4:7], s61 offen sc1
  s_waitcnt lgkmcnt(0)
  v_smfmac_f32_16x16x64_bf16 v[60:63], v[40:43], v[68:75], v1
  s_cmp_lg_u32 s13, 3
  v_cvt_pk_bf16_f32 v56, v56, v57
  v_cvt_pk_bf16_f32 v57, v58, v59
  s_nop 4
  v_cvt_pk_bf16_f32 v59, v62, v63
  v_cvt_pk_bf16_f32 v58, v60, v61
  v_and_or_b32 v58, v58, -2, s16
  v_and_or_b32 v56, v56, -2, s16
  v_permlane16_swap_b32 v57, v59
  s_nop 0
  v_permlane16_swap_b32 v56, v58
  buffer_store_dwordx4 v[56:59], v9, s[4:7], s49 offen sc1
  s_cbranch_scc1 W3_84
  v_cmp_gt_u32 vcc, s53, v64
  s_nop 0
  s_andn2_b64 vcc, vcc, s[10:11]
  s_cbranch_scc1 SPIN_86
GO_87:
  s_barrier
  v_mov_b32 v32, 0
  v_mov_b32 v33, 0
  v_mov_b32 v34, 0
  v_mov_b32 v35, 0
  v_mov_b32 v36, 0
  v_mov_b32 v37, 0
  v_mov_b32 v38, 0
  v_mov_b32 v39, 0
  v_mov_b32 v40, 0
  v_mov_b32 v41, 0
  v_mov_b32 v42, 0
  v_mov_b32 v43, 0
  v_mov_b32 v44, 0
  v_mov_b32 v45, 0
  v_mov_b32 v46, 0
  v_mov_b32 v47, 0
  s_mov_b32 s40, 0
  s_add_u32 s37, s14, 3
  s_lshr_b32 s37, s37, 2
  s_add_u32 s37, s37, 1
  s_min_u32 s37, s37, 16
  v_mov_b32 v52, 162880
  ds_read2_b32 v[52:53], v52 offset0:64 offset1:128
  s_waitcnt lgkmcnt(0)
  v_min_u32 v52, v52, v53
  s_nop 0
  v_readfirstlane_b32 s38, v52
  s_nop 0
  s_max_u32 s44, s44, s38
  s_cmp_ge_u32 s44, s37
  s_cbranch_scc1 KVOK_89
  s_mov_b32 s40, 0
KVW_88:
  v_mov_b32 v58, 0
  buffer_load_dword v59, v58, s[4:7], s43 offen offset:256 sc1
  buffer_load_dword v58, v58, s[4:7], s43 offen sc1
  s_add_u32 s40, s40, 1
  s_cmp_gt_u32 s40, 200000
  s_cbranch_scc1 L_fail
  s_waitcnt vmcnt(0)
  v_min_u32 v58, v58, v59
  s_nop 0
  v_readfirstlane_b32 s44, v58
  s_nop 0
  s_cmp_lt_u32 s44, s37
  s_cbranch_scc1 KVW_88
KVOK_89:
  s_nop 15
  s_nop 15
  s_nop 15
  s_nop 15
  s_nop 15
  s_nop 7
  ds_read_b128 v[60:63], v4 offset:8192
  s_waitcnt vmcnt(0)
  ds_read_b128 v[64:67], v4 offset:9216
  ds_read_b128 v[68:71], v4 offset:18432
  ds_read_b128 v[72:75], v4 offset:19456
  s_add_u32 s41, s19, s48
  s_add_u32 s39, s19, s22
  s_xor_b32 s16, s16, 1
  s_mov_b32 s37, s21
  s_mov_b32 s21, s20
  s_mov_b32 s20, s19
  s_mov_b32 s19, s37
  s_add_u32 s18, s24, 8192
  s_add_u32 s24, s24, 524288
  s_add_u32 s27, s27, 524288
  s_add_u32 s25, s25, 65536
  s_mov_b32 s64, s26
  s_add_u32 s26, s26, 131072
  s_add_u32 s14, s14, 1
  s_mov_b32 s40, 0
  s_add_u32 s53, s14, 1
  s_add_u32 s65, s21, s45
  s_add_u32 s62, s14, 8
  s_lshr_b32 s62, s62, 2
  s_min_u32 s62, s62, 16
  buffer_load_dwordx4 v[24:27], v0, s[4:7], s41 offen offset:0 sc1
  s_nop 15
  s_nop 15
  s_nop 5
  buffer_load_dwordx4 v[24:27], v0, s[4:7], s41 offen offset:0 sc1
  s_nop 15
  s_nop 3
  buffer_load_dwordx4 v[76:79], v0, s[4:7], s39 offen sc1
  s_waitcnt vmcnt(2)
  v_max3_u32 v48, v24, v25, v26
  v_max_u32 v48, v48, v27
  v_cmp_eq_u32 vcc, -1, v48
  s_cbranch_vccnz P2S_91
  ds_write_b128 v8, v[24:27] offset:0
  s_branch CBA_1
W3_84:
  ds_read_b128 v[76:79], v0 offset:14400
  s_cmp_lg_u32 s13, 0
  s_cbranch_scc1 W2_83
  s_barrier
  s_nop 3
  buffer_load_dwordx4 v[60:63], v0, s[4:7], s17 offen offset:0 sc1
  buffer_load_dwordx4 v[64:67], v0, s[4:7], s17 offen offset:1024 sc1
  buffer_load_dwordx4 v[68:71], v0, s[4:7], s17 offen offset:2048 sc1
  buffer_load_dwordx4 v[72:75], v0, s[4:7], s17 offen offset:3072 sc1
  v_mov_b32 v32, 0
  v_mov_b32 v33, 0
  v_mov_b32 v34, 0
  v_mov_b32 v35, 0
  v_mov_b32 v36, 0
  v_mov_b32 v37, 0
  v_mov_b32 v38, 0
  v_mov_b32 v39, 0
  v_mov_b32 v40, 0
  v_mov_b32 v41, 0
  v_mov_b32 v42, 0
  v_mov_b32 v43, 0
  v_mov_b32 v44, 0
  v_mov_b32 v45, 0
  v_mov_b32 v46, 0
  v_mov_b32 v47, 0
  s_mov_b32 s40, 0
  s_waitcnt vmcnt(3) lgkmcnt(0)
  v_mfma_f32_16x16x32_bf16 v[48:51], v[60:63], v[76:79], 0
  v_bitop3_b32 v52, v60, v62, s16 bitop3:0x7e
  s_waitcnt vmcnt(2)
  v_mfma_f32_16x16x32_bf16 v[48:51], v[64:67], v[76:79], v[48:51]
  v_bitop3_b32 v52, v52, v64, s16 bitop3:0xf6
  v_bitop3_b32 v52, v52, v66, s16 bitop3:0xf6
  s_waitcnt vmcnt(1)
  v_mfma_f32_16x16x32_bf16 v[48:51], v[68:71], v[76:79], v[48:51]
  v_bitop3_b32 v52, v52, v68, s16 bitop3:0xf6
  v_bitop3_b32 v52, v52, v70, s16 bitop3:0xf6
  s_waitcnt vmcnt(0)
  v_mfma_f32_16x16x32_bf16 v[48:51], v[72:75], v[76:79], v[48:51]
  v_bitop3_b32 v52, v52, v72, s16 bitop3:0xf6
  v_bitop3_b32 v52, v52, v74, s16 bitop3:0xf6
  v_and_b32 v52, 1, v52
  v_cmp_ne_u32 vcc, 0, v52
  s_cbranch_vccnz P1_92
P1K_93:
  s_nop 2
  v_permlane32_swap_b32 v48, v50
  v_permlane32_swap_b32 v49, v51
  v_pk_add_f32 v[48:49], v[48:49], v[50:51]
  v_cvt_pk_bf16_f32 v48, v48, v49
  buffer_store_dword v48, v11, s[4:7], s19 offen sc1
  ds_read_b128 v[60:63], v4 offset:8192
  ds_read_b128 v[64:67], v4 offset:9216
  ds_read_b128 v[68:71], v4 offset:18432
  ds_read_b128 v[72:75], v4 offset:19456
  s_add_u32 s41, s19, s48
  s_add_u32 s39, s19, s22
  s_xor_b32 s16, s16, 1
  s_mov_b32 s37, s21
  s_mov_b32 s21, s20
  s_mov_b32 s20, s19
  s_mov_b32 s19, s37
  s_add_u32 s18, s24, 8192
  s_add_u32 s24, s24, 524288
  s_add_u32 s27, s27, 524288
  s_add_u32 s25, s25, 65536
  s_mov_b32 s64, s26
  s_add_u32 s26, s26, 131072
  s_add_u32 s14, s14, 1
  s_mov_b32 s40, 0
  s_add_u32 s53, s14, 1
  s_add_u32 s65, s21, s45
  s_add_u32 s62, s14, 8
  s_lshr_b32 s62, s62, 2
  s_min_u32 s62, s62, 16
  s_nop 15
  s_nop 8
  buffer_load_dwordx4 v[24:27], v0, s[4:7], s41 offen offset:0 sc1
  buffer_load_dwordx4 v[28:31], v0, s[4:7], s41 offen offset:2048 sc1
  s_nop 15
  s_nop 15
  s_nop 5
  buffer_load_dwordx4 v[24:27], v0, s[4:7], s41 offen offset:0 sc1
  buffer_load_dwordx4 v[28:31], v0, s[4:7], s41 offen offset:2048 sc1
  s_nop 15
  s_nop 3
  buffer_load_dwordx4 v[76:79], v0, s[4:7], s39 offen sc1
  s_waitcnt vmcnt(4)
  v_max3_u32 v48, v24, v25, v26
  v_max_u32 v48, v48, v27
  ds_write_b128 v8, v[24:27] offset:0
  s_waitcnt vmcnt(3)
  v_max3_u32 v48, v48, v28, v29
  v_max3_u32 v48, v48, v30, v31
  v_cmp_eq_u32 vcc, -1, v48
  s_cbranch_vccnz P2S_96
  ds_write_b128 v8, v[28:31] offset:1024
  s_branch CBA_1
W2_83:
  s_cmp_lg_u32 s13, 2
  s_cbranch_scc1 W1_82
  v_lshrrev_b32 v53, 5, v0
  v_lshlrev_b32 v53, 7, v53
  v_and_or_b32 v53, v0, 16, v53
  s_barrier
  buffer_load_dwordx4 v[60:63], v53, s[4:7], s17 offen sc1
  v_mov_b32 v32, 0
  v_mov_b32 v33, 0
  v_mov_b32 v34, 0
  v_mov_b32 v35, 0
  v_mov_b32 v36, 0
  v_mov_b32 v37, 0
  v_mov_b32 v38, 0
  v_mov_b32 v39, 0
  v_mov_b32 v40, 0
  v_mov_b32 v41, 0
  v_mov_b32 v42, 0
  v_mov_b32 v43, 0
  v_mov_b32 v44, 0
  v_mov_b32 v45, 0
  v_mov_b32 v46, 0
  v_mov_b32 v47, 0
  s_mov_b32 s40, 0
  s_waitcnt vmcnt(0) lgkmcnt(0)
  v_mfma_f32_16x16x32_bf16 v[48:51], v[60:63], v[76:79], 0
  v_bitop3_b32 v52, v60, v62, s16 bitop3:0x7e
  v_and_b32 v52, 1, v52
  v_cmp_ne_u32 vcc, 0, v52
  s_cbranch_vccnz Q1_97
Q1K_98:
  s_nop 3
  v_pk_add_f32 v[48:49], v[48:49], v[50:51]
  s_nop 1
  v_permlane32_swap_b32 v48, v49
  v_add_f32 v48, v48, v49
  v_mov_b32 v49, v48
  s_nop 1
  v_permlane16_swap_b32 v48, v49
  v_add_f32 v48, v48, v49
  v_mov_b32 v49, v48
  s_nop 1
  v_permlane32_swap_b32 v48, v49
  v_cvt_pk_bf16_f32 v48, v48, v49
  buffer_store_dword v48, v11, s[4:7], s19 offen sc1
  ds_read_b128 v[60:63], v4 offset:8192
  ds_read_b128 v[64:67], v4 offset:9216
  ds_read_b128 v[68:71], v4 offset:18432
  ds_read_b128 v[72:75], v4 offset:19456
  s_add_u32 s41, s19, s48
  s_add_u32 s39, s19, s22
  s_xor_b32 s16, s16, 1
  s_mov_b32 s37, s21
  s_mov_b32 s21, s20
  s_mov_b32 s20, s19
  s_mov_b32 s19, s37
  s_add_u32 s18, s24, 8192
  s_add_u32 s24, s24, 524288
  s_add_u32 s27, s27, 524288
  s_add_u32 s25, s25, 65536
  s_mov_b32 s64, s26
  s_add_u32 s26, s26, 131072
  s_add_u32 s14, s14, 1
  s_mov_b32 s40, 0
  s_add_u32 s53, s14, 1
  s_add_u32 s65, s21, s45
  s_add_u32 s62, s14, 8
  s_lshr_b32 s62, s62, 2
  s_min_u32 s62, s62, 16
  s_nop 15
  s_nop 13
  buffer_load_dwordx4 v[24:27], v0, s[4:7], s41 offen offset:0 sc1
  buffer_load_dwordx4 v[28:31], v0, s[4:7], s41 offen offset:2048 sc1
  s_nop 15
  s_nop 15
  s_nop 5
  buffer_load_dwordx4 v[24:27], v0, s[4:7], s41 offen offset:0 sc1
  buffer_load_dwordx4 v[28:31], v0, s[4:7], s41 offen offset:2048 sc1
  s_nop 15
  s_nop 3
  buffer_load_dwordx4 v[76:79], v0, s[4:7], s39 offen sc1
  s_waitcnt vmcnt(4)
  v_max3_u32 v48, v24, v25, v26
  v_max_u32 v48, v48, v27
  ds_write_b128 v8, v[24:27] offset:0
  s_waitcnt vmcnt(3)
  v_max3_u32 v48, v48, v28, v29
  v_max3_u32 v48, v48, v30, v31
  v_cmp_eq_u32 vcc, -1, v48
  s_cbranch_vccnz P2S_101
  ds_write_b128 v8, v[28:31] offset:1024
  s_branch CBA_1
W1_82:
  v_mov_b32 v32, 0
  v_mov_b32 v33, 0
  v_mov_b32 v34, 0
  v_mov_b32 v35, 0
  v_mov_b32 v36, 0
  v_mov_b32 v37, 0
  v_mov_b32 v38, 0
  v_mov_b32 v39, 0
  v_mov_b32 v40, 0
  v_mov_b32 v41, 0
  v_mov_b32 v42, 0
  v_mov_b32 v43, 0
  v_mov_b32 v44, 0
  v_mov_b32 v45, 0
  v_mov_b32 v46, 0
  v_mov_b32 v47, 0
  s_mov_b32 s40, 0
  s_barrier
  s_nop 15
  s_nop 15
  s_nop 15
  s_nop 9
  buffer_load_dwordx4 v[60:63], v0, s[4:7], s17 offen offset:0 sc1
  buffer_load_dwordx4 v[64:67], v0, s[4:7], s17 offen offset:1024 sc1
  buffer_load_dwordx4 v[68:71], v0, s[4:7], s17 offen offset:2048 sc1
  buffer_load_dwordx4 v[72:75], v0, s[4:7], s17 offen offset:3072 sc1
  s_waitcnt vmcnt(3) lgkmcnt(0)
  v_mfma_f32_16x16x32_bf16 v[48:51], v[60:63], v[76:79], 0
  v_bitop3_b32 v52, v60, v62, s16 bitop3:0x7e
  s_waitcnt vmcnt(2)
  v_mfma_f32_16x16x32_bf16 v[48:51], v[64:67], v[76:79], v[48:51]
  v_bitop3_b32 v52, v52, v64, s16 bitop3:0xf6
  v_bitop3_b32 v52, v52, v66, s16 bitop3:0xf6
  s_waitcnt vmcnt(1)
  v_mfma_f32_16x16x32_bf16 v[48:51], v[68:71], v[76:79], v[48:51]
  v_bitop3_b32 v52, v52, v68, s16 bitop3:0xf6
  v_bitop3_b32 v52, v52, v70, s16 bitop3:0xf6
  s_waitcnt vmcnt(0)
  v_mfma_f32_16x16x32_bf16 v[48:51], v[72:75], v[76:79], v[48:51]
  v_bitop3_b32 v52, v52, v72, s16 bitop3:0xf6
  v_bitop3_b32 v52, v52, v74, s16 bitop3:0xf6
  v_and_b32 v52, 1, v52
  v_cmp_ne_u32 vcc, 0, v52
  s_cbranch_vccnz P1_102
P1K_103:
  s_nop 2
  v_permlane32_swap_b32 v48, v50
  v_permlane32_swap_b32 v49, v51
  v_pk_add_f32 v[48:49], v[48:49], v[50:51]
  v_cvt_pk_bf16_f32 v48, v48, v49
  buffer_store_dword v48, v11, s[4:7], s19 offen sc1
  ds_read_b128 v[60:63], v4 offset:8192
  ds_read_b128 v[64:67], v4 offset:9216
  ds_read_b128 v[68:71], v4 offset:18432
  ds_read_b128 v[72:75], v4 offset:19456
  s_add_u32 s41, s19, s48
  s_add_u32 s39, s19, s22
  s_xor_b32 s16, s16, 1
  s_mov_b32 s37, s21
  s_mov_b32 s21, s20
  s_mov_b32 s20, s19
  s_mov_b32 s19, s37
  s_add_u32 s18, s24, 8192
  s_add_u32 s24, s24, 524288
  s_add_u32 s27, s27, 524288
  s_add_u32 s25, s25, 65536
  s_mov_b32 s64, s26
  s_add_u32 s26, s26, 131072
  s_add_u32 s14, s14, 1
  s_mov_b32 s40, 0
  s_add_u32 s53, s14, 1
  s_add_u32 s65, s21, s45
  s_add_u32 s62, s14, 8
  s_lshr_b32 s62, s62, 2
  s_min_u32 s62, s62, 16
  s_nop 15
  s_nop 15
  s_nop 15
  s_nop 15
  s_nop 9
  buffer_load_dwordx4 v[76:79], v0, s[4:7], s39 offen sc1
  s_branch CBA_1
LATE_75:
  buffer_load_dwordx4 v[76:79], v0, s[4:7], s39 offen sc1
  s_add_u32 s40, s40, 1
  s_add_u32 s92, s92, 1
  s_cmp_gt_u32 s40, 200000
  s_cbranch_scc1 L_fail
  s_waitcnt vmcnt(0)
  ds_write_b128 v13, v[76:79] offset:5120
  s_nop 1
  v_max3_u32 v76, v76, v77, v78
  v_max_u32 v76, v76, v79
  v_cmp_eq_u32 vcc, -1, v76
  s_cbranch_vccnz LATE_75
  s_waitcnt lgkmcnt(0)
  s_branch LOK_77
KVF_78:
  buffer_load_dword v15, s[4:7], s68 offen offset:256 sc1 lds
  buffer_load_dword v15, s[4:7], s68 offen offset:512 sc1 lds
  s_branch KVB_79
SMX_80:
  ds_read_b128 v[36:39], v0 offset:9216
  ds_read_b128 v[52:55], v0 offset:10240
  ds_read_b128 v[56:59], v0 offset:11264
  ds_read_b128 v[60:63], v0 offset:12288
  ds_read_b128 v[48:51], v0 offset:13312
  s_waitcnt lgkmcnt(3)
  v_pk_add_f32 v[36:37], v[36:37], v[52:53]
  v_pk_add_f32 v[38:39], v[38:39], v[54:55]
  s_waitcnt lgkmcnt(1)
  v_pk_add_f32 v[56:57], v[56:57], v[60:61]
  v_pk_add_f32 v[58:59], v[58:59], v[62:63]
  v_pk_add_f32 v[36:37], v[36:37], v[56:57]
  v_pk_add_f32 v[38:39], v[38:39], v[58:59]
  v_mov_b32 v32, v36
  v_mov_b32 v33, v37
  v_mov_b32 v34, v38
  v_mov_b32 v35, v39
  v_pk_mul_f32 v[32:33], v[32:33], s[70:71]
  v_pk_mul_f32 v[34:35], v[34:35], s[70:71]
  s_waitcnt lgkmcnt(0)
  v_pk_add_f32 v[48:49], v[48:49], v[50:51]
  v_add_f32 v48, v48, v49
  v_mul_f32 v48, s70, v48
  v_max3_f32 v74, v32, v33, v34
  v_max3_f32 v74, v74, v48, v35
  s_nop 1
  v_max_f32_dpp v74, v74, v74 row_ror:8 row_mask:0xf bank_mask:0xf
  v_mov_b32 v75, v74
  s_nop 1
  v_permlane32_swap_b32 v74, v75
  v_max_f32 v74, v74, v75
  v_mov_b32 v75, v74
  s_nop 1
  v_permlane16_swap_b32 v74, v75
  v_max_f32 v74, v74, v75
  v_sub_f32 v48, v48, v74
  v_sub_f32 v32, v32, v74
  v_sub_f32 v33, v33, v74
  v_sub_f32 v34, v34, v74
  v_sub_f32 v35, v35, v74
  v_exp_f32 v32, v32
  v_exp_f32 v33, v33
  v_exp_f32 v34, v34
  v_exp_f32 v35, v35
  v_cvt_pk_bf16_f32 v44, v32, v33
  v_cvt_pk_bf16_f32 v46, v32, v33
  v_cvt_pk_bf16_f32 v45, v34, v35
  v_cvt_pk_bf16_f32 v47, v34, v35
  v_mov_b32_dpp v44, v46 row_ror:8 row_mask:0xf bank_mask:0xc
  s_nop 0
  v_mov_b32_dpp v45, v47 row_ror:8 row_mask:0xf bank_mask:0xc
  v_mov_b32_dpp v46, v46 row_ror:8 row_mask:0xf bank_mask:0x3
  v_mov_b32_dpp v47, v47 row_ror:8 row_mask:0xf bank_mask:0x3
  v_exp_f32 v49, v48
  s_nop 0
  v_mfma_f32_16x16x32_bf16 v[76:79], v[68:71], v[44:47], 0
  v_mov_b32 v48, v49
  v_mfma_f32_16x16x32_bf16 v[32:35], v[24:27], v[44:47], 0
  s_nop 0
  v_mov_b32_dpp v48, v49 row_ror:8 row_mask:0xf bank_mask:0xc
  v_mov_b32_dpp v49, v49 row_ror:8 row_mask:0xf bank_mask:0x3
  v_mfma_f32_16x16x32_bf16 v[36:39], v[28:31], v[44:47], 0
  v_cvt_pk_bf16_f32 v40, v48, v49
  v_cvt_pk_bf16_f32 v41, v48, v49
  v_mov_b32 v48, 0
  v_mov_b32 v49, 0
  v_permlane32_swap_b32 v40, v41
  v_mov_b32 v50, 0
  v_mov_b32 v51, 0
  v_mfma_f32_16x16x16_bf16 v[76:79], v[72:73], v[40:41], v[76:79]
  ds_read_b128 v[52:55], v15
  v_mfma_f32_16x16x16_bf16 v[32:35], v[64:65], v[40:41], v[32:35]
  ds_read_b128 v[56:59], v15
  v_mfma_f32_16x16x16_bf16 v[36:39], v[66:67], v[40:41], v[36:39]
  v_xor_b32 v40, 1536, v6
  s_nop 2
  v_rcp_f32 v42, v76
  s_branch SMK_81
SPIN_86:
  s_mov_b32 s40, 0
SPIN_86_l:
  buffer_load_dword v64, v7, s[4:7], s61 offen sc1
  s_add_u32 s91, s91, 1
  s_nop 1
  v_cmp_gt_u32 vcc, s53, v64
  s_nop 0
  s_andn2_b64 vcc, vcc, s[10:11]
  s_cbranch_scc0 SPIN_86_d
  buffer_load_dword v64, v7, s[4:7], s61 offen sc1
  s_add_u32 s91, s91, 1
  s_nop 1
  v_cmp_gt_u32 vcc, s53, v64
  s_nop 0
  s_andn2_b64 vcc, vcc, s[10:11]
  s_cbranch_scc0 SPIN_86_d
  buffer_load_dword v64, v7, s[4:7], s61 offen sc1
  s_add_u32 s91, s91, 1
  s_nop 1
  v_cmp_gt_u32 vcc, s53, v64
  s_nop 0
  s_andn2_b64 vcc, vcc, s[10:11]
  s_cbranch_scc0 SPIN_86_d
  buffer_load_dword v64, v7, s[4:7], s61 offen sc1
  s_add_u32 s91, s91, 1
  s_nop 1
  v_cmp_gt_u32 vcc, s53, v64
  s_nop 0
  s_andn2_b64 vcc, vcc, s[10:11]
  s_cbranch_scc0 SPIN_86_d
  s_add_u32 s40, s40, 1
  s_cmp_lt_u32 s40, 32
  s_cbranch_scc1 SPIN_86_l
SPIN_86_d:
  s_branch GO_87
P2S_91:
  s_add_u32 s89, s89, 1
  s_waitcnt vmcnt(1)
  v_max3_u32 v48, v24, v25, v26
  v_max_u32 v48, v48, v27
  v_cmp_eq_u32 vcc, -1, v48
  s_cbranch_vccnz P2_90
  ds_write_b128 v8, v[24:27] offset:0
  s_branch CBA_1
P2_90:
  buffer_load_dwordx4 v[24:27], v0, s[4:7], s41 offen offset:0 sc1
  buffer_load_dwordx4 v[76:79], v0, s[4:7], s39 offen sc1
  s_add_u32 s40, s40, 1
  s_add_u32 s94, s94, 1
  s_cmp_gt_u32 s40, 200000
  s_cbranch_scc1 L_fail
  s_waitcnt vmcnt(1)
  v_max3_u32 v48, v24, v25, v26
  v_max_u32 v48, v48, v27
  v_cmp_eq_u32 vcc, -1, v48
  s_cbranch_vccnz P2_90
  ds_write_b128 v8, v[24:27] offset:0
  s_branch CBA_1
P1_92:
  buffer_load_dwordx4 v[60:63], v0, s[4:7], s17 offen offset:0 sc1
  buffer_load_dwordx4 v[64:67], v0, s[4:7], s17 offen offset:1024 sc1
  buffer_load_dwordx4 v[68:71], v0, s[4:7], s17 offen offset:2048 sc1
  buffer_load_dwordx4 v[72:75], v0, s[4:7], s17 offen offset:3072 sc1
  s_add_u32 s40, s40, 1
  s_add_u32 s93, s93, 1
  s_cmp_gt_u32 s40, 200000
  s_cbranch_scc1 L_fail
  s_waitcnt vmcnt(3)
  v_mfma_f32_16x16x32_bf16 v[48:51], v[60:63], v[76:79], 0
  v_bitop3_b32 v52, v60, v62, s16 bitop3:0x7e
  s_waitcnt vmcnt(2)
  v_mfma_f32_16x16x32_bf16 v[48:51], v[64:67], v[76:79], v[48:51]
  v_bitop3_b32 v52, v52, v64, s16 bitop3:0xf6
  v_bitop3_b32 v52, v52, v66, s16 bitop3:0xf6
  s_waitcnt vmcnt(1)
  v_mfma_f32_16x16x32_bf16 v[48:51], v[68:71], v[76:79], v[48:51]
  v_bitop3_b32 v52, v52, v68, s16 bitop3:0xf6
  v_bitop3_b32 v52, v52, v70, s16 bitop3:0xf6
  s_waitcnt vmcnt(0)
  v_mfma_f32_16x16x32_bf16 v[48:51], v[72:75], v[76:79], v[48:51]
  v_bitop3_b32 v52, v52, v72, s16 bitop3:0xf6
  v_bitop3_b32 v52, v52, v74, s16 bitop3:0xf6
  v_and_b32 v52, 1, v52
  v_cmp_ne_u32 vcc, 0, v52
  s_cbranch_vccz P1K_93
  s_branch P1_92
P2S_96:
  s_add_u32 s89, s89, 1
  s_waitcnt vmcnt(2)
  v_max3_u32 v48, v24, v25, v26
  v_max_u32 v48, v48, v27
  ds_write_b128 v8, v[24:27] offset:0
  s_waitcnt vmcnt(1)
  v_max3_u32 v48, v48, v28, v29
  v_max3_u32 v48, v48, v30, v31
  v_cmp_eq_u32 vcc, -1, v48
  s_cbranch_vccnz P2_95
  ds_write_b128 v8, v[28:31] offset:1024
  s_branch CBA_1
P2_95:
  buffer_load_dwordx4 v[24:27], v0, s[4:7], s41 offen offset:0 sc1
  buffer_load_dwordx4 v[28:31], v0, s[4:7], s41 offen offset:2048 sc1
  buffer_load_dwordx4 v[76:79], v0, s[4:7], s39 offen sc1
  s_add_u32 s40, s40, 1
  s_add_u32 s94, s94, 1
  s_cmp_gt_u32 s40, 200000
  s_cbranch_scc1 L_fail
  s_waitcnt vmcnt(2)
  v_max3_u32 v48, v24, v25, v26
  v_max_u32 v48, v48, v27
  ds_write_b128 v8, v[24:27] offset:0
  s_waitcnt vmcnt(1)
  v_max3_u32 v48, v48, v28, v29
  v_max3_u32 v48, v48, v30, v31
  v_cmp_eq_u32 vcc, -1, v48
  s_cbranch_vccnz P2_95
  ds_write_b128 v8, v[28:31] offset:1024
  s_branch CBA_1
Q1_97:
  buffer_load_dwordx4 v[60:63], v53, s[4:7], s17 offen sc1
  s_add_u32 s40, s40, 1
  s_add_u32 s93, s93, 1
  s_cmp_gt_u32 s40, 200000
  s_cbranch_scc1 L_fail
  s_waitcnt vmcnt(0)
  v_mfma_f32_16x16x32_bf16 v[48:51], v[60:63], v[76:79], 0
  v_bitop3_b32 v52, v60, v62, s16 bitop3:0x7e
  v_and_b32 v52, 1, v52
  v_cmp_ne_u32 vcc, 0, v52
  s_cbranch_vccz Q1K_98
  s_branch Q1_97
P2S_101:
  s_add_u32 s89, s89, 1
  s_waitcnt vmcnt(2)
  v_max3_u32 v48, v24, v25, v26
  v_max_u32 v48, v48, v27
  ds_write_b128 v8, v[24:27] offset:0
  s_waitcnt vmcnt(1)
  v_max3_u32 v48, v48, v28, v29
  v_max3_u32 v48, v48, v30, v31
  v_cmp_eq_u32 vcc, -1, v48
  s_cbranch_vccnz P2_100
  ds_write_b128 v8, v[28:31] offset:1024
  s_branch CBA_1
P2_100:
  buffer_load_dwordx4 v[24:27], v0, s[4:7], s41 offen offset:0 sc1
  buffer_load_dwordx4 v[28:31], v0, s[4:7], s41 offen offset:2048 sc1
  buffer_load_dwordx4 v[76:79], v0, s[4:7], s39 offen sc1
  s_add_u32 s40, s40, 1
  s_add_u32 s94, s94, 1
  s_cmp_gt_u32 s40, 200000
  s_cbranch_scc1 L_fail
  s_waitcnt vmcnt(2)
  v_max3_u32 v48, v24, v25, v26
  v_max_u32 v48, v48, v27
  ds_write_b128 v8, v[24:27] offset:0
  s_waitcnt vmcnt(1)
  v_max3_u32 v48, v48, v28, v29
  v_max3_u32 v48, v48, v30, v31
  v_cmp_eq_u32 vcc, -1, v48
  s_cbranch_vccnz P2_100
  ds_write_b128 v8, v[28:31] offset:1024
  s_branch CBA_1
P1_102:
  buffer_load_dwordx4 v[60:63], v0, s[4:7], s17 offen offset:0 sc1
  buffer_load_dwordx4 v[64:67], v0, s[4:7], s17 offen offset:1024 sc1
  buffer_load_dwordx4 v[68:71], v0, s[4:7], s17 offen offset:2048 sc1
  buffer_load_dwordx4 v[72:75], v0, s[4:7], s17 offen offset:3072 sc1
  s_add_u32 s40, s40, 1
  s_add_u32 s93, s93, 1
  s_cmp_gt_u32 s40, 200000
  s_cbranch_scc1 L_fail
  s_waitcnt vmcnt(3)
  v_mfma_f32_16x16x32_bf16 v[48:51], v[60:63], v[76:79], 0
  v_bitop3_b32 v52, v60, v62, s16 bitop3:0x7e
  s_waitcnt vmcnt(2)
  v_mfma_f32_16x16x32_bf16 v[48:51], v[64:67], v[76:79], v[48:51]
  v_bitop3_b32 v52, v52, v64, s16 bitop3:0xf6
  v_bitop3_b32 v52, v52, v66, s16 bitop3:0xf6
  s_waitcnt vmcnt(1)
  v_mfma_f32_16x16x32_bf16 v[48:51], v[68:71], v[76:79], v[48:51]
  v_bitop3_b32 v52, v52, v68, s16 bitop3:0xf6
  v_bitop3_b32 v52, v52, v70, s16 bitop3:0xf6
  s_waitcnt vmcnt(0)
  v_mfma_f32_16x16x32_bf16 v[48:51], v[72:75], v[76:79], v[48:51]
  v_bitop3_b32 v52, v52, v72, s16 bitop3:0xf6
  v_bitop3_b32 v52, v52, v74, s16 bitop3:0xf6
  v_and_b32 v52, 1, v52
  v_cmp_ne_u32 vcc, 0, v52
  s_cbranch_vccz P1K_103
  s_branch P1_102
CDONE_44:
  buffer_store_dwordx4 v[64:67], v0, s[4:7], s26 offen sc1
  s_waitcnt lgkmcnt(0)
  s_waitcnt vmcnt(0)
  s_barrier
  s_cmp_lg_u32 s13, 3
  s_cbranch_scc1 L_end
  v_mov_b32 v32, 0
  v_mov_b32 v33, 64
  buffer_store_dword v33, v32, s[4:7], s8 offen sc1
  s_branch L_end
L_fail:
L_end:
L_exit:
  s_endpgm
.section .rodata,"a"
.p2align 6
.amdhsa_kernel concat_heads__grouped_kv_mqa__memory_aug_recurrent_mem_tr__prompt_kernel
  .amdhsa_next_free_vgpr 512
  .amdhsa_next_free_sgpr 102
  .amdhsa_accum_offset 256
  .amdhsa_group_segment_fixed_size 0
  .amdhsa_kernarg_size 120
  .amdhsa_user_sgpr_count 2
  .amdhsa_user_sgpr_kernarg_segment_ptr 1
  .amdhsa_system_sgpr_workgroup_id_x 1
.end_amdhsa_kernel
```
